```python
import torch

def _softmax(x, axis=-1):
    return torch.softmax(x, dim=axis)
def _gelu(x):
    return torch.nn.functional.gelu(x, approximate="tanh")
def _silu(x):
    return torch.nn.functional.silu(x)
def _sigmoid(x):
    return torch.sigmoid(x)
def _layernorm(x, axis=-1, eps=1e-5):
    m = x.mean(dim=axis, keepdim=True)
    v = x.var(dim=axis, keepdim=True, unbiased=False)
    return (x - m) / torch.sqrt(v + eps)
def _scatter_add(tgt, idx, src, axis=0):
    return tgt.clone().index_add_(axis, idx, src)
def _segment_sum(src, seg, n):
    out = torch.zeros((n,) + src.shape[1:], dtype=src.dtype)
    return out.index_add_(0, seg, src)
def _pad(x, pw):
    flat = tuple(v for pair in reversed(pw) for v in pair)
    return torch.nn.functional.pad(x, flat)

kernel_name = 'recurrent_scan__linear_attn_block__glu_gated_swiglu__prompt'

def setup_inputs():

    _w = (lambda a: (lambda t: t.to(torch.bfloat16) if t.is_floating_point() else t)(torch.as_tensor(a)))
    def _A_setup():
        B, S, D = 1, 2048, 640
        return {
            "x": _w((lambda *s: torch.randn(*s, dtype=torch.bfloat16) * 0.05)(B, S, D)),
            "wqkv": _w((lambda *s: torch.randn(*s, dtype=torch.bfloat16) * 0.8)(D, 3 * D)),
            "wo": _w((lambda *s: torch.randn(*s, dtype=torch.bfloat16) * 0.8)(D, D)),
        }
    _A_in = _A_setup()

    def _B_setup():
        B, S, D, F = 1, 2048, 640, 1728
        return {
            "x": _w((lambda *s: torch.randn(*s, dtype=torch.bfloat16) * 0.05)(B, S, D)),
            "w1": _w((lambda *s: torch.randn(*s, dtype=torch.bfloat16) * 0.2)(D, F) * (2.0 / D) ** 0.5),
            "w3": _w((lambda *s: torch.randn(*s, dtype=torch.bfloat16) * 0.2)(D, F) * (2.0 / D) ** 0.5),
            "w2": _w((lambda *s: torch.randn(*s, dtype=torch.bfloat16) * 0.2)(F, D) * (2.0 / F) ** 0.5),
        }
    _B_in = _B_setup()

    return {
        "A_x": _A_in["x"],
        "A_wqkv": _A_in["wqkv"],
        "A_wo": _A_in["wo"],
        "B_x": _B_in["x"],
        "B_w1": _B_in["w1"],
        "B_w3": _B_in["w3"],
        "B_w2": _B_in["w2"],
    }

def reference(A_x, A_wqkv, A_wo, B_x, B_w1, B_w3, B_w2):
    def _A_ref(x, wqkv, wo):
        B, S, D = x.shape
        H = 32; Dh = D // H
        qkv = (lambda x, *d: x.permute(*d))((x @ wqkv).reshape(B, S, 3, H, Dh), 2, 0, 3, 1, 4)
        q, k, v = qkv[0], qkv[1], qkv[2]
        phi = lambda t: torch.where(t > 0, t + 1, torch.exp(t)) + 1e-6
        pq, pk = phi(q), phi(k)
        kv = torch.einsum("bhsd,bhse->bhde", pk, v)
        z = torch.einsum("bhsd->bhd", pk)
        num = torch.einsum("bhqd,bhde->bhqe", pq, kv)
        den = torch.einsum("bhqd,bhd->bhq", pq, z)[..., None] + 1e-6
        o = num / den
        return (lambda x, *d: x.permute(*d))(o, 0, 2, 1, 3).reshape(B, S, D) @ wo

    def _B_ref(x, w1, w3, w2):
        gate = torch.einsum("bsd,df->bsf", x, w1)
        up = torch.einsum("bsd,df->bsf", x, w3)
        h = _silu(gate) * up
        out = torch.einsum("bsf,fd->bsd", h, w2)
        return out

    x = A_x
    xn = _layernorm(x, axis=-1)
    s = _A_ref(xn, A_wqkv, A_wo)
    g = _silu(_B_ref(xn, B_w1, B_w3, B_w2))
    return x + s * g
```

```asm
; @launch grid=(256,1,1) block=(256,1,1) lds=163840
.amdgcn_target "amdgcn-amd-amdhsa--gfx950"
.macro M3 a:vararg
v_mfma_f32_32x32x16_bf16 \a
.endm
.macro M1 a:vararg
v_mfma_f32_16x16x32_bf16 \a
.endm
.macro TR a:vararg
ds_read_b64_tr_b16 \a
.endm
.macro AR a:vararg
v_accvgpr_read_b32 \a
.endm
.macro BL a:vararg
buffer_load_dwordx4 \a
.endm
.macro CV a:vararg
v_cvt_pk_bf16_f32 \a
.endm
.macro D2 a:vararg
v_dot2_f32_bf16 \a
.endm
.text
.globl recurrent_scan__linear_attn_block__glu_gated_swiglu__prompt_kernel
.p2align 8
.type recurrent_scan__linear_attn_block__glu_gated_swiglu__prompt_kernel,@function
recurrent_scan__linear_attn_block__glu_gated_swiglu__prompt_kernel:
s_cmp_lt_u32 s2, 256
s_cbranch_scc1 K1_GO
s_endpgm
K1_GO:
s_load_dwordx2 s[8:9], s[0:1], 0
s_memrealtime s[100:101]
s_load_dwordx2 s[70:71], s[0:1], 8
s_load_dwordx2 s[72:73], s[0:1], 16
s_load_dwordx4 s[76:79], s[0:1], 32
s_load_dwordx2 s[74:75], s[0:1], 48
s_load_dwordx4 s[80:83], s[0:1], 64
v_lshrrev_b32 v1, 6, v0
s_and_b32 s4, s2, 7
s_lshr_b32 s5, s2, 3
v_readfirstlane_b32 s3, v1
v_and_b32 v1, 63, v0
s_and_b32 s7, s4, 3
s_lshl_b32 s7, s7, 2
s_lshr_b32 s4, s4, 2
s_lshl_b32 s4, s4, 3
s_lshr_b32 s6, s5, 2
s_and_b32 s5, s5, 3
s_add_u32 s7, s7, s5
s_add_u32 s5, s4, s6
s_mov_b32 s4, s7
s_mul_i32 s6, s3, 40960
v_lshrrev_b32 v40, 3, v1
v_mul_u32_u24 v41, 1280, v40
v_lshrrev_b32 v42, 4, v1
v_and_b32 v43, 7, v1
v_xor_b32 v43, v43, v42
v_lshl_add_u32 v30, v43, 4, v41
v_xor_b32 v31, 64, v30
v_add_u32 v31, 10240, v31
s_mul_i32 s43, s4, 163840
s_add_u32 s43, s43, s6
s_mov_b32 s10, 2621440
s_mov_b32 s11, 0x20000
s_and_b32 s7, s4, 3
s_mul_i32 s7, s7, 3
s_and_b32 s84, s5, 7
s_add_u32 s7, s7, s84
s_cmp_ge_u32 s7, 10
s_cselect_b32 s84, 10, 0
s_sub_u32 s7, s7, s84
s_mul_i32 s7, s7, 4
s_mov_b32 s58, 0x76543210
s_mov_b32 s59, 0x98
s_lshr_b64 s[84:85], s[58:59], s7
s_sub_u32 s7, 40, s7
s_lshl_b64 s[58:59], s[58:59], s7
s_or_b64 s[58:59], s[58:59], s[84:85]
s_cmp_eq_u32 s5, 15
s_cbranch_scc1 K1_GU2
s_bfe_u32 s44, s58, 0x40000
s_mul_i32 s44, s44, 128
s_add_u32 s44, s44, s43
s_add_u32 s61, s44, 20480
s_add_u32 m0, s6, 12288
s_waitcnt lgkmcnt(0)
BL v30,s[8:11],s44 offen lds
s_add_u32 m0, s6, 13312
s_nop 0
BL v31,s[8:11],s44 offen lds
s_add_u32 m0, s6, 14336
s_nop 0
BL v30,s[8:11],s61 offen lds
s_add_u32 m0, s6, 15360
s_nop 0
BL v31,s[8:11],s61 offen lds
s_getpc_b64 s[98:99]
K1_C_pc:
s_and_b32 s7, s4, 3
s_lshl_b32 s84, s3, 2
s_add_u32 s7, s7, s84
s_cmp_ge_u32 s7, 5
s_cbranch_scc1 K1_C_nopf
s_lshl_b32 s7, s7, 13
s_mov_b32 s84, K1_GU3-K1_C_pc
s_cmp_lt_u32 s5, 8
s_cselect_b32 s84, K1_KVGU-K1_C_pc, s84
s_cmp_lt_u32 s5, 4
s_cselect_b32 s84, K1_KVQ-K1_C_pc, s84
s_add_u32 s7, s7, s84
v_lshl_add_u32 v94, v1, 7, s7
v_min_u32 v94, K1_END-K1_C_pc, v94
global_load_dword v255, v94, s[98:99]
K1_C_nopf:
s_bfe_u32 s44, s58, 0x40004
s_mul_i32 s44, s44, 128
s_add_u32 s44, s44, s43
s_add_u32 s61, s44, 20480
s_add_u32 m0, s6, 16384
s_nop 0
BL v30,s[8:11],s44 offen lds
s_add_u32 m0, s6, 17408
s_nop 0
BL v31,s[8:11],s44 offen lds
s_add_u32 m0, s6, 18432
s_nop 0
BL v30,s[8:11],s61 offen lds
s_add_u32 m0, s6, 19456
s_nop 0
BL v31,s[8:11],s61 offen lds
s_bfe_u32 s44, s58, 0x40008
s_mul_i32 s44, s44, 128
s_add_u32 s44, s44, s43
s_add_u32 s61, s44, 20480
s_add_u32 m0, s6, 20480
s_nop 0
BL v30,s[8:11],s44 offen lds
s_add_u32 m0, s6, 21504
s_nop 0
BL v31,s[8:11],s44 offen lds
s_add_u32 m0, s6, 22528
s_nop 0
BL v30,s[8:11],s61 offen lds
s_add_u32 m0, s6, 23552
s_nop 0
BL v31,s[8:11],s61 offen lds
s_bfe_u32 s44, s58, 0x4000c
s_mul_i32 s44, s44, 128
s_add_u32 s44, s44, s43
s_add_u32 s61, s44, 20480
s_add_u32 m0, s6, 24576
s_nop 0
BL v30,s[8:11],s44 offen lds
s_add_u32 m0, s6, 25600
s_nop 0
BL v31,s[8:11],s44 offen lds
s_add_u32 m0, s6, 26624
s_nop 0
BL v30,s[8:11],s61 offen lds
s_add_u32 m0, s6, 27648
s_nop 0
BL v31,s[8:11],s61 offen lds
s_waitcnt lgkmcnt(0)
s_or_b32 s100, s100, 1
s_mov_b32 s101, 0x40000
s_mov_b32 s93, 0
v_mov_b32 v20, 1073741824
v_cmp_eq_u32 vcc, 0, v1
s_nop 1
v_cndmask_b32 v20, v20, 0, vcc
s_mov_b32 s24, s82
s_mov_b32 s25, s83
s_mov_b32 s26, 20971520
s_mov_b32 s27, 0x20000
s_mov_b32 s28, s80
s_mov_b32 s29, s81
s_mov_b32 s30, 256
s_mov_b32 s31, 0x20000
s_sub_u32 s12, s76, 3072
s_subb_u32 s13, s77, 0
s_mov_b32 s14, 2214912
s_mov_b32 s15, 0x20000
s_sub_u32 s16, s78, 3072
s_subb_u32 s17, s79, 0
s_mov_b32 s18, 2214912
s_mov_b32 s19, 0x20000
s_sub_u32 s20, s70, 3072
s_subb_u32 s21, s71, 0
s_mov_b32 s22, 2460672
s_mov_b32 s23, 0x20000
s_or_b32 s7, s2, s3
s_cmp_eq_u32 s7, 0
s_cselect_b32 s7, 240, 1073741824
v_mov_b32 v26, s100
v_mov_b32 v27, 240
buffer_store_dword v26, v20, s[28:31], s7 offen sc1
s_cmp_lt_u32 s5, 4
s_cbranch_scc1 K1_KVQ
s_cmp_lt_u32 s5, 8
s_cbranch_scc1 K1_KVGU
s_branch K1_GU3
.p2align 6
K1_KVQ:
v_and_b32 v56, 31, v1
v_lshrrev_b32 v57, 5, v1
v_bfe_u32 v58, v1, 1, 3
v_lshlrev_b32 v59, 7, v56
v_add_u32 v59, s6, v59
s_mov_b32 s49, 0x3f803f80
v_add_u32 v60, 0, v57
v_xor_b32 v60, v60, v58
v_lshl_add_u32 v34, v60, 4, v59
v_add_u32 v60, 2, v57
v_xor_b32 v60, v60, v58
v_lshl_add_u32 v35, v60, 4, v59
v_add_u32 v60, 4, v57
v_xor_b32 v60, v60, v58
v_lshl_add_u32 v36, v60, 4, v59
v_add_u32 v60, 6, v57
v_xor_b32 v60, v60, v58
v_lshl_add_u32 v37, v60, 4, v59
v_mov_b32 v48, 0
v_mov_b32 v49, 0
v_mov_b32 v50, 0
v_mov_b32 v51, 0
v_mov_b32 v52, 0
v_mov_b32 v53, 0
v_mov_b32 v54, 0
v_mov_b32 v55, 0
s_mov_b32 s54, 0xffff
s_mov_b32 s55, 0xffff
v_add_u32 v40, 0, v1
v_mul_u32_u24 v41, 3277, v40
v_lshrrev_b32 v41, 16, v41
v_mul_u32_u24 v42, 20, v41
v_sub_u32 v42, v40, v42
v_mul_u32_u24 v41, 3840, v41
v_add_u32 v41, 3072, v41
v_lshl_add_u32 v10, v42, 4, v41
v_cmp_lt_u32 vcc, 9, v42
v_mov_b32 v43, 1280
v_mov_b32 v44, 2400
v_cndmask_b32 v43, v43, v44, vcc
s_waitcnt vmcnt(12)
ds_read_b128 v[96:99], v34 offset:12288
ds_read_b128 v[100:103], v35 offset:12288
ds_read_b128 v[104:107], v36 offset:12288
ds_read_b128 v[108:111], v37 offset:12288
s_bfe_u32 s44, s58, 0x40010
s_mul_i32 s44, s44, 128
s_add_u32 s44, s44, s43
s_add_u32 s61, s44, 20480
s_add_u32 m0, s6, 28672
s_nop 0
BL v30,s[8:11],s44 offen lds
v_add_u32 v10, v10, v43
v_add_u32 v40, 64, v1
v_mul_u32_u24 v41, 3277, v40
v_lshrrev_b32 v41, 16, v41
v_mul_u32_u24 v42, 20, v41
v_sub_u32 v42, v40, v42
s_add_u32 m0, s6, 29696
s_nop 0
BL v31,s[8:11],s44 offen lds
v_mul_u32_u24 v41, 3840, v41
v_add_u32 v41, 2048, v41
v_lshl_add_u32 v11, v42, 4, v41
v_cmp_lt_u32 vcc, 9, v42
v_mov_b32 v43, 1280
v_mov_b32 v44, 2400
s_add_u32 m0, s6, 30720
s_nop 0
BL v30,s[8:11],s61 offen lds
v_cndmask_b32 v43, v43, v44, vcc
v_add_u32 v11, v11, v43
v_add_u32 v40, 128, v1
v_mul_u32_u24 v41, 3277, v40
v_lshrrev_b32 v41, 16, v41
v_mul_u32_u24 v42, 20, v41
s_add_u32 m0, s6, 31744
s_nop 0
BL v31,s[8:11],s61 offen lds
v_sub_u32 v42, v40, v42
v_mul_u32_u24 v41, 3840, v41
v_add_u32 v41, 1024, v41
v_lshl_add_u32 v12, v42, 4, v41
v_cmp_lt_u32 vcc, 9, v42
v_mov_b32 v43, 1280
s_waitcnt vmcnt(12)
ds_read_b128 v[112:115], v34 offset:16384
ds_read_b128 v[116:119], v35 offset:16384
ds_read_b128 v[120:123], v36 offset:16384
ds_read_b128 v[124:127], v37 offset:16384
s_waitcnt lgkmcnt(4)
s_bfe_u32 s44, s58, 0x40014
s_mul_i32 s44, s44, 128
s_add_u32 s44, s44, s43
s_add_u32 s61, s44, 20480
s_add_u32 m0, s6, 32768
s_nop 0
BL v30,s[8:11],s44 offen lds
D2 v48,v96,s49,v48
D2 v52,v96,v96,v52
D2 v49,v97,s49,v49
D2 v53,v97,v97,v53
D2 v50,v98,s49,v50
D2 v54,v98,v98,v54
D2 v51,v99,s49,v51
D2 v55,v99,v99,v55
v_mov_b32 v44, 2400
v_cndmask_b32 v43, v43, v44, vcc
v_add_u32 v12, v12, v43
v_add_u32 v40, 192, v1
v_mul_u32_u24 v41, 3277, v40
v_lshrrev_b32 v41, 16, v41
s_add_u32 m0, s6, 33792
s_nop 0
BL v31,s[8:11],s44 offen lds
D2 v48,v100,s49,v48
D2 v52,v100,v100,v52
D2 v49,v101,s49,v49
D2 v53,v101,v101,v53
D2 v50,v102,s49,v50
D2 v54,v102,v102,v54
D2 v51,v103,s49,v51
D2 v55,v103,v103,v55
v_mul_u32_u24 v42, 20, v41
v_sub_u32 v42, v40, v42
v_mul_u32_u24 v41, 3840, v41
v_add_u32 v41, 0, v41
v_lshl_add_u32 v13, v42, 4, v41
v_cmp_lt_u32 vcc, 9, v42
s_add_u32 m0, s6, 34816
s_nop 0
BL v30,s[8:11],s61 offen lds
D2 v48,v104,s49,v48
D2 v52,v104,v104,v52
D2 v49,v105,s49,v49
D2 v53,v105,v105,v53
D2 v50,v106,s49,v50
D2 v54,v106,v106,v54
D2 v51,v107,s49,v51
D2 v55,v107,v107,v55
v_mov_b32 v43, 1280
v_mov_b32 v44, 2400
v_cndmask_b32 v43, v43, v44, vcc
v_add_u32 v13, v13, v43
v_add_u32 v40, 256, v1
v_mul_u32_u24 v41, 3277, v40
s_add_u32 m0, s6, 35840
s_nop 0
BL v31,s[8:11],s61 offen lds
D2 v48,v108,s49,v48
D2 v52,v108,v108,v52
D2 v49,v109,s49,v49
D2 v53,v109,v109,v53
D2 v50,v110,s49,v50
D2 v54,v110,v110,v54
D2 v51,v111,s49,v51
D2 v55,v111,v111,v55
v_lshrrev_b32 v41, 16, v41
v_mul_u32_u24 v42, 20, v41
v_sub_u32 v42, v40, v42
v_mul_u32_u24 v41, 3840, v41
v_add_u32 v41, 3072, v41
v_lshl_add_u32 v14, v42, 4, v41
s_waitcnt vmcnt(12)
ds_read_b128 v[128:131], v34 offset:20480
ds_read_b128 v[132:135], v35 offset:20480
ds_read_b128 v[136:139], v36 offset:20480
ds_read_b128 v[140:143], v37 offset:20480
s_waitcnt lgkmcnt(4)
s_bfe_u32 s44, s58, 0x40018
s_mul_i32 s44, s44, 128
s_add_u32 s44, s44, s43
s_add_u32 s61, s44, 20480
s_add_u32 m0, s6, 36864
s_nop 0
BL v30,s[8:11],s44 offen lds
D2 v48,v112,s49,v48
D2 v52,v112,v112,v52
D2 v49,v113,s49,v49
D2 v53,v113,v113,v53
D2 v50,v114,s49,v50
D2 v54,v114,v114,v54
D2 v51,v115,s49,v51
D2 v55,v115,v115,v55
v_cmp_lt_u32 vcc, 9, v42
v_mov_b32 v43, 1280
v_mov_b32 v44, 2400
v_cndmask_b32 v43, v43, v44, vcc
v_add_u32 v14, v14, v43
s_mul_i32 s40, s3, 61440
s_add_u32 m0, s6, 37888
s_nop 0
BL v31,s[8:11],s44 offen lds
D2 v48,v116,s49,v48
D2 v52,v116,v116,v52
D2 v49,v117,s49,v49
D2 v53,v117,v117,v53
D2 v50,v118,s49,v50
D2 v54,v118,v118,v54
D2 v51,v119,s49,v51
D2 v55,v119,v119,v55
s_mul_i32 s7, s5, 160
s_add_u32 s40, s40, s7
v_lshrrev_b32 v40, 4, v1
v_and_b32 v41, 1, v40
v_lshrrev_b32 v40, 1, v40
v_bfe_u32 v42, v1, 2, 2
s_add_u32 m0, s6, 38912
s_nop 0
BL v30,s[8:11],s61 offen lds
D2 v48,v120,s49,v48
D2 v52,v120,v120,v52
D2 v49,v121,s49,v49
D2 v53,v121,v121,v53
D2 v50,v122,s49,v50
D2 v54,v122,v122,v54
D2 v51,v123,s49,v51
D2 v55,v123,v123,v55
v_and_b32 v43, 3, v1
v_lshl_add_u32 v44, v40, 3, v42
v_mul_u32_u24 v44, 320, v44
v_mul_u32_u24 v45, 40, v41
v_lshl_add_u32 v45, v43, 3, v45
v_add_u32 v2, v44, v45
s_add_u32 m0, s6, 39936
s_nop 0
BL v31,s[8:11],s61 offen lds
D2 v48,v124,s49,v48
D2 v52,v124,v124,v52
D2 v49,v125,s49,v49
D2 v53,v125,v125,v53
D2 v50,v126,s49,v50
D2 v54,v126,v126,v54
D2 v51,v127,s49,v51
D2 v55,v127,v127,v55
v_add_u32 v3, 81920, v2
v_lshl_add_u32 v45, v41, 2, v43
v_mul_u32_u24 v45, 40, v45
v_add3_u32 v4, v44, v45, 32
v_add_u32 v5, 81920, v4
s_lshl_b32 s7, s5, 2
s_waitcnt vmcnt(12)
ds_read_b128 v[144:147], v34 offset:24576
ds_read_b128 v[148:151], v35 offset:24576
ds_read_b128 v[152:155], v36 offset:24576
ds_read_b128 v[156:159], v37 offset:24576
s_waitcnt lgkmcnt(4)
s_bfe_u32 s44, s58, 0x4001c
s_mul_i32 s44, s44, 128
s_add_u32 s44, s44, s43
s_add_u32 s61, s44, 20480
s_add_u32 m0, s6, 12288
s_nop 0
BL v30,s[8:11],s44 offen lds
D2 v48,v128,s49,v48
D2 v52,v128,v128,v52
D2 v49,v129,s49,v49
D2 v53,v129,v129,v53
D2 v50,v130,s49,v50
D2 v54,v130,v130,v54
D2 v51,v131,s49,v51
D2 v55,v131,v131,v55
s_add_u32 s62, s7, s3
s_mul_i32 s62, s62, 40960
s_mul_i32 s63, s4, 2560
s_add_u32 s62, s62, s63
s_add_u32 s62, s62, 16777216
s_sub_u32 s84, s5, 4
s_add_u32 m0, s6, 13312
s_nop 0
BL v31,s[8:11],s44 offen lds
D2 v48,v132,s49,v48
D2 v52,v132,v132,v52
D2 v49,v133,s49,v49
D2 v53,v133,v133,v53
D2 v50,v134,s49,v50
D2 v54,v134,v134,v54
D2 v51,v135,s49,v51
D2 v55,v135,v135,v55
s_lshl_b32 s84, s84, 4
s_add_u32 s84, s84, s4
s_lshl_b32 s84, s84, 2
s_add_u32 s84, s84, s3
s_min_u32 s85, s84, 159
s_mul_i32 s63, s85, 205
s_add_u32 m0, s6, 14336
s_nop 0
BL v30,s[8:11],s61 offen lds
D2 v48,v136,s49,v48
D2 v52,v136,v136,v52
D2 v49,v137,s49,v49
D2 v53,v137,v137,v53
D2 v50,v138,s49,v50
D2 v54,v138,v138,v54
D2 v51,v139,s49,v51
D2 v55,v139,v139,v55
s_lshr_b32 s63, s63, 10
s_mov_b32 s7, s63
s_mul_i32 s63, s63, 5
s_sub_u32 s85, s85, s63
s_mul_i32 s63, s7, 40960
s_lshl_b32 s64, s85, 7
s_add_u32 m0, s6, 15360
s_nop 0
BL v31,s[8:11],s61 offen lds
D2 v48,v140,s49,v48
D2 v52,v140,v140,v52
D2 v49,v141,s49,v49
D2 v53,v141,v141,v53
D2 v50,v142,s49,v50
D2 v54,v142,v142,v54
D2 v51,v143,s49,v51
D2 v55,v143,v143,v55
s_add_u32 s63, s63, s64
s_add_u32 s63, s63, 16777216
s_mul_i32 s64, s7, 1920
s_mul_i32 s85, s85, 384
s_add_u32 s64, s64, s85
s_add_u32 s64, s64, 18874368
s_waitcnt vmcnt(12)
ds_read_b128 v[160:163], v34 offset:28672
ds_read_b128 v[164:167], v35 offset:28672
ds_read_b128 v[168:171], v36 offset:28672
ds_read_b128 v[172:175], v37 offset:28672
s_waitcnt lgkmcnt(4)
s_bfe_u32 s44, s59, 0x40000
s_mul_i32 s44, s44, 128
s_add_u32 s44, s44, s43
s_add_u32 s61, s44, 20480
s_add_u32 m0, s6, 16384
s_nop 0
BL v30,s[8:11],s44 offen lds
D2 v48,v144,s49,v48
D2 v52,v144,v144,v52
D2 v49,v145,s49,v49
D2 v53,v145,v145,v53
D2 v50,v146,s49,v50
D2 v54,v146,v146,v54
D2 v51,v147,s49,v51
D2 v55,v147,v147,v55
s_cmp_lt_u32 s84, 160
s_cselect_b32 s64, s64, 1073741824
v_add_u32 v40, 0, v1
v_mul_u32_u24 v41, 3277, v40
v_lshrrev_b32 v41, 16, v41
v_mul_u32_u24 v42, 20, v41
s_add_u32 m0, s6, 17408
s_nop 0
BL v31,s[8:11],s44 offen lds
D2 v48,v148,s49,v48
D2 v52,v148,v148,v52
D2 v49,v149,s49,v49
D2 v53,v149,v149,v53
D2 v50,v150,s49,v50
D2 v54,v150,v150,v54
D2 v51,v151,s49,v51
D2 v55,v151,v151,v55
v_sub_u32 v42, v40, v42
v_mul_u32_u24 v41, 3840, v41
v_add_u32 v41, 3072, v41
v_lshl_add_u32 v15, v42, 4, v41
v_add_u32 v40, 64, v1
v_mul_u32_u24 v41, 3277, v40
s_add_u32 m0, s6, 18432
s_nop 0
BL v30,s[8:11],s61 offen lds
D2 v48,v152,s49,v48
D2 v52,v152,v152,v52
D2 v49,v153,s49,v49
D2 v53,v153,v153,v53
D2 v50,v154,s49,v50
D2 v54,v154,v154,v54
D2 v51,v155,s49,v51
D2 v55,v155,v155,v55
v_lshrrev_b32 v41, 16, v41
v_mul_u32_u24 v42, 20, v41
v_sub_u32 v42, v40, v42
v_mul_u32_u24 v41, 3840, v41
v_add_u32 v41, 2048, v41
v_lshl_add_u32 v16, v42, 4, v41
s_add_u32 m0, s6, 19456
s_nop 0
BL v31,s[8:11],s61 offen lds
D2 v48,v156,s49,v48
D2 v52,v156,v156,v52
D2 v49,v157,s49,v49
D2 v53,v157,v157,v53
D2 v50,v158,s49,v50
D2 v54,v158,v158,v54
D2 v51,v159,s49,v51
D2 v55,v159,v159,v55
v_add_u32 v40, 128, v1
v_mul_u32_u24 v41, 3277, v40
v_lshrrev_b32 v41, 16, v41
v_mul_u32_u24 v42, 20, v41
v_sub_u32 v42, v40, v42
v_mul_u32_u24 v41, 3840, v41
s_waitcnt vmcnt(12)
ds_read_b128 v[176:179], v34 offset:32768
ds_read_b128 v[180:183], v35 offset:32768
ds_read_b128 v[184:187], v36 offset:32768
ds_read_b128 v[188:191], v37 offset:32768
s_waitcnt lgkmcnt(4)
s_bfe_u32 s44, s59, 0x40004
s_mul_i32 s44, s44, 128
s_add_u32 s44, s44, s43
s_add_u32 s61, s44, 20480
s_add_u32 m0, s6, 20480
s_nop 0
BL v30,s[8:11],s44 offen lds
D2 v48,v160,s49,v48
D2 v52,v160,v160,v52
D2 v49,v161,s49,v49
D2 v53,v161,v161,v53
D2 v50,v162,s49,v50
D2 v54,v162,v162,v54
D2 v51,v163,s49,v51
D2 v55,v163,v163,v55
v_add_u32 v41, 1024, v41
v_lshl_add_u32 v17, v42, 4, v41
v_add_u32 v40, 192, v1
v_mul_u32_u24 v41, 3277, v40
v_lshrrev_b32 v41, 16, v41
v_mul_u32_u24 v42, 20, v41
s_add_u32 m0, s6, 21504
s_nop 0
BL v31,s[8:11],s44 offen lds
D2 v48,v164,s49,v48
D2 v52,v164,v164,v52
D2 v49,v165,s49,v49
D2 v53,v165,v165,v53
D2 v50,v166,s49,v50
D2 v54,v166,v166,v54
D2 v51,v167,s49,v51
D2 v55,v167,v167,v55
v_sub_u32 v42, v40, v42
v_mul_u32_u24 v41, 3840, v41
v_add_u32 v41, 0, v41
v_lshl_add_u32 v18, v42, 4, v41
v_add_u32 v40, 256, v1
v_mul_u32_u24 v41, 3277, v40
s_add_u32 m0, s6, 22528
s_nop 0
BL v30,s[8:11],s61 offen lds
D2 v48,v168,s49,v48
D2 v52,v168,v168,v52
D2 v49,v169,s49,v49
D2 v53,v169,v169,v53
D2 v50,v170,s49,v50
D2 v54,v170,v170,v54
D2 v51,v171,s49,v51
D2 v55,v171,v171,v55
v_lshrrev_b32 v41, 16, v41
v_mul_u32_u24 v42, 20, v41
v_sub_u32 v42, v40, v42
v_mul_u32_u24 v41, 3840, v41
v_add_u32 v41, 3072, v41
v_lshl_add_u32 v19, v42, 4, v41
s_add_u32 m0, s6, 23552
s_nop 0
BL v31,s[8:11],s61 offen lds
D2 v48,v172,s49,v48
D2 v52,v172,v172,v52
D2 v49,v173,s49,v49
D2 v53,v173,v173,v53
D2 v50,v174,s49,v50
D2 v54,v174,v174,v54
D2 v51,v175,s49,v51
D2 v55,v175,v175,v55
v_lshrrev_b32 v40, 4, v1
v_and_b32 v41, 1, v40
v_lshrrev_b32 v40, 1, v40
v_bfe_u32 v42, v1, 2, 2
v_and_b32 v43, 3, v1
v_lshl_add_u32 v44, v40, 3, v42
s_waitcnt vmcnt(12)
ds_read_b128 v[192:195], v34 offset:36864
ds_read_b128 v[196:199], v35 offset:36864
ds_read_b128 v[200:203], v36 offset:36864
ds_read_b128 v[204:207], v37 offset:36864
v_mul_u32_u24 v44, 320, v44
v_mul_u32_u24 v45, 160, v41
v_lshl_add_u32 v45, v43, 3, v45
v_add_u32 v6, v44, v45
v_add_u32 v7, 81920, v6
v_lshl_add_u32 v45, v41, 2, v43
v_mul_u32_u24 v45, 40, v45
v_add3_u32 v4, v44, v45, 32
v_add_u32 v5, 81920, v4
s_mul_i32 s41, s3, 61440
s_mul_i32 s7, s5, 320
s_add_u32 s41, s41, s7
v_and_b32 v40, 31, v1
v_lshrrev_b32 v41, 5, v1
s_and_b32 s7, s3, 1
s_lshl_b32 s7, s7, 4
s_lshr_b32 s84, s3, 1
s_lshl_b32 s84, s84, 6
s_add_u32 s7, s7, s84
s_lshl_b32 s85, s3, 2
v_add_u32 v42, s7, v40
v_add_u32 v43, s85, v40
v_add_u32 v44, 128, v42
v_add_u32 v45, 320, v43
v_cmp_gt_u32 vcc, 20, v40
v_mov_b32 v46, 320
s_nop 0
v_cndmask_b32 v45, v46, v45, vcc
v_min_u32 v46, 19, v40
v_add_u32 v46, s85, v46
v_add_u32 v46, 240, v46
v_cmp_gt_u32 vcc, 16, v40
s_nop 1
v_cndmask_b32 v44, v45, v44, vcc
v_cndmask_b32 v42, v46, v42, vcc
v_lshl_add_u32 v44, v41, 5, v44
v_lshl_add_u32 v42, v41, 5, v42
v_lshlrev_b32 v44, 4, v44
v_lshlrev_b32 v42, 4, v42
v_add_u32 v8, 25600, v44
v_add_u32 v9, 107520, v44
v_add_u32 v22, 25600, v42
v_add_u32 v23, 107520, v42
v_mul_u32_u24 v41, 20, v41
v_add_u32 v41, v41, v40
v_lshlrev_b32 v41, 4, v41
v_mov_b32 v46, 1073741824
v_cmp_gt_u32 vcc, 20, v40
s_nop 1
v_cndmask_b32 v24, v46, v41, vcc
s_lshl_b32 s7, s4, 1
s_lshr_b32 s45, s3, 1
s_add_u32 s7, s7, s45
s_mul_i32 s45, s7, 303104
s_and_b32 s7, s3, 1
s_lshl_b32 s7, s7, 11
s_add_u32 s45, s45, s7
v_bfe_u32 v40, v1, 4, 1
v_lshlrev_b32 v40, 10, v40
v_lshrrev_b32 v41, 5, v1
v_lshl_add_u32 v40, v41, 8, v40
v_and_b32 v41, 15, v1
v_lshl_add_u32 v28, v41, 4, v40
v_add_u32 v29, 4096, v28
s_mov_b32 s50, 0xbfb8aa3b
s_mov_b32 s51, 0x3fb8aa3b
s_mov_b32 s52, 0xffff0000
s_mov_b32 s53, 0x358637bd
s_and_b32 s7, s5, 7
s_mul_i32 s32, s3, 112
s_add_u32 s7, s7, s32
s_mul_i32 s7, s7, 5120
s_sub_u32 s34, 3031040, s7
s_add_u32 s7, s7, 10485760
s_add_u32 s32, s82, s7
s_addc_u32 s33, s83, 0
s_mov_b32 s35, 0x20000
s_and_b32 s7, s5, 7
s_add_u32 s7, s7, s4
s_and_b32 s7, s7, 3
s_mul_i32 s7, s7, 0
s_mov_b32 s84, 0x03020100
s_mov_b32 s85, s84
s_lshr_b64 s[84:85], s[84:85], s7
s_mov_b32 s87, s84
s_add_u32 s89, s84, 0x0a0a0a0a
s_sub_u32 s70, s89, 0x02020202
s_cmp_eq_u32 s3, 3
s_cselect_b32 s89, s70, s89
s_mov_b32 s70, 0x0908
s_cselect_b32 s70, 0x0706, s70
s_mov_b32 s84, 0x07060504
s_cselect_b32 s84, 0xffff0504, s84
s_mul_i32 s71, s3, 9
s_sub_u32 s71, 54, s71
s_add_u32 s85, s71, 4
s_lshl_b32 s85, s85, 16
s_or_b32 s70, s70, s85
s_mul_i32 s71, s71, 0x01010101
s_add_u32 s71, s71, s87
s_mov_b32 s85, s84
s_lshr_b64 s[84:85], s[84:85], s7
s_mov_b32 s88, s84
s_lshl_b32 s96, s4, 12
s_lshr_b32 s7, s3, 1
s_lshl_b32 s7, s7, 11
s_add_u32 s96, s96, s7
s_lshl_b32 s7, s5, 7
s_add_u32 s96, s96, s7
s_and_b32 s7, s3, 1
s_lshl_b32 s7, s7, 2
s_add_u32 s96, s96, s7
s_add_u32 s96, s96, 15466496
s_lshl_b32 s97, s4, 12
s_lshr_b32 s7, s5, 3
s_lshl_b32 s7, s7, 11
s_add_u32 s97, s97, s7
s_add_u32 s97, s97, 15466496
s_waitcnt lgkmcnt(4)
D2 v48,v176,s49,v48
D2 v52,v176,v176,v52
D2 v49,v177,s49,v49
D2 v53,v177,v177,v53
D2 v50,v178,s49,v50
D2 v54,v178,v178,v54
D2 v51,v179,s49,v51
D2 v55,v179,v179,v55
D2 v48,v180,s49,v48
D2 v52,v180,v180,v52
D2 v49,v181,s49,v49
D2 v53,v181,v181,v53
D2 v50,v182,s49,v50
D2 v54,v182,v182,v54
D2 v51,v183,s49,v51
D2 v55,v183,v183,v55
D2 v48,v184,s49,v48
D2 v52,v184,v184,v52
D2 v49,v185,s49,v49
D2 v53,v185,v185,v53
D2 v50,v186,s49,v50
D2 v54,v186,v186,v54
D2 v51,v187,s49,v51
D2 v55,v187,v187,v55
D2 v48,v188,s49,v48
D2 v52,v188,v188,v52
D2 v49,v189,s49,v49
D2 v53,v189,v189,v53
D2 v50,v190,s49,v50
D2 v54,v190,v190,v54
D2 v51,v191,s49,v51
D2 v55,v191,v191,v55
s_waitcnt vmcnt(8)
ds_read_b128 v[208:211], v34 offset:12288
ds_read_b128 v[212:215], v35 offset:12288
ds_read_b128 v[216:219], v36 offset:12288
ds_read_b128 v[220:223], v37 offset:12288
s_waitcnt lgkmcnt(4)
s_add_u32 m0, s6, 0
s_bfe_u32 s60, s58, 0x40000
s_mul_i32 s60, s60, 245760
s_add_u32 s60, s60, s40
BL v10,s[20:23],s60 offen lds
D2 v48,v192,s49,v48
D2 v52,v192,v192,v52
D2 v49,v193,s49,v49
D2 v53,v193,v193,v53
D2 v50,v194,s49,v50
D2 v54,v194,v194,v54
D2 v51,v195,s49,v51
BL v11,s[20:23],s60 offen offset:1024 lds
D2 v55,v195,v195,v55
D2 v48,v196,s49,v48
D2 v52,v196,v196,v52
D2 v49,v197,s49,v49
D2 v53,v197,v197,v53
D2 v50,v198,s49,v50
D2 v54,v198,v198,v54
BL v12,s[20:23],s60 offen offset:2048 lds
D2 v51,v199,s49,v51
D2 v55,v199,v199,v55
D2 v48,v200,s49,v48
D2 v52,v200,v200,v52
D2 v49,v201,s49,v49
D2 v53,v201,v201,v53
BL v13,s[20:23],s60 offen offset:3072 lds
D2 v50,v202,s49,v50
D2 v54,v202,v202,v54
D2 v51,v203,s49,v51
D2 v55,v203,v203,v55
D2 v48,v204,s49,v48
D2 v52,v204,v204,v52
s_add_u32 m0, s6, 4096
s_nop 0
BL v14,s[20:23],s60 offen lds
D2 v49,v205,s49,v49
D2 v53,v205,v205,v53
D2 v50,v206,s49,v50
D2 v54,v206,v206,v54
D2 v51,v207,s49,v51
D2 v55,v207,v207,v55
s_waitcnt vmcnt(9)
ds_read_b128 v[224:227], v34 offset:16384
ds_read_b128 v[228:231], v35 offset:16384
ds_read_b128 v[232:235], v36 offset:16384
ds_read_b128 v[236:239], v37 offset:16384
s_waitcnt lgkmcnt(4)
D2 v48,v208,s49,v48
D2 v52,v208,v208,v52
D2 v49,v209,s49,v49
D2 v53,v209,v209,v53
D2 v50,v210,s49,v50
D2 v54,v210,v210,v54
D2 v51,v211,s49,v51
D2 v55,v211,v211,v55
D2 v48,v212,s49,v48
D2 v52,v212,v212,v52
D2 v49,v213,s49,v49
D2 v53,v213,v213,v53
D2 v50,v214,s49,v50
D2 v54,v214,v214,v54
D2 v51,v215,s49,v51
D2 v55,v215,v215,v55
D2 v48,v216,s49,v48
D2 v52,v216,v216,v52
D2 v49,v217,s49,v49
D2 v53,v217,v217,v53
D2 v50,v218,s49,v50
D2 v54,v218,v218,v54
D2 v51,v219,s49,v51
D2 v55,v219,v219,v55
D2 v48,v220,s49,v48
D2 v52,v220,v220,v52
D2 v49,v221,s49,v49
D2 v53,v221,v221,v53
D2 v50,v222,s49,v50
D2 v54,v222,v222,v54
D2 v51,v223,s49,v51
D2 v55,v223,v223,v55
s_waitcnt vmcnt(5)
ds_read_b128 v[240:243], v34 offset:20480
ds_read_b128 v[244:247], v35 offset:20480
ds_read_b128 v[248:251], v36 offset:20480
ds_read_b128 v[252:255], v37 offset:20480
s_waitcnt lgkmcnt(4)
s_add_u32 m0, s6, 5120
s_bfe_u32 s60, s58, 0x40004
s_mul_i32 s60, s60, 245760
s_add_u32 s60, s60, s40
BL v10,s[20:23],s60 offen lds
D2 v48,v224,s49,v48
D2 v52,v224,v224,v52
D2 v49,v225,s49,v49
D2 v53,v225,v225,v53
D2 v50,v226,s49,v50
D2 v54,v226,v226,v54
D2 v51,v227,s49,v51
BL v11,s[20:23],s60 offen offset:1024 lds
D2 v55,v227,v227,v55
D2 v48,v228,s49,v48
D2 v52,v228,v228,v52
D2 v49,v229,s49,v49
D2 v53,v229,v229,v53
D2 v50,v230,s49,v50
D2 v54,v230,v230,v54
BL v12,s[20:23],s60 offen offset:2048 lds
D2 v51,v231,s49,v51
D2 v55,v231,v231,v55
D2 v48,v232,s49,v48
D2 v52,v232,v232,v52
D2 v49,v233,s49,v49
D2 v53,v233,v233,v53
BL v13,s[20:23],s60 offen offset:3072 lds
D2 v50,v234,s49,v50
D2 v54,v234,v234,v54
D2 v51,v235,s49,v51
D2 v55,v235,v235,v55
D2 v48,v236,s49,v48
D2 v52,v236,v236,v52
s_add_u32 m0, s6, 9216
s_nop 0
BL v14,s[20:23],s60 offen lds
D2 v49,v237,s49,v49
D2 v53,v237,v237,v53
D2 v50,v238,s49,v50
D2 v54,v238,v238,v54
D2 v51,v239,s49,v51
D2 v55,v239,v239,v55
s_waitcnt lgkmcnt(0)
D2 v48,v240,s49,v48
D2 v52,v240,v240,v52
D2 v49,v241,s49,v49
D2 v53,v241,v241,v53
D2 v50,v242,s49,v50
D2 v54,v242,v242,v54
D2 v51,v243,s49,v51
D2 v55,v243,v243,v55
D2 v48,v244,s49,v48
D2 v52,v244,v244,v52
D2 v49,v245,s49,v49
D2 v53,v245,v245,v53
D2 v50,v246,s49,v50
D2 v54,v246,v246,v54
D2 v51,v247,s49,v51
D2 v55,v247,v247,v55
D2 v48,v248,s49,v48
D2 v52,v248,v248,v52
D2 v49,v249,s49,v49
D2 v53,v249,v249,v53
D2 v50,v250,s49,v50
D2 v54,v250,v250,v54
D2 v51,v251,s49,v51
D2 v55,v251,v251,v55
D2 v48,v252,s49,v48
D2 v52,v252,v252,v52
D2 v49,v253,s49,v49
D2 v53,v253,v253,v53
D2 v50,v254,s49,v50
D2 v54,v254,v254,v54
D2 v51,v255,s49,v51
D2 v55,v255,v255,v55
s_nop 2
v_add_f32 v48, v48, v49
v_add_f32 v50, v50, v51
v_add_f32 v52, v52, v53
v_add_f32 v54, v54, v55
v_add_f32 v48, v48, v50
v_add_f32 v52, v52, v54
v_mov_b32 v49, v48
v_mov_b32 v53, v52
s_nop 0
v_permlane32_swap_b32 v48, v49
v_permlane32_swap_b32 v52, v53
v_add_f32 v48, v48, v49
v_add_f32 v52, v52, v53
v_mul_f32 v48, 0x3acccccd, v48
v_mul_f32 v52, 0x3acccccd, v52
v_fma_f32 v52, -v48, v48, v52
v_max_f32 v52, 0, v52
CV v50,v48,v52
v_and_b32 v52, s52, v50
v_lshlrev_b32 v48, 16, v50
v_add_f32 v52, 0x3727c5ac, v52
CV v52,v52,v52
v_and_b32 v52, s52, v52
v_sqrt_f32 v52, v52
s_nop 0
CV v52,v52,v52
v_and_b32 v52, s52, v52
v_rcp_f32 v32, v52
s_nop 0
v_mul_f32 v33, v48, v32
v_sub_f32 v33, 0, v33
s_waitcnt vmcnt(5)
s_barrier
TR a[224:225],v2
TR a[226:227],v2 offset:1280
TR a[228:229],v2 offset:80
TR a[230:231],v2 offset:1360
TR a[232:233],v2 offset:160
TR a[234:235],v2 offset:1440
TR a[236:237],v2 offset:240
TR a[238:239],v2 offset:1520
TR a[240:241],v4
TR a[242:243],v4 offset:1280
TR a[244:245],v2 offset:40960
TR a[246:247],v2 offset:42240
TR a[248:249],v2 offset:41040
TR a[250:251],v2 offset:42320
v_lshlrev_b32 v34, 16, v96
v_and_b32 v35, s52, v96
v_lshlrev_b32 v36, 16, v97
v_and_b32 v37, s52, v97
v_lshlrev_b32 v38, 16, v98
v_and_b32 v39, s52, v98
v_lshlrev_b32 v88, 16, v99
v_and_b32 v89, s52, v99
v_fma_f32 v34, v34, v32, v33
v_fma_f32 v35, v35, v32, v33
v_fma_f32 v36, v36, v32, v33
v_fma_f32 v37, v37, v32, v33
v_fma_f32 v38, v38, v32, v33
v_fma_f32 v39, v39, v32, v33
v_fma_f32 v88, v88, v32, v33
v_fma_f32 v89, v89, v32, v33
CV v96,v34,v35
CV v97,v36,v37
CV v98,v38,v39
CV v99,v88,v89
v_lshlrev_b32 v34, 16, v100
v_and_b32 v35, s52, v100
v_lshlrev_b32 v36, 16, v101
v_and_b32 v37, s52, v101
s_waitcnt lgkmcnt(6)
M3 a[0:15],v[96:99],a[224:227],0
TR a[252:253],v2 offset:41120
TR a[254:255],v2 offset:42400
v_lshlrev_b32 v38, 16, v102
v_and_b32 v39, s52, v102
v_lshlrev_b32 v88, 16, v103
v_and_b32 v89, s52, v103
s_add_u32 m0, s6, 10240
s_bfe_u32 s60, s58, 0x40008
s_mul_i32 s60, s60, 245760
s_add_u32 s60, s60, s40
BL v10,s[20:23],s60 offen lds
M3 a[16:31],v[96:99],a[228:231],0
TR a[224:225],v2 offset:41200
TR a[226:227],v2 offset:42480
v_fma_f32 v34, v34, v32, v33
v_fma_f32 v35, v35, v32, v33
v_fma_f32 v36, v36, v32, v33
v_fma_f32 v37, v37, v32, v33
M3 a[32:47],v[96:99],a[232:235],0
TR a[228:229],v4 offset:40960
TR a[230:231],v4 offset:42240
v_fma_f32 v38, v38, v32, v33
v_fma_f32 v39, v39, v32, v33
v_fma_f32 v88, v88, v32, v33
v_fma_f32 v89, v89, v32, v33
BL v11,s[20:23],s60 offen offset:1024 lds
M3 a[48:63],v[96:99],a[236:239],0
TR a[232:233],v3
TR a[234:235],v3 offset:1280
CV v100,v34,v35
CV v101,v36,v37
CV v102,v38,v39
CV v103,v88,v89
s_waitcnt lgkmcnt(6)
M3 a[64:79],v[96:99],a[240:243],0
TR a[236:237],v3 offset:80
TR a[238:239],v3 offset:1360
v_lshlrev_b32 v34, 16, v104
v_and_b32 v35, s52, v104
v_lshlrev_b32 v36, 16, v105
v_and_b32 v37, s52, v105
BL v12,s[20:23],s60 offen offset:2048 lds
M3 a[0:15],v[100:103],a[244:247],a[0:15]
TR a[240:241],v3 offset:160
TR a[242:243],v3 offset:1440
v_lshlrev_b32 v38, 16, v106
v_and_b32 v39, s52, v106
v_lshlrev_b32 v88, 16, v107
v_and_b32 v89, s52, v107
M3 a[16:31],v[100:103],a[248:251],a[16:31]
TR a[244:245],v3 offset:240
TR a[246:247],v3 offset:1520
v_fma_f32 v34, v34, v32, v33
v_fma_f32 v35, v35, v32, v33
v_fma_f32 v36, v36, v32, v33
v_fma_f32 v37, v37, v32, v33
BL v13,s[20:23],s60 offen offset:3072 lds
M3 a[32:47],v[100:103],a[252:255],a[32:47]
TR a[248:249],v5
TR a[250:251],v5 offset:1280
v_fma_f32 v38, v38, v32, v33
v_fma_f32 v39, v39, v32, v33
v_fma_f32 v88, v88, v32, v33
v_fma_f32 v89, v89, v32, v33
s_waitcnt lgkmcnt(6)
M3 a[48:63],v[100:103],a[224:227],a[48:63]
TR a[252:253],v3 offset:40960
TR a[254:255],v3 offset:42240
CV v104,v34,v35
CV v105,v36,v37
CV v106,v38,v39
CV v107,v88,v89
s_add_u32 m0, s6, 14336
s_nop 0
BL v14,s[20:23],s60 offen lds
M3 a[64:79],v[100:103],a[228:231],a[64:79]
TR a[224:225],v3 offset:41040
TR a[226:227],v3 offset:42320
v_lshlrev_b32 v34, 16, v108
v_and_b32 v35, s52, v108
v_lshlrev_b32 v36, 16, v109
v_and_b32 v37, s52, v109
M3 a[0:15],v[104:107],a[232:235],a[0:15]
buffer_load_dword v26, v27, s[28:31], 0 offen sc1
TR a[228:229],v3 offset:41120
TR a[230:231],v3 offset:42400
v_lshlrev_b32 v38, 16, v110
v_and_b32 v39, s52, v110
v_lshlrev_b32 v88, 16, v111
v_and_b32 v89, s52, v111
s_add_u32 m0, s6, 15360
s_bfe_u32 s60, s58, 0x4000c
s_mul_i32 s60, s60, 245760
s_add_u32 s60, s60, s40
BL v10,s[20:23],s60 offen lds
M3 a[16:31],v[104:107],a[236:239],a[16:31]
TR a[232:233],v3 offset:41200
TR a[234:235],v3 offset:42480
v_fma_f32 v34, v34, v32, v33
v_fma_f32 v35, v35, v32, v33
v_fma_f32 v36, v36, v32, v33
v_fma_f32 v37, v37, v32, v33
s_waitcnt lgkmcnt(6)
M3 a[32:47],v[104:107],a[240:243],a[32:47]
TR a[236:237],v5 offset:40960
TR a[238:239],v5 offset:42240
v_fma_f32 v38, v38, v32, v33
v_fma_f32 v39, v39, v32, v33
v_fma_f32 v88, v88, v32, v33
v_fma_f32 v89, v89, v32, v33
BL v11,s[20:23],s60 offen offset:1024 lds
M3 a[48:63],v[104:107],a[244:247],a[48:63]
CV v108,v34,v35
CV v109,v36,v37
CV v110,v38,v39
CV v111,v88,v89
M3 a[64:79],v[104:107],a[248:251],a[64:79]
v_lshlrev_b32 v34, 16, v112
v_and_b32 v35, s52, v112
v_lshlrev_b32 v36, 16, v113
v_and_b32 v37, s52, v113
BL v12,s[20:23],s60 offen offset:2048 lds
M3 a[0:15],v[108:111],a[252:255],a[0:15]
s_waitcnt vmcnt(9) lgkmcnt(0)
s_barrier
TR a[240:241],v2 offset:5120
TR a[242:243],v2 offset:6400
TR a[244:245],v2 offset:5200
TR a[246:247],v2 offset:6480
v_lshlrev_b32 v38, 16, v114
v_and_b32 v39, s52, v114
v_lshlrev_b32 v88, 16, v115
v_and_b32 v89, s52, v115
M3 a[16:31],v[108:111],a[224:227],a[16:31]
TR a[248:249],v2 offset:5280
TR a[250:251],v2 offset:6560
TR a[252:253],v2 offset:5360
TR a[254:255],v2 offset:6640
v_fma_f32 v34, v34, v32, v33
v_fma_f32 v35, v35, v32, v33
v_fma_f32 v36, v36, v32, v33
v_fma_f32 v37, v37, v32, v33
BL v13,s[20:23],s60 offen offset:3072 lds
M3 a[32:47],v[108:111],a[228:231],a[32:47]
TR a[224:225],v4 offset:5120
TR a[226:227],v4 offset:6400
v_fma_f32 v38, v38, v32, v33
v_fma_f32 v39, v39, v32, v33
v_fma_f32 v88, v88, v32, v33
v_fma_f32 v89, v89, v32, v33
M3 a[48:63],v[108:111],a[232:235],a[48:63]
TR a[228:229],v2 offset:46080
TR a[230:231],v2 offset:47360
CV v112,v34,v35
CV v113,v36,v37
CV v114,v38,v39
CV v115,v88,v89
s_add_u32 m0, s6, 19456
s_nop 0
BL v14,s[20:23],s60 offen lds
M3 a[64:79],v[108:111],a[236:239],a[64:79]
TR a[232:233],v2 offset:46160
TR a[234:235],v2 offset:47440
v_lshlrev_b32 v34, 16, v116
v_and_b32 v35, s52, v116
v_lshlrev_b32 v36, 16, v117
v_and_b32 v37, s52, v117
s_waitcnt lgkmcnt(6)
M3 a[0:15],v[112:115],a[240:243],a[0:15]
TR a[236:237],v2 offset:46240
TR a[238:239],v2 offset:47520
v_lshlrev_b32 v38, 16, v118
v_and_b32 v39, s52, v118
v_lshlrev_b32 v88, 16, v119
v_and_b32 v89, s52, v119
s_add_u32 m0, s6, 20480
s_bfe_u32 s60, s58, 0x40010
s_mul_i32 s60, s60, 245760
s_add_u32 s60, s60, s40
BL v10,s[20:23],s60 offen lds
M3 a[16:31],v[112:115],a[244:247],a[16:31]
TR a[240:241],v2 offset:46320
TR a[242:243],v2 offset:47600
v_fma_f32 v34, v34, v32, v33
v_fma_f32 v35, v35, v32, v33
v_fma_f32 v36, v36, v32, v33
v_fma_f32 v37, v37, v32, v33
M3 a[32:47],v[112:115],a[248:251],a[32:47]
TR a[244:245],v4 offset:46080
TR a[246:247],v4 offset:47360
v_fma_f32 v38, v38, v32, v33
v_fma_f32 v39, v39, v32, v33
v_fma_f32 v88, v88, v32, v33
v_fma_f32 v89, v89, v32, v33
BL v11,s[20:23],s60 offen offset:1024 lds
M3 a[48:63],v[112:115],a[252:255],a[48:63]
TR a[248:249],v3 offset:5120
TR a[250:251],v3 offset:6400
CV v116,v34,v35
CV v117,v36,v37
CV v118,v38,v39
CV v119,v88,v89
s_waitcnt lgkmcnt(6)
M3 a[64:79],v[112:115],a[224:227],a[64:79]
TR a[252:253],v3 offset:5200
TR a[254:255],v3 offset:6480
v_lshlrev_b32 v34, 16, v120
v_and_b32 v35, s52, v120
v_lshlrev_b32 v36, 16, v121
v_and_b32 v37, s52, v121
BL v12,s[20:23],s60 offen offset:2048 lds
M3 a[0:15],v[116:119],a[228:231],a[0:15]
TR a[224:225],v3 offset:5280
TR a[226:227],v3 offset:6560
v_lshlrev_b32 v38, 16, v122
v_and_b32 v39, s52, v122
v_lshlrev_b32 v88, 16, v123
v_and_b32 v89, s52, v123
M3 a[16:31],v[116:119],a[232:235],a[16:31]
TR a[228:229],v3 offset:5360
TR a[230:231],v3 offset:6640
v_fma_f32 v34, v34, v32, v33
v_fma_f32 v35, v35, v32, v33
v_fma_f32 v36, v36, v32, v33
v_fma_f32 v37, v37, v32, v33
BL v13,s[20:23],s60 offen offset:3072 lds
M3 a[32:47],v[116:119],a[236:239],a[32:47]
TR a[232:233],v5 offset:5120
TR a[234:235],v5 offset:6400
v_fma_f32 v38, v38, v32, v33
v_fma_f32 v39, v39, v32, v33
v_fma_f32 v88, v88, v32, v33
v_fma_f32 v89, v89, v32, v33
s_waitcnt lgkmcnt(6)
M3 a[48:63],v[116:119],a[240:243],a[48:63]
TR a[236:237],v3 offset:46080
TR a[238:239],v3 offset:47360
CV v120,v34,v35
CV v121,v36,v37
CV v122,v38,v39
CV v123,v88,v89
s_add_u32 m0, s6, 24576
s_nop 0
BL v14,s[20:23],s60 offen lds
M3 a[64:79],v[116:119],a[244:247],a[64:79]
TR a[240:241],v3 offset:46160
TR a[242:243],v3 offset:47440
v_lshlrev_b32 v34, 16, v124
v_and_b32 v35, s52, v124
v_lshlrev_b32 v36, 16, v125
v_and_b32 v37, s52, v125
M3 a[0:15],v[120:123],a[248:251],a[0:15]
TR a[244:245],v3 offset:46240
TR a[246:247],v3 offset:47520
v_lshlrev_b32 v38, 16, v126
v_and_b32 v39, s52, v126
v_lshlrev_b32 v88, 16, v127
v_and_b32 v89, s52, v127
s_add_u32 m0, s6, 0
s_bfe_u32 s60, s58, 0x40014
s_mul_i32 s60, s60, 245760
s_add_u32 s60, s60, s40
BL v10,s[20:23],s60 offen lds
M3 a[16:31],v[120:123],a[252:255],a[16:31]
TR a[248:249],v3 offset:46320
TR a[250:251],v3 offset:47600
v_fma_f32 v34, v34, v32, v33
v_fma_f32 v35, v35, v32, v33
v_fma_f32 v36, v36, v32, v33
v_fma_f32 v37, v37, v32, v33
s_waitcnt lgkmcnt(6)
M3 a[32:47],v[120:123],a[224:227],a[32:47]
TR a[252:253],v5 offset:46080
TR a[254:255],v5 offset:47360
v_fma_f32 v38, v38, v32, v33
v_fma_f32 v39, v39, v32, v33
v_fma_f32 v88, v88, v32, v33
v_fma_f32 v89, v89, v32, v33
BL v11,s[20:23],s60 offen offset:1024 lds
M3 a[48:63],v[120:123],a[228:231],a[48:63]
CV v124,v34,v35
CV v125,v36,v37
CV v126,v38,v39
CV v127,v88,v89
M3 a[64:79],v[120:123],a[232:235],a[64:79]
v_lshlrev_b32 v34, 16, v128
v_and_b32 v35, s52, v128
v_lshlrev_b32 v36, 16, v129
v_and_b32 v37, s52, v129
BL v12,s[20:23],s60 offen offset:2048 lds
M3 a[0:15],v[124:127],a[236:239],a[0:15]
s_waitcnt vmcnt(14) lgkmcnt(0)
s_barrier
TR a[224:225],v2 offset:10240
TR a[226:227],v2 offset:11520
TR a[228:229],v2 offset:10320
TR a[230:231],v2 offset:11600
v_lshlrev_b32 v38, 16, v130
v_and_b32 v39, s52, v130
v_lshlrev_b32 v88, 16, v131
v_and_b32 v89, s52, v131
M3 a[16:31],v[124:127],a[240:243],a[16:31]
TR a[232:233],v2 offset:10400
TR a[234:235],v2 offset:11680
TR a[236:237],v2 offset:10480
TR a[238:239],v2 offset:11760
v_fma_f32 v34, v34, v32, v33
v_fma_f32 v35, v35, v32, v33
v_fma_f32 v36, v36, v32, v33
v_fma_f32 v37, v37, v32, v33
BL v13,s[20:23],s60 offen offset:3072 lds
M3 a[32:47],v[124:127],a[244:247],a[32:47]
TR a[240:241],v4 offset:10240
TR a[242:243],v4 offset:11520
v_fma_f32 v38, v38, v32, v33
v_fma_f32 v39, v39, v32, v33
v_fma_f32 v88, v88, v32, v33
v_fma_f32 v89, v89, v32, v33
M3 a[48:63],v[124:127],a[248:251],a[48:63]
TR a[244:245],v2 offset:51200
TR a[246:247],v2 offset:52480
CV v128,v34,v35
CV v129,v36,v37
CV v130,v38,v39
CV v131,v88,v89
s_add_u32 m0, s6, 4096
s_nop 0
BL v14,s[20:23],s60 offen lds
M3 a[64:79],v[124:127],a[252:255],a[64:79]
TR a[248:249],v2 offset:51280
TR a[250:251],v2 offset:52560
v_lshlrev_b32 v34, 16, v132
v_and_b32 v35, s52, v132
v_lshlrev_b32 v36, 16, v133
v_and_b32 v37, s52, v133
s_waitcnt lgkmcnt(6)
M3 a[0:15],v[128:131],a[224:227],a[0:15]
s_waitcnt vmcnt(15)
K1_KVQ_N_chk:
v_cmp_eq_u32 vcc, 0, v26
s_nop 0
s_cmp_eq_u64 vcc, 0
s_cbranch_scc1 K1_KVQ_N_ok
s_cmp_eq_u32 s101, 0
s_cbranch_scc1 K1_KVQ_N_ok
s_sub_u32 s101, s101, 1
s_sleep 10
buffer_load_dword v26, v27, s[28:31], 0 offen sc1
s_waitcnt vmcnt(0)
s_branch K1_KVQ_N_chk
K1_KVQ_N_ok:
TR a[252:253],v2 offset:51360
TR a[254:255],v2 offset:52640
v_lshlrev_b32 v38, 16, v134
v_and_b32 v39, s52, v134
v_lshlrev_b32 v88, 16, v135
v_and_b32 v89, s52, v135
s_add_u32 m0, s6, 5120
s_bfe_u32 s60, s58, 0x40018
s_mul_i32 s60, s60, 245760
s_add_u32 s60, s60, s40
BL v10,s[20:23],s60 offen lds
M3 a[16:31],v[128:131],a[228:231],a[16:31]
TR a[224:225],v2 offset:51440
TR a[226:227],v2 offset:52720
v_fma_f32 v34, v34, v32, v33
v_fma_f32 v35, v35, v32, v33
v_fma_f32 v36, v36, v32, v33
v_fma_f32 v37, v37, v32, v33
M3 a[32:47],v[128:131],a[232:235],a[32:47]
TR a[228:229],v4 offset:51200
TR a[230:231],v4 offset:52480
v_fma_f32 v38, v38, v32, v33
v_fma_f32 v39, v39, v32, v33
v_fma_f32 v88, v88, v32, v33
v_fma_f32 v89, v89, v32, v33
BL v11,s[20:23],s60 offen offset:1024 lds
M3 a[48:63],v[128:131],a[236:239],a[48:63]
TR a[232:233],v3 offset:10240
TR a[234:235],v3 offset:11520
CV v132,v34,v35
CV v133,v36,v37
CV v134,v38,v39
CV v135,v88,v89
s_waitcnt lgkmcnt(6)
M3 a[64:79],v[128:131],a[240:243],a[64:79]
TR a[236:237],v3 offset:10320
TR a[238:239],v3 offset:11600
v_lshlrev_b32 v34, 16, v136
v_and_b32 v35, s52, v136
v_lshlrev_b32 v36, 16, v137
v_and_b32 v37, s52, v137
BL v12,s[20:23],s60 offen offset:2048 lds
M3 a[0:15],v[132:135],a[244:247],a[0:15]
TR a[240:241],v3 offset:10400
TR a[242:243],v3 offset:11680
v_lshlrev_b32 v38, 16, v138
v_and_b32 v39, s52, v138
v_lshlrev_b32 v88, 16, v139
v_and_b32 v89, s52, v139
M3 a[16:31],v[132:135],a[248:251],a[16:31]
TR a[244:245],v3 offset:10480
TR a[246:247],v3 offset:11760
v_fma_f32 v34, v34, v32, v33
v_fma_f32 v35, v35, v32, v33
v_fma_f32 v36, v36, v32, v33
v_fma_f32 v37, v37, v32, v33
BL v13,s[20:23],s60 offen offset:3072 lds
M3 a[32:47],v[132:135],a[252:255],a[32:47]
TR a[248:249],v5 offset:10240
TR a[250:251],v5 offset:11520
v_fma_f32 v38, v38, v32, v33
v_fma_f32 v39, v39, v32, v33
v_fma_f32 v88, v88, v32, v33
v_fma_f32 v89, v89, v32, v33
s_waitcnt lgkmcnt(6)
M3 a[48:63],v[132:135],a[224:227],a[48:63]
TR a[252:253],v3 offset:51200
TR a[254:255],v3 offset:52480
CV v136,v34,v35
CV v137,v36,v37
CV v138,v38,v39
CV v139,v88,v89
s_add_u32 m0, s6, 9216
s_nop 0
BL v14,s[20:23],s60 offen lds
M3 a[64:79],v[132:135],a[228:231],a[64:79]
TR a[224:225],v3 offset:51280
TR a[226:227],v3 offset:52560
v_lshlrev_b32 v34, 16, v140
v_and_b32 v35, s52, v140
v_lshlrev_b32 v36, 16, v141
v_and_b32 v37, s52, v141
M3 a[0:15],v[136:139],a[232:235],a[0:15]
TR a[228:229],v3 offset:51360
TR a[230:231],v3 offset:52640
v_lshlrev_b32 v38, 16, v142
v_and_b32 v39, s52, v142
v_lshlrev_b32 v88, 16, v143
v_and_b32 v89, s52, v143
M3 a[16:31],v[136:139],a[236:239],a[16:31]
TR a[232:233],v3 offset:51440
TR a[234:235],v3 offset:52720
v_fma_f32 v34, v34, v32, v33
v_fma_f32 v35, v35, v32, v33
v_fma_f32 v36, v36, v32, v33
v_fma_f32 v37, v37, v32, v33
s_waitcnt lgkmcnt(6)
M3 a[32:47],v[136:139],a[240:243],a[32:47]
TR a[236:237],v5 offset:51200
TR a[238:239],v5 offset:52480
v_fma_f32 v38, v38, v32, v33
v_fma_f32 v39, v39, v32, v33
v_fma_f32 v88, v88, v32, v33
v_fma_f32 v89, v89, v32, v33
M3 a[48:63],v[136:139],a[244:247],a[48:63]
CV v140,v34,v35
CV v141,v36,v37
CV v142,v38,v39
CV v143,v88,v89
M3 a[64:79],v[136:139],a[248:251],a[64:79]
v_lshlrev_b32 v34, 16, v144
v_and_b32 v35, s52, v144
v_lshlrev_b32 v36, 16, v145
v_and_b32 v37, s52, v145
M3 a[0:15],v[140:143],a[252:255],a[0:15]
s_waitcnt vmcnt(15) lgkmcnt(0)
s_barrier
TR a[240:241],v2 offset:15360
TR a[242:243],v2 offset:16640
TR a[244:245],v2 offset:15440
TR a[246:247],v2 offset:16720
v_lshlrev_b32 v38, 16, v146
v_and_b32 v39, s52, v146
v_lshlrev_b32 v88, 16, v147
v_and_b32 v89, s52, v147
M3 a[16:31],v[140:143],a[224:227],a[16:31]
TR a[248:249],v2 offset:15520
TR a[250:251],v2 offset:16800
TR a[252:253],v2 offset:15600
TR a[254:255],v2 offset:16880
v_fma_f32 v34, v34, v32, v33
v_fma_f32 v35, v35, v32, v33
v_fma_f32 v36, v36, v32, v33
v_fma_f32 v37, v37, v32, v33
s_add_u32 m0, s6, 10240
s_bfe_u32 s60, s58, 0x4001c
s_mul_i32 s60, s60, 245760
s_add_u32 s60, s60, s40
BL v10,s[20:23],s60 offen lds
M3 a[32:47],v[140:143],a[228:231],a[32:47]
TR a[224:225],v4 offset:15360
TR a[226:227],v4 offset:16640
v_fma_f32 v38, v38, v32, v33
v_fma_f32 v39, v39, v32, v33
v_fma_f32 v88, v88, v32, v33
v_fma_f32 v89, v89, v32, v33
M3 a[48:63],v[140:143],a[232:235],a[48:63]
TR a[228:229],v2 offset:56320
TR a[230:231],v2 offset:57600
CV v144,v34,v35
CV v145,v36,v37
CV v146,v38,v39
CV v147,v88,v89
BL v11,s[20:23],s60 offen offset:1024 lds
M3 a[64:79],v[140:143],a[236:239],a[64:79]
TR a[232:233],v2 offset:56400
TR a[234:235],v2 offset:57680
v_lshlrev_b32 v34, 16, v148
v_and_b32 v35, s52, v148
v_lshlrev_b32 v36, 16, v149
v_and_b32 v37, s52, v149
s_waitcnt lgkmcnt(6)
M3 a[0:15],v[144:147],a[240:243],a[0:15]
TR a[236:237],v2 offset:56480
TR a[238:239],v2 offset:57760
v_lshlrev_b32 v38, 16, v150
v_and_b32 v39, s52, v150
v_lshlrev_b32 v88, 16, v151
v_and_b32 v89, s52, v151
BL v12,s[20:23],s60 offen offset:2048 lds
M3 a[16:31],v[144:147],a[244:247],a[16:31]
TR a[240:241],v2 offset:56560
TR a[242:243],v2 offset:57840
v_fma_f32 v34, v34, v32, v33
v_fma_f32 v35, v35, v32, v33
v_fma_f32 v36, v36, v32, v33
v_fma_f32 v37, v37, v32, v33
M3 a[32:47],v[144:147],a[248:251],a[32:47]
TR a[244:245],v4 offset:56320
TR a[246:247],v4 offset:57600
v_fma_f32 v38, v38, v32, v33
v_fma_f32 v39, v39, v32, v33
v_fma_f32 v88, v88, v32, v33
v_fma_f32 v89, v89, v32, v33
BL v13,s[20:23],s60 offen offset:3072 lds
M3 a[48:63],v[144:147],a[252:255],a[48:63]
TR a[248:249],v3 offset:15360
TR a[250:251],v3 offset:16640
CV v148,v34,v35
CV v149,v36,v37
CV v150,v38,v39
CV v151,v88,v89
s_waitcnt lgkmcnt(6)
M3 a[64:79],v[144:147],a[224:227],a[64:79]
TR a[252:253],v3 offset:15440
TR a[254:255],v3 offset:16720
v_lshlrev_b32 v34, 16, v152
v_and_b32 v35, s52, v152
v_lshlrev_b32 v36, 16, v153
v_and_b32 v37, s52, v153
s_add_u32 m0, s6, 14336
s_nop 0
BL v14,s[20:23],s60 offen lds
M3 a[0:15],v[148:151],a[228:231],a[0:15]
TR a[224:225],v3 offset:15520
TR a[226:227],v3 offset:16800
v_lshlrev_b32 v38, 16, v154
v_and_b32 v39, s52, v154
v_lshlrev_b32 v88, 16, v155
v_and_b32 v89, s52, v155
M3 a[16:31],v[148:151],a[232:235],a[16:31]
TR a[228:229],v3 offset:15600
TR a[230:231],v3 offset:16880
v_fma_f32 v34, v34, v32, v33
v_fma_f32 v35, v35, v32, v33
v_fma_f32 v36, v36, v32, v33
v_fma_f32 v37, v37, v32, v33
M3 a[32:47],v[148:151],a[236:239],a[32:47]
TR a[232:233],v5 offset:15360
TR a[234:235],v5 offset:16640
v_fma_f32 v38, v38, v32, v33
v_fma_f32 v39, v39, v32, v33
v_fma_f32 v88, v88, v32, v33
v_fma_f32 v89, v89, v32, v33
s_waitcnt lgkmcnt(6)
M3 a[48:63],v[148:151],a[240:243],a[48:63]
TR a[236:237],v3 offset:56320
TR a[238:239],v3 offset:57600
CV v152,v34,v35
CV v153,v36,v37
CV v154,v38,v39
CV v155,v88,v89
M3 a[64:79],v[148:151],a[244:247],a[64:79]
TR a[240:241],v3 offset:56400
TR a[242:243],v3 offset:57680
v_lshlrev_b32 v34, 16, v156
v_and_b32 v35, s52, v156
v_lshlrev_b32 v36, 16, v157
v_and_b32 v37, s52, v157
M3 a[0:15],v[152:155],a[248:251],a[0:15]
TR a[244:245],v3 offset:56480
TR a[246:247],v3 offset:57760
v_lshlrev_b32 v38, 16, v158
v_and_b32 v39, s52, v158
v_lshlrev_b32 v88, 16, v159
v_and_b32 v89, s52, v159
M3 a[16:31],v[152:155],a[252:255],a[16:31]
TR a[248:249],v3 offset:56560
TR a[250:251],v3 offset:57840
v_fma_f32 v34, v34, v32, v33
v_fma_f32 v35, v35, v32, v33
v_fma_f32 v36, v36, v32, v33
v_fma_f32 v37, v37, v32, v33
s_waitcnt lgkmcnt(6)
M3 a[32:47],v[152:155],a[224:227],a[32:47]
TR a[252:253],v5 offset:56320
TR a[254:255],v5 offset:57600
v_fma_f32 v38, v38, v32, v33
v_fma_f32 v39, v39, v32, v33
v_fma_f32 v88, v88, v32, v33
v_fma_f32 v89, v89, v32, v33
M3 a[48:63],v[152:155],a[228:231],a[48:63]
CV v156,v34,v35
CV v157,v36,v37
CV v158,v38,v39
CV v159,v88,v89
M3 a[64:79],v[152:155],a[232:235],a[64:79]
v_lshlrev_b32 v34, 16, v160
v_and_b32 v35, s52, v160
v_lshlrev_b32 v36, 16, v161
v_and_b32 v37, s52, v161
M3 a[0:15],v[156:159],a[236:239],a[0:15]
s_waitcnt vmcnt(15) lgkmcnt(0)
s_barrier
TR a[224:225],v2 offset:20480
TR a[226:227],v2 offset:21760
TR a[228:229],v2 offset:20560
TR a[230:231],v2 offset:21840
v_lshlrev_b32 v38, 16, v162
v_and_b32 v39, s52, v162
v_lshlrev_b32 v88, 16, v163
v_and_b32 v89, s52, v163
M3 a[16:31],v[156:159],a[240:243],a[16:31]
TR a[232:233],v2 offset:20640
TR a[234:235],v2 offset:21920
TR a[236:237],v2 offset:20720
TR a[238:239],v2 offset:22000
v_fma_f32 v34, v34, v32, v33
v_fma_f32 v35, v35, v32, v33
v_fma_f32 v36, v36, v32, v33
v_fma_f32 v37, v37, v32, v33
s_add_u32 m0, s6, 15360
s_bfe_u32 s60, s59, 0x40000
s_mul_i32 s60, s60, 245760
s_add_u32 s60, s60, s40
BL v10,s[20:23],s60 offen lds
M3 a[32:47],v[156:159],a[244:247],a[32:47]
TR a[240:241],v4 offset:20480
TR a[242:243],v4 offset:21760
v_fma_f32 v38, v38, v32, v33
v_fma_f32 v39, v39, v32, v33
v_fma_f32 v88, v88, v32, v33
v_fma_f32 v89, v89, v32, v33
M3 a[48:63],v[156:159],a[248:251],a[48:63]
TR a[244:245],v2 offset:61440
TR a[246:247],v2 offset:62720
CV v160,v34,v35
CV v161,v36,v37
CV v162,v38,v39
CV v163,v88,v89
BL v11,s[20:23],s60 offen offset:1024 lds
M3 a[64:79],v[156:159],a[252:255],a[64:79]
TR a[248:249],v2 offset:61520
TR a[250:251],v2 offset:62800
v_lshlrev_b32 v34, 16, v164
v_and_b32 v35, s52, v164
v_lshlrev_b32 v36, 16, v165
v_and_b32 v37, s52, v165
s_waitcnt lgkmcnt(6)
M3 a[0:15],v[160:163],a[224:227],a[0:15]
TR a[252:253],v2 offset:61600
TR a[254:255],v2 offset:62880
v_lshlrev_b32 v38, 16, v166
v_and_b32 v39, s52, v166
v_lshlrev_b32 v88, 16, v167
v_and_b32 v89, s52, v167
BL v12,s[20:23],s60 offen offset:2048 lds
M3 a[16:31],v[160:163],a[228:231],a[16:31]
TR a[224:225],v2 offset:61680
TR a[226:227],v2 offset:62960
v_fma_f32 v34, v34, v32, v33
v_fma_f32 v35, v35, v32, v33
v_fma_f32 v36, v36, v32, v33
v_fma_f32 v37, v37, v32, v33
M3 a[32:47],v[160:163],a[232:235],a[32:47]
TR a[228:229],v4 offset:61440
TR a[230:231],v4 offset:62720
v_fma_f32 v38, v38, v32, v33
v_fma_f32 v39, v39, v32, v33
v_fma_f32 v88, v88, v32, v33
v_fma_f32 v89, v89, v32, v33
BL v13,s[20:23],s60 offen offset:3072 lds
M3 a[48:63],v[160:163],a[236:239],a[48:63]
TR a[232:233],v3 offset:20480
TR a[234:235],v3 offset:21760
CV v164,v34,v35
CV v165,v36,v37
CV v166,v38,v39
CV v167,v88,v89
s_waitcnt lgkmcnt(6)
M3 a[64:79],v[160:163],a[240:243],a[64:79]
TR a[236:237],v3 offset:20560
TR a[238:239],v3 offset:21840
v_lshlrev_b32 v34, 16, v168
v_and_b32 v35, s52, v168
v_lshlrev_b32 v36, 16, v169
v_and_b32 v37, s52, v169
s_add_u32 m0, s6, 19456
s_nop 0
BL v14,s[20:23],s60 offen lds
M3 a[0:15],v[164:167],a[244:247],a[0:15]
TR a[240:241],v3 offset:20640
TR a[242:243],v3 offset:21920
v_lshlrev_b32 v38, 16, v170
v_and_b32 v39, s52, v170
v_lshlrev_b32 v88, 16, v171
v_and_b32 v89, s52, v171
M3 a[16:31],v[164:167],a[248:251],a[16:31]
TR a[244:245],v3 offset:20720
TR a[246:247],v3 offset:22000
v_fma_f32 v34, v34, v32, v33
v_fma_f32 v35, v35, v32, v33
v_fma_f32 v36, v36, v32, v33
v_fma_f32 v37, v37, v32, v33
M3 a[32:47],v[164:167],a[252:255],a[32:47]
TR a[248:249],v5 offset:20480
TR a[250:251],v5 offset:21760
v_fma_f32 v38, v38, v32, v33
v_fma_f32 v39, v39, v32, v33
v_fma_f32 v88, v88, v32, v33
v_fma_f32 v89, v89, v32, v33
s_waitcnt lgkmcnt(6)
M3 a[48:63],v[164:167],a[224:227],a[48:63]
TR a[252:253],v3 offset:61440
TR a[254:255],v3 offset:62720
CV v168,v34,v35
CV v169,v36,v37
CV v170,v38,v39
CV v171,v88,v89
M3 a[64:79],v[164:167],a[228:231],a[64:79]
TR a[224:225],v3 offset:61520
TR a[226:227],v3 offset:62800
v_lshlrev_b32 v34, 16, v172
v_and_b32 v35, s52, v172
v_lshlrev_b32 v36, 16, v173
v_and_b32 v37, s52, v173
M3 a[0:15],v[168:171],a[232:235],a[0:15]
TR a[228:229],v3 offset:61600
TR a[230:231],v3 offset:62880
v_lshlrev_b32 v38, 16, v174
v_and_b32 v39, s52, v174
v_lshlrev_b32 v88, 16, v175
v_and_b32 v89, s52, v175
M3 a[16:31],v[168:171],a[236:239],a[16:31]
TR a[232:233],v3 offset:61680
TR a[234:235],v3 offset:62960
v_fma_f32 v34, v34, v32, v33
v_fma_f32 v35, v35, v32, v33
v_fma_f32 v36, v36, v32, v33
v_fma_f32 v37, v37, v32, v33
s_waitcnt lgkmcnt(6)
M3 a[32:47],v[168:171],a[240:243],a[32:47]
TR a[236:237],v5 offset:61440
TR a[238:239],v5 offset:62720
v_fma_f32 v38, v38, v32, v33
v_fma_f32 v39, v39, v32, v33
v_fma_f32 v88, v88, v32, v33
v_fma_f32 v89, v89, v32, v33
M3 a[48:63],v[168:171],a[244:247],a[48:63]
CV v172,v34,v35
CV v173,v36,v37
CV v174,v38,v39
CV v175,v88,v89
M3 a[64:79],v[168:171],a[248:251],a[64:79]
v_lshlrev_b32 v34, 16, v176
v_and_b32 v35, s52, v176
v_lshlrev_b32 v36, 16, v177
v_and_b32 v37, s52, v177
M3 a[0:15],v[172:175],a[252:255],a[0:15]
s_waitcnt vmcnt(15) lgkmcnt(0)
s_barrier
TR a[240:241],v2
TR a[242:243],v2 offset:1280
TR a[244:245],v2 offset:80
TR a[246:247],v2 offset:1360
v_lshlrev_b32 v38, 16, v178
v_and_b32 v39, s52, v178
v_lshlrev_b32 v88, 16, v179
v_and_b32 v89, s52, v179
M3 a[16:31],v[172:175],a[224:227],a[16:31]
TR a[248:249],v2 offset:160
TR a[250:251],v2 offset:1440
TR a[252:253],v2 offset:240
TR a[254:255],v2 offset:1520
v_fma_f32 v34, v34, v32, v33
v_fma_f32 v35, v35, v32, v33
v_fma_f32 v36, v36, v32, v33
v_fma_f32 v37, v37, v32, v33
s_add_u32 m0, s6, 20480
s_bfe_u32 s60, s59, 0x40004
s_mul_i32 s60, s60, 245760
s_add_u32 s60, s60, s40
BL v10,s[20:23],s60 offen lds
M3 a[32:47],v[172:175],a[228:231],a[32:47]
TR a[224:225],v4
TR a[226:227],v4 offset:1280
v_fma_f32 v38, v38, v32, v33
v_fma_f32 v39, v39, v32, v33
v_fma_f32 v88, v88, v32, v33
v_fma_f32 v89, v89, v32, v33
M3 a[48:63],v[172:175],a[232:235],a[48:63]
TR a[228:229],v2 offset:40960
TR a[230:231],v2 offset:42240
CV v176,v34,v35
CV v177,v36,v37
CV v178,v38,v39
CV v179,v88,v89
BL v11,s[20:23],s60 offen offset:1024 lds
M3 a[64:79],v[172:175],a[236:239],a[64:79]
TR a[232:233],v2 offset:41040
TR a[234:235],v2 offset:42320
v_lshlrev_b32 v34, 16, v180
v_and_b32 v35, s52, v180
v_lshlrev_b32 v36, 16, v181
v_and_b32 v37, s52, v181
s_waitcnt lgkmcnt(6)
M3 a[0:15],v[176:179],a[240:243],a[0:15]
TR a[236:237],v2 offset:41120
TR a[238:239],v2 offset:42400
v_lshlrev_b32 v38, 16, v182
v_and_b32 v39, s52, v182
v_lshlrev_b32 v88, 16, v183
v_and_b32 v89, s52, v183
BL v12,s[20:23],s60 offen offset:2048 lds
M3 a[16:31],v[176:179],a[244:247],a[16:31]
TR a[240:241],v2 offset:41200
TR a[242:243],v2 offset:42480
v_fma_f32 v34, v34, v32, v33
v_fma_f32 v35, v35, v32, v33
v_fma_f32 v36, v36, v32, v33
v_fma_f32 v37, v37, v32, v33
M3 a[32:47],v[176:179],a[248:251],a[32:47]
TR a[244:245],v4 offset:40960
TR a[246:247],v4 offset:42240
v_fma_f32 v38, v38, v32, v33
v_fma_f32 v39, v39, v32, v33
v_fma_f32 v88, v88, v32, v33
v_fma_f32 v89, v89, v32, v33
BL v13,s[20:23],s60 offen offset:3072 lds
M3 a[48:63],v[176:179],a[252:255],a[48:63]
TR a[248:249],v3
TR a[250:251],v3 offset:1280
CV v180,v34,v35
CV v181,v36,v37
CV v182,v38,v39
CV v183,v88,v89
s_waitcnt lgkmcnt(6)
M3 a[64:79],v[176:179],a[224:227],a[64:79]
TR a[252:253],v3 offset:80
TR a[254:255],v3 offset:1360
v_lshlrev_b32 v34, 16, v184
v_and_b32 v35, s52, v184
v_lshlrev_b32 v36, 16, v185
v_and_b32 v37, s52, v185
s_add_u32 m0, s6, 24576
s_nop 0
BL v14,s[20:23],s60 offen lds
M3 a[0:15],v[180:183],a[228:231],a[0:15]
TR a[224:225],v3 offset:160
TR a[226:227],v3 offset:1440
v_lshlrev_b32 v38, 16, v186
v_and_b32 v39, s52, v186
v_lshlrev_b32 v88, 16, v187
v_and_b32 v89, s52, v187
M3 a[16:31],v[180:183],a[232:235],a[16:31]
TR a[228:229],v3 offset:240
TR a[230:231],v3 offset:1520
v_fma_f32 v34, v34, v32, v33
v_fma_f32 v35, v35, v32, v33
v_fma_f32 v36, v36, v32, v33
v_fma_f32 v37, v37, v32, v33
M3 a[32:47],v[180:183],a[236:239],a[32:47]
TR a[232:233],v5
TR a[234:235],v5 offset:1280
v_fma_f32 v38, v38, v32, v33
v_fma_f32 v39, v39, v32, v33
v_fma_f32 v88, v88, v32, v33
v_fma_f32 v89, v89, v32, v33
s_waitcnt lgkmcnt(6)
M3 a[48:63],v[180:183],a[240:243],a[48:63]
TR a[236:237],v3 offset:40960
TR a[238:239],v3 offset:42240
CV v184,v34,v35
CV v185,v36,v37
CV v186,v38,v39
CV v187,v88,v89
M3 a[64:79],v[180:183],a[244:247],a[64:79]
TR a[240:241],v3 offset:41040
TR a[242:243],v3 offset:42320
v_lshlrev_b32 v34, 16, v188
v_and_b32 v35, s52, v188
v_lshlrev_b32 v36, 16, v189
v_and_b32 v37, s52, v189
M3 a[0:15],v[184:187],a[248:251],a[0:15]
TR a[244:245],v3 offset:41120
TR a[246:247],v3 offset:42400
v_lshlrev_b32 v38, 16, v190
v_and_b32 v39, s52, v190
v_lshlrev_b32 v88, 16, v191
v_and_b32 v89, s52, v191
M3 a[16:31],v[184:187],a[252:255],a[16:31]
TR a[248:249],v3 offset:41200
TR a[250:251],v3 offset:42480
v_fma_f32 v34, v34, v32, v33
v_fma_f32 v35, v35, v32, v33
v_fma_f32 v36, v36, v32, v33
v_fma_f32 v37, v37, v32, v33
s_waitcnt lgkmcnt(6)
M3 a[32:47],v[184:187],a[224:227],a[32:47]
TR a[252:253],v5 offset:40960
TR a[254:255],v5 offset:42240
v_fma_f32 v38, v38, v32, v33
v_fma_f32 v39, v39, v32, v33
v_fma_f32 v88, v88, v32, v33
v_fma_f32 v89, v89, v32, v33
M3 a[48:63],v[184:187],a[228:231],a[48:63]
CV v188,v34,v35
CV v189,v36,v37
CV v190,v38,v39
CV v191,v88,v89
M3 a[64:79],v[184:187],a[232:235],a[64:79]
v_lshlrev_b32 v34, 16, v192
v_and_b32 v35, s52, v192
v_lshlrev_b32 v36, 16, v193
v_and_b32 v37, s52, v193
M3 a[0:15],v[188:191],a[236:239],a[0:15]
s_waitcnt vmcnt(15) lgkmcnt(0)
s_barrier
TR a[224:225],v2 offset:5120
TR a[226:227],v2 offset:6400
TR a[228:229],v2 offset:5200
TR a[230:231],v2 offset:6480
v_lshlrev_b32 v38, 16, v194
v_and_b32 v39, s52, v194
v_lshlrev_b32 v88, 16, v195
v_and_b32 v89, s52, v195
M3 a[16:31],v[188:191],a[240:243],a[16:31]
TR a[232:233],v2 offset:5280
TR a[234:235],v2 offset:6560
TR a[236:237],v2 offset:5360
TR a[238:239],v2 offset:6640
v_fma_f32 v34, v34, v32, v33
v_fma_f32 v35, v35, v32, v33
v_fma_f32 v36, v36, v32, v33
v_fma_f32 v37, v37, v32, v33
s_add_u32 m0, s6, 0
s_bfe_u32 s60, s58, 0x40000
s_mul_i32 s60, s60, 245760
s_add_u32 s60, s60, s41
BL v15,s[20:23],s60 offen lds
M3 a[32:47],v[188:191],a[244:247],a[32:47]
TR a[240:241],v4 offset:5120
TR a[242:243],v4 offset:6400
v_fma_f32 v38, v38, v32, v33
v_fma_f32 v39, v39, v32, v33
v_fma_f32 v88, v88, v32, v33
v_fma_f32 v89, v89, v32, v33
M3 a[48:63],v[188:191],a[248:251],a[48:63]
TR a[244:245],v2 offset:46080
TR a[246:247],v2 offset:47360
CV v192,v34,v35
CV v193,v36,v37
CV v194,v38,v39
CV v195,v88,v89
BL v16,s[20:23],s60 offen offset:1024 lds
M3 a[64:79],v[188:191],a[252:255],a[64:79]
TR a[248:249],v2 offset:46160
TR a[250:251],v2 offset:47440
v_lshlrev_b32 v34, 16, v196
v_and_b32 v35, s52, v196
v_lshlrev_b32 v36, 16, v197
v_and_b32 v37, s52, v197
s_waitcnt lgkmcnt(6)
M3 a[0:15],v[192:195],a[224:227],a[0:15]
TR a[252:253],v2 offset:46240
TR a[254:255],v2 offset:47520
v_lshlrev_b32 v38, 16, v198
v_and_b32 v39, s52, v198
v_lshlrev_b32 v88, 16, v199
v_and_b32 v89, s52, v199
BL v17,s[20:23],s60 offen offset:2048 lds
M3 a[16:31],v[192:195],a[228:231],a[16:31]
TR a[224:225],v2 offset:46320
TR a[226:227],v2 offset:47600
v_fma_f32 v34, v34, v32, v33
v_fma_f32 v35, v35, v32, v33
v_fma_f32 v36, v36, v32, v33
v_fma_f32 v37, v37, v32, v33
M3 a[32:47],v[192:195],a[232:235],a[32:47]
TR a[228:229],v4 offset:46080
TR a[230:231],v4 offset:47360
v_fma_f32 v38, v38, v32, v33
v_fma_f32 v39, v39, v32, v33
v_fma_f32 v88, v88, v32, v33
v_fma_f32 v89, v89, v32, v33
BL v18,s[20:23],s60 offen offset:3072 lds
M3 a[48:63],v[192:195],a[236:239],a[48:63]
TR a[232:233],v3 offset:5120
TR a[234:235],v3 offset:6400
CV v196,v34,v35
CV v197,v36,v37
CV v198,v38,v39
CV v199,v88,v89
s_waitcnt lgkmcnt(6)
M3 a[64:79],v[192:195],a[240:243],a[64:79]
TR a[236:237],v3 offset:5200
TR a[238:239],v3 offset:6480
v_lshlrev_b32 v34, 16, v200
v_and_b32 v35, s52, v200
v_lshlrev_b32 v36, 16, v201
v_and_b32 v37, s52, v201
s_add_u32 m0, s6, 4096
s_nop 0
BL v19,s[20:23],s60 offen lds
M3 a[0:15],v[196:199],a[244:247],a[0:15]
TR a[240:241],v3 offset:5280
TR a[242:243],v3 offset:6560
v_lshlrev_b32 v38, 16, v202
v_and_b32 v39, s52, v202
v_lshlrev_b32 v88, 16, v203
v_and_b32 v89, s52, v203
M3 a[16:31],v[196:199],a[248:251],a[16:31]
TR a[244:245],v3 offset:5360
TR a[246:247],v3 offset:6640
v_fma_f32 v34, v34, v32, v33
v_fma_f32 v35, v35, v32, v33
v_fma_f32 v36, v36, v32, v33
v_fma_f32 v37, v37, v32, v33
M3 a[32:47],v[196:199],a[252:255],a[32:47]
TR a[248:249],v5 offset:5120
TR a[250:251],v5 offset:6400
v_fma_f32 v38, v38, v32, v33
v_fma_f32 v39, v39, v32, v33
v_fma_f32 v88, v88, v32, v33
v_fma_f32 v89, v89, v32, v33
s_waitcnt lgkmcnt(6)
M3 a[48:63],v[196:199],a[224:227],a[48:63]
TR a[252:253],v3 offset:46080
TR a[254:255],v3 offset:47360
CV v200,v34,v35
CV v201,v36,v37
CV v202,v38,v39
CV v203,v88,v89
M3 a[64:79],v[196:199],a[228:231],a[64:79]
TR a[224:225],v3 offset:46160
TR a[226:227],v3 offset:47440
v_lshlrev_b32 v34, 16, v204
v_and_b32 v35, s52, v204
v_lshlrev_b32 v36, 16, v205
v_and_b32 v37, s52, v205
M3 a[0:15],v[200:203],a[232:235],a[0:15]
TR a[228:229],v3 offset:46240
TR a[230:231],v3 offset:47520
v_lshlrev_b32 v38, 16, v206
v_and_b32 v39, s52, v206
v_lshlrev_b32 v88, 16, v207
v_and_b32 v89, s52, v207
M3 a[16:31],v[200:203],a[236:239],a[16:31]
TR a[232:233],v3 offset:46320
TR a[234:235],v3 offset:47600
v_fma_f32 v34, v34, v32, v33
v_fma_f32 v35, v35, v32, v33
v_fma_f32 v36, v36, v32, v33
v_fma_f32 v37, v37, v32, v33
s_waitcnt lgkmcnt(6)
M3 a[32:47],v[200:203],a[240:243],a[32:47]
TR a[236:237],v5 offset:46080
TR a[238:239],v5 offset:47360
v_fma_f32 v38, v38, v32, v33
v_fma_f32 v39, v39, v32, v33
v_fma_f32 v88, v88, v32, v33
v_fma_f32 v89, v89, v32, v33
M3 a[48:63],v[200:203],a[244:247],a[48:63]
CV v204,v34,v35
CV v205,v36,v37
CV v206,v38,v39
CV v207,v88,v89
M3 a[64:79],v[200:203],a[248:251],a[64:79]
v_lshlrev_b32 v34, 16, v208
v_and_b32 v35, s52, v208
v_lshlrev_b32 v36, 16, v209
v_and_b32 v37, s52, v209
M3 a[0:15],v[204:207],a[252:255],a[0:15]
s_waitcnt vmcnt(15) lgkmcnt(0)
s_barrier
TR a[240:241],v2 offset:10240
TR a[242:243],v2 offset:11520
TR a[244:245],v2 offset:10320
TR a[246:247],v2 offset:11600
v_lshlrev_b32 v38, 16, v210
v_and_b32 v39, s52, v210
v_lshlrev_b32 v88, 16, v211
v_and_b32 v89, s52, v211
M3 a[16:31],v[204:207],a[224:227],a[16:31]
TR a[248:249],v2 offset:10400
TR a[250:251],v2 offset:11680
TR a[252:253],v2 offset:10480
TR a[254:255],v2 offset:11760
v_fma_f32 v34, v34, v32, v33
v_fma_f32 v35, v35, v32, v33
v_fma_f32 v36, v36, v32, v33
v_fma_f32 v37, v37, v32, v33
s_add_u32 m0, s6, 5120
s_bfe_u32 s60, s58, 0x40004
s_mul_i32 s60, s60, 245760
s_add_u32 s60, s60, s41
BL v15,s[20:23],s60 offen lds
M3 a[32:47],v[204:207],a[228:231],a[32:47]
TR a[224:225],v4 offset:10240
TR a[226:227],v4 offset:11520
v_fma_f32 v38, v38, v32, v33
v_fma_f32 v39, v39, v32, v33
v_fma_f32 v88, v88, v32, v33
v_fma_f32 v89, v89, v32, v33
M3 a[48:63],v[204:207],a[232:235],a[48:63]
TR a[228:229],v2 offset:51200
TR a[230:231],v2 offset:52480
CV v208,v34,v35
CV v209,v36,v37
CV v210,v38,v39
CV v211,v88,v89
BL v16,s[20:23],s60 offen offset:1024 lds
M3 a[64:79],v[204:207],a[236:239],a[64:79]
TR a[232:233],v2 offset:51280
TR a[234:235],v2 offset:52560
v_lshlrev_b32 v34, 16, v212
v_and_b32 v35, s52, v212
v_lshlrev_b32 v36, 16, v213
v_and_b32 v37, s52, v213
s_waitcnt lgkmcnt(6)
M3 a[0:15],v[208:211],a[240:243],a[0:15]
TR a[236:237],v2 offset:51360
TR a[238:239],v2 offset:52640
v_lshlrev_b32 v38, 16, v214
v_and_b32 v39, s52, v214
v_lshlrev_b32 v88, 16, v215
v_and_b32 v89, s52, v215
BL v17,s[20:23],s60 offen offset:2048 lds
M3 a[16:31],v[208:211],a[244:247],a[16:31]
TR a[240:241],v2 offset:51440
TR a[242:243],v2 offset:52720
v_fma_f32 v34, v34, v32, v33
v_fma_f32 v35, v35, v32, v33
v_fma_f32 v36, v36, v32, v33
v_fma_f32 v37, v37, v32, v33
M3 a[32:47],v[208:211],a[248:251],a[32:47]
TR a[244:245],v4 offset:51200
TR a[246:247],v4 offset:52480
v_fma_f32 v38, v38, v32, v33
v_fma_f32 v39, v39, v32, v33
v_fma_f32 v88, v88, v32, v33
v_fma_f32 v89, v89, v32, v33
BL v18,s[20:23],s60 offen offset:3072 lds
M3 a[48:63],v[208:211],a[252:255],a[48:63]
TR a[248:249],v3 offset:10240
TR a[250:251],v3 offset:11520
CV v212,v34,v35
CV v213,v36,v37
CV v214,v38,v39
CV v215,v88,v89
s_waitcnt lgkmcnt(6)
M3 a[64:79],v[208:211],a[224:227],a[64:79]
TR a[252:253],v3 offset:10320
TR a[254:255],v3 offset:11600
v_lshlrev_b32 v34, 16, v216
v_and_b32 v35, s52, v216
v_lshlrev_b32 v36, 16, v217
v_and_b32 v37, s52, v217
s_add_u32 m0, s6, 9216
s_nop 0
BL v19,s[20:23],s60 offen lds
M3 a[0:15],v[212:215],a[228:231],a[0:15]
TR a[224:225],v3 offset:10400
TR a[226:227],v3 offset:11680
v_lshlrev_b32 v38, 16, v218
v_and_b32 v39, s52, v218
v_lshlrev_b32 v88, 16, v219
v_and_b32 v89, s52, v219
M3 a[16:31],v[212:215],a[232:235],a[16:31]
TR a[228:229],v3 offset:10480
TR a[230:231],v3 offset:11760
v_fma_f32 v34, v34, v32, v33
v_fma_f32 v35, v35, v32, v33
v_fma_f32 v36, v36, v32, v33
v_fma_f32 v37, v37, v32, v33
M3 a[32:47],v[212:215],a[236:239],a[32:47]
TR a[232:233],v5 offset:10240
TR a[234:235],v5 offset:11520
v_fma_f32 v38, v38, v32, v33
v_fma_f32 v39, v39, v32, v33
v_fma_f32 v88, v88, v32, v33
v_fma_f32 v89, v89, v32, v33
s_waitcnt lgkmcnt(6)
M3 a[48:63],v[212:215],a[240:243],a[48:63]
TR a[236:237],v3 offset:51200
TR a[238:239],v3 offset:52480
CV v216,v34,v35
CV v217,v36,v37
CV v218,v38,v39
CV v219,v88,v89
M3 a[64:79],v[212:215],a[244:247],a[64:79]
TR a[240:241],v3 offset:51280
TR a[242:243],v3 offset:52560
v_lshlrev_b32 v34, 16, v220
v_and_b32 v35, s52, v220
v_lshlrev_b32 v36, 16, v221
v_and_b32 v37, s52, v221
M3 a[0:15],v[216:219],a[248:251],a[0:15]
TR a[244:245],v3 offset:51360
TR a[246:247],v3 offset:52640
v_lshlrev_b32 v38, 16, v222
v_and_b32 v39, s52, v222
v_lshlrev_b32 v88, 16, v223
v_and_b32 v89, s52, v223
M3 a[16:31],v[216:219],a[252:255],a[16:31]
TR a[248:249],v3 offset:51440
TR a[250:251],v3 offset:52720
v_fma_f32 v34, v34, v32, v33
v_fma_f32 v35, v35, v32, v33
v_fma_f32 v36, v36, v32, v33
v_fma_f32 v37, v37, v32, v33
s_waitcnt lgkmcnt(6)
M3 a[32:47],v[216:219],a[224:227],a[32:47]
TR a[252:253],v5 offset:51200
TR a[254:255],v5 offset:52480
v_fma_f32 v38, v38, v32, v33
v_fma_f32 v39, v39, v32, v33
v_fma_f32 v88, v88, v32, v33
v_fma_f32 v89, v89, v32, v33
M3 a[48:63],v[216:219],a[228:231],a[48:63]
CV v220,v34,v35
CV v221,v36,v37
CV v222,v38,v39
CV v223,v88,v89
M3 a[64:79],v[216:219],a[232:235],a[64:79]
v_lshlrev_b32 v34, 16, v224
v_and_b32 v35, s52, v224
v_lshlrev_b32 v36, 16, v225
v_and_b32 v37, s52, v225
M3 a[0:15],v[220:223],a[236:239],a[0:15]
s_waitcnt vmcnt(15) lgkmcnt(0)
s_barrier
TR a[224:225],v2 offset:15360
TR a[226:227],v2 offset:16640
TR a[228:229],v2 offset:15440
TR a[230:231],v2 offset:16720
v_lshlrev_b32 v38, 16, v226
v_and_b32 v39, s52, v226
v_lshlrev_b32 v88, 16, v227
v_and_b32 v89, s52, v227
M3 a[16:31],v[220:223],a[240:243],a[16:31]
TR a[232:233],v2 offset:15520
TR a[234:235],v2 offset:16800
TR a[236:237],v2 offset:15600
TR a[238:239],v2 offset:16880
v_fma_f32 v34, v34, v32, v33
v_fma_f32 v35, v35, v32, v33
v_fma_f32 v36, v36, v32, v33
v_fma_f32 v37, v37, v32, v33
s_add_u32 m0, s6, 10240
s_bfe_u32 s60, s58, 0x40008
s_mul_i32 s60, s60, 245760
s_add_u32 s60, s60, s41
BL v15,s[20:23],s60 offen lds
M3 a[32:47],v[220:223],a[244:247],a[32:47]
TR a[240:241],v4 offset:15360
TR a[242:243],v4 offset:16640
v_fma_f32 v38, v38, v32, v33
v_fma_f32 v39, v39, v32, v33
v_fma_f32 v88, v88, v32, v33
v_fma_f32 v89, v89, v32, v33
M3 a[48:63],v[220:223],a[248:251],a[48:63]
TR a[244:245],v2 offset:56320
TR a[246:247],v2 offset:57600
CV v224,v34,v35
CV v225,v36,v37
CV v226,v38,v39
CV v227,v88,v89
BL v16,s[20:23],s60 offen offset:1024 lds
M3 a[64:79],v[220:223],a[252:255],a[64:79]
TR a[248:249],v2 offset:56400
TR a[250:251],v2 offset:57680
v_lshlrev_b32 v34, 16, v228
v_and_b32 v35, s52, v228
v_lshlrev_b32 v36, 16, v229
v_and_b32 v37, s52, v229
s_waitcnt lgkmcnt(6)
M3 a[0:15],v[224:227],a[224:227],a[0:15]
TR a[252:253],v2 offset:56480
TR a[254:255],v2 offset:57760
v_lshlrev_b32 v38, 16, v230
v_and_b32 v39, s52, v230
v_lshlrev_b32 v88, 16, v231
v_and_b32 v89, s52, v231
BL v17,s[20:23],s60 offen offset:2048 lds
M3 a[16:31],v[224:227],a[228:231],a[16:31]
TR a[224:225],v2 offset:56560
TR a[226:227],v2 offset:57840
v_fma_f32 v34, v34, v32, v33
v_fma_f32 v35, v35, v32, v33
v_fma_f32 v36, v36, v32, v33
v_fma_f32 v37, v37, v32, v33
M3 a[32:47],v[224:227],a[232:235],a[32:47]
TR a[228:229],v4 offset:56320
TR a[230:231],v4 offset:57600
v_fma_f32 v38, v38, v32, v33
v_fma_f32 v39, v39, v32, v33
v_fma_f32 v88, v88, v32, v33
v_fma_f32 v89, v89, v32, v33
BL v18,s[20:23],s60 offen offset:3072 lds
M3 a[48:63],v[224:227],a[236:239],a[48:63]
TR a[232:233],v3 offset:15360
TR a[234:235],v3 offset:16640
CV v228,v34,v35
CV v229,v36,v37
CV v230,v38,v39
CV v231,v88,v89
s_waitcnt lgkmcnt(6)
M3 a[64:79],v[224:227],a[240:243],a[64:79]
TR a[236:237],v3 offset:15440
TR a[238:239],v3 offset:16720
v_lshlrev_b32 v34, 16, v232
v_and_b32 v35, s52, v232
v_lshlrev_b32 v36, 16, v233
v_and_b32 v37, s52, v233
s_add_u32 m0, s6, 14336
s_nop 0
BL v19,s[20:23],s60 offen lds
M3 a[0:15],v[228:231],a[244:247],a[0:15]
TR a[240:241],v3 offset:15520
TR a[242:243],v3 offset:16800
v_lshlrev_b32 v38, 16, v234
v_and_b32 v39, s52, v234
v_lshlrev_b32 v88, 16, v235
v_and_b32 v89, s52, v235
M3 a[16:31],v[228:231],a[248:251],a[16:31]
TR a[244:245],v3 offset:15600
TR a[246:247],v3 offset:16880
v_fma_f32 v34, v34, v32, v33
v_fma_f32 v35, v35, v32, v33
v_fma_f32 v36, v36, v32, v33
v_fma_f32 v37, v37, v32, v33
M3 a[32:47],v[228:231],a[252:255],a[32:47]
TR a[248:249],v5 offset:15360
TR a[250:251],v5 offset:16640
v_fma_f32 v38, v38, v32, v33
v_fma_f32 v39, v39, v32, v33
v_fma_f32 v88, v88, v32, v33
v_fma_f32 v89, v89, v32, v33
s_waitcnt lgkmcnt(6)
M3 a[48:63],v[228:231],a[224:227],a[48:63]
TR a[252:253],v3 offset:56320
TR a[254:255],v3 offset:57600
CV v232,v34,v35
CV v233,v36,v37
CV v234,v38,v39
CV v235,v88,v89
M3 a[64:79],v[228:231],a[228:231],a[64:79]
TR a[224:225],v3 offset:56400
TR a[226:227],v3 offset:57680
v_lshlrev_b32 v34, 16, v236
v_and_b32 v35, s52, v236
v_lshlrev_b32 v36, 16, v237
v_and_b32 v37, s52, v237
M3 a[0:15],v[232:235],a[232:235],a[0:15]
TR a[228:229],v3 offset:56480
TR a[230:231],v3 offset:57760
v_lshlrev_b32 v38, 16, v238
v_and_b32 v39, s52, v238
v_lshlrev_b32 v88, 16, v239
v_and_b32 v89, s52, v239
M3 a[16:31],v[232:235],a[236:239],a[16:31]
TR a[232:233],v3 offset:56560
TR a[234:235],v3 offset:57840
v_fma_f32 v34, v34, v32, v33
v_fma_f32 v35, v35, v32, v33
v_fma_f32 v36, v36, v32, v33
v_fma_f32 v37, v37, v32, v33
s_waitcnt lgkmcnt(6)
M3 a[32:47],v[232:235],a[240:243],a[32:47]
TR a[236:237],v5 offset:56320
TR a[238:239],v5 offset:57600
v_fma_f32 v38, v38, v32, v33
v_fma_f32 v39, v39, v32, v33
v_fma_f32 v88, v88, v32, v33
v_fma_f32 v89, v89, v32, v33
M3 a[48:63],v[232:235],a[244:247],a[48:63]
CV v236,v34,v35
CV v237,v36,v37
CV v238,v38,v39
CV v239,v88,v89
M3 a[64:79],v[232:235],a[248:251],a[64:79]
v_lshlrev_b32 v34, 16, v240
v_and_b32 v35, s52, v240
v_lshlrev_b32 v36, 16, v241
v_and_b32 v37, s52, v241
M3 a[0:15],v[236:239],a[252:255],a[0:15]
s_waitcnt vmcnt(15) lgkmcnt(0)
s_barrier
TR a[240:241],v2 offset:20480
TR a[242:243],v2 offset:21760
TR a[244:245],v2 offset:20560
TR a[246:247],v2 offset:21840
v_lshlrev_b32 v38, 16, v242
v_and_b32 v39, s52, v242
v_lshlrev_b32 v88, 16, v243
v_and_b32 v89, s52, v243
M3 a[16:31],v[236:239],a[224:227],a[16:31]
TR a[248:249],v2 offset:20640
TR a[250:251],v2 offset:21920
TR a[252:253],v2 offset:20720
TR a[254:255],v2 offset:22000
v_fma_f32 v34, v34, v32, v33
v_fma_f32 v35, v35, v32, v33
v_fma_f32 v36, v36, v32, v33
v_fma_f32 v37, v37, v32, v33
s_add_u32 m0, s6, 15360
s_bfe_u32 s60, s58, 0x4000c
s_mul_i32 s60, s60, 245760
s_add_u32 s60, s60, s41
BL v15,s[20:23],s60 offen lds
M3 a[32:47],v[236:239],a[228:231],a[32:47]
TR a[224:225],v4 offset:20480
TR a[226:227],v4 offset:21760
v_fma_f32 v38, v38, v32, v33
v_fma_f32 v39, v39, v32, v33
v_fma_f32 v88, v88, v32, v33
v_fma_f32 v89, v89, v32, v33
M3 a[48:63],v[236:239],a[232:235],a[48:63]
TR a[228:229],v2 offset:61440
TR a[230:231],v2 offset:62720
CV v240,v34,v35
CV v241,v36,v37
CV v242,v38,v39
CV v243,v88,v89
BL v16,s[20:23],s60 offen offset:1024 lds
M3 a[64:79],v[236:239],a[236:239],a[64:79]
TR a[232:233],v2 offset:61520
TR a[234:235],v2 offset:62800
v_lshlrev_b32 v34, 16, v244
v_and_b32 v35, s52, v244
v_lshlrev_b32 v36, 16, v245
v_and_b32 v37, s52, v245
s_waitcnt lgkmcnt(6)
M3 a[0:15],v[240:243],a[240:243],a[0:15]
TR a[236:237],v2 offset:61600
TR a[238:239],v2 offset:62880
v_lshlrev_b32 v38, 16, v246
v_and_b32 v39, s52, v246
v_lshlrev_b32 v88, 16, v247
v_and_b32 v89, s52, v247
BL v17,s[20:23],s60 offen offset:2048 lds
M3 a[16:31],v[240:243],a[244:247],a[16:31]
TR a[240:241],v2 offset:61680
TR a[242:243],v2 offset:62960
v_fma_f32 v34, v34, v32, v33
v_fma_f32 v35, v35, v32, v33
v_fma_f32 v36, v36, v32, v33
v_fma_f32 v37, v37, v32, v33
M3 a[32:47],v[240:243],a[248:251],a[32:47]
TR a[244:245],v4 offset:61440
TR a[246:247],v4 offset:62720
v_fma_f32 v38, v38, v32, v33
v_fma_f32 v39, v39, v32, v33
v_fma_f32 v88, v88, v32, v33
v_fma_f32 v89, v89, v32, v33
BL v18,s[20:23],s60 offen offset:3072 lds
M3 a[48:63],v[240:243],a[252:255],a[48:63]
TR a[248:249],v3 offset:20480
TR a[250:251],v3 offset:21760
CV v244,v34,v35
CV v245,v36,v37
CV v246,v38,v39
CV v247,v88,v89
s_waitcnt lgkmcnt(6)
M3 a[64:79],v[240:243],a[224:227],a[64:79]
TR a[252:253],v3 offset:20560
TR a[254:255],v3 offset:21840
v_lshlrev_b32 v34, 16, v248
v_and_b32 v35, s52, v248
v_lshlrev_b32 v36, 16, v249
v_and_b32 v37, s52, v249
s_add_u32 m0, s6, 19456
s_nop 0
BL v19,s[20:23],s60 offen lds
M3 a[0:15],v[244:247],a[228:231],a[0:15]
TR a[224:225],v3 offset:20640
TR a[226:227],v3 offset:21920
v_lshlrev_b32 v38, 16, v250
v_and_b32 v39, s52, v250
v_lshlrev_b32 v88, 16, v251
v_and_b32 v89, s52, v251
M3 a[16:31],v[244:247],a[232:235],a[16:31]
TR a[228:229],v3 offset:20720
TR a[230:231],v3 offset:22000
v_fma_f32 v34, v34, v32, v33
v_fma_f32 v35, v35, v32, v33
v_fma_f32 v36, v36, v32, v33
v_fma_f32 v37, v37, v32, v33
M3 a[32:47],v[244:247],a[236:239],a[32:47]
TR a[232:233],v5 offset:20480
TR a[234:235],v5 offset:21760
v_fma_f32 v38, v38, v32, v33
v_fma_f32 v39, v39, v32, v33
v_fma_f32 v88, v88, v32, v33
v_fma_f32 v89, v89, v32, v33
s_waitcnt lgkmcnt(6)
M3 a[48:63],v[244:247],a[240:243],a[48:63]
TR a[236:237],v3 offset:61440
TR a[238:239],v3 offset:62720
CV v248,v34,v35
CV v249,v36,v37
CV v250,v38,v39
CV v251,v88,v89
M3 a[64:79],v[244:247],a[244:247],a[64:79]
TR a[240:241],v3 offset:61520
TR a[242:243],v3 offset:62800
v_lshlrev_b32 v34, 16, v252
v_and_b32 v35, s52, v252
v_lshlrev_b32 v36, 16, v253
v_and_b32 v37, s52, v253
M3 a[0:15],v[248:251],a[248:251],a[0:15]
TR a[244:245],v3 offset:61600
TR a[246:247],v3 offset:62880
v_lshlrev_b32 v38, 16, v254
v_and_b32 v39, s52, v254
v_lshlrev_b32 v88, 16, v255
v_and_b32 v89, s52, v255
M3 a[16:31],v[248:251],a[252:255],a[16:31]
TR a[248:249],v3 offset:61680
TR a[250:251],v3 offset:62960
v_fma_f32 v34, v34, v32, v33
v_fma_f32 v35, v35, v32, v33
v_fma_f32 v36, v36, v32, v33
v_fma_f32 v37, v37, v32, v33
s_waitcnt lgkmcnt(6)
M3 a[32:47],v[248:251],a[224:227],a[32:47]
TR a[252:253],v5 offset:61440
TR a[254:255],v5 offset:62720
v_fma_f32 v38, v38, v32, v33
v_fma_f32 v39, v39, v32, v33
v_fma_f32 v88, v88, v32, v33
v_fma_f32 v89, v89, v32, v33
M3 a[48:63],v[248:251],a[228:231],a[48:63]
CV v252,v34,v35
CV v253,v36,v37
CV v254,v38,v39
CV v255,v88,v89
M3 a[64:79],v[248:251],a[232:235],a[64:79]
s_nop 0
M3 a[0:15],v[252:255],a[236:239],a[0:15]
s_waitcnt vmcnt(15) lgkmcnt(0)
s_barrier
TR a[224:225],v6
TR a[226:227],v6 offset:1280
TR a[228:229],v6 offset:40
TR a[230:231],v6 offset:1320
M3 a[16:31],v[252:255],a[240:243],a[16:31]
TR a[232:233],v6 offset:80
TR a[234:235],v6 offset:1360
TR a[236:237],v6 offset:120
TR a[238:239],v6 offset:1400
s_add_u32 m0, s6, 20480
s_bfe_u32 s60, s58, 0x40010
s_mul_i32 s60, s60, 245760
s_add_u32 s60, s60, s41
BL v15,s[20:23],s60 offen lds
M3 a[32:47],v[252:255],a[244:247],a[32:47]
TR a[240:241],v4
TR a[242:243],v4 offset:1280
M3 a[48:63],v[252:255],a[248:251],a[48:63]
TR a[244:245],v6 offset:40960
TR a[246:247],v6 offset:42240
BL v16,s[20:23],s60 offen offset:1024 lds
M3 a[64:79],v[252:255],a[252:255],a[64:79]
TR a[248:249],v6 offset:41000
TR a[250:251],v6 offset:42280
v_lshlrev_b32 v34, 4, v1
v_add_u32 v34, s6, v34
AR v88,a0
AR v89,a1
AR v90,a2
AR v91,a3
v_pk_mul_f32 v[92:93], v[88:89], s[50:51] op_sel:[0,1] op_sel_hi:[1,1]
v_pk_mul_f32 v[94:95], v[90:91], s[50:51] op_sel:[0,1] op_sel_hi:[1,1]
v_exp_f32_e64 v92, v92 clamp
v_max_f32 v88, s53, v88
v_exp_f32_e64 v93, v93 clamp
v_max_f32 v89, s53, v89
v_exp_f32_e64 v94, v94 clamp
v_max_f32 v90, s53, v90
v_exp_f32_e64 v95, v95 clamp
v_max_f32 v91, s53, v91
v_pk_add_f32 v[88:89], v[88:89], v[92:93]
v_pk_add_f32 v[90:91], v[90:91], v[94:95]
CV v40,v88,v89
CV v41,v90,v91
AR v88,a4
AR v89,a5
AR v90,a6
AR v91,a7
v_pk_mul_f32 v[92:93], v[88:89], s[50:51] op_sel:[0,1] op_sel_hi:[1,1]
v_pk_mul_f32 v[94:95], v[90:91], s[50:51] op_sel:[0,1] op_sel_hi:[1,1]
v_exp_f32_e64 v92, v92 clamp
v_max_f32 v88, s53, v88
v_exp_f32_e64 v93, v93 clamp
v_max_f32 v89, s53, v89
v_exp_f32_e64 v94, v94 clamp
v_max_f32 v90, s53, v90
v_exp_f32_e64 v95, v95 clamp
v_max_f32 v91, s53, v91
v_pk_add_f32 v[88:89], v[88:89], v[92:93]
v_pk_add_f32 v[90:91], v[90:91], v[94:95]
CV v42,v88,v89
CV v43,v90,v91
AR v88,a8
AR v89,a9
AR v90,a10
AR v91,a11
v_pk_mul_f32 v[92:93], v[88:89], s[50:51] op_sel:[0,1] op_sel_hi:[1,1]
v_pk_mul_f32 v[94:95], v[90:91], s[50:51] op_sel:[0,1] op_sel_hi:[1,1]
v_exp_f32_e64 v92, v92 clamp
v_max_f32 v88, s53, v88
v_exp_f32_e64 v93, v93 clamp
v_max_f32 v89, s53, v89
v_exp_f32_e64 v94, v94 clamp
v_max_f32 v90, s53, v90
v_exp_f32_e64 v95, v95 clamp
v_max_f32 v91, s53, v91
v_pk_add_f32 v[88:89], v[88:89], v[92:93]
v_pk_add_f32 v[90:91], v[90:91], v[94:95]
CV v44,v88,v89
CV v45,v90,v91
AR v88,a12
AR v89,a13
AR v90,a14
AR v91,a15
v_pk_mul_f32 v[92:93], v[88:89], s[50:51] op_sel:[0,1] op_sel_hi:[1,1]
v_pk_mul_f32 v[94:95], v[90:91], s[50:51] op_sel:[0,1] op_sel_hi:[1,1]
v_exp_f32_e64 v92, v92 clamp
v_max_f32 v88, s53, v88
v_exp_f32_e64 v93, v93 clamp
v_max_f32 v89, s53, v89
v_exp_f32_e64 v94, v94 clamp
v_max_f32 v90, s53, v90
v_exp_f32_e64 v95, v95 clamp
v_max_f32 v91, s53, v91
v_pk_add_f32 v[88:89], v[88:89], v[92:93]
v_pk_add_f32 v[90:91], v[90:91], v[94:95]
CV v46,v88,v89
CV v47,v90,v91
ds_write_b128 v34, v[40:43] offset:25600
ds_write_b128 v34, v[44:47] offset:31744
AR v88,a16
AR v89,a17
AR v90,a18
AR v91,a19
v_pk_mul_f32 v[92:93], v[88:89], s[50:51] op_sel:[0,1] op_sel_hi:[1,1]
v_pk_mul_f32 v[94:95], v[90:91], s[50:51] op_sel:[0,1] op_sel_hi:[1,1]
v_exp_f32_e64 v92, v92 clamp
v_max_f32 v88, s53, v88
v_exp_f32_e64 v93, v93 clamp
v_max_f32 v89, s53, v89
v_exp_f32_e64 v94, v94 clamp
v_max_f32 v90, s53, v90
v_exp_f32_e64 v95, v95 clamp
v_max_f32 v91, s53, v91
v_pk_add_f32 v[88:89], v[88:89], v[92:93]
v_pk_add_f32 v[90:91], v[90:91], v[94:95]
CV v48,v88,v89
CV v49,v90,v91
AR v88,a20
AR v89,a21
AR v90,a22
AR v91,a23
v_pk_mul_f32 v[92:93], v[88:89], s[50:51] op_sel:[0,1] op_sel_hi:[1,1]
v_pk_mul_f32 v[94:95], v[90:91], s[50:51] op_sel:[0,1] op_sel_hi:[1,1]
v_exp_f32_e64 v92, v92 clamp
v_max_f32 v88, s53, v88
v_exp_f32_e64 v93, v93 clamp
v_max_f32 v89, s53, v89
v_exp_f32_e64 v94, v94 clamp
v_max_f32 v90, s53, v90
v_exp_f32_e64 v95, v95 clamp
v_max_f32 v91, s53, v91
v_pk_add_f32 v[88:89], v[88:89], v[92:93]
v_pk_add_f32 v[90:91], v[90:91], v[94:95]
CV v50,v88,v89
CV v51,v90,v91
AR v88,a24
AR v89,a25
AR v90,a26
AR v91,a27
v_pk_mul_f32 v[92:93], v[88:89], s[50:51] op_sel:[0,1] op_sel_hi:[1,1]
v_pk_mul_f32 v[94:95], v[90:91], s[50:51] op_sel:[0,1] op_sel_hi:[1,1]
v_exp_f32_e64 v92, v92 clamp
v_max_f32 v88, s53, v88
v_exp_f32_e64 v93, v93 clamp
v_max_f32 v89, s53, v89
v_exp_f32_e64 v94, v94 clamp
v_max_f32 v90, s53, v90
v_exp_f32_e64 v95, v95 clamp
v_max_f32 v91, s53, v91
v_pk_add_f32 v[88:89], v[88:89], v[92:93]
v_pk_add_f32 v[90:91], v[90:91], v[94:95]
CV v52,v88,v89
CV v53,v90,v91
AR v88,a28
AR v89,a29
AR v90,a30
AR v91,a31
v_pk_mul_f32 v[92:93], v[88:89], s[50:51] op_sel:[0,1] op_sel_hi:[1,1]
v_pk_mul_f32 v[94:95], v[90:91], s[50:51] op_sel:[0,1] op_sel_hi:[1,1]
v_exp_f32_e64 v92, v92 clamp
v_max_f32 v88, s53, v88
v_exp_f32_e64 v93, v93 clamp
v_max_f32 v89, s53, v89
v_exp_f32_e64 v94, v94 clamp
v_max_f32 v90, s53, v90
v_exp_f32_e64 v95, v95 clamp
v_max_f32 v91, s53, v91
v_pk_add_f32 v[88:89], v[88:89], v[92:93]
v_pk_add_f32 v[90:91], v[90:91], v[94:95]
CV v54,v88,v89
CV v55,v90,v91
ds_write_b128 v34, v[48:51] offset:26624
ds_write_b128 v34, v[52:55] offset:32768
AR v88,a32
AR v89,a33
AR v90,a34
AR v91,a35
CV v56,v88,v89
CV v57,v90,v91
AR v88,a36
AR v89,a37
AR v90,a38
AR v91,a39
CV v58,v88,v89
CV v59,v90,v91
AR v88,a40
AR v89,a41
AR v90,a42
AR v91,a43
CV v60,v88,v89
CV v61,v90,v91
AR v88,a44
AR v89,a45
AR v90,a46
AR v91,a47
CV v62,v88,v89
CV v63,v90,v91
ds_write_b128 v34, v[56:59] offset:27648
ds_write_b128 v34, v[60:63] offset:33792
AR v88,a48
AR v89,a49
AR v90,a50
AR v91,a51
CV v64,v88,v89
CV v65,v90,v91
AR v88,a52
AR v89,a53
AR v90,a54
AR v91,a55
CV v66,v88,v89
CV v67,v90,v91
AR v88,a56
AR v89,a57
AR v90,a58
AR v91,a59
CV v68,v88,v89
CV v69,v90,v91
AR v88,a60
AR v89,a61
AR v90,a62
AR v91,a63
CV v70,v88,v89
CV v71,v90,v91
ds_write_b128 v34, v[64:67] offset:28672
ds_write_b128 v34, v[68:71] offset:34816
AR v88,a64
AR v89,a65
AR v90,a66
AR v91,a67
CV v80,v88,v89
CV v81,v90,v91
v_pk_mul_f32 v[92:93], v[88:89], s[50:51] op_sel:[0,1] op_sel_hi:[1,1]
v_pk_mul_f32 v[94:95], v[90:91], s[50:51] op_sel:[0,1] op_sel_hi:[1,1]
v_exp_f32_e64 v92, v92 clamp
v_max_f32 v88, s53, v88
v_exp_f32_e64 v93, v93 clamp
v_max_f32 v89, s53, v89
v_exp_f32_e64 v94, v94 clamp
v_max_f32 v90, s53, v90
v_exp_f32_e64 v95, v95 clamp
v_max_f32 v91, s53, v91
v_pk_add_f32 v[88:89], v[88:89], v[92:93]
v_pk_add_f32 v[90:91], v[90:91], v[94:95]
CV v72,v88,v89
CV v73,v90,v91
AR v88,a68
AR v89,a69
AR v90,a70
AR v91,a71
CV v82,v88,v89
CV v83,v90,v91
v_pk_mul_f32 v[92:93], v[88:89], s[50:51] op_sel:[0,1] op_sel_hi:[1,1]
v_pk_mul_f32 v[94:95], v[90:91], s[50:51] op_sel:[0,1] op_sel_hi:[1,1]
v_exp_f32_e64 v92, v92 clamp
v_max_f32 v88, s53, v88
v_exp_f32_e64 v93, v93 clamp
v_max_f32 v89, s53, v89
v_exp_f32_e64 v94, v94 clamp
v_max_f32 v90, s53, v90
v_exp_f32_e64 v95, v95 clamp
v_max_f32 v91, s53, v91
v_pk_add_f32 v[88:89], v[88:89], v[92:93]
v_pk_add_f32 v[90:91], v[90:91], v[94:95]
CV v74,v88,v89
CV v75,v90,v91
AR v88,a72
AR v89,a73
AR v90,a74
AR v91,a75
CV v84,v88,v89
CV v85,v90,v91
v_pk_mul_f32 v[92:93], v[88:89], s[50:51] op_sel:[0,1] op_sel_hi:[1,1]
v_pk_mul_f32 v[94:95], v[90:91], s[50:51] op_sel:[0,1] op_sel_hi:[1,1]
v_exp_f32_e64 v92, v92 clamp
v_max_f32 v88, s53, v88
v_exp_f32_e64 v93, v93 clamp
v_max_f32 v89, s53, v89
v_exp_f32_e64 v94, v94 clamp
v_max_f32 v90, s53, v90
v_exp_f32_e64 v95, v95 clamp
v_max_f32 v91, s53, v91
v_pk_add_f32 v[88:89], v[88:89], v[92:93]
v_pk_add_f32 v[90:91], v[90:91], v[94:95]
CV v76,v88,v89
CV v77,v90,v91
AR v88,a76
AR v89,a77
AR v90,a78
AR v91,a79
CV v86,v88,v89
CV v87,v90,v91
v_pk_mul_f32 v[92:93], v[88:89], s[50:51] op_sel:[0,1] op_sel_hi:[1,1]
v_pk_mul_f32 v[94:95], v[90:91], s[50:51] op_sel:[0,1] op_sel_hi:[1,1]
v_exp_f32_e64 v92, v92 clamp
v_max_f32 v88, s53, v88
v_exp_f32_e64 v93, v93 clamp
v_max_f32 v89, s53, v89
v_exp_f32_e64 v94, v94 clamp
v_max_f32 v90, s53, v90
v_exp_f32_e64 v95, v95 clamp
v_max_f32 v91, s53, v91
v_pk_add_f32 v[88:89], v[88:89], v[92:93]
v_pk_add_f32 v[90:91], v[90:91], v[94:95]
CV v78,v88,v89
CV v79,v90,v91
ds_write_b128 v34, v[72:75] offset:29696
ds_write_b128 v34, v[76:79] offset:35840
v_mov_b32 v88, 0x3f803f80
v_cndmask_b32 v80, v80, v88, s[54:55]
v_cndmask_b32 v81, v81, v88, s[54:55]
v_cndmask_b32 v82, v82, v88, s[54:55]
v_cndmask_b32 v83, v83, v88, s[54:55]
v_cndmask_b32 v84, v84, v88, s[54:55]
v_cndmask_b32 v85, v85, v88, s[54:55]
v_cndmask_b32 v86, v86, v88, s[54:55]
v_cndmask_b32 v87, v87, v88, s[54:55]
ds_write_b128 v34, v[80:83] offset:30720
ds_write_b128 v34, v[84:87] offset:36864
s_waitcnt lgkmcnt(0)
s_barrier
ds_read_b128 a[0:3], v8
ds_read_b128 a[4:7], v22
ds_read_b128 a[8:11], v8 offset:6144
ds_read_b128 a[12:15], v22 offset:6144
ds_read_b128 a[16:19], v8 offset:40960
ds_read_b128 a[20:23], v22 offset:40960
M3 a[80:95],a[224:227],v[96:99],0
TR a[252:253],v6 offset:41040
TR a[254:255],v6 offset:42320
BL v17,s[20:23],s60 offen offset:2048 lds
s_mov_b32 s57, 15532032
v_lshlrev_b32 v27, 4, v1
v_lshlrev_b32 v37, 2, v1
v_add_u32 v25, 4096, v27
BL v[30:33],v27,s[24:27],s57 offen sc1
buffer_load_dword v36, v37, s[24:27], s57 offen offset:1024 sc1
ds_read_b128 a[24:27], v8 offset:47104
ds_read_b128 a[28:31], v22 offset:47104
M3 a[96:111],a[228:231],v[96:99],0
TR a[224:225],v6 offset:41080
TR a[226:227],v6 offset:42360
ds_read_b128 a[32:35], v9
ds_read_b128 a[36:39], v23
ds_read_b128 a[40:43], v9 offset:6144
ds_read_b128 a[44:47], v23 offset:6144
M3 a[112:127],a[232:235],v[96:99],0
TR a[228:229],v4 offset:40960
TR a[230:231],v4 offset:42240
BL v18,s[20:23],s60 offen offset:3072 lds
ds_read_b128 a[48:51], v9 offset:40960
ds_read_b128 a[52:55], v23 offset:40960
M3 a[128:143],a[236:239],v[96:99],0
TR a[232:233],v7
TR a[234:235],v7 offset:1280
ds_read_b128 a[56:59], v9 offset:47104
ds_read_b128 a[60:63], v23 offset:47104
s_waitcnt lgkmcnt(15)
M3 a[208:223],a[0:3],a[4:7],0
M3 a[144:159],a[240:243],v[96:99],0
TR a[236:237],v7 offset:40
TR a[238:239],v7 offset:1320
s_add_u32 m0, s6, 24576
s_nop 0
BL v19,s[20:23],s60 offen lds
M3 a[80:95],a[244:247],v[100:103],a[80:95]
TR a[240:241],v7 offset:80
TR a[242:243],v7 offset:1360
M3 a[96:111],a[248:251],v[100:103],a[96:111]
TR a[244:245],v7 offset:120
TR a[246:247],v7 offset:1400
M3 a[208:223],a[8:11],a[12:15],a[208:223]
M3 a[112:127],a[252:255],v[100:103],a[112:127]
TR a[248:249],v5
TR a[250:251],v5 offset:1280
s_waitcnt lgkmcnt(6)
M3 a[128:143],a[224:227],v[100:103],a[128:143]
TR a[252:253],v7 offset:40960
TR a[254:255],v7 offset:42240
M3 a[208:223],a[16:19],a[20:23],a[208:223]
M3 a[144:159],a[228:231],v[100:103],a[144:159]
TR a[224:225],v7 offset:41000
TR a[226:227],v7 offset:42280
M3 a[80:95],a[232:235],v[104:107],a[80:95]
TR a[228:229],v7 offset:41040
TR a[230:231],v7 offset:42320
M3 a[208:223],a[24:27],a[28:31],a[208:223]
M3 a[96:111],a[236:239],v[104:107],a[96:111]
TR a[232:233],v7 offset:41080
TR a[234:235],v7 offset:42360
s_waitcnt lgkmcnt(6)
M3 a[112:127],a[240:243],v[104:107],a[112:127]
TR a[236:237],v5 offset:40960
TR a[238:239],v5 offset:42240
M3 a[208:223],a[32:35],a[36:39],a[208:223]
M3 a[128:143],a[244:247],v[104:107],a[128:143]
M3 a[208:223],a[40:43],a[44:47],a[208:223]
M3 a[144:159],a[248:251],v[104:107],a[144:159]
M3 a[80:95],a[252:255],v[108:111],a[80:95]
s_waitcnt vmcnt(17) lgkmcnt(0)
s_barrier
TR a[240:241],v6 offset:5120
TR a[242:243],v6 offset:6400
TR a[244:245],v6 offset:5160
TR a[246:247],v6 offset:6440
M3 a[96:111],a[224:227],v[108:111],a[96:111]
TR a[248:249],v6 offset:5200
TR a[250:251],v6 offset:6480
TR a[252:253],v6 offset:5240
TR a[254:255],v6 offset:6520
s_add_u32 m0, s6, 0
s_bfe_u32 s60, s58, 0x40014
s_mul_i32 s60, s60, 245760
s_add_u32 s60, s60, s41
BL v15,s[20:23],s60 offen lds
M3 a[112:127],a[228:231],v[108:111],a[112:127]
TR a[224:225],v4 offset:5120
TR a[226:227],v4 offset:6400
M3 a[128:143],a[232:235],v[108:111],a[128:143]
TR a[228:229],v6 offset:46080
TR a[230:231],v6 offset:47360
BL v16,s[20:23],s60 offen offset:1024 lds
M3 a[208:223],a[48:51],a[52:55],a[208:223]
M3 a[144:159],a[236:239],v[108:111],a[144:159]
TR a[232:233],v6 offset:46120
TR a[234:235],v6 offset:47400
s_waitcnt lgkmcnt(6)
M3 a[80:95],a[240:243],v[112:115],a[80:95]
TR a[236:237],v6 offset:46160
TR a[238:239],v6 offset:47440
BL v17,s[20:23],s60 offen offset:2048 lds
s_waitcnt vmcnt(5)
K1_KVQ_W_chk:
v_cmp_ne_u32 vcc, v30, v26
v_cmp_ne_u32 s[84:85], v31, v26
s_nop 0
s_or_b64 vcc, vcc, s[84:85]
v_cmp_ne_u32 s[84:85], v32, v26
s_nop 0
s_or_b64 vcc, vcc, s[84:85]
v_cmp_ne_u32 s[84:85], v33, v26
s_nop 0
s_or_b64 vcc, vcc, s[84:85]
v_cmp_ne_u32 s[84:85], v36, v26
s_nop 0
s_or_b64 vcc, vcc, s[84:85]
s_cmp_eq_u64 vcc, 0
s_cbranch_scc1 K1_KVQ_W_ok
s_cmp_eq_u32 s101, 0
s_cbranch_scc1 K1_KVQ_W_ok
s_sub_u32 s101, s101, 1
s_sleep 10
BL v[30:33],v27,s[24:27],s57 offen sc1
buffer_load_dword v36, v37, s[24:27], s57 offen offset:1024 sc1
s_waitcnt vmcnt(0)
s_branch K1_KVQ_W_chk
K1_KVQ_W_ok:
M3 a[96:111],a[244:247],v[112:115],a[96:111]
TR a[240:241],v6 offset:46200
TR a[242:243],v6 offset:47480
M3 a[112:127],a[248:251],v[112:115],a[112:127]
TR a[244:245],v4 offset:46080
TR a[246:247],v4 offset:47360
BL v18,s[20:23],s60 offen offset:3072 lds
M3 a[128:143],a[252:255],v[112:115],a[128:143]
TR a[248:249],v7 offset:5120
TR a[250:251],v7 offset:6400
M3 a[208:223],a[56:59],a[60:63],a[208:223]
s_waitcnt lgkmcnt(6)
M3 a[144:159],a[224:227],v[112:115],a[144:159]
TR a[252:253],v7 offset:5160
TR a[254:255],v7 offset:6440
s_add_u32 m0, s6, 4096
s_nop 0
BL v19,s[20:23],s60 offen lds
M3 a[80:95],a[228:231],v[116:119],a[80:95]
TR a[224:225],v7 offset:5200
TR a[226:227],v7 offset:6480
v_mov_b32 v43, v26
M3 a[96:111],a[232:235],v[116:119],a[96:111]
TR a[228:229],v7 offset:5240
TR a[230:231],v7 offset:6520
s_bfe_u32 s65, s87, 0x80000
s_mul_i32 s65, s65, 40960
BL a[160:163],v27,s[32:35],s65 offen sc1
M3 a[112:127],a[236:239],v[116:119],a[112:127]
TR a[232:233],v5 offset:5120
TR a[234:235],v5 offset:6400
v_mov_b32 v47, v26
v_mov_b32 v51, v26
v_mov_b32 v55, v26
v_and_b32 v92, 7, v1
s_waitcnt lgkmcnt(6)
M3 a[128:143],a[240:243],v[116:119],a[128:143]
TR a[236:237],v7 offset:46080
TR a[238:239],v7 offset:47360
BL a[164:167],v27,s[32:35],s65 offen offset:1024 sc1
v_lshrrev_b32 v91, 3, v1
v_mul_u32_u24 v93, 2560, v91
M3 a[144:159],a[244:247],v[116:119],a[144:159]
TR a[240:241],v7 offset:46120
TR a[242:243],v7 offset:47400
v_lshl_add_u32 v88, v92, 4, v93
v_add_u32 v89, 20480, v88
v_mul_u32_u24 v93, 48, v92
v_lshl_add_u32 v93, v91, 4, v93
M3 a[80:95],a[248:251],v[120:123],a[80:95]
TR a[244:245],v7 offset:46160
TR a[246:247],v7 offset:47440
BL a[168:171],v27,s[32:35],s65 offen offset:2048 sc1
v_mov_b32 v92, 1073741824
M3 a[96:111],a[252:255],v[120:123],a[96:111]
TR a[248:249],v7 offset:46200
TR a[250:251],v7 offset:47480
v_cmp_gt_u32 vcc, 3, v91
s_nop 1
v_cndmask_b32 v90, v92, v93, vcc
AR v40,a208
AR v41,a209
s_waitcnt lgkmcnt(6)
M3 a[112:127],a[224:227],v[120:123],a[112:127]
TR a[252:253],v5 offset:46080
TR a[254:255],v5 offset:47360
BL a[172:175],v27,s[32:35],s65 offen offset:3072 sc1
AR v42,a210
AR v52,a211
M3 a[128:143],a[228:231],v[120:123],a[128:143]
AR v44,a212
AR v45,a213
AR v46,a214
AR v53,a215
AR v48,a216
AR v49,a217
M3 a[144:159],a[232:235],v[120:123],a[144:159]
BL a[176:179],v25,s[32:35],s65 offen sc1
AR v50,a218
AR v54,a219
buffer_store_dwordx4 v[40:43], v24, s[24:27], s62 offen sc1
M3 a[80:95],a[236:239],v[124:127],a[80:95]
s_waitcnt lgkmcnt(0)
s_barrier
TR a[224:225],v6 offset:10240
TR a[226:227],v6 offset:11520
TR a[228:229],v6 offset:10280
TR a[230:231],v6 offset:11560
M3 a[96:111],a[240:243],v[124:127],a[96:111]
TR a[232:233],v6 offset:10320
TR a[234:235],v6 offset:11600
TR a[236:237],v6 offset:10360
TR a[238:239],v6 offset:11640
s_add_u32 m0, s6, 5120
s_bfe_u32 s60, s58, 0x40018
s_mul_i32 s60, s60, 245760
s_add_u32 s60, s60, s41
BL v15,s[20:23],s60 offen lds
M3 a[112:127],a[244:247],v[124:127],a[112:127]
TR a[240:241],v4 offset:10240
TR a[242:243],v4 offset:11520
M3 a[128:143],a[248:251],v[124:127],a[128:143]
TR a[244:245],v6 offset:51200
TR a[246:247],v6 offset:52480
BL v16,s[20:23],s60 offen offset:1024 lds
buffer_store_dwordx4 v[44:47], v24, s[24:27], s62 offen offset:640 sc1
M3 a[144:159],a[252:255],v[124:127],a[144:159]
TR a[248:249],v6 offset:51240
TR a[250:251],v6 offset:52520
buffer_store_dwordx4 v[48:51], v24, s[24:27], s62 offen offset:1280 sc1
buffer_store_dwordx4 v[52:55], v24, s[24:27], s62 offen offset:1920 sc1
s_waitcnt lgkmcnt(6)
M3 a[80:95],a[224:227],v[128:131],a[80:95]
TR a[252:253],v6 offset:51280
TR a[254:255],v6 offset:52560
BL v17,s[20:23],s60 offen offset:2048 lds
M3 a[96:111],a[228:231],v[128:131],a[96:111]
TR a[224:225],v6 offset:51320
TR a[226:227],v6 offset:52600
M3 a[112:127],a[232:235],v[128:131],a[112:127]
TR a[228:229],v4 offset:51200
TR a[230:231],v4 offset:52480
BL v18,s[20:23],s60 offen offset:3072 lds
M3 a[128:143],a[236:239],v[128:131],a[128:143]
TR a[232:233],v7 offset:10240
TR a[234:235],v7 offset:11520
s_waitcnt lgkmcnt(6)
M3 a[144:159],a[240:243],v[128:131],a[144:159]
TR a[236:237],v7 offset:10280
TR a[238:239],v7 offset:11560
s_add_u32 m0, s6, 9216
s_nop 0
BL v19,s[20:23],s60 offen lds
M3 a[80:95],a[244:247],v[132:135],a[80:95]
TR a[240:241],v7 offset:10320
TR a[242:243],v7 offset:11600
M3 a[96:111],a[248:251],v[132:135],a[96:111]
TR a[244:245],v7 offset:10360
TR a[246:247],v7 offset:11640
s_bfe_u32 s65, s87, 0x80008
s_mul_i32 s65, s65, 40960
BL a[180:183],v27,s[32:35],s65 offen sc1
M3 a[112:127],a[252:255],v[132:135],a[112:127]
TR a[248:249],v5 offset:10240
TR a[250:251],v5 offset:11520
s_waitcnt lgkmcnt(6)
M3 a[128:143],a[224:227],v[132:135],a[128:143]
TR a[252:253],v7 offset:51200
TR a[254:255],v7 offset:52480
BL a[184:187],v27,s[32:35],s65 offen offset:1024 sc1
M3 a[144:159],a[228:231],v[132:135],a[144:159]
TR a[224:225],v7 offset:51240
TR a[226:227],v7 offset:52520
M3 a[80:95],a[232:235],v[136:139],a[80:95]
TR a[228:229],v7 offset:51280
TR a[230:231],v7 offset:52560
BL a[188:191],v27,s[32:35],s65 offen offset:2048 sc1
M3 a[96:111],a[236:239],v[136:139],a[96:111]
TR a[232:233],v7 offset:51320
TR a[234:235],v7 offset:52600
s_waitcnt lgkmcnt(6)
M3 a[112:127],a[240:243],v[136:139],a[112:127]
TR a[236:237],v5 offset:51200
TR a[238:239],v5 offset:52480
BL a[192:195],v27,s[32:35],s65 offen offset:3072 sc1
M3 a[128:143],a[244:247],v[136:139],a[128:143]
M3 a[144:159],a[248:251],v[136:139],a[144:159]
BL a[196:199],v25,s[32:35],s65 offen sc1
M3 a[80:95],a[252:255],v[140:143],a[80:95]
s_waitcnt lgkmcnt(0)
s_barrier
TR a[240:241],v6 offset:15360
TR a[242:243],v6 offset:16640
TR a[244:245],v6 offset:15400
TR a[246:247],v6 offset:16680
M3 a[96:111],a[224:227],v[140:143],a[96:111]
TR a[248:249],v6 offset:15440
TR a[250:251],v6 offset:16720
TR a[252:253],v6 offset:15480
TR a[254:255],v6 offset:16760
s_add_u32 m0, s6, 10240
s_bfe_u32 s60, s58, 0x4001c
s_mul_i32 s60, s60, 245760
s_add_u32 s60, s60, s41
BL v15,s[20:23],s60 offen lds
M3 a[112:127],a[228:231],v[140:143],a[112:127]
TR a[224:225],v4 offset:15360
TR a[226:227],v4 offset:16640
M3 a[128:143],a[232:235],v[140:143],a[128:143]
TR a[228:229],v6 offset:56320
TR a[230:231],v6 offset:57600
BL v16,s[20:23],s60 offen offset:1024 lds
M3 a[144:159],a[236:239],v[140:143],a[144:159]
TR a[232:233],v6 offset:56360
TR a[234:235],v6 offset:57640
s_waitcnt lgkmcnt(6)
M3 a[80:95],a[240:243],v[144:147],a[80:95]
TR a[236:237],v6 offset:56400
TR a[238:239],v6 offset:57680
BL v17,s[20:23],s60 offen offset:2048 lds
M3 a[96:111],a[244:247],v[144:147],a[96:111]
TR a[240:241],v6 offset:56440
TR a[242:243],v6 offset:57720
M3 a[112:127],a[248:251],v[144:147],a[112:127]
TR a[244:245],v4 offset:56320
TR a[246:247],v4 offset:57600
BL v18,s[20:23],s60 offen offset:3072 lds
M3 a[128:143],a[252:255],v[144:147],a[128:143]
TR a[248:249],v7 offset:15360
TR a[250:251],v7 offset:16640
s_waitcnt lgkmcnt(6)
M3 a[144:159],a[224:227],v[144:147],a[144:159]
TR a[252:253],v7 offset:15400
TR a[254:255],v7 offset:16680
s_add_u32 m0, s6, 14336
s_nop 0
BL v19,s[20:23],s60 offen lds
M3 a[80:95],a[228:231],v[148:151],a[80:95]
TR a[224:225],v7 offset:15440
TR a[226:227],v7 offset:16720
M3 a[96:111],a[232:235],v[148:151],a[96:111]
TR a[228:229],v7 offset:15480
TR a[230:231],v7 offset:16760
s_bfe_u32 s65, s87, 0x80010
s_mul_i32 s65, s65, 40960
BL a[200:203],v27,s[32:35],s65 offen sc1
M3 a[112:127],a[236:239],v[148:151],a[112:127]
TR a[232:233],v5 offset:15360
TR a[234:235],v5 offset:16640
s_waitcnt lgkmcnt(6)
M3 a[128:143],a[240:243],v[148:151],a[128:143]
TR a[236:237],v7 offset:56320
TR a[238:239],v7 offset:57600
BL a[204:207],v27,s[32:35],s65 offen offset:1024 sc1
M3 a[144:159],a[244:247],v[148:151],a[144:159]
TR a[240:241],v7 offset:56360
TR a[242:243],v7 offset:57640
M3 a[80:95],a[248:251],v[152:155],a[80:95]
TR a[244:245],v7 offset:56400
TR a[246:247],v7 offset:57680
BL a[208:211],v27,s[32:35],s65 offen offset:2048 sc1
M3 a[96:111],a[252:255],v[152:155],a[96:111]
TR a[248:249],v7 offset:56440
TR a[250:251],v7 offset:57720
s_waitcnt lgkmcnt(6)
M3 a[112:127],a[224:227],v[152:155],a[112:127]
TR a[252:253],v5 offset:56320
TR a[254:255],v5 offset:57600
BL a[212:215],v27,s[32:35],s65 offen offset:3072 sc1
M3 a[128:143],a[228:231],v[152:155],a[128:143]
M3 a[144:159],a[232:235],v[152:155],a[144:159]
BL a[216:219],v25,s[32:35],s65 offen sc1
M3 a[80:95],a[236:239],v[156:159],a[80:95]
s_waitcnt vmcnt(34) lgkmcnt(0)
s_barrier
TR a[224:225],v6 offset:20480
TR a[226:227],v6 offset:21760
TR a[228:229],v6 offset:20520
TR a[230:231],v6 offset:21800
M3 a[96:111],a[240:243],v[156:159],a[96:111]
TR a[232:233],v6 offset:20560
TR a[234:235],v6 offset:21840
TR a[236:237],v6 offset:20600
TR a[238:239],v6 offset:21880
s_add_u32 m0, s6, 15360
s_bfe_u32 s60, s59, 0x40000
s_mul_i32 s60, s60, 245760
s_add_u32 s60, s60, s41
BL v15,s[20:23],s60 offen lds
M3 a[112:127],a[244:247],v[156:159],a[112:127]
TR a[240:241],v4 offset:20480
TR a[242:243],v4 offset:21760
M3 a[128:143],a[248:251],v[156:159],a[128:143]
TR a[244:245],v6 offset:61440
TR a[246:247],v6 offset:62720
BL v16,s[20:23],s60 offen offset:1024 lds
M3 a[144:159],a[252:255],v[156:159],a[144:159]
TR a[248:249],v6 offset:61480
TR a[250:251],v6 offset:62760
s_waitcnt lgkmcnt(6)
M3 a[80:95],a[224:227],v[160:163],a[80:95]
TR a[252:253],v6 offset:61520
TR a[254:255],v6 offset:62800
BL v17,s[20:23],s60 offen offset:2048 lds
M3 a[96:111],a[228:231],v[160:163],a[96:111]
TR a[224:225],v6 offset:61560
TR a[226:227],v6 offset:62840
M3 a[112:127],a[232:235],v[160:163],a[112:127]
TR a[228:229],v4 offset:61440
TR a[230:231],v4 offset:62720
BL v18,s[20:23],s60 offen offset:3072 lds
M3 a[128:143],a[236:239],v[160:163],a[128:143]
TR a[232:233],v7 offset:20480
TR a[234:235],v7 offset:21760
s_waitcnt lgkmcnt(6)
M3 a[144:159],a[240:243],v[160:163],a[144:159]
TR a[236:237],v7 offset:20520
TR a[238:239],v7 offset:21800
s_add_u32 m0, s6, 19456
s_nop 0
BL v19,s[20:23],s60 offen lds
M3 a[80:95],a[244:247],v[164:167],a[80:95]
TR a[240:241],v7 offset:20560
TR a[242:243],v7 offset:21840
M3 a[96:111],a[248:251],v[164:167],a[96:111]
TR a[244:245],v7 offset:20600
TR a[246:247],v7 offset:21880
s_bfe_u32 s65, s87, 0x80018
s_mul_i32 s65, s65, 40960
BL a[220:223],v27,s[32:35],s65 offen sc1
M3 a[112:127],a[252:255],v[164:167],a[112:127]
TR a[248:249],v5 offset:20480
TR a[250:251],v5 offset:21760
s_waitcnt lgkmcnt(6)
M3 a[128:143],a[224:227],v[164:167],a[128:143]
TR a[252:253],v7 offset:61440
TR a[254:255],v7 offset:62720
s_add_u32 m0, s6, 32768
s_nop 0
BL v27,s[32:35],s65 offen offset:1024 sc1 lds
M3 a[144:159],a[228:231],v[164:167],a[144:159]
TR a[224:225],v7 offset:61480
TR a[226:227],v7 offset:62760
M3 a[80:95],a[232:235],v[168:171],a[80:95]
TR a[228:229],v7 offset:61520
TR a[230:231],v7 offset:62800
BL v27,s[32:35],s65 offen offset:2048 sc1 lds
M3 a[96:111],a[236:239],v[168:171],a[96:111]
TR a[232:233],v7 offset:61560
TR a[234:235],v7 offset:62840
s_waitcnt lgkmcnt(6)
M3 a[112:127],a[240:243],v[168:171],a[112:127]
TR a[236:237],v5 offset:61440
TR a[238:239],v5 offset:62720
BL v27,s[32:35],s65 offen offset:3072 sc1 lds
M3 a[128:143],a[244:247],v[168:171],a[128:143]
M3 a[144:159],a[248:251],v[168:171],a[144:159]
s_add_u32 m0, s6, 36864
s_nop 0
BL v25,s[32:35],s65 offen sc1 lds
M3 a[80:95],a[252:255],v[172:175],a[80:95]
s_waitcnt vmcnt(39) lgkmcnt(0)
s_barrier
TR a[240:241],v6
TR a[242:243],v6 offset:1280
TR a[244:245],v6 offset:40
TR a[246:247],v6 offset:1320
M3 a[96:111],a[224:227],v[172:175],a[96:111]
TR a[248:249],v6 offset:80
TR a[250:251],v6 offset:1360
TR a[252:253],v6 offset:120
TR a[254:255],v6 offset:1400
s_add_u32 m0, s6, 20480
s_bfe_u32 s60, s59, 0x40004
s_mul_i32 s60, s60, 245760
s_add_u32 s60, s60, s41
BL v15,s[20:23],s60 offen lds
M3 a[112:127],a[228:231],v[172:175],a[112:127]
TR a[224:225],v4
TR a[226:227],v4 offset:1280
M3 a[128:143],a[232:235],v[172:175],a[128:143]
TR a[228:229],v6 offset:40960
TR a[230:231],v6 offset:42240
BL v16,s[20:23],s60 offen offset:1024 lds
M3 a[144:159],a[236:239],v[172:175],a[144:159]
TR a[232:233],v6 offset:41000
TR a[234:235],v6 offset:42280
s_waitcnt lgkmcnt(6)
M3 a[80:95],a[240:243],v[176:179],a[80:95]
TR a[236:237],v6 offset:41040
TR a[238:239],v6 offset:42320
BL v17,s[20:23],s60 offen offset:2048 lds
M3 a[96:111],a[244:247],v[176:179],a[96:111]
TR a[240:241],v6 offset:41080
TR a[242:243],v6 offset:42360
M3 a[112:127],a[248:251],v[176:179],a[112:127]
TR a[244:245],v4 offset:40960
TR a[246:247],v4 offset:42240
BL v18,s[20:23],s60 offen offset:3072 lds
M3 a[128:143],a[252:255],v[176:179],a[128:143]
TR a[248:249],v7
TR a[250:251],v7 offset:1280
s_waitcnt lgkmcnt(6)
M3 a[144:159],a[224:227],v[176:179],a[144:159]
TR a[252:253],v7 offset:40
TR a[254:255],v7 offset:1320
s_add_u32 m0, s6, 24576
s_nop 0
BL v19,s[20:23],s60 offen lds
M3 a[80:95],a[228:231],v[180:183],a[80:95]
TR a[224:225],v7 offset:80
TR a[226:227],v7 offset:1360
M3 a[96:111],a[232:235],v[180:183],a[96:111]
TR a[228:229],v7 offset:120
TR a[230:231],v7 offset:1400
s_add_u32 m0, s6, 37888
s_bfe_u32 s65, s88, 0x80000
s_mul_i32 s65, s65, 40960
BL v27,s[32:35],s65 offen sc1 lds
M3 a[112:127],a[236:239],v[180:183],a[112:127]
TR a[232:233],v5
TR a[234:235],v5 offset:1280
s_waitcnt lgkmcnt(6)
M3 a[128:143],a[240:243],v[180:183],a[128:143]
TR a[236:237],v7 offset:40960
TR a[238:239],v7 offset:42240
BL v27,s[32:35],s65 offen offset:1024 sc1 lds
M3 a[144:159],a[244:247],v[180:183],a[144:159]
TR a[240:241],v7 offset:41000
TR a[242:243],v7 offset:42280
M3 a[80:95],a[248:251],v[184:187],a[80:95]
TR a[244:245],v7 offset:41040
TR a[246:247],v7 offset:42320
BL v27,s[32:35],s65 offen offset:2048 sc1 lds
M3 a[96:111],a[252:255],v[184:187],a[96:111]
TR a[248:249],v7 offset:41080
TR a[250:251],v7 offset:42360
s_waitcnt lgkmcnt(6)
M3 a[112:127],a[224:227],v[184:187],a[112:127]
TR a[252:253],v5 offset:40960
TR a[254:255],v5 offset:42240
BL a[64:67],v27,s[32:35],s65 offen offset:3072 sc1
M3 a[128:143],a[228:231],v[184:187],a[128:143]
M3 a[144:159],a[232:235],v[184:187],a[144:159]
BL a[68:71],v25,s[32:35],s65 offen sc1
M3 a[80:95],a[236:239],v[188:191],a[80:95]
s_waitcnt vmcnt(35) lgkmcnt(0)
s_barrier
TR a[224:225],v6 offset:5120
TR a[226:227],v6 offset:6400
TR a[228:229],v6 offset:5160
TR a[230:231],v6 offset:6440
M3 a[96:111],a[240:243],v[188:191],a[96:111]
TR a[232:233],v6 offset:5200
TR a[234:235],v6 offset:6480
TR a[236:237],v6 offset:5240
TR a[238:239],v6 offset:6520
s_bfe_u32 s65, s88, 0x80008
s_mul_i32 s65, s65, 40960
BL a[72:75],v27,s[32:35],s65 offen sc1
M3 a[112:127],a[244:247],v[188:191],a[112:127]
TR a[240:241],v4 offset:5120
TR a[242:243],v4 offset:6400
M3 a[128:143],a[248:251],v[188:191],a[128:143]
TR a[244:245],v6 offset:46080
TR a[246:247],v6 offset:47360
BL a[76:79],v27,s[32:35],s65 offen offset:1024 sc1
M3 a[144:159],a[252:255],v[188:191],a[144:159]
TR a[248:249],v6 offset:46120
TR a[250:251],v6 offset:47400
s_waitcnt lgkmcnt(6)
M3 a[80:95],a[224:227],v[192:195],a[80:95]
TR a[252:253],v6 offset:46160
TR a[254:255],v6 offset:47440
s_add_u32 m0, s6, 23552
s_nop 0
BL v27,s[32:35],s65 offen offset:2048 sc1 lds
M3 a[96:111],a[228:231],v[192:195],a[96:111]
TR a[224:225],v6 offset:46200
TR a[226:227],v6 offset:47480
M3 a[112:127],a[232:235],v[192:195],a[112:127]
TR a[228:229],v4 offset:46080
TR a[230:231],v4 offset:47360
BL v27,s[32:35],s65 offen offset:3072 sc1 lds
M3 a[128:143],a[236:239],v[192:195],a[128:143]
TR a[232:233],v7 offset:5120
TR a[234:235],v7 offset:6400
s_waitcnt lgkmcnt(6)
M3 a[144:159],a[240:243],v[192:195],a[144:159]
TR a[236:237],v7 offset:5160
TR a[238:239],v7 offset:6440
s_add_u32 m0, s6, 27648
s_nop 0
BL v25,s[32:35],s65 offen sc1 lds
M3 a[80:95],a[244:247],v[196:199],a[80:95]
TR a[240:241],v7 offset:5200
TR a[242:243],v7 offset:6480
M3 a[96:111],a[248:251],v[196:199],a[96:111]
TR a[244:245],v7 offset:5240
TR a[246:247],v7 offset:6520
s_add_u32 m0, s6, 28672
s_bfe_u32 s65, s88, 0x80010
s_mul_i32 s65, s65, 40960
BL v27,s[32:35],s65 offen sc1 lds
M3 a[112:127],a[252:255],v[196:199],a[112:127]
TR a[248:249],v5 offset:5120
TR a[250:251],v5 offset:6400
s_waitcnt lgkmcnt(6)
M3 a[128:143],a[224:227],v[196:199],a[128:143]
TR a[252:253],v7 offset:46080
TR a[254:255],v7 offset:47360
BL v27,s[32:35],s65 offen offset:1024 sc1 lds
M3 a[144:159],a[228:231],v[196:199],a[144:159]
TR a[224:225],v7 offset:46120
TR a[226:227],v7 offset:47400
M3 a[80:95],a[232:235],v[200:203],a[80:95]
TR a[228:229],v7 offset:46160
TR a[230:231],v7 offset:47440
s_lshr_b32 s7, s5, 3
s_lshl_b32 s98, s4, 1
s_add_u32 s98, s98, s7
s_mul_i32 s99, s98, 74
s_mul_i32 s61, s3, 14
s_add_u32 s99, s99, s61
s_lshl_b32 s99, s99, 12
s_add_u32 s99, s99, 0
s_add_u32 s36, s82, s99
s_addc_u32 s37, s83, 0
s_sub_u32 s38, 74, s61
s_lshl_b32 s38, s38, 12
s_mov_b32 s39, 0x20000
v_and_b32 v30, 1, v1
v_lshlrev_b32 v30, 2, v30
v_and_b32 v31, 2, v1
v_lshl_add_u32 v30, v31, 6, v30
s_lshl_b32 s7, s3, 8
s_add_u32 s7, s7, 1024
v_add_u32 v30, s7, v30
s_add_u32 s98, s97, 4294836224
s_add_u32 s99, s97, 4294901760
buffer_load_dword v31, v30, s[24:27], s98 offen sc1
BL v27,s[32:35],s65 offen offset:2048 sc1 lds
M3 a[96:111],a[236:239],v[200:203],a[96:111]
TR a[232:233],v7 offset:46200
TR a[234:235],v7 offset:47480
s_waitcnt lgkmcnt(6)
M3 a[112:127],a[240:243],v[200:203],a[112:127]
TR a[236:237],v5 offset:46080
TR a[238:239],v5 offset:47360
BL v27,s[32:35],s65 offen offset:3072 sc1 lds
M3 a[128:143],a[244:247],v[200:203],a[128:143]
M3 a[144:159],a[248:251],v[200:203],a[144:159]
s_add_u32 m0, s6, 32768
s_nop 0
BL v25,s[32:35],s65 offen sc1 lds
M3 a[80:95],a[252:255],v[204:207],a[80:95]
s_waitcnt vmcnt(36) lgkmcnt(0)
s_barrier
TR a[240:241],v6 offset:10240
TR a[242:243],v6 offset:11520
TR a[244:245],v6 offset:10280
TR a[246:247],v6 offset:11560
M3 a[96:111],a[224:227],v[204:207],a[96:111]
TR a[248:249],v6 offset:10320
TR a[250:251],v6 offset:11600
TR a[252:253],v6 offset:10360
TR a[254:255],v6 offset:11640
s_bfe_u32 s65, s88, 0x80018
s_mul_i32 s65, s65, 40960
BL a[0:3],v27,s[32:35],s65 offen sc1
M3 a[112:127],a[228:231],v[204:207],a[112:127]
TR a[224:225],v4 offset:10240
TR a[226:227],v4 offset:11520
M3 a[128:143],a[232:235],v[204:207],a[128:143]
TR a[228:229],v6 offset:51200
TR a[230:231],v6 offset:52480
BL a[4:7],v27,s[32:35],s65 offen offset:1024 sc1
M3 a[144:159],a[236:239],v[204:207],a[144:159]
TR a[232:233],v6 offset:51240
TR a[234:235],v6 offset:52520
s_waitcnt lgkmcnt(6)
M3 a[80:95],a[240:243],v[208:211],a[80:95]
TR a[236:237],v6 offset:51280
TR a[238:239],v6 offset:52560
BL a[8:11],v27,s[32:35],s65 offen offset:2048 sc1
M3 a[96:111],a[244:247],v[208:211],a[96:111]
TR a[240:241],v6 offset:51320
TR a[242:243],v6 offset:52600
M3 a[112:127],a[248:251],v[208:211],a[112:127]
TR a[244:245],v4 offset:51200
TR a[246:247],v4 offset:52480
BL a[12:15],v27,s[32:35],s65 offen offset:3072 sc1
M3 a[128:143],a[252:255],v[208:211],a[128:143]
TR a[248:249],v7 offset:10240
TR a[250:251],v7 offset:11520
s_waitcnt lgkmcnt(6)
M3 a[144:159],a[224:227],v[208:211],a[144:159]
TR a[252:253],v7 offset:10280
TR a[254:255],v7 offset:11560
BL a[16:19],v25,s[32:35],s65 offen sc1
M3 a[80:95],a[228:231],v[212:215],a[80:95]
TR a[224:225],v7 offset:10320
TR a[226:227],v7 offset:11600
M3 a[96:111],a[232:235],v[212:215],a[96:111]
TR a[228:229],v7 offset:10360
TR a[230:231],v7 offset:11640
s_bfe_u32 s65, s70, 0x80000
s_mul_i32 s65, s65, 40960
BL a[20:23],v27,s[32:35],s65 offen sc1
M3 a[112:127],a[236:239],v[212:215],a[112:127]
TR a[232:233],v5 offset:10240
TR a[234:235],v5 offset:11520
s_waitcnt lgkmcnt(6)
M3 a[128:143],a[240:243],v[212:215],a[128:143]
TR a[236:237],v7 offset:51200
TR a[238:239],v7 offset:52480
BL a[24:27],v27,s[32:35],s65 offen offset:1024 sc1
M3 a[144:159],a[244:247],v[212:215],a[144:159]
TR a[240:241],v7 offset:51240
TR a[242:243],v7 offset:52520
M3 a[80:95],a[248:251],v[216:219],a[80:95]
TR a[244:245],v7 offset:51280
TR a[246:247],v7 offset:52560
BL a[28:31],v27,s[32:35],s65 offen offset:2048 sc1
M3 a[96:111],a[252:255],v[216:219],a[96:111]
TR a[248:249],v7 offset:51320
TR a[250:251],v7 offset:52600
s_waitcnt lgkmcnt(6)
M3 a[112:127],a[224:227],v[216:219],a[112:127]
TR a[252:253],v5 offset:51200
TR a[254:255],v5 offset:52480
BL a[32:35],v27,s[32:35],s65 offen offset:3072 sc1
M3 a[128:143],a[228:231],v[216:219],a[128:143]
M3 a[144:159],a[232:235],v[216:219],a[144:159]
BL a[36:39],v25,s[32:35],s65 offen sc1
M3 a[80:95],a[236:239],v[220:223],a[80:95]
s_waitcnt vmcnt(36) lgkmcnt(0)
s_barrier
TR a[224:225],v6 offset:15360
TR a[226:227],v6 offset:16640
TR a[228:229],v6 offset:15400
TR a[230:231],v6 offset:16680
M3 a[96:111],a[240:243],v[220:223],a[96:111]
TR a[232:233],v6 offset:15440
TR a[234:235],v6 offset:16720
TR a[236:237],v6 offset:15480
TR a[238:239],v6 offset:16760
s_bfe_u32 s65, s70, 0x80008
s_mul_i32 s65, s65, 40960
BL a[40:43],v27,s[32:35],s65 offen sc1
M3 a[112:127],a[244:247],v[220:223],a[112:127]
TR a[240:241],v4 offset:15360
TR a[242:243],v4 offset:16640
M3 a[128:143],a[248:251],v[220:223],a[128:143]
TR a[244:245],v6 offset:56320
TR a[246:247],v6 offset:57600
BL a[44:47],v27,s[32:35],s65 offen offset:1024 sc1
M3 a[144:159],a[252:255],v[220:223],a[144:159]
TR a[248:249],v6 offset:56360
TR a[250:251],v6 offset:57640
s_waitcnt lgkmcnt(6)
M3 a[80:95],a[224:227],v[224:227],a[80:95]
TR a[252:253],v6 offset:56400
TR a[254:255],v6 offset:57680
s_waitcnt vmcnt(15)
K1_KVQ_E_chk:
v_cmp_ne_u32 vcc, v31, v26
s_nop 0
s_cmp_eq_u64 vcc, 0
s_cbranch_scc1 K1_KVQ_E_ok
s_cmp_eq_u32 s101, 0
s_cbranch_scc1 K1_KVQ_E_ok
s_sub_u32 s101, s101, 1
s_sleep 10
buffer_load_dword v31, v30, s[24:27], s98 offen sc1
s_waitcnt vmcnt(0)
s_branch K1_KVQ_E_chk
K1_KVQ_E_ok:
s_bfe_u32 s61, s87, 0x80000
s_mul_i32 s61, s61, 4096
BL v[96:99],v27,s[36:39],s61 offen sc1
M3 a[96:111],a[228:231],v[224:227],a[96:111]
TR a[224:225],v6 offset:56440
TR a[226:227],v6 offset:57720
M3 a[112:127],a[232:235],v[224:227],a[112:127]
TR a[228:229],v4 offset:56320
TR a[230:231],v4 offset:57600
s_bfe_u32 s61, s87, 0x80000
s_mul_i32 s61, s61, 4096
BL v[100:103],v27,s[36:39],s61 offen offset:1024 sc1
M3 a[128:143],a[236:239],v[224:227],a[128:143]
TR a[232:233],v7 offset:15360
TR a[234:235],v7 offset:16640
s_waitcnt lgkmcnt(6)
M3 a[144:159],a[240:243],v[224:227],a[144:159]
TR a[236:237],v7 offset:15400
TR a[238:239],v7 offset:16680
s_bfe_u32 s61, s87, 0x80000
s_mul_i32 s61, s61, 4096
BL v[104:107],v27,s[36:39],s61 offen offset:2048 sc1
M3 a[80:95],a[244:247],v[228:231],a[80:95]
TR a[240:241],v7 offset:15440
TR a[242:243],v7 offset:16720
M3 a[96:111],a[248:251],v[228:231],a[96:111]
TR a[244:245],v7 offset:15480
TR a[246:247],v7 offset:16760
s_bfe_u32 s61, s87, 0x80000
s_mul_i32 s61, s61, 4096
BL v[108:111],v27,s[36:39],s61 offen offset:3072 sc1
M3 a[112:127],a[252:255],v[228:231],a[112:127]
TR a[248:249],v5 offset:15360
TR a[250:251],v5 offset:16640
s_waitcnt lgkmcnt(6)
M3 a[128:143],a[224:227],v[228:231],a[128:143]
TR a[252:253],v7 offset:56320
TR a[254:255],v7 offset:57600
s_bfe_u32 s61, s87, 0x80008
s_mul_i32 s61, s61, 4096
BL v[112:115],v27,s[36:39],s61 offen sc1
M3 a[144:159],a[228:231],v[228:231],a[144:159]
TR a[224:225],v7 offset:56360
TR a[226:227],v7 offset:57640
M3 a[80:95],a[232:235],v[232:235],a[80:95]
TR a[228:229],v7 offset:56400
TR a[230:231],v7 offset:57680
s_bfe_u32 s61, s87, 0x80008
s_mul_i32 s61, s61, 4096
BL v[116:119],v27,s[36:39],s61 offen offset:1024 sc1
M3 a[96:111],a[236:239],v[232:235],a[96:111]
TR a[232:233],v7 offset:56440
TR a[234:235],v7 offset:57720
s_waitcnt lgkmcnt(6)
M3 a[112:127],a[240:243],v[232:235],a[112:127]
TR a[236:237],v5 offset:56320
TR a[238:239],v5 offset:57600
s_bfe_u32 s61, s87, 0x80008
s_mul_i32 s61, s61, 4096
BL v[120:123],v27,s[36:39],s61 offen offset:2048 sc1
M3 a[128:143],a[244:247],v[232:235],a[128:143]
M3 a[144:159],a[248:251],v[232:235],a[144:159]
s_bfe_u32 s61, s87, 0x80008
s_mul_i32 s61, s61, 4096
BL v[124:127],v27,s[36:39],s61 offen offset:3072 sc1
M3 a[80:95],a[252:255],v[236:239],a[80:95]
s_waitcnt lgkmcnt(0)
s_barrier
TR a[240:241],v6 offset:20480
TR a[242:243],v6 offset:21760
TR a[244:245],v6 offset:20520
TR a[246:247],v6 offset:21800
M3 a[96:111],a[224:227],v[236:239],a[96:111]
TR a[248:249],v6 offset:20560
TR a[250:251],v6 offset:21840
TR a[252:253],v6 offset:20600
TR a[254:255],v6 offset:21880
s_bfe_u32 s61, s87, 0x80010
s_mul_i32 s61, s61, 4096
BL v[128:131],v27,s[36:39],s61 offen sc1
M3 a[112:127],a[228:231],v[236:239],a[112:127]
TR a[224:225],v4 offset:20480
TR a[226:227],v4 offset:21760
M3 a[128:143],a[232:235],v[236:239],a[128:143]
TR a[228:229],v6 offset:61440
TR a[230:231],v6 offset:62720
s_bfe_u32 s61, s87, 0x80010
s_mul_i32 s61, s61, 4096
BL v[132:135],v27,s[36:39],s61 offen offset:1024 sc1
M3 a[144:159],a[236:239],v[236:239],a[144:159]
TR a[232:233],v6 offset:61480
TR a[234:235],v6 offset:62760
s_waitcnt lgkmcnt(6)
M3 a[80:95],a[240:243],v[240:243],a[80:95]
TR a[236:237],v6 offset:61520
TR a[238:239],v6 offset:62800
s_bfe_u32 s61, s87, 0x80010
s_mul_i32 s61, s61, 4096
BL v[136:139],v27,s[36:39],s61 offen offset:2048 sc1
M3 a[96:111],a[244:247],v[240:243],a[96:111]
TR a[240:241],v6 offset:61560
TR a[242:243],v6 offset:62840
M3 a[112:127],a[248:251],v[240:243],a[112:127]
TR a[244:245],v4 offset:61440
TR a[246:247],v4 offset:62720
s_bfe_u32 s61, s87, 0x80010
s_mul_i32 s61, s61, 4096
BL v[140:143],v27,s[36:39],s61 offen offset:3072 sc1
M3 a[128:143],a[252:255],v[240:243],a[128:143]
TR a[248:249],v7 offset:20480
TR a[250:251],v7 offset:21760
s_waitcnt lgkmcnt(6)
M3 a[144:159],a[224:227],v[240:243],a[144:159]
TR a[252:253],v7 offset:20520
TR a[254:255],v7 offset:21800
s_bfe_u32 s61, s87, 0x80018
s_mul_i32 s61, s61, 4096
BL v[144:147],v27,s[36:39],s61 offen sc1
M3 a[80:95],a[228:231],v[244:247],a[80:95]
TR a[224:225],v7 offset:20560
TR a[226:227],v7 offset:21840
M3 a[96:111],a[232:235],v[244:247],a[96:111]
TR a[228:229],v7 offset:20600
TR a[230:231],v7 offset:21880
s_bfe_u32 s61, s87, 0x80018
s_mul_i32 s61, s61, 4096
BL v[148:151],v27,s[36:39],s61 offen offset:1024 sc1
M3 a[112:127],a[236:239],v[244:247],a[112:127]
TR a[232:233],v5 offset:20480
TR a[234:235],v5 offset:21760
s_waitcnt lgkmcnt(6)
M3 a[128:143],a[240:243],v[244:247],a[128:143]
TR a[236:237],v7 offset:61440
TR a[238:239],v7 offset:62720
s_bfe_u32 s61, s87, 0x80018
s_mul_i32 s61, s61, 4096
BL v[152:155],v27,s[36:39],s61 offen offset:2048 sc1
M3 a[144:159],a[244:247],v[244:247],a[144:159]
TR a[240:241],v7 offset:61480
TR a[242:243],v7 offset:62760
M3 a[80:95],a[248:251],v[248:251],a[80:95]
TR a[244:245],v7 offset:61520
TR a[246:247],v7 offset:62800
s_bfe_u32 s61, s87, 0x80018
s_mul_i32 s61, s61, 4096
BL v[156:159],v27,s[36:39],s61 offen offset:3072 sc1
M3 a[96:111],a[252:255],v[248:251],a[96:111]
TR a[248:249],v7 offset:61560
TR a[250:251],v7 offset:62840
s_waitcnt lgkmcnt(6)
M3 a[112:127],a[224:227],v[248:251],a[112:127]
TR a[252:253],v5 offset:61440
TR a[254:255],v5 offset:62720
BL a[48:51],v27,s[32:35],s65 offen offset:2048 sc1
M3 a[128:143],a[228:231],v[248:251],a[128:143]
M3 a[144:159],a[232:235],v[248:251],a[144:159]
BL a[52:55],v27,s[32:35],s65 offen offset:3072 sc1
M3 a[80:95],a[236:239],v[252:255],a[80:95]
s_waitcnt lgkmcnt(0)
M3 a[96:111],a[240:243],v[252:255],a[96:111]
BL a[56:59],v25,s[32:35],s65 offen sc1
M3 a[112:127],a[244:247],v[252:255],a[112:127]
M3 a[128:143],a[248:251],v[252:255],a[128:143]
s_add_u32 m0, s6, 0
s_bfe_u32 s65, s89, 0x80000
s_mul_i32 s65, s65, 40960
BL v27,s[32:35],s65 offen sc1 lds
M3 a[144:159],a[252:255],v[252:255],a[144:159]
s_barrier
s_nop 10
AR v40,a144
AR v41,a145
AR v42,a146
AR v43,a147
v_pk_mul_f32 v[44:45], v[40:41], s[50:51] op_sel:[0,1] op_sel_hi:[1,1]
v_pk_mul_f32 v[46:47], v[42:43], s[50:51] op_sel:[0,1] op_sel_hi:[1,1]
v_exp_f32_e64 v44, v44 clamp
v_max_f32 v40, s53, v40
v_exp_f32_e64 v45, v45 clamp
v_max_f32 v41, s53, v41
v_exp_f32_e64 v46, v46 clamp
v_max_f32 v42, s53, v42
v_exp_f32_e64 v47, v47 clamp
v_max_f32 v43, s53, v43
v_pk_add_f32 v[40:41], v[40:41], v[44:45]
v_pk_add_f32 v[42:43], v[42:43], v[46:47]
CV v80,v40,v41
CV v81,v42,v43
AR v40,a148
AR v41,a149
AR v42,a150
AR v43,a151
BL v27,s[32:35],s65 offen offset:1024 sc1 lds
v_pk_mul_f32 v[44:45], v[40:41], s[50:51] op_sel:[0,1] op_sel_hi:[1,1]
v_pk_mul_f32 v[46:47], v[42:43], s[50:51] op_sel:[0,1] op_sel_hi:[1,1]
v_exp_f32_e64 v44, v44 clamp
v_max_f32 v40, s53, v40
v_exp_f32_e64 v45, v45 clamp
v_max_f32 v41, s53, v41
v_exp_f32_e64 v46, v46 clamp
v_max_f32 v42, s53, v42
v_exp_f32_e64 v47, v47 clamp
v_max_f32 v43, s53, v43
v_pk_add_f32 v[40:41], v[40:41], v[44:45]
v_pk_add_f32 v[42:43], v[42:43], v[46:47]
CV v82,v40,v41
CV v83,v42,v43
AR v40,a152
AR v41,a153
AR v42,a154
AR v43,a155
v_pk_mul_f32 v[44:45], v[40:41], s[50:51] op_sel:[0,1] op_sel_hi:[1,1]
v_pk_mul_f32 v[46:47], v[42:43], s[50:51] op_sel:[0,1] op_sel_hi:[1,1]
v_exp_f32_e64 v44, v44 clamp
v_max_f32 v40, s53, v40
BL v27,s[32:35],s65 offen offset:2048 sc1 lds
v_exp_f32_e64 v45, v45 clamp
v_max_f32 v41, s53, v41
v_exp_f32_e64 v46, v46 clamp
v_max_f32 v42, s53, v42
v_exp_f32_e64 v47, v47 clamp
v_max_f32 v43, s53, v43
v_pk_add_f32 v[40:41], v[40:41], v[44:45]
v_pk_add_f32 v[42:43], v[42:43], v[46:47]
CV v84,v40,v41
CV v85,v42,v43
AR v40,a156
AR v41,a157
AR v42,a158
AR v43,a159
v_pk_mul_f32 v[44:45], v[40:41], s[50:51] op_sel:[0,1] op_sel_hi:[1,1]
v_pk_mul_f32 v[46:47], v[42:43], s[50:51] op_sel:[0,1] op_sel_hi:[1,1]
v_exp_f32_e64 v44, v44 clamp
v_max_f32 v40, s53, v40
v_exp_f32_e64 v45, v45 clamp
v_max_f32 v41, s53, v41
v_exp_f32_e64 v46, v46 clamp
v_max_f32 v42, s53, v42
BL v27,s[32:35],s65 offen offset:3072 sc1 lds
v_exp_f32_e64 v47, v47 clamp
v_max_f32 v43, s53, v43
v_pk_add_f32 v[40:41], v[40:41], v[44:45]
v_pk_add_f32 v[42:43], v[42:43], v[46:47]
CV v86,v40,v41
CV v87,v42,v43
AR v40,a80
AR v41,a81
AR v42,a82
AR v43,a83
v_pk_mul_f32 v[44:45], v[40:41], s[50:51] op_sel:[0,1] op_sel_hi:[1,1]
v_pk_mul_f32 v[46:47], v[42:43], s[50:51] op_sel:[0,1] op_sel_hi:[1,1]
v_exp_f32_e64 v44, v44 clamp
v_max_f32 v40, s53, v40
v_exp_f32_e64 v45, v45 clamp
v_max_f32 v41, s53, v41
v_exp_f32_e64 v46, v46 clamp
v_max_f32 v42, s53, v42
v_exp_f32_e64 v47, v47 clamp
v_max_f32 v43, s53, v43
v_pk_add_f32 v[40:41], v[40:41], v[44:45]
v_pk_add_f32 v[42:43], v[42:43], v[46:47]
s_add_u32 m0, s6, 4096
s_nop 0
BL v25,s[32:35],s65 offen sc1 lds
CV v28,v40,v41
CV v29,v42,v43
AR v40,a84
AR v41,a85
AR v42,a86
AR v43,a87
v_pk_mul_f32 v[44:45], v[40:41], s[50:51] op_sel:[0,1] op_sel_hi:[1,1]
v_pk_mul_f32 v[46:47], v[42:43], s[50:51] op_sel:[0,1] op_sel_hi:[1,1]
v_exp_f32_e64 v44, v44 clamp
v_max_f32 v40, s53, v40
v_exp_f32_e64 v45, v45 clamp
v_max_f32 v41, s53, v41
v_exp_f32_e64 v46, v46 clamp
v_max_f32 v42, s53, v42
v_exp_f32_e64 v47, v47 clamp
v_max_f32 v43, s53, v43
v_pk_add_f32 v[40:41], v[40:41], v[44:45]
v_pk_add_f32 v[42:43], v[42:43], v[46:47]
CV v30,v40,v41
CV v31,v42,v43
AR v40,a88
AR v41,a89
s_add_u32 m0, s6, 5120
s_bfe_u32 s65, s89, 0x80008
s_mul_i32 s65, s65, 40960
BL v27,s[32:35],s65 offen sc1 lds
AR v42,a90
AR v43,a91
v_pk_mul_f32 v[44:45], v[40:41], s[50:51] op_sel:[0,1] op_sel_hi:[1,1]
v_pk_mul_f32 v[46:47], v[42:43], s[50:51] op_sel:[0,1] op_sel_hi:[1,1]
v_exp_f32_e64 v44, v44 clamp
v_max_f32 v40, s53, v40
v_exp_f32_e64 v45, v45 clamp
v_max_f32 v41, s53, v41
v_exp_f32_e64 v46, v46 clamp
v_max_f32 v42, s53, v42
v_exp_f32_e64 v47, v47 clamp
v_max_f32 v43, s53, v43
v_pk_add_f32 v[40:41], v[40:41], v[44:45]
v_pk_add_f32 v[42:43], v[42:43], v[46:47]
CV v240,v40,v41
CV v241,v42,v43
AR v40,a92
AR v41,a93
AR v42,a94
AR v43,a95
v_pk_mul_f32 v[44:45], v[40:41], s[50:51] op_sel:[0,1] op_sel_hi:[1,1]
v_pk_mul_f32 v[46:47], v[42:43], s[50:51] op_sel:[0,1] op_sel_hi:[1,1]
BL v27,s[32:35],s65 offen offset:1024 sc1 lds
v_exp_f32_e64 v44, v44 clamp
v_max_f32 v40, s53, v40
v_exp_f32_e64 v45, v45 clamp
v_max_f32 v41, s53, v41
v_exp_f32_e64 v46, v46 clamp
v_max_f32 v42, s53, v42
v_exp_f32_e64 v47, v47 clamp
v_max_f32 v43, s53, v43
v_pk_add_f32 v[40:41], v[40:41], v[44:45]
v_pk_add_f32 v[42:43], v[42:43], v[46:47]
CV v242,v40,v41
CV v243,v42,v43
AR v40,a96
AR v41,a97
AR v42,a98
AR v43,a99
v_pk_mul_f32 v[44:45], v[40:41], s[50:51] op_sel:[0,1] op_sel_hi:[1,1]
v_pk_mul_f32 v[46:47], v[42:43], s[50:51] op_sel:[0,1] op_sel_hi:[1,1]
v_exp_f32_e64 v44, v44 clamp
v_max_f32 v40, s53, v40
v_exp_f32_e64 v45, v45 clamp
v_max_f32 v41, s53, v41
BL v27,s[32:35],s65 offen offset:2048 sc1 lds
v_exp_f32_e64 v46, v46 clamp
v_max_f32 v42, s53, v42
v_exp_f32_e64 v47, v47 clamp
v_max_f32 v43, s53, v43
v_pk_add_f32 v[40:41], v[40:41], v[44:45]
v_pk_add_f32 v[42:43], v[42:43], v[46:47]
CV v32,v40,v41
CV v33,v42,v43
AR v40,a100
AR v41,a101
AR v42,a102
AR v43,a103
v_pk_mul_f32 v[44:45], v[40:41], s[50:51] op_sel:[0,1] op_sel_hi:[1,1]
v_pk_mul_f32 v[46:47], v[42:43], s[50:51] op_sel:[0,1] op_sel_hi:[1,1]
v_exp_f32_e64 v44, v44 clamp
v_max_f32 v40, s53, v40
v_exp_f32_e64 v45, v45 clamp
v_max_f32 v41, s53, v41
v_exp_f32_e64 v46, v46 clamp
v_max_f32 v42, s53, v42
v_exp_f32_e64 v47, v47 clamp
v_max_f32 v43, s53, v43
BL v27,s[32:35],s65 offen offset:3072 sc1 lds
v_pk_add_f32 v[40:41], v[40:41], v[44:45]
v_pk_add_f32 v[42:43], v[42:43], v[46:47]
CV v34,v40,v41
CV v35,v42,v43
AR v40,a104
AR v41,a105
AR v42,a106
AR v43,a107
v_pk_mul_f32 v[44:45], v[40:41], s[50:51] op_sel:[0,1] op_sel_hi:[1,1]
v_pk_mul_f32 v[46:47], v[42:43], s[50:51] op_sel:[0,1] op_sel_hi:[1,1]
v_exp_f32_e64 v44, v44 clamp
v_max_f32 v40, s53, v40
v_exp_f32_e64 v45, v45 clamp
v_max_f32 v41, s53, v41
v_exp_f32_e64 v46, v46 clamp
v_max_f32 v42, s53, v42
v_exp_f32_e64 v47, v47 clamp
v_max_f32 v43, s53, v43
v_pk_add_f32 v[40:41], v[40:41], v[44:45]
v_pk_add_f32 v[42:43], v[42:43], v[46:47]
CV v244,v40,v41
CV v245,v42,v43
s_add_u32 m0, s6, 9216
s_nop 0
BL v25,s[32:35],s65 offen sc1 lds
AR v40,a108
AR v41,a109
AR v42,a110
AR v43,a111
v_pk_mul_f32 v[44:45], v[40:41], s[50:51] op_sel:[0,1] op_sel_hi:[1,1]
v_pk_mul_f32 v[46:47], v[42:43], s[50:51] op_sel:[0,1] op_sel_hi:[1,1]
v_exp_f32_e64 v44, v44 clamp
v_max_f32 v40, s53, v40
v_exp_f32_e64 v45, v45 clamp
v_max_f32 v41, s53, v41
v_exp_f32_e64 v46, v46 clamp
v_max_f32 v42, s53, v42
v_exp_f32_e64 v47, v47 clamp
v_max_f32 v43, s53, v43
v_pk_add_f32 v[40:41], v[40:41], v[44:45]
v_pk_add_f32 v[42:43], v[42:43], v[46:47]
CV v246,v40,v41
CV v247,v42,v43
s_mov_b32 s58, s5
s_mul_i32 s57, s58, 15360
s_add_u32 s57, s57, 18874368
s_mul_i32 s56, s58, 20480
s_add_u32 s56, s56, s45
s_add_u32 s56, s56, 221184
s_mov_b32 s58, -1
s_mov_b32 s59, 0
v_lshlrev_b32 v10, 4, v0
v_add_u32 v11, 4096, v10
v_add_u32 v12, 8192, v10
v_add_u32 v13, 768, v0
v_min_u32 v13, 959, v13
v_lshlrev_b32 v13, 4, v13
BL v[224:227],v10,s[24:27],s57 offen sc1
BL v[228:231],v11,s[24:27],s57 offen sc1
BL v[232:235],v12,s[24:27],s57 offen sc1
BL v[236:239],v13,s[24:27],s57 offen sc1
AR v40,a112
AR v41,a113
AR v42,a114
AR v43,a115
v_pk_mul_f32 v[44:45], v[40:41], s[50:51] op_sel:[0,1] op_sel_hi:[1,1]
v_pk_mul_f32 v[46:47], v[42:43], s[50:51] op_sel:[0,1] op_sel_hi:[1,1]
v_exp_f32_e64 v44, v44 clamp
v_max_f32 v40, s53, v40
v_exp_f32_e64 v45, v45 clamp
v_max_f32 v41, s53, v41
v_exp_f32_e64 v46, v46 clamp
v_max_f32 v42, s53, v42
v_exp_f32_e64 v47, v47 clamp
v_max_f32 v43, s53, v43
v_pk_add_f32 v[40:41], v[40:41], v[44:45]
v_pk_add_f32 v[42:43], v[42:43], v[46:47]
CV v36,v40,v41
CV v37,v42,v43
AR v40,a116
AR v41,a117
AR v42,a118
AR v43,a119
s_add_u32 m0, s6, 10240
s_bfe_u32 s65, s89, 0x80010
s_mul_i32 s65, s65, 40960
BL v27,s[32:35],s65 offen sc1 lds
v_pk_mul_f32 v[44:45], v[40:41], s[50:51] op_sel:[0,1] op_sel_hi:[1,1]
v_pk_mul_f32 v[46:47], v[42:43], s[50:51] op_sel:[0,1] op_sel_hi:[1,1]
v_exp_f32_e64 v44, v44 clamp
v_max_f32 v40, s53, v40
v_exp_f32_e64 v45, v45 clamp
v_max_f32 v41, s53, v41
v_exp_f32_e64 v46, v46 clamp
v_max_f32 v42, s53, v42
v_exp_f32_e64 v47, v47 clamp
v_max_f32 v43, s53, v43
v_pk_add_f32 v[40:41], v[40:41], v[44:45]
v_pk_add_f32 v[42:43], v[42:43], v[46:47]
CV v38,v40,v41
CV v39,v42,v43
AR v40,a120
AR v41,a121
AR v42,a122
AR v43,a123
v_pk_mul_f32 v[44:45], v[40:41], s[50:51] op_sel:[0,1] op_sel_hi:[1,1]
v_pk_mul_f32 v[46:47], v[42:43], s[50:51] op_sel:[0,1] op_sel_hi:[1,1]
v_exp_f32_e64 v44, v44 clamp
v_max_f32 v40, s53, v40
BL v27,s[32:35],s65 offen offset:1024 sc1 lds
v_exp_f32_e64 v45, v45 clamp
v_max_f32 v41, s53, v41
v_exp_f32_e64 v46, v46 clamp
v_max_f32 v42, s53, v42
v_exp_f32_e64 v47, v47 clamp
v_max_f32 v43, s53, v43
v_pk_add_f32 v[40:41], v[40:41], v[44:45]
v_pk_add_f32 v[42:43], v[42:43], v[46:47]
CV v248,v40,v41
CV v249,v42,v43
AR v40,a124
AR v41,a125
AR v42,a126
AR v43,a127
v_pk_mul_f32 v[44:45], v[40:41], s[50:51] op_sel:[0,1] op_sel_hi:[1,1]
v_pk_mul_f32 v[46:47], v[42:43], s[50:51] op_sel:[0,1] op_sel_hi:[1,1]
v_exp_f32_e64 v44, v44 clamp
v_max_f32 v40, s53, v40
v_exp_f32_e64 v45, v45 clamp
v_max_f32 v41, s53, v41
v_exp_f32_e64 v46, v46 clamp
v_max_f32 v42, s53, v42
BL v27,s[32:35],s65 offen offset:2048 sc1 lds
v_exp_f32_e64 v47, v47 clamp
v_max_f32 v43, s53, v43
v_pk_add_f32 v[40:41], v[40:41], v[44:45]
v_pk_add_f32 v[42:43], v[42:43], v[46:47]
CV v250,v40,v41
CV v251,v42,v43
AR v40,a128
AR v41,a129
AR v42,a130
AR v43,a131
v_pk_mul_f32 v[44:45], v[40:41], s[50:51] op_sel:[0,1] op_sel_hi:[1,1]
v_pk_mul_f32 v[46:47], v[42:43], s[50:51] op_sel:[0,1] op_sel_hi:[1,1]
v_exp_f32_e64 v44, v44 clamp
v_max_f32 v40, s53, v40
v_exp_f32_e64 v45, v45 clamp
v_max_f32 v41, s53, v41
v_exp_f32_e64 v46, v46 clamp
v_max_f32 v42, s53, v42
v_exp_f32_e64 v47, v47 clamp
v_max_f32 v43, s53, v43
v_pk_add_f32 v[40:41], v[40:41], v[44:45]
v_pk_add_f32 v[42:43], v[42:43], v[46:47]
BL v27,s[32:35],s65 offen offset:3072 sc1 lds
CV v92,v40,v41
CV v93,v42,v43
AR v40,a132
AR v41,a133
AR v42,a134
AR v43,a135
v_pk_mul_f32 v[44:45], v[40:41], s[50:51] op_sel:[0,1] op_sel_hi:[1,1]
v_pk_mul_f32 v[46:47], v[42:43], s[50:51] op_sel:[0,1] op_sel_hi:[1,1]
v_exp_f32_e64 v44, v44 clamp
v_max_f32 v40, s53, v40
v_exp_f32_e64 v45, v45 clamp
v_max_f32 v41, s53, v41
v_exp_f32_e64 v46, v46 clamp
v_max_f32 v42, s53, v42
v_exp_f32_e64 v47, v47 clamp
v_max_f32 v43, s53, v43
v_pk_add_f32 v[40:41], v[40:41], v[44:45]
v_pk_add_f32 v[42:43], v[42:43], v[46:47]
CV v94,v40,v41
CV v95,v42,v43
AR v40,a136
AR v41,a137
s_add_u32 m0, s6, 14336
s_nop 0
BL v25,s[32:35],s65 offen sc1 lds
AR v42,a138
AR v43,a139
v_pk_mul_f32 v[44:45], v[40:41], s[50:51] op_sel:[0,1] op_sel_hi:[1,1]
v_pk_mul_f32 v[46:47], v[42:43], s[50:51] op_sel:[0,1] op_sel_hi:[1,1]
v_exp_f32_e64 v44, v44 clamp
v_max_f32 v40, s53, v40
v_exp_f32_e64 v45, v45 clamp
v_max_f32 v41, s53, v41
v_exp_f32_e64 v46, v46 clamp
v_max_f32 v42, s53, v42
v_exp_f32_e64 v47, v47 clamp
v_max_f32 v43, s53, v43
v_pk_add_f32 v[40:41], v[40:41], v[44:45]
v_pk_add_f32 v[42:43], v[42:43], v[46:47]
CV v252,v40,v41
CV v253,v42,v43
AR v40,a140
AR v41,a141
AR v42,a142
AR v43,a143
v_pk_mul_f32 v[44:45], v[40:41], s[50:51] op_sel:[0,1] op_sel_hi:[1,1]
v_pk_mul_f32 v[46:47], v[42:43], s[50:51] op_sel:[0,1] op_sel_hi:[1,1]
s_add_u32 m0, s6, 15360
s_bfe_u32 s65, s89, 0x80018
s_mul_i32 s65, s65, 40960
BL v27,s[32:35],s65 offen sc1 lds
v_exp_f32_e64 v44, v44 clamp
v_max_f32 v40, s53, v40
v_exp_f32_e64 v45, v45 clamp
v_max_f32 v41, s53, v41
v_exp_f32_e64 v46, v46 clamp
v_max_f32 v42, s53, v42
v_exp_f32_e64 v47, v47 clamp
v_max_f32 v43, s53, v43
v_pk_add_f32 v[40:41], v[40:41], v[44:45]
v_pk_add_f32 v[42:43], v[42:43], v[46:47]
CV v254,v40,v41
CV v255,v42,v43
s_mov_b32 s84, 21504
v_bfe_u32 v44, v1, 4, 1
v_and_b32 v45, 3, v1
v_lshl_add_u32 v44, v44, 2, v45
v_subrev_u32 v45, 1, v44
v_min_u32 v45, 5, v45
v_cmp_gt_u32 vcc, 5, v44
s_nop 1
v_cndmask_b32 v44, v45, v44, vcc
v_bfe_u32 v45, v1, 2, 2
v_mul_u32_u24 v45, 48, v45
BL v27,s[32:35],s65 offen offset:1024 sc1 lds
v_lshl_add_u32 v44, v44, 3, v45
v_add_u32 v45, 22272, v44
v_lshrrev_b32 v46, 5, v1
v_mul_u32_u24 v46, 192, v46
v_add3_u32 v44, v44, v46, s84
v_bfe_u32 v46, v1, 4, 1
v_lshlrev_b32 v46, 10, v46
v_lshrrev_b32 v47, 5, v1
v_lshl_add_u32 v46, v47, 8, v46
v_and_b32 v47, 15, v1
v_lshl_add_u32 v46, v47, 4, v46
v_lshrrev_b32 v64, 4, v10
v_mul_u32_u24 v65, 21846, v64
v_lshrrev_b32 v65, 16, v65
v_mul_u32_u24 v66, 3, v65
v_sub_u32 v64, v64, v66
v_mul_u32_u24 v66, 3277, v65
v_lshrrev_b32 v66, 16, v66
v_mul_u32_u24 v67, 20, v66
v_sub_u32 v65, v65, v67
v_mul_u32_u24 v65, 48, v65
v_lshl_add_u32 v65, v64, 4, v65
BL v27,s[32:35],s65 offen offset:2048 sc1 lds
v_and_b32 v67, 1, v66
v_lshl_add_u32 v65, v67, 3, v65
v_bfe_u32 v67, v66, 1, 2
v_mul_u32_u24 v67, 960, v67
v_lshrrev_b32 v66, 3, v66
v_mul_u32_u24 v66, 40960, v66
v_add3_u32 v65, v65, v66, v67
v_add_u32 v48, 21504, v65
v_lshrrev_b32 v64, 4, v11
v_mul_u32_u24 v65, 21846, v64
v_lshrrev_b32 v65, 16, v65
v_mul_u32_u24 v66, 3, v65
v_sub_u32 v64, v64, v66
v_mul_u32_u24 v66, 3277, v65
v_lshrrev_b32 v66, 16, v66
v_mul_u32_u24 v67, 20, v66
v_sub_u32 v65, v65, v67
v_mul_u32_u24 v65, 48, v65
v_lshl_add_u32 v65, v64, 4, v65
v_and_b32 v67, 1, v66
v_lshl_add_u32 v65, v67, 3, v65
v_bfe_u32 v67, v66, 1, 2
BL v27,s[32:35],s65 offen offset:3072 sc1 lds
v_mul_u32_u24 v67, 960, v67
v_lshrrev_b32 v66, 3, v66
v_mul_u32_u24 v66, 40960, v66
v_add3_u32 v65, v65, v66, v67
v_add_u32 v49, 21504, v65
v_lshrrev_b32 v64, 4, v12
v_mul_u32_u24 v65, 21846, v64
v_lshrrev_b32 v65, 16, v65
v_mul_u32_u24 v66, 3, v65
v_sub_u32 v64, v64, v66
v_mul_u32_u24 v66, 3277, v65
v_lshrrev_b32 v66, 16, v66
v_mul_u32_u24 v67, 20, v66
v_sub_u32 v65, v65, v67
v_mul_u32_u24 v65, 48, v65
v_lshl_add_u32 v65, v64, 4, v65
v_and_b32 v67, 1, v66
v_lshl_add_u32 v65, v67, 3, v65
v_bfe_u32 v67, v66, 1, 2
v_mul_u32_u24 v67, 960, v67
v_lshrrev_b32 v66, 3, v66
v_mul_u32_u24 v66, 40960, v66
s_add_u32 m0, s6, 19456
s_nop 0
BL v25,s[32:35],s65 offen sc1 lds
v_add3_u32 v65, v65, v66, v67
v_add_u32 v50, 21504, v65
v_lshrrev_b32 v64, 4, v13
v_mul_u32_u24 v65, 21846, v64
v_lshrrev_b32 v65, 16, v65
v_mul_u32_u24 v66, 3, v65
v_sub_u32 v64, v64, v66
v_mul_u32_u24 v66, 3277, v65
v_lshrrev_b32 v66, 16, v66
v_mul_u32_u24 v67, 20, v66
v_sub_u32 v65, v65, v67
v_mul_u32_u24 v65, 48, v65
v_lshl_add_u32 v65, v64, 4, v65
v_and_b32 v67, 1, v66
v_lshl_add_u32 v65, v67, 3, v65
v_bfe_u32 v67, v66, 1, 2
v_mul_u32_u24 v67, 960, v67
v_lshrrev_b32 v66, 3, v66
v_mul_u32_u24 v66, 40960, v66
v_add3_u32 v65, v65, v66, v67
v_add_u32 v51, 21504, v65
v_mov_b32 v52, 0
s_bfe_u32 s65, s71, 0x80008
s_mul_i32 s65, s65, 40960
BL a[224:227],v27,s[32:35],s65 offen sc1
v_mov_b32 v53, 0
v_mov_b32 v56, 0
v_mov_b32 v57, 0
v_mov_b32 v58, 0
v_mov_b32 v59, 0
v_mov_b32 v62, 0
v_mov_b32 v63, 0
s_waitcnt vmcnt(11)
K1_KVQ_C_chk:
v_cmp_ne_u32 vcc, v226, v26
v_cmp_ne_u32 s[84:85], v230, v26
s_nop 0
s_or_b64 vcc, vcc, s[84:85]
v_cmp_ne_u32 s[84:85], v234, v26
s_nop 0
s_or_b64 vcc, vcc, s[84:85]
v_cmp_ne_u32 s[84:85], v238, v26
s_nop 0
s_or_b64 vcc, vcc, s[84:85]
s_cmp_eq_u64 vcc, 0
s_cbranch_scc1 K1_KVQ_C_ok
s_cmp_eq_u32 s101, 0
s_cbranch_scc1 K1_KVQ_C_ok
s_sub_u32 s101, s101, 1
s_sleep 8
BL v[224:227],v10,s[24:27],s57 offen sc1
BL v[228:231],v11,s[24:27],s57 offen sc1
BL v[232:235],v12,s[24:27],s57 offen sc1
BL v[236:239],v13,s[24:27],s57 offen sc1
s_waitcnt vmcnt(0)
s_branch K1_KVQ_C_chk
K1_KVQ_C_ok:
ds_write_b64 v48, v[224:225]
ds_write_b64 v49, v[228:229]
ds_write_b64 v50, v[232:233]
ds_write_b64 v51, v[236:237]
s_waitcnt lgkmcnt(0)
s_barrier
TR v[64:65],v45
TR a[148:149],v44
TR a[150:151],v44 offset:384
TR v[66:67],v45 offset:960
TR a[152:153],v44 offset:960
TR a[154:155],v44 offset:1344
TR v[68:69],v45 offset:1920
TR a[156:157],v44 offset:1920
TR a[158:159],v44 offset:2304
s_waitcnt lgkmcnt(6)
v_cndmask_b32 v54, 0, v64, s[58:59]
v_cndmask_b32 v55, 0, v65, s[58:59]
BL a[228:231],v27,s[32:35],s65 offen offset:1024 sc1
M3 v[176:191],a[148:151],v[28:31],0
TR v[70:71],v45 offset:2880
TR a[148:149],v44 offset:2880
TR a[150:151],v44 offset:3264
M3 v[176:191],v[54:57],v[80:83],v[176:191]
s_waitcnt lgkmcnt(6)
v_cndmask_b32 v60, v66, 0, s[58:59]
v_cndmask_b32 v61, v67, 0, s[58:59]
M3 v[192:207],a[152:155],v[32:35],0
TR v[72:73],v45 offset:40960
TR a[152:153],v44 offset:40960
TR a[154:155],v44 offset:41344
BL a[232:235],v27,s[32:35],s65 offen offset:2048 sc1
M3 v[192:207],v[60:63],v[80:83],v[192:207]
s_waitcnt lgkmcnt(6)
v_cndmask_b32 v54, 0, v68, s[58:59]
v_cndmask_b32 v55, 0, v69, s[58:59]
M3 v[208:223],a[156:159],v[36:39],0
TR v[74:75],v45 offset:41920
TR a[156:157],v44 offset:41920
TR a[158:159],v44 offset:42304
v_add_f32 v188, s53, v188
v_rcp_f32 v188, v188
s_nop 0
v_mul_f32 v176, v176, v188
v_mul_f32 v177, v177, v188
BL a[236:239],v27,s[32:35],s65 offen offset:3072 sc1
v_mul_f32 v178, v178, v188
v_mul_f32 v179, v179, v188
v_mul_f32 v180, v180, v188
v_mul_f32 v181, v181, v188
M3 v[208:223],v[52:55],v[80:83],v[208:223]
v_mul_f32 v182, v182, v188
v_mul_f32 v183, v183, v188
v_mul_f32 v184, v184, v188
v_mul_f32 v185, v185, v188
v_mul_f32 v186, v186, v188
v_mul_f32 v187, v187, v188
CV v28,v176,v177
BL a[240:243],v25,s[32:35],s65 offen sc1
CV v29,v178,v179
CV v30,v180,v181
CV v31,v182,v183
CV v64,v184,v185
CV v65,v186,v187
s_add_u32 s7, s56, 0
buffer_store_dwordx4 v[28:31], v46, s[24:27], s7 offen sc1
s_waitcnt lgkmcnt(6)
v_cndmask_b32 v60, v70, 0, s[58:59]
v_cndmask_b32 v61, v71, 0, s[58:59]
M3 v[224:239],a[148:151],v[92:95],0
TR v[76:77],v45 offset:42880
s_bfe_u32 s65, s71, 0x80010
s_mul_i32 s65, s65, 40960
BL a[244:247],v27,s[32:35],s65 offen sc1
TR a[148:149],v44 offset:42880
TR a[150:151],v44 offset:43264
v_add_f32 v204, s53, v204
v_rcp_f32 v204, v204
s_nop 0
v_mul_f32 v192, v192, v204
v_mul_f32 v193, v193, v204
v_mul_f32 v194, v194, v204
v_mul_f32 v195, v195, v204
v_mul_f32 v196, v196, v204
v_mul_f32 v197, v197, v204
M3 v[224:239],v[58:61],v[80:83],v[224:239]
v_mul_f32 v198, v198, v204
BL a[248:251],v27,s[32:35],s65 offen offset:1024 sc1
v_mul_f32 v199, v199, v204
v_mul_f32 v200, v200, v204
v_mul_f32 v201, v201, v204
v_mul_f32 v202, v202, v204
v_mul_f32 v203, v203, v204
CV v32,v192,v193
CV v33,v194,v195
CV v34,v196,v197
CV v35,v198,v199
CV v66,v200,v201
CV v67,v202,v203
buffer_store_dwordx4 v[32:35], v46, s[24:27], s7 offen offset:512 sc1
BL a[252:255],v27,s[32:35],s65 offen offset:2048 sc1
s_waitcnt lgkmcnt(6)
v_cndmask_b32 v54, 0, v72, s[58:59]
v_cndmask_b32 v55, 0, v73, s[58:59]
M3 v[176:191],a[152:155],v[240:243],0
TR v[78:79],v45 offset:43840
TR a[152:153],v44 offset:43840
TR a[154:155],v44 offset:44224
v_add_f32 v220, s53, v220
v_rcp_f32 v220, v220
s_nop 0
v_mul_f32 v208, v208, v220
v_mul_f32 v209, v209, v220
v_mul_f32 v210, v210, v220
v_mul_f32 v211, v211, v220
v_mul_f32 v212, v212, v220
v_mul_f32 v213, v213, v220
M3 v[176:191],v[54:57],v[84:87],v[176:191]
v_mul_f32 v214, v214, v220
v_mul_f32 v215, v215, v220
v_mul_f32 v216, v216, v220
v_mul_f32 v217, v217, v220
v_mul_f32 v218, v218, v220
v_mul_f32 v219, v219, v220
CV v36,v208,v209
CV v37,v210,v211
CV v38,v212,v213
CV v39,v214,v215
CV v68,v216,v217
CV v69,v218,v219
s_add_u32 s7, s56, 4096
buffer_store_dwordx4 v[36:39], v46, s[24:27], s7 offen sc1
s_waitcnt lgkmcnt(6)
v_cndmask_b32 v60, v74, 0, s[58:59]
v_cndmask_b32 v61, v75, 0, s[58:59]
M3 v[192:207],a[156:159],v[244:247],0
v_add_f32 v236, s53, v236
v_rcp_f32 v236, v236
s_nop 0
v_mul_f32 v224, v224, v236
v_mul_f32 v225, v225, v236
v_mul_f32 v226, v226, v236
v_mul_f32 v227, v227, v236
v_mul_f32 v228, v228, v236
v_mul_f32 v229, v229, v236
M3 v[192:207],v[60:63],v[84:87],v[192:207]
v_mul_f32 v230, v230, v236
v_mul_f32 v231, v231, v236
v_mul_f32 v232, v232, v236
v_mul_f32 v233, v233, v236
v_mul_f32 v234, v234, v236
v_mul_f32 v235, v235, v236
CV v92,v224,v225
CV v93,v226,v227
CV v94,v228,v229
CV v95,v230,v231
CV v70,v232,v233
CV v71,v234,v235
buffer_store_dwordx4 v[92:95], v46, s[24:27], s7 offen offset:512 sc1
s_waitcnt lgkmcnt(3)
v_cndmask_b32 v54, 0, v76, s[58:59]
v_cndmask_b32 v55, 0, v77, s[58:59]
M3 v[208:223],a[148:151],v[248:251],0
v_add_f32 v188, s53, v188
v_rcp_f32 v188, v188
s_nop 0
v_mul_f32 v176, v176, v188
v_mul_f32 v177, v177, v188
v_mul_f32 v178, v178, v188
v_mul_f32 v179, v179, v188
v_mul_f32 v180, v180, v188
v_mul_f32 v181, v181, v188
M3 v[208:223],v[52:55],v[84:87],v[208:223]
v_mul_f32 v182, v182, v188
v_mul_f32 v183, v183, v188
v_mul_f32 v184, v184, v188
v_mul_f32 v185, v185, v188
v_mul_f32 v186, v186, v188
v_mul_f32 v187, v187, v188
CV v240,v176,v177
CV v241,v178,v179
CV v242,v180,v181
CV v243,v182,v183
CV v72,v184,v185
CV v73,v186,v187
s_add_u32 s7, s56, 8192
buffer_store_dwordx4 v[240:243], v46, s[24:27], s7 offen sc1
s_waitcnt lgkmcnt(0)
v_cndmask_b32 v60, v78, 0, s[58:59]
v_cndmask_b32 v61, v79, 0, s[58:59]
M3 v[224:239],a[152:155],v[252:255],0
v_add_f32 v204, s53, v204
v_rcp_f32 v204, v204
s_nop 0
v_mul_f32 v192, v192, v204
v_mul_f32 v193, v193, v204
v_mul_f32 v194, v194, v204
v_mul_f32 v195, v195, v204
v_mul_f32 v196, v196, v204
v_mul_f32 v197, v197, v204
M3 v[224:239],v[58:61],v[84:87],v[224:239]
v_mul_f32 v198, v198, v204
v_mul_f32 v199, v199, v204
v_mul_f32 v200, v200, v204
v_mul_f32 v201, v201, v204
v_mul_f32 v202, v202, v204
v_mul_f32 v203, v203, v204
CV v244,v192,v193
CV v245,v194,v195
CV v246,v196,v197
CV v247,v198,v199
CV v74,v200,v201
CV v75,v202,v203
buffer_store_dwordx4 v[244:247], v46, s[24:27], s7 offen offset:512 sc1
v_add_f32 v220, s53, v220
v_rcp_f32 v220, v220
s_nop 0
v_pk_mul_f32 v[208:209], v[208:209], v[220:221] op_sel_hi:[1,0]
v_pk_mul_f32 v[210:211], v[210:211], v[220:221] op_sel_hi:[1,0]
v_pk_mul_f32 v[212:213], v[212:213], v[220:221] op_sel_hi:[1,0]
v_pk_mul_f32 v[214:215], v[214:215], v[220:221] op_sel_hi:[1,0]
v_pk_mul_f32 v[216:217], v[216:217], v[220:221] op_sel_hi:[1,0]
v_pk_mul_f32 v[218:219], v[218:219], v[220:221] op_sel_hi:[1,0]
CV v248,v208,v209
CV v249,v210,v211
CV v250,v212,v213
CV v251,v214,v215
CV v76,v216,v217
CV v77,v218,v219
s_add_u32 s7, s56, 12288
buffer_store_dwordx4 v[248:251], v46, s[24:27], s7 offen sc1
v_add_f32 v236, s53, v236
v_rcp_f32 v236, v236
s_nop 0
v_pk_mul_f32 v[224:225], v[224:225], v[236:237] op_sel_hi:[1,0]
v_pk_mul_f32 v[226:227], v[226:227], v[236:237] op_sel_hi:[1,0]
v_pk_mul_f32 v[228:229], v[228:229], v[236:237] op_sel_hi:[1,0]
v_pk_mul_f32 v[230:231], v[230:231], v[236:237] op_sel_hi:[1,0]
v_pk_mul_f32 v[232:233], v[232:233], v[236:237] op_sel_hi:[1,0]
v_pk_mul_f32 v[234:235], v[234:235], v[236:237] op_sel_hi:[1,0]
CV v252,v224,v225
CV v253,v226,v227
CV v254,v228,v229
CV v255,v230,v231
CV v78,v232,v233
CV v79,v234,v235
buffer_store_dwordx4 v[252:255], v46, s[24:27], s7 offen offset:512 sc1
s_add_u32 s7, s56, 16384
v_cndmask_b32 v80, v66, v64, s[58:59]
v_cndmask_b32 v81, v67, v65, s[58:59]
v_cndmask_b32 v82, v70, v68, s[58:59]
v_cndmask_b32 v83, v71, v69, s[58:59]
buffer_store_dwordx4 v[80:83], v46, s[24:27], s7 offen sc1
v_cndmask_b32 v84, v74, v72, s[58:59]
v_cndmask_b32 v85, v75, v73, s[58:59]
v_cndmask_b32 v86, v78, v76, s[58:59]
v_cndmask_b32 v87, v79, v77, s[58:59]
buffer_store_dwordx4 v[84:87], v46, s[24:27], s7 offen offset:512 sc1
s_barrier
s_waitcnt vmcnt(0)
buffer_store_dword v26, v20, s[24:27], s96 offen sc1
v_and_b32 v2, 1, v1
v_lshlrev_b32 v2, 2, v2
v_and_b32 v7, 2, v1
v_lshl_add_u32 v2, v7, 6, v2
s_lshl_b32 s7, s3, 8
s_add_u32 s7, s7, 1024
v_add_u32 v2, s7, v2
v_and_b32 v3, 1, v1
v_lshlrev_b32 v3, 2, v3
s_lshl_b32 s7, s3, 7
v_add_u32 v3, s7, v3
v_add_u32 v19, 512, v3
buffer_load_dword v6, v2, s[24:27], s99 offen sc1
buffer_load_dword v7, v19, s[24:27], s97 offen sc1
s_load_dwordx2 s[48:49], s[0:1], 56
s_and_b32 s7, s5, 7
s_lshl_b32 s40, s4, 1
s_lshr_b32 s7, s5, 3
s_add_u32 s40, s40, s7
s_and_b32 s7, s5, 7
s_mul_i32 s47, s40, 81920
s_mul_i32 s7, s7, 160
s_add_u32 s47, s47, s7
v_add_u32 v88, 0, v0
v_mul_u32_u24 v89, 6554, v88
v_lshrrev_b32 v89, 16, v89
v_mul_u32_u24 v90, 10, v89
v_sub_u32 v90, v88, v90
v_mul_u32_u24 v91, 1280, v89
v_lshl_add_u32 v10, v90, 4, v91
v_bfe_u32 v91, v89, 1, 2
v_lshlrev_b32 v90, 1, v90
v_xor_b32 v90, v90, v91
v_mul_u32_u24 v91, 320, v89
v_lshl_add_u32 v28, v90, 4, v91
v_xor_b32 v29, 16, v28
v_add_u32 v30, 81920, v28
v_add_u32 v31, 81920, v29
v_add_u32 v88, 256, v0
v_mul_u32_u24 v89, 6554, v88
v_lshrrev_b32 v89, 16, v89
v_mul_u32_u24 v90, 10, v89
v_sub_u32 v90, v88, v90
v_mul_u32_u24 v91, 1280, v89
v_lshl_add_u32 v11, v90, 4, v91
v_bfe_u32 v91, v89, 1, 2
v_lshlrev_b32 v90, 1, v90
v_xor_b32 v90, v90, v91
v_mul_u32_u24 v91, 320, v89
v_lshl_add_u32 v32, v90, 4, v91
v_xor_b32 v33, 16, v32
v_add_u32 v34, 81920, v32
v_add_u32 v35, 81920, v33
v_add_u32 v88, 512, v0
v_mul_u32_u24 v89, 6554, v88
v_lshrrev_b32 v89, 16, v89
v_mul_u32_u24 v90, 10, v89
v_sub_u32 v90, v88, v90
v_mul_u32_u24 v91, 1280, v89
v_lshl_add_u32 v12, v90, 4, v91
v_bfe_u32 v91, v89, 1, 2
v_lshlrev_b32 v90, 1, v90
v_xor_b32 v90, v90, v91
v_mul_u32_u24 v91, 320, v89
v_lshl_add_u32 v36, v90, 4, v91
v_xor_b32 v37, 16, v36
v_add_u32 v38, 81920, v36
v_add_u32 v39, 81920, v37
v_mov_b32 v91, 1073741824
v_cmp_gt_u32 vcc, 128, v0
s_nop 1
v_cndmask_b32 v12, v91, v12, vcc
v_and_b32 v88, 15, v1
v_bfe_u32 v90, v1, 1, 2
v_mul_u32_u24 v88, 320, v88
v_lshrrev_b32 v89, 4, v1
v_xor_b32 v89, v89, v90
v_lshl_add_u32 v88, v89, 4, v88
v_add_u32 v9, s6, v88
v_add_u32 v8, s6, v27
s_waitcnt lgkmcnt(0)
s_mov_b32 s12, s48
s_mov_b32 s13, s49
s_mov_b32 s14, 2621440
s_mov_b32 s15, 0x20000
M1 v[176:179],a[160:163],v[96:99],0
M1 v[192:195],a[164:167],v[96:99],0
s_add_u32 m0, s6, 20480
s_bfe_u32 s65, s71, 0x80000
s_mul_i32 s65, s65, 40960
BL v27,s[32:35],s65 offen sc1 lds
M1 v[208:211],a[168:171],v[96:99],0
M1 v[224:227],a[172:175],v[96:99],0
BL v27,s[32:35],s65 offen offset:1024 sc1 lds
M1 v[240:243],a[176:179],v[96:99],0
M1 v[180:183],a[160:163],v[100:103],0
M1 v[196:199],a[164:167],v[100:103],0
BL v27,s[32:35],s65 offen offset:2048 sc1 lds
M1 v[212:215],a[168:171],v[100:103],0
M1 v[228:231],a[172:175],v[100:103],0
BL v27,s[32:35],s65 offen offset:3072 sc1 lds
M1 v[244:247],a[176:179],v[100:103],0
M1 v[184:187],a[160:163],v[104:107],0
M1 v[200:203],a[164:167],v[104:107],0
s_add_u32 m0, s6, 24576
s_nop 0
BL v25,s[32:35],s65 offen sc1 lds
M1 v[216:219],a[168:171],v[104:107],0
M1 v[232:235],a[172:175],v[104:107],0
M1 v[248:251],a[176:179],v[104:107],0
M1 v[188:191],a[160:163],v[108:111],0
M1 v[204:207],a[164:167],v[108:111],0
M1 v[220:223],a[168:171],v[108:111],0
M1 v[236:239],a[172:175],v[108:111],0
M1 v[252:255],a[176:179],v[108:111],0
s_waitcnt vmcnt(6)
P2_KVQ_E_chk:
v_cmp_ne_u32 vcc, v6, v26
s_nop 0
s_cmp_eq_u64 vcc, 0
s_cbranch_scc1 P2_KVQ_E_ok
s_cmp_eq_u32 s101, 0
s_cbranch_scc1 P2_KVQ_E_ok
s_sub_u32 s101, s101, 1
s_sleep 10
buffer_load_dword v6, v2, s[24:27], s99 offen sc1
s_waitcnt vmcnt(0)
s_branch P2_KVQ_E_chk
P2_KVQ_E_ok:
M1 v[176:179],a[180:183],v[112:115],v[176:179]
M1 v[192:195],a[184:187],v[112:115],v[192:195]
s_bfe_u32 s41, s88, 0x80000
s_mul_i32 s41, s41, 4096
BL a[80:83],v27,s[36:39],s41 offen sc1
M1 v[208:211],a[188:191],v[112:115],v[208:211]
M1 v[224:227],a[192:195],v[112:115],v[224:227]
BL a[84:87],v27,s[36:39],s41 offen offset:1024 sc1
M1 v[240:243],a[196:199],v[112:115],v[240:243]
M1 v[180:183],a[180:183],v[116:119],v[180:183]
M1 v[196:199],a[184:187],v[116:119],v[196:199]
BL a[88:91],v27,s[36:39],s41 offen offset:2048 sc1
M1 v[212:215],a[188:191],v[116:119],v[212:215]
M1 v[228:231],a[192:195],v[116:119],v[228:231]
BL a[92:95],v27,s[36:39],s41 offen offset:3072 sc1
M1 v[244:247],a[196:199],v[116:119],v[244:247]
M1 v[184:187],a[180:183],v[120:123],v[184:187]
M1 v[200:203],a[184:187],v[120:123],v[200:203]
s_bfe_u32 s41, s88, 0x80008
s_mul_i32 s41, s41, 4096
BL a[96:99],v27,s[36:39],s41 offen sc1
M1 v[216:219],a[188:191],v[120:123],v[216:219]
M1 v[232:235],a[192:195],v[120:123],v[232:235]
BL a[100:103],v27,s[36:39],s41 offen offset:1024 sc1
M1 v[248:251],a[196:199],v[120:123],v[248:251]
M1 v[188:191],a[180:183],v[124:127],v[188:191]
M1 v[204:207],a[184:187],v[124:127],v[204:207]
BL a[104:107],v27,s[36:39],s41 offen offset:2048 sc1
M1 v[220:223],a[188:191],v[124:127],v[220:223]
M1 v[236:239],a[192:195],v[124:127],v[236:239]
BL a[108:111],v27,s[36:39],s41 offen offset:3072 sc1
M1 v[252:255],a[196:199],v[124:127],v[252:255]
s_bfe_u32 s41, s88, 0x80010
s_mul_i32 s41, s41, 4096
BL a[112:115],v27,s[36:39],s41 offen sc1
BL a[116:119],v27,s[36:39],s41 offen offset:1024 sc1
BL a[120:123],v27,s[36:39],s41 offen offset:2048 sc1
BL a[124:127],v27,s[36:39],s41 offen offset:3072 sc1
s_bfe_u32 s41, s88, 0x80018
s_mul_i32 s41, s41, 4096
BL a[128:131],v27,s[36:39],s41 offen sc1
BL a[132:135],v27,s[36:39],s41 offen offset:1024 sc1
BL a[136:139],v27,s[36:39],s41 offen offset:2048 sc1
BL a[140:143],v27,s[36:39],s41 offen offset:3072 sc1
s_bfe_u32 s65, s71, 0x80010
s_mul_i32 s65, s65, 40960
BL v[160:163],v27,s[32:35],s65 offen offset:3072 sc1
BL v[164:167],v25,s[32:35],s65 offen sc1
s_bfe_u32 s65, s71, 0x80018
s_mul_i32 s65, s65, 40960
BL v[168:171],v27,s[32:35],s65 offen sc1
BL v[172:175],v27,s[32:35],s65 offen offset:1024 sc1
BL a[144:147],v27,s[32:35],s65 offen offset:2048 sc1
s_waitcnt vmcnt(26)
P2_KVQ_K_chk:
v_cmp_ne_u32 vcc, v7, v26
s_nop 0
s_cmp_eq_u64 vcc, 0
s_cbranch_scc1 P2_KVQ_K_ok
s_cmp_eq_u32 s101, 0
s_cbranch_scc1 P2_KVQ_K_ok
s_sub_u32 s101, s101, 1
s_sleep 10
buffer_load_dword v7, v19, s[24:27], s97 offen sc1
s_waitcnt vmcnt(0)
s_branch P2_KVQ_K_chk
P2_KVQ_K_ok:
M1 v[176:179],a[200:203],v[128:131],v[176:179]
M1 v[192:195],a[204:207],v[128:131],v[192:195]
ds_read_b128 v[64:67], v8 offset:33792
M1 v[208:211],a[208:211],v[128:131],v[208:211]
M1 v[224:227],a[212:215],v[128:131],v[224:227]
ds_read_b128 v[68:71], v8 offset:34816
M1 v[240:243],a[216:219],v[128:131],v[240:243]
M1 v[180:183],a[200:203],v[132:135],v[180:183]
M1 v[196:199],a[204:207],v[132:135],v[196:199]
ds_read_b128 v[72:75], v8 offset:35840
M1 v[212:215],a[208:211],v[132:135],v[212:215]
M1 v[228:231],a[212:215],v[132:135],v[228:231]
ds_read_b128 v[76:79], v8 offset:36864
M1 v[244:247],a[216:219],v[132:135],v[244:247]
M1 v[184:187],a[200:203],v[136:139],v[184:187]
M1 v[200:203],a[204:207],v[136:139],v[200:203]
s_bfe_u32 s41, s70, 0x80000
s_mul_i32 s41, s41, 4096
BL a[160:163],v27,s[36:39],s41 offen sc1
M1 v[216:219],a[208:211],v[136:139],v[216:219]
M1 v[232:235],a[212:215],v[136:139],v[232:235]
BL a[164:167],v27,s[36:39],s41 offen offset:1024 sc1
M1 v[248:251],a[216:219],v[136:139],v[248:251]
M1 v[188:191],a[200:203],v[140:143],v[188:191]
M1 v[204:207],a[204:207],v[140:143],v[204:207]
BL a[168:171],v27,s[36:39],s41 offen offset:2048 sc1
M1 v[220:223],a[208:211],v[140:143],v[220:223]
M1 v[236:239],a[212:215],v[140:143],v[236:239]
BL a[172:175],v27,s[36:39],s41 offen offset:3072 sc1
M1 v[252:255],a[216:219],v[140:143],v[252:255]
s_bfe_u32 s41, s70, 0x80008
s_mul_i32 s41, s41, 4096
BL a[176:179],v27,s[36:39],s41 offen sc1
BL a[180:183],v27,s[36:39],s41 offen offset:1024 sc1
BL a[184:187],v27,s[36:39],s41 offen offset:2048 sc1
BL a[188:191],v27,s[36:39],s41 offen offset:3072 sc1
buffer_load_dword v4, v2, s[24:27], s97 offen sc1
BL a[148:151],v27,s[32:35],s65 offen offset:3072 sc1
BL a[152:155],v25,s[32:35],s65 offen sc1
s_bfe_u32 s65, s70, 0x80010
s_mul_i32 s65, s65, 40960
BL a[156:159],v27,s[32:35],s65 offen sc1
M1 v[176:179],a[220:223],v[144:147],v[176:179]
s_waitcnt lgkmcnt(3)
M1 v[192:195],v[64:67],v[144:147],v[192:195]
ds_read_b128 v[40:43], v8 offset:37888
s_waitcnt lgkmcnt(3)
M1 v[208:211],v[68:71],v[144:147],v[208:211]
s_waitcnt lgkmcnt(2)
M1 v[224:227],v[72:75],v[144:147],v[224:227]
ds_read_b128 v[44:47], v8 offset:38912
s_waitcnt lgkmcnt(2)
M1 v[240:243],v[76:79],v[144:147],v[240:243]
M1 v[180:183],a[220:223],v[148:151],v[180:183]
M1 v[196:199],v[64:67],v[148:151],v[196:199]
ds_read_b128 v[48:51], v8 offset:39936
M1 v[212:215],v[68:71],v[148:151],v[212:215]
M1 v[228:231],v[72:75],v[148:151],v[228:231]
M1 v[244:247],v[76:79],v[148:151],v[244:247]
M1 v[184:187],a[220:223],v[152:155],v[184:187]
M1 v[200:203],v[64:67],v[152:155],v[200:203]
M1 v[216:219],v[68:71],v[152:155],v[216:219]
M1 v[232:235],v[72:75],v[152:155],v[232:235]
M1 v[248:251],v[76:79],v[152:155],v[248:251]
M1 v[188:191],a[220:223],v[156:159],v[188:191]
M1 v[204:207],v[64:67],v[156:159],v[204:207]
M1 v[220:223],v[68:71],v[156:159],v[220:223]
M1 v[236:239],v[72:75],v[156:159],v[236:239]
M1 v[252:255],v[76:79],v[156:159],v[252:255]
s_waitcnt vmcnt(3)
P2_KVQ_L_chk:
v_cmp_ne_u32 vcc, v4, v26
s_nop 0
s_cmp_eq_u64 vcc, 0
s_cbranch_scc1 P2_KVQ_L_ok
s_cmp_eq_u32 s101, 0
s_cbranch_scc1 P2_KVQ_L_ok
s_sub_u32 s101, s101, 1
s_sleep 10
buffer_load_dword v4, v2, s[24:27], s97 offen sc1
s_waitcnt vmcnt(0)
s_branch P2_KVQ_L_chk
P2_KVQ_L_ok:
s_waitcnt lgkmcnt(2)
M1 v[176:179],v[40:43],a[80:83],v[176:179]
s_waitcnt lgkmcnt(1)
M1 v[192:195],v[44:47],a[80:83],v[192:195]
ds_read_b128 v[68:71], v8 offset:25600
s_waitcnt lgkmcnt(1)
M1 v[208:211],v[48:51],a[80:83],v[208:211]
M1 v[224:227],a[64:67],a[80:83],v[224:227]
ds_read_b128 v[72:75], v8 offset:26624
M1 v[240:243],a[68:71],a[80:83],v[240:243]
M1 v[180:183],v[40:43],a[84:87],v[180:183]
M1 v[196:199],v[44:47],a[84:87],v[196:199]
ds_read_b128 v[76:79], v8 offset:27648
M1 v[212:215],v[48:51],a[84:87],v[212:215]
M1 v[228:231],a[64:67],a[84:87],v[228:231]
s_bfe_u32 s41, s89, 0x80000
s_mul_i32 s41, s41, 4096
BL v[96:99],v27,s[36:39],s41 offen sc1
M1 v[244:247],a[68:71],a[84:87],v[244:247]
M1 v[184:187],v[40:43],a[88:91],v[184:187]
M1 v[200:203],v[44:47],a[88:91],v[200:203]
BL v[100:103],v27,s[36:39],s41 offen offset:1024 sc1
M1 v[216:219],v[48:51],a[88:91],v[216:219]
M1 v[232:235],a[64:67],a[88:91],v[232:235]
BL v[104:107],v27,s[36:39],s41 offen offset:2048 sc1
M1 v[248:251],a[68:71],a[88:91],v[248:251]
M1 v[188:191],v[40:43],a[92:95],v[188:191]
M1 v[204:207],v[44:47],a[92:95],v[204:207]
BL v[108:111],v27,s[36:39],s41 offen offset:3072 sc1
M1 v[220:223],v[48:51],a[92:95],v[220:223]
M1 v[236:239],a[64:67],a[92:95],v[236:239]
s_bfe_u32 s41, s89, 0x80008
s_mul_i32 s41, s41, 4096
BL v[112:115],v27,s[36:39],s41 offen sc1
M1 v[252:255],a[68:71],a[92:95],v[252:255]
BL v[116:119],v27,s[36:39],s41 offen offset:1024 sc1
BL v[120:123],v27,s[36:39],s41 offen offset:2048 sc1
BL v[124:127],v27,s[36:39],s41 offen offset:3072 sc1
s_bfe_u32 s41, s89, 0x80010
s_mul_i32 s41, s41, 4096
BL v[128:131],v27,s[36:39],s41 offen sc1
BL v[132:135],v27,s[36:39],s41 offen offset:1024 sc1
BL v[136:139],v27,s[36:39],s41 offen offset:2048 sc1
BL v[140:143],v27,s[36:39],s41 offen offset:3072 sc1
s_bfe_u32 s41, s89, 0x80018
s_mul_i32 s41, s41, 4096
BL v[144:147],v27,s[36:39],s41 offen sc1
BL v[148:151],v27,s[36:39],s41 offen offset:1024 sc1
BL v[152:155],v27,s[36:39],s41 offen offset:2048 sc1
BL v[156:159],v27,s[36:39],s41 offen offset:3072 sc1
BL a[208:211],v27,s[32:35],s65 offen offset:1024 sc1
BL a[212:215],v27,s[32:35],s65 offen offset:2048 sc1
BL a[216:219],v27,s[32:35],s65 offen offset:3072 sc1
BL a[220:223],v25,s[32:35],s65 offen sc1
M1 v[176:179],a[72:75],a[96:99],v[176:179]
M1 v[192:195],a[76:79],a[96:99],v[192:195]
ds_read_b128 v[40:43], v8 offset:28672
s_waitcnt lgkmcnt(3)
M1 v[208:211],v[68:71],a[96:99],v[208:211]
s_waitcnt lgkmcnt(2)
M1 v[224:227],v[72:75],a[96:99],v[224:227]
ds_read_b128 v[44:47], v8 offset:29696
s_waitcnt lgkmcnt(2)
M1 v[240:243],v[76:79],a[96:99],v[240:243]
M1 v[180:183],a[72:75],a[100:103],v[180:183]
M1 v[196:199],a[76:79],a[100:103],v[196:199]
ds_read_b128 v[48:51], v8 offset:30720
M1 v[212:215],v[68:71],a[100:103],v[212:215]
M1 v[228:231],v[72:75],a[100:103],v[228:231]
ds_read_b128 v[52:55], v8 offset:31744
M1 v[244:247],v[76:79],a[100:103],v[244:247]
M1 v[184:187],a[72:75],a[104:107],v[184:187]
M1 v[200:203],a[76:79],a[104:107],v[200:203]
ds_read_b128 v[56:59], v8 offset:32768
M1 v[216:219],v[68:71],a[104:107],v[216:219]
M1 v[232:235],v[72:75],a[104:107],v[232:235]
M1 v[248:251],v[76:79],a[104:107],v[248:251]
M1 v[188:191],a[72:75],a[108:111],v[188:191]
M1 v[204:207],a[76:79],a[108:111],v[204:207]
M1 v[220:223],v[68:71],a[108:111],v[220:223]
M1 v[236:239],v[72:75],a[108:111],v[236:239]
M1 v[252:255],v[76:79],a[108:111],v[252:255]
s_waitcnt lgkmcnt(4)
M1 v[176:179],v[40:43],a[112:115],v[176:179]
s_waitcnt lgkmcnt(3)
M1 v[192:195],v[44:47],a[112:115],v[192:195]
s_waitcnt lgkmcnt(2)
M1 v[208:211],v[48:51],a[112:115],v[208:211]
s_waitcnt lgkmcnt(1)
M1 v[224:227],v[52:55],a[112:115],v[224:227]
s_waitcnt lgkmcnt(0)
M1 v[240:243],v[56:59],a[112:115],v[240:243]
M1 v[180:183],v[40:43],a[116:119],v[180:183]
M1 v[196:199],v[44:47],a[116:119],v[196:199]
M1 v[212:215],v[48:51],a[116:119],v[212:215]
M1 v[228:231],v[52:55],a[116:119],v[228:231]
M1 v[244:247],v[56:59],a[116:119],v[244:247]
M1 v[184:187],v[40:43],a[120:123],v[184:187]
M1 v[200:203],v[44:47],a[120:123],v[200:203]
M1 v[216:219],v[48:51],a[120:123],v[216:219]
M1 v[232:235],v[52:55],a[120:123],v[232:235]
M1 v[248:251],v[56:59],a[120:123],v[248:251]
M1 v[188:191],v[40:43],a[124:127],v[188:191]
M1 v[204:207],v[44:47],a[124:127],v[204:207]
M1 v[220:223],v[48:51],a[124:127],v[220:223]
M1 v[236:239],v[52:55],a[124:127],v[236:239]
M1 v[252:255],v[56:59],a[124:127],v[252:255]
M1 v[176:179],a[0:3],a[128:131],v[176:179]
M1 v[192:195],a[4:7],a[128:131],v[192:195]
M1 v[208:211],a[8:11],a[128:131],v[208:211]
M1 v[224:227],a[12:15],a[128:131],v[224:227]
M1 v[240:243],a[16:19],a[128:131],v[240:243]
M1 v[180:183],a[0:3],a[132:135],v[180:183]
M1 v[196:199],a[4:7],a[132:135],v[196:199]
M1 v[212:215],a[8:11],a[132:135],v[212:215]
M1 v[228:231],a[12:15],a[132:135],v[228:231]
M1 v[244:247],a[16:19],a[132:135],v[244:247]
M1 v[184:187],a[0:3],a[136:139],v[184:187]
M1 v[200:203],a[4:7],a[136:139],v[200:203]
M1 v[216:219],a[8:11],a[136:139],v[216:219]
M1 v[232:235],a[12:15],a[136:139],v[232:235]
M1 v[248:251],a[16:19],a[136:139],v[248:251]
M1 v[188:191],a[0:3],a[140:143],v[188:191]
M1 v[204:207],a[4:7],a[140:143],v[204:207]
M1 v[220:223],a[8:11],a[140:143],v[220:223]
M1 v[236:239],a[12:15],a[140:143],v[236:239]
M1 v[252:255],a[16:19],a[140:143],v[252:255]
M1 v[176:179],a[20:23],a[160:163],v[176:179]
M1 v[192:195],a[24:27],a[160:163],v[192:195]
M1 v[208:211],a[28:31],a[160:163],v[208:211]
M1 v[224:227],a[32:35],a[160:163],v[224:227]
M1 v[240:243],a[36:39],a[160:163],v[240:243]
M1 v[180:183],a[20:23],a[164:167],v[180:183]
M1 v[196:199],a[24:27],a[164:167],v[196:199]
M1 v[212:215],a[28:31],a[164:167],v[212:215]
M1 v[228:231],a[32:35],a[164:167],v[228:231]
M1 v[244:247],a[36:39],a[164:167],v[244:247]
M1 v[184:187],a[20:23],a[168:171],v[184:187]
M1 v[200:203],a[24:27],a[168:171],v[200:203]
M1 v[216:219],a[28:31],a[168:171],v[216:219]
M1 v[232:235],a[32:35],a[168:171],v[232:235]
M1 v[248:251],a[36:39],a[168:171],v[248:251]
M1 v[188:191],a[20:23],a[172:175],v[188:191]
M1 v[204:207],a[24:27],a[172:175],v[204:207]
M1 v[220:223],a[28:31],a[172:175],v[220:223]
M1 v[236:239],a[32:35],a[172:175],v[236:239]
M1 v[252:255],a[36:39],a[172:175],v[252:255]
M1 v[176:179],a[40:43],a[176:179],v[176:179]
M1 v[192:195],a[44:47],a[176:179],v[192:195]
ds_read_b128 v[40:43], v8
M1 v[208:211],a[48:51],a[176:179],v[208:211]
M1 v[224:227],a[52:55],a[176:179],v[224:227]
ds_read_b128 v[44:47], v8 offset:1024
M1 v[240:243],a[56:59],a[176:179],v[240:243]
M1 v[180:183],a[40:43],a[180:183],v[180:183]
M1 v[196:199],a[44:47],a[180:183],v[196:199]
ds_read_b128 v[48:51], v8 offset:2048
M1 v[212:215],a[48:51],a[180:183],v[212:215]
M1 v[228:231],a[52:55],a[180:183],v[228:231]
ds_read_b128 v[52:55], v8 offset:3072
M1 v[244:247],a[56:59],a[180:183],v[244:247]
M1 v[184:187],a[40:43],a[184:187],v[184:187]
M1 v[200:203],a[44:47],a[184:187],v[200:203]
ds_read_b128 v[56:59], v8 offset:4096
M1 v[216:219],a[48:51],a[184:187],v[216:219]
M1 v[232:235],a[52:55],a[184:187],v[232:235]
M1 v[248:251],a[56:59],a[184:187],v[248:251]
M1 v[188:191],a[40:43],a[188:191],v[188:191]
M1 v[204:207],a[44:47],a[188:191],v[204:207]
M1 v[220:223],a[48:51],a[188:191],v[220:223]
M1 v[236:239],a[52:55],a[188:191],v[236:239]
M1 v[252:255],a[56:59],a[188:191],v[252:255]
s_waitcnt vmcnt(19)
s_waitcnt lgkmcnt(4)
M1 v[176:179],v[40:43],v[96:99],v[176:179]
s_waitcnt lgkmcnt(3)
M1 v[192:195],v[44:47],v[96:99],v[192:195]
ds_read_b128 v[60:63], v8 offset:5120
s_waitcnt lgkmcnt(3)
M1 v[208:211],v[48:51],v[96:99],v[208:211]
s_waitcnt lgkmcnt(2)
M1 v[224:227],v[52:55],v[96:99],v[224:227]
ds_read_b128 v[64:67], v8 offset:6144
s_waitcnt lgkmcnt(2)
M1 v[240:243],v[56:59],v[96:99],v[240:243]
s_waitcnt vmcnt(18)
M1 v[180:183],v[40:43],v[100:103],v[180:183]
M1 v[196:199],v[44:47],v[100:103],v[196:199]
ds_read_b128 v[68:71], v8 offset:7168
M1 v[212:215],v[48:51],v[100:103],v[212:215]
M1 v[228:231],v[52:55],v[100:103],v[228:231]
ds_read_b128 v[72:75], v8 offset:8192
M1 v[244:247],v[56:59],v[100:103],v[244:247]
s_waitcnt vmcnt(17)
M1 v[184:187],v[40:43],v[104:107],v[184:187]
M1 v[200:203],v[44:47],v[104:107],v[200:203]
ds_read_b128 v[76:79], v8 offset:9216
M1 v[216:219],v[48:51],v[104:107],v[216:219]
M1 v[232:235],v[52:55],v[104:107],v[232:235]
BL v[80:83],v10,s[8:11],s47 offen
M1 v[248:251],v[56:59],v[104:107],v[248:251]
s_waitcnt vmcnt(17)
M1 v[188:191],v[40:43],v[108:111],v[188:191]
M1 v[204:207],v[44:47],v[108:111],v[204:207]
BL v[84:87],v11,s[8:11],s47 offen
M1 v[220:223],v[48:51],v[108:111],v[220:223]
M1 v[236:239],v[52:55],v[108:111],v[236:239]
BL v[88:91],v12,s[8:11],s47 offen
M1 v[252:255],v[56:59],v[108:111],v[252:255]
buffer_load_dword v5, v3, s[24:27], s97 offen sc1
s_waitcnt vmcnt(19)
s_waitcnt lgkmcnt(4)
M1 v[176:179],v[60:63],v[112:115],v[176:179]
s_waitcnt lgkmcnt(3)
M1 v[192:195],v[64:67],v[112:115],v[192:195]
ds_read_b128 v[40:43], v8 offset:10240
s_waitcnt lgkmcnt(3)
M1 v[208:211],v[68:71],v[112:115],v[208:211]
s_waitcnt lgkmcnt(2)
M1 v[224:227],v[72:75],v[112:115],v[224:227]
ds_read_b128 v[44:47], v8 offset:11264
s_waitcnt lgkmcnt(2)
M1 v[240:243],v[76:79],v[112:115],v[240:243]
s_waitcnt vmcnt(18)
M1 v[180:183],v[60:63],v[116:119],v[180:183]
M1 v[196:199],v[64:67],v[116:119],v[196:199]
ds_read_b128 v[48:51], v8 offset:12288
M1 v[212:215],v[68:71],v[116:119],v[212:215]
M1 v[228:231],v[72:75],v[116:119],v[228:231]
ds_read_b128 v[52:55], v8 offset:13312
M1 v[244:247],v[76:79],v[116:119],v[244:247]
s_waitcnt vmcnt(17)
M1 v[184:187],v[60:63],v[120:123],v[184:187]
M1 v[200:203],v[64:67],v[120:123],v[200:203]
ds_read_b128 v[56:59], v8 offset:14336
M1 v[216:219],v[68:71],v[120:123],v[216:219]
M1 v[232:235],v[72:75],v[120:123],v[232:235]
M1 v[248:251],v[76:79],v[120:123],v[248:251]
s_waitcnt vmcnt(16)
M1 v[188:191],v[60:63],v[124:127],v[188:191]
M1 v[204:207],v[64:67],v[124:127],v[204:207]
M1 v[220:223],v[68:71],v[124:127],v[220:223]
M1 v[236:239],v[72:75],v[124:127],v[236:239]
M1 v[252:255],v[76:79],v[124:127],v[252:255]
s_waitcnt vmcnt(0)
P2_KVQ_O_chk:
v_cmp_ne_u32 vcc, v5, v26
s_nop 0
s_cmp_eq_u64 vcc, 0
s_cbranch_scc1 P2_KVQ_O_ok
s_cmp_eq_u32 s101, 0
s_cbranch_scc1 P2_KVQ_O_ok
s_sub_u32 s101, s101, 1
s_sleep 4
buffer_load_dword v5, v3, s[24:27], s97 offen sc1
s_waitcnt vmcnt(0)
s_branch P2_KVQ_O_chk
P2_KVQ_O_ok:
s_waitcnt lgkmcnt(4)
M1 v[176:179],v[40:43],v[128:131],v[176:179]
s_waitcnt lgkmcnt(3)
M1 v[192:195],v[44:47],v[128:131],v[192:195]
ds_read_b128 v[60:63], v8 offset:15360
s_waitcnt lgkmcnt(3)
M1 v[208:211],v[48:51],v[128:131],v[208:211]
s_waitcnt lgkmcnt(2)
M1 v[224:227],v[52:55],v[128:131],v[224:227]
ds_read_b128 v[64:67], v8 offset:16384
s_waitcnt lgkmcnt(2)
M1 v[240:243],v[56:59],v[128:131],v[240:243]
M1 v[180:183],v[40:43],v[132:135],v[180:183]
M1 v[196:199],v[44:47],v[132:135],v[196:199]
ds_read_b128 v[68:71], v8 offset:17408
M1 v[212:215],v[48:51],v[132:135],v[212:215]
M1 v[228:231],v[52:55],v[132:135],v[228:231]
ds_read_b128 v[72:75], v8 offset:18432
M1 v[244:247],v[56:59],v[132:135],v[244:247]
M1 v[184:187],v[40:43],v[136:139],v[184:187]
M1 v[200:203],v[44:47],v[136:139],v[200:203]
ds_read_b128 v[76:79], v8 offset:19456
M1 v[216:219],v[48:51],v[136:139],v[216:219]
M1 v[232:235],v[52:55],v[136:139],v[232:235]
s_bfe_u32 s41, s71, 0x80000
s_mul_i32 s41, s41, 4096
BL a[80:83],v27,s[36:39],s41 offen sc1
M1 v[248:251],v[56:59],v[136:139],v[248:251]
M1 v[188:191],v[40:43],v[140:143],v[188:191]
M1 v[204:207],v[44:47],v[140:143],v[204:207]
BL a[84:87],v27,s[36:39],s41 offen offset:1024 sc1
M1 v[220:223],v[48:51],v[140:143],v[220:223]
M1 v[236:239],v[52:55],v[140:143],v[236:239]
BL a[88:91],v27,s[36:39],s41 offen offset:2048 sc1
M1 v[252:255],v[56:59],v[140:143],v[252:255]
BL a[92:95],v27,s[36:39],s41 offen offset:3072 sc1
s_bfe_u32 s41, s71, 0x80008
s_mul_i32 s41, s41, 4096
BL a[96:99],v27,s[36:39],s41 offen sc1
BL a[100:103],v27,s[36:39],s41 offen offset:1024 sc1
BL a[104:107],v27,s[36:39],s41 offen offset:2048 sc1
BL a[108:111],v27,s[36:39],s41 offen offset:3072 sc1
s_bfe_u32 s41, s71, 0x80010
s_mul_i32 s41, s41, 4096
BL a[112:115],v27,s[36:39],s41 offen sc1
BL a[116:119],v27,s[36:39],s41 offen offset:1024 sc1
BL a[120:123],v27,s[36:39],s41 offen offset:2048 sc1
BL a[124:127],v27,s[36:39],s41 offen offset:3072 sc1
s_bfe_u32 s41, s71, 0x80018
s_mul_i32 s41, s41, 4096
BL a[128:131],v27,s[36:39],s41 offen sc1
BL a[132:135],v27,s[36:39],s41 offen offset:1024 sc1
BL a[136:139],v27,s[36:39],s41 offen offset:2048 sc1
BL a[140:143],v27,s[36:39],s41 offen offset:3072 sc1
s_bfe_u32 s41, s70, 0x80010
s_mul_i32 s41, s41, 4096
BL a[192:195],v27,s[36:39],s41 offen sc1
BL a[196:199],v27,s[36:39],s41 offen offset:1024 sc1
BL a[200:203],v27,s[36:39],s41 offen offset:2048 sc1
BL a[204:207],v27,s[36:39],s41 offen offset:3072 sc1
s_waitcnt lgkmcnt(4)
M1 v[176:179],v[60:63],v[144:147],v[176:179]
s_waitcnt lgkmcnt(3)
M1 v[192:195],v[64:67],v[144:147],v[192:195]
ds_read_b128 v[40:43], v8 offset:20480
s_waitcnt lgkmcnt(3)
M1 v[208:211],v[68:71],v[144:147],v[208:211]
s_waitcnt lgkmcnt(2)
M1 v[224:227],v[72:75],v[144:147],v[224:227]
ds_read_b128 v[44:47], v8 offset:21504
s_waitcnt lgkmcnt(2)
M1 v[240:243],v[76:79],v[144:147],v[240:243]
M1 v[180:183],v[60:63],v[148:151],v[180:183]
M1 v[196:199],v[64:67],v[148:151],v[196:199]
ds_read_b128 v[48:51], v8 offset:22528
M1 v[212:215],v[68:71],v[148:151],v[212:215]
M1 v[228:231],v[72:75],v[148:151],v[228:231]
ds_read_b128 v[52:55], v8 offset:23552
M1 v[244:247],v[76:79],v[148:151],v[244:247]
M1 v[184:187],v[60:63],v[152:155],v[184:187]
M1 v[200:203],v[64:67],v[152:155],v[200:203]
ds_read_b128 v[56:59], v8 offset:24576
M1 v[216:219],v[68:71],v[152:155],v[216:219]
M1 v[232:235],v[72:75],v[152:155],v[232:235]
M1 v[248:251],v[76:79],v[152:155],v[248:251]
M1 v[188:191],v[60:63],v[156:159],v[188:191]
M1 v[204:207],v[64:67],v[156:159],v[204:207]
M1 v[220:223],v[68:71],v[156:159],v[220:223]
M1 v[236:239],v[72:75],v[156:159],v[236:239]
M1 v[252:255],v[76:79],v[156:159],v[252:255]
s_waitcnt vmcnt(19)
s_waitcnt lgkmcnt(4)
M1 a[0:3],v[40:43],a[80:83],0
s_waitcnt lgkmcnt(3)
M1 a[16:19],v[44:47],a[80:83],0
s_waitcnt lgkmcnt(2)
M1 a[32:35],v[48:51],a[80:83],0
s_waitcnt lgkmcnt(1)
M1 a[48:51],v[52:55],a[80:83],0
s_waitcnt lgkmcnt(0)
M1 a[64:67],v[56:59],a[80:83],0
s_waitcnt vmcnt(18)
M1 a[4:7],v[40:43],a[84:87],0
M1 a[20:23],v[44:47],a[84:87],0
M1 a[36:39],v[48:51],a[84:87],0
M1 a[52:55],v[52:55],a[84:87],0
M1 a[68:71],v[56:59],a[84:87],0
s_waitcnt vmcnt(17)
M1 a[8:11],v[40:43],a[88:91],0
M1 a[24:27],v[44:47],a[88:91],0
ds_write_b128 v9, v[176:179]
M1 a[40:43],v[48:51],a[88:91],0
M1 a[56:59],v[52:55],a[88:91],0
ds_write_b128 v9, v[180:183] offset:5120
M1 a[72:75],v[56:59],a[88:91],0
s_waitcnt vmcnt(16)
M1 a[12:15],v[40:43],a[92:95],0
M1 a[28:31],v[44:47],a[92:95],0
ds_write_b128 v9, v[184:187] offset:10240
M1 a[44:47],v[48:51],a[92:95],0
M1 a[60:63],v[52:55],a[92:95],0
ds_write_b128 v9, v[188:191] offset:15360
M1 a[76:79],v[56:59],a[92:95],0
s_waitcnt vmcnt(15)
M1 a[0:3],a[224:227],a[96:99],a[0:3]
M1 a[16:19],a[228:231],a[96:99],a[16:19]
ds_write_b128 v9, v[192:195] offset:64
M1 a[32:35],a[232:235],a[96:99],a[32:35]
M1 a[48:51],a[236:239],a[96:99],a[48:51]
ds_write_b128 v9, v[196:199] offset:5184
M1 a[64:67],a[240:243],a[96:99],a[64:67]
s_waitcnt vmcnt(14)
M1 a[4:7],a[224:227],a[100:103],a[4:7]
M1 a[20:23],a[228:231],a[100:103],a[20:23]
ds_write_b128 v9, v[200:203] offset:10304
M1 a[36:39],a[232:235],a[100:103],a[36:39]
M1 a[52:55],a[236:239],a[100:103],a[52:55]
ds_write_b128 v9, v[204:207] offset:15424
M1 a[68:71],a[240:243],a[100:103],a[68:71]
s_waitcnt vmcnt(13)
M1 a[8:11],a[224:227],a[104:107],a[8:11]
M1 a[24:27],a[228:231],a[104:107],a[24:27]
ds_write_b128 v9, v[208:211] offset:128
M1 a[40:43],a[232:235],a[104:107],a[40:43]
M1 a[56:59],a[236:239],a[104:107],a[56:59]
ds_write_b128 v9, v[212:215] offset:5248
M1 a[72:75],a[240:243],a[104:107],a[72:75]
s_waitcnt vmcnt(12)
M1 a[12:15],a[224:227],a[108:111],a[12:15]
M1 a[28:31],a[228:231],a[108:111],a[28:31]
ds_write_b128 v9, v[216:219] offset:10368
M1 a[44:47],a[232:235],a[108:111],a[44:47]
M1 a[60:63],a[236:239],a[108:111],a[60:63]
ds_write_b128 v9, v[220:223] offset:15488
M1 a[76:79],a[240:243],a[108:111],a[76:79]
s_waitcnt vmcnt(11)
M1 a[0:3],a[244:247],a[112:115],a[0:3]
M1 a[16:19],a[248:251],a[112:115],a[16:19]
ds_write_b128 v9, v[224:227] offset:192
M1 a[32:35],a[252:255],a[112:115],a[32:35]
M1 a[48:51],v[160:163],a[112:115],a[48:51]
ds_write_b128 v9, v[228:231] offset:5312
M1 a[64:67],v[164:167],a[112:115],a[64:67]
s_waitcnt vmcnt(10)
M1 a[4:7],a[244:247],a[116:119],a[4:7]
M1 a[20:23],a[248:251],a[116:119],a[20:23]
ds_write_b128 v9, v[232:235] offset:10432
M1 a[36:39],a[252:255],a[116:119],a[36:39]
M1 a[52:55],v[160:163],a[116:119],a[52:55]
ds_write_b128 v9, v[236:239] offset:15552
M1 a[68:71],v[164:167],a[116:119],a[68:71]
s_waitcnt vmcnt(9)
M1 a[8:11],a[244:247],a[120:123],a[8:11]
M1 a[24:27],a[248:251],a[120:123],a[24:27]
ds_write_b128 v9, v[240:243] offset:256
M1 a[40:43],a[252:255],a[120:123],a[40:43]
M1 a[56:59],v[160:163],a[120:123],a[56:59]
ds_write_b128 v9, v[244:247] offset:5376
M1 a[72:75],v[164:167],a[120:123],a[72:75]
s_waitcnt vmcnt(8)
M1 a[12:15],a[244:247],a[124:127],a[12:15]
M1 a[28:31],a[248:251],a[124:127],a[28:31]
ds_write_b128 v9, v[248:251] offset:10496
M1 a[44:47],a[252:255],a[124:127],a[44:47]
M1 a[60:63],v[160:163],a[124:127],a[60:63]
ds_write_b128 v9, v[252:255] offset:15616
M1 a[76:79],v[164:167],a[124:127],a[76:79]
s_waitcnt vmcnt(7)
M1 a[0:3],v[168:171],a[128:131],a[0:3]
M1 a[16:19],v[172:175],a[128:131],a[16:19]
M1 a[32:35],a[144:147],a[128:131],a[32:35]
M1 a[48:51],a[148:151],a[128:131],a[48:51]
M1 a[64:67],a[152:155],a[128:131],a[64:67]
s_waitcnt vmcnt(6)
M1 a[4:7],v[168:171],a[132:135],a[4:7]
M1 a[20:23],v[172:175],a[132:135],a[20:23]
M1 a[36:39],a[144:147],a[132:135],a[36:39]
M1 a[52:55],a[148:151],a[132:135],a[52:55]
M1 a[68:71],a[152:155],a[132:135],a[68:71]
s_waitcnt vmcnt(5)
M1 a[8:11],v[168:171],a[136:139],a[8:11]
M1 a[24:27],v[172:175],a[136:139],a[24:27]
M1 a[40:43],a[144:147],a[136:139],a[40:43]
M1 a[56:59],a[148:151],a[136:139],a[56:59]
M1 a[72:75],a[152:155],a[136:139],a[72:75]
s_waitcnt vmcnt(4)
M1 a[12:15],v[168:171],a[140:143],a[12:15]
M1 a[28:31],v[172:175],a[140:143],a[28:31]
M1 a[44:47],a[144:147],a[140:143],a[44:47]
M1 a[60:63],a[148:151],a[140:143],a[60:63]
M1 a[76:79],a[152:155],a[140:143],a[76:79]
s_waitcnt lgkmcnt(0)
s_barrier
s_waitcnt vmcnt(3)
M1 a[0:3],a[156:159],a[192:195],a[0:3]
M1 a[16:19],a[208:211],a[192:195],a[16:19]
ds_read_b128 v[96:99], v28
ds_read_b128 v[100:103], v29
ds_read_b128 v[104:107], v28 offset:40960
M1 a[32:35],a[212:215],a[192:195],a[32:35]
M1 a[48:51],a[216:219],a[192:195],a[48:51]
ds_read_b128 v[108:111], v29 offset:40960
ds_read_b128 v[112:115], v30
ds_read_b128 v[116:119], v31
M1 a[64:67],a[220:223],a[192:195],a[64:67]
s_waitcnt vmcnt(2)
M1 a[4:7],a[156:159],a[196:199],a[4:7]
M1 a[20:23],a[208:211],a[196:199],a[20:23]
ds_read_b128 v[120:123], v30 offset:40960
ds_read_b128 v[124:127], v31 offset:40960
ds_read_b128 v[160:163], v32
M1 a[36:39],a[212:215],a[196:199],a[36:39]
M1 a[52:55],a[216:219],a[196:199],a[52:55]
ds_read_b128 v[164:167], v33
ds_read_b128 v[168:171], v32 offset:40960
ds_read_b128 v[172:175], v33 offset:40960
M1 a[68:71],a[220:223],a[196:199],a[68:71]
s_waitcnt vmcnt(1)
M1 a[8:11],a[156:159],a[200:203],a[8:11]
M1 a[24:27],a[208:211],a[200:203],a[24:27]
ds_read_b128 v[176:179], v34
ds_read_b128 v[180:183], v35
ds_read_b128 v[184:187], v34 offset:40960
M1 a[40:43],a[212:215],a[200:203],a[40:43]
M1 a[56:59],a[216:219],a[200:203],a[56:59]
ds_read_b128 v[188:191], v35 offset:40960
ds_read_b128 v[224:227], v36
ds_read_b128 v[228:231], v37
M1 a[72:75],a[220:223],a[200:203],a[72:75]
s_waitcnt vmcnt(0)
M1 a[12:15],a[156:159],a[204:207],a[12:15]
M1 a[28:31],a[208:211],a[204:207],a[28:31]
ds_read_b128 v[232:235], v36 offset:40960
ds_read_b128 v[236:239], v37 offset:40960
ds_read_b128 v[240:243], v38
M1 a[44:47],a[212:215],a[204:207],a[44:47]
M1 a[60:63],a[216:219],a[204:207],a[60:63]
ds_read_b128 v[244:247], v39
ds_read_b128 v[248:251], v38 offset:40960
ds_read_b128 v[252:255], v39 offset:40960
M1 a[76:79],a[220:223],a[204:207],a[76:79]
ds_write_b128 v9, a[0:3] offset:20480
s_waitcnt lgkmcnt(15)
v_pk_add_f32 v[96:97], v[96:97], v[104:105]
v_pk_add_f32 v[98:99], v[98:99], v[106:107]
v_pk_add_f32 v[100:101], v[100:101], v[108:109]
v_pk_add_f32 v[102:103], v[102:103], v[110:111]
v_pk_add_f32 v[112:113], v[112:113], v[120:121]
v_pk_add_f32 v[114:115], v[114:115], v[122:123]
ds_write_b128 v9, a[4:7] offset:25600
v_pk_add_f32 v[116:117], v[116:117], v[124:125]
v_pk_add_f32 v[118:119], v[118:119], v[126:127]
v_pk_add_f32 v[96:97], v[96:97], v[112:113]
v_pk_add_f32 v[98:99], v[98:99], v[114:115]
v_pk_add_f32 v[100:101], v[100:101], v[116:117]
v_pk_add_f32 v[102:103], v[102:103], v[118:119]
v_pk_mul_f32 v[104:105], v[96:97], s[50:51] op_sel_hi:[1,0]
ds_write_b128 v9, a[8:11] offset:30720
v_pk_mul_f32 v[106:107], v[98:99], s[50:51] op_sel_hi:[1,0]
v_pk_mul_f32 v[108:109], v[100:101], s[50:51] op_sel_hi:[1,0]
v_pk_mul_f32 v[110:111], v[102:103], s[50:51] op_sel_hi:[1,0]
v_exp_f32 v104, v104
v_lshlrev_b32 v112, 16, v80
v_exp_f32 v105, v105
v_and_b32 v113, s52, v80
ds_write_b128 v9, a[12:15] offset:35840
v_exp_f32 v106, v106
v_lshlrev_b32 v114, 16, v81
v_exp_f32 v107, v107
v_and_b32 v115, s52, v81
v_exp_f32 v108, v108
v_lshlrev_b32 v116, 16, v82
v_exp_f32 v109, v109
ds_write_b128 v9, a[16:19] offset:20544
v_and_b32 v117, s52, v82
v_exp_f32 v110, v110
v_lshlrev_b32 v118, 16, v83
v_exp_f32 v111, v111
v_and_b32 v119, s52, v83
v_pk_add_f32 v[104:105], v[104:105], 1.0 op_sel_hi:[1,0]
v_pk_add_f32 v[106:107], v[106:107], 1.0 op_sel_hi:[1,0]
ds_write_b128 v9, a[20:23] offset:25664
v_pk_add_f32 v[108:109], v[108:109], 1.0 op_sel_hi:[1,0]
v_pk_add_f32 v[110:111], v[110:111], 1.0 op_sel_hi:[1,0]
v_rcp_f32 v104, v104
v_rcp_f32 v105, v105
v_rcp_f32 v106, v106
v_rcp_f32 v107, v107
v_rcp_f32 v108, v108
ds_write_b128 v9, a[24:27] offset:30784
v_rcp_f32 v109, v109
v_rcp_f32 v110, v110
v_rcp_f32 v111, v111
v_pk_mul_f32 v[96:97], v[96:97], v[104:105]
v_pk_mul_f32 v[98:99], v[98:99], v[106:107]
v_pk_mul_f32 v[100:101], v[100:101], v[108:109]
v_pk_mul_f32 v[102:103], v[102:103], v[110:111]
ds_write_b128 v9, a[28:31] offset:35904
s_waitcnt lgkmcnt(15)
v_pk_add_f32 v[160:161], v[160:161], v[168:169]
v_pk_add_f32 v[162:163], v[162:163], v[170:171]
v_pk_add_f32 v[164:165], v[164:165], v[172:173]
v_pk_add_f32 v[166:167], v[166:167], v[174:175]
v_pk_add_f32 v[176:177], v[176:177], v[184:185]
v_pk_add_f32 v[178:179], v[178:179], v[186:187]
ds_write_b128 v9, a[32:35] offset:20608
v_pk_add_f32 v[180:181], v[180:181], v[188:189]
v_pk_add_f32 v[182:183], v[182:183], v[190:191]
v_pk_add_f32 v[160:161], v[160:161], v[176:177]
v_pk_add_f32 v[162:163], v[162:163], v[178:179]
v_pk_add_f32 v[164:165], v[164:165], v[180:181]
v_pk_add_f32 v[166:167], v[166:167], v[182:183]
v_pk_mul_f32 v[168:169], v[160:161], s[50:51] op_sel_hi:[1,0]
ds_write_b128 v9, a[36:39] offset:25728
v_pk_mul_f32 v[170:171], v[162:163], s[50:51] op_sel_hi:[1,0]
v_pk_mul_f32 v[172:173], v[164:165], s[50:51] op_sel_hi:[1,0]
v_pk_mul_f32 v[174:175], v[166:167], s[50:51] op_sel_hi:[1,0]
v_exp_f32 v168, v168
v_lshlrev_b32 v176, 16, v84
v_exp_f32 v169, v169
v_and_b32 v177, s52, v84
ds_write_b128 v9, a[40:43] offset:30848
v_exp_f32 v170, v170
v_lshlrev_b32 v178, 16, v85
v_exp_f32 v171, v171
v_and_b32 v179, s52, v85
v_exp_f32 v172, v172
v_lshlrev_b32 v180, 16, v86
v_exp_f32 v173, v173
ds_write_b128 v9, a[44:47] offset:35968
v_and_b32 v181, s52, v86
v_exp_f32 v174, v174
v_lshlrev_b32 v182, 16, v87
v_exp_f32 v175, v175
v_and_b32 v183, s52, v87
v_pk_add_f32 v[168:169], v[168:169], 1.0 op_sel_hi:[1,0]
v_pk_add_f32 v[170:171], v[170:171], 1.0 op_sel_hi:[1,0]
ds_write_b128 v9, a[48:51] offset:20672
v_pk_add_f32 v[172:173], v[172:173], 1.0 op_sel_hi:[1,0]
v_pk_add_f32 v[174:175], v[174:175], 1.0 op_sel_hi:[1,0]
v_rcp_f32 v168, v168
v_rcp_f32 v169, v169
v_rcp_f32 v170, v170
v_rcp_f32 v171, v171
v_rcp_f32 v172, v172
ds_write_b128 v9, a[52:55] offset:25792
v_rcp_f32 v173, v173
v_rcp_f32 v174, v174
v_rcp_f32 v175, v175
v_pk_mul_f32 v[160:161], v[160:161], v[168:169]
v_pk_mul_f32 v[162:163], v[162:163], v[170:171]
v_pk_mul_f32 v[164:165], v[164:165], v[172:173]
v_pk_mul_f32 v[166:167], v[166:167], v[174:175]
ds_write_b128 v9, a[56:59] offset:30912
s_waitcnt lgkmcnt(15)
v_pk_add_f32 v[224:225], v[224:225], v[232:233]
v_pk_add_f32 v[226:227], v[226:227], v[234:235]
v_pk_add_f32 v[228:229], v[228:229], v[236:237]
v_pk_add_f32 v[230:231], v[230:231], v[238:239]
v_pk_add_f32 v[240:241], v[240:241], v[248:249]
v_pk_add_f32 v[242:243], v[242:243], v[250:251]
ds_write_b128 v9, a[60:63] offset:36032
v_pk_add_f32 v[244:245], v[244:245], v[252:253]
v_pk_add_f32 v[246:247], v[246:247], v[254:255]
v_pk_add_f32 v[224:225], v[224:225], v[240:241]
v_pk_add_f32 v[226:227], v[226:227], v[242:243]
v_pk_add_f32 v[228:229], v[228:229], v[244:245]
v_pk_add_f32 v[230:231], v[230:231], v[246:247]
v_pk_mul_f32 v[232:233], v[224:225], s[50:51] op_sel_hi:[1,0]
ds_write_b128 v9, a[64:67] offset:20736
v_pk_mul_f32 v[234:235], v[226:227], s[50:51] op_sel_hi:[1,0]
v_pk_mul_f32 v[236:237], v[228:229], s[50:51] op_sel_hi:[1,0]
v_pk_mul_f32 v[238:239], v[230:231], s[50:51] op_sel_hi:[1,0]
v_exp_f32 v232, v232
v_lshlrev_b32 v240, 16, v88
v_exp_f32 v233, v233
v_and_b32 v241, s52, v88
ds_write_b128 v9, a[68:71] offset:25856
v_exp_f32 v234, v234
v_lshlrev_b32 v242, 16, v89
v_exp_f32 v235, v235
v_and_b32 v243, s52, v89
v_exp_f32 v236, v236
v_lshlrev_b32 v244, 16, v90
v_exp_f32 v237, v237
ds_write_b128 v9, a[72:75] offset:30976
v_and_b32 v245, s52, v90
v_exp_f32 v238, v238
v_lshlrev_b32 v246, 16, v91
v_exp_f32 v239, v239
v_and_b32 v247, s52, v91
v_pk_add_f32 v[232:233], v[232:233], 1.0 op_sel_hi:[1,0]
v_pk_add_f32 v[234:235], v[234:235], 1.0 op_sel_hi:[1,0]
ds_write_b128 v9, a[76:79] offset:36096
v_pk_add_f32 v[236:237], v[236:237], 1.0 op_sel_hi:[1,0]
v_pk_add_f32 v[238:239], v[238:239], 1.0 op_sel_hi:[1,0]
v_rcp_f32 v232, v232
v_rcp_f32 v233, v233
v_rcp_f32 v234, v234
v_rcp_f32 v235, v235
v_rcp_f32 v236, v236
v_rcp_f32 v237, v237
v_rcp_f32 v238, v238
v_rcp_f32 v239, v239
v_pk_mul_f32 v[224:225], v[224:225], v[232:233]
v_pk_mul_f32 v[226:227], v[226:227], v[234:235]
v_pk_mul_f32 v[228:229], v[228:229], v[236:237]
v_pk_mul_f32 v[230:231], v[230:231], v[238:239]
s_waitcnt lgkmcnt(0)
s_barrier
ds_read_b128 v[128:131], v28 offset:20480
ds_read_b128 v[132:135], v29 offset:20480
ds_read_b128 v[136:139], v28 offset:61440
ds_read_b128 v[140:143], v29 offset:61440
ds_read_b128 v[144:147], v30 offset:20480
ds_read_b128 v[148:151], v31 offset:20480
ds_read_b128 v[152:155], v30 offset:61440
ds_read_b128 v[156:159], v31 offset:61440
ds_read_b128 v[192:195], v32 offset:20480
ds_read_b128 v[196:199], v33 offset:20480
ds_read_b128 v[200:203], v32 offset:61440
ds_read_b128 v[204:207], v33 offset:61440
ds_read_b128 v[208:211], v34 offset:20480
ds_read_b128 v[212:215], v35 offset:20480
ds_read_b128 v[216:219], v34 offset:61440
ds_read_b128 v[220:223], v35 offset:61440
ds_read_b128 v[40:43], v36 offset:20480
ds_read_b128 v[44:47], v37 offset:20480
ds_read_b128 v[48:51], v36 offset:61440
ds_read_b128 v[52:55], v37 offset:61440
ds_read_b128 v[56:59], v38 offset:20480
ds_read_b128 v[60:63], v39 offset:20480
ds_read_b128 v[64:67], v38 offset:61440
ds_read_b128 v[68:71], v39 offset:61440
s_waitcnt lgkmcnt(15)
v_pk_add_f32 v[128:129], v[128:129], v[136:137]
v_pk_add_f32 v[130:131], v[130:131], v[138:139]
v_pk_add_f32 v[132:133], v[132:133], v[140:141]
v_pk_add_f32 v[134:135], v[134:135], v[142:143]
v_pk_add_f32 v[144:145], v[144:145], v[152:153]
v_pk_add_f32 v[146:147], v[146:147], v[154:155]
v_pk_add_f32 v[148:149], v[148:149], v[156:157]
v_pk_add_f32 v[150:151], v[150:151], v[158:159]
v_pk_add_f32 v[128:129], v[128:129], v[144:145]
v_pk_add_f32 v[130:131], v[130:131], v[146:147]
v_pk_add_f32 v[132:133], v[132:133], v[148:149]
v_pk_add_f32 v[134:135], v[134:135], v[150:151]
v_pk_fma_f32 v[96:97], v[96:97], v[128:129], v[112:113]
v_pk_fma_f32 v[98:99], v[98:99], v[130:131], v[114:115]
v_pk_fma_f32 v[100:101], v[100:101], v[132:133], v[116:117]
v_pk_fma_f32 v[102:103], v[102:103], v[134:135], v[118:119]
CV v104,v96,v97
CV v105,v98,v99
CV v106,v100,v101
CV v107,v102,v103
buffer_store_dwordx4 v[104:107], v10, s[12:15], s47 offen sc1
s_waitcnt lgkmcnt(8)
v_pk_add_f32 v[192:193], v[192:193], v[200:201]
v_pk_add_f32 v[194:195], v[194:195], v[202:203]
v_pk_add_f32 v[196:197], v[196:197], v[204:205]
v_pk_add_f32 v[198:199], v[198:199], v[206:207]
v_pk_add_f32 v[208:209], v[208:209], v[216:217]
v_pk_add_f32 v[210:211], v[210:211], v[218:219]
v_pk_add_f32 v[212:213], v[212:213], v[220:221]
v_pk_add_f32 v[214:215], v[214:215], v[222:223]
v_pk_add_f32 v[192:193], v[192:193], v[208:209]
v_pk_add_f32 v[194:195], v[194:195], v[210:211]
v_pk_add_f32 v[196:197], v[196:197], v[212:213]
v_pk_add_f32 v[198:199], v[198:199], v[214:215]
v_pk_fma_f32 v[160:161], v[160:161], v[192:193], v[176:177]
v_pk_fma_f32 v[162:163], v[162:163], v[194:195], v[178:179]
v_pk_fma_f32 v[164:165], v[164:165], v[196:197], v[180:181]
v_pk_fma_f32 v[166:167], v[166:167], v[198:199], v[182:183]
CV v168,v160,v161
CV v169,v162,v163
CV v170,v164,v165
CV v171,v166,v167
buffer_store_dwordx4 v[168:171], v11, s[12:15], s47 offen sc1
s_waitcnt lgkmcnt(0)
v_pk_add_f32 v[40:41], v[40:41], v[48:49]
v_pk_add_f32 v[42:43], v[42:43], v[50:51]
v_pk_add_f32 v[44:45], v[44:45], v[52:53]
v_pk_add_f32 v[46:47], v[46:47], v[54:55]
v_pk_add_f32 v[56:57], v[56:57], v[64:65]
v_pk_add_f32 v[58:59], v[58:59], v[66:67]
v_pk_add_f32 v[60:61], v[60:61], v[68:69]
v_pk_add_f32 v[62:63], v[62:63], v[70:71]
v_pk_add_f32 v[40:41], v[40:41], v[56:57]
v_pk_add_f32 v[42:43], v[42:43], v[58:59]
v_pk_add_f32 v[44:45], v[44:45], v[60:61]
v_pk_add_f32 v[46:47], v[46:47], v[62:63]
v_pk_fma_f32 v[224:225], v[224:225], v[40:41], v[240:241]
v_pk_fma_f32 v[226:227], v[226:227], v[42:43], v[242:243]
v_pk_fma_f32 v[228:229], v[228:229], v[44:45], v[244:245]
v_pk_fma_f32 v[230:231], v[230:231], v[46:47], v[246:247]
CV v232,v224,v225
CV v233,v226,v227
CV v234,v228,v229
CV v235,v230,v231
buffer_store_dwordx4 v[232:235], v12, s[12:15], s47 offen sc1
s_endpgm
.p2align 6
K1_KVGU:
s_sub_u32 s86, s5, 4
s_lshl_b32 s86, s86, 4
s_add_u32 s86, s86, s4
s_lshl_b32 s86, s86, 2
s_add_u32 s86, s86, s3
s_mov_b32 s36, s74
s_mov_b32 s37, s75
s_mov_b32 s38, 2211840
s_mov_b32 s39, 0x20000
s_mov_b32 s64, s72
s_mov_b32 s65, s73
s_mov_b32 s66, 819200
s_mov_b32 s67, 0x20000
v_lshrrev_b32 v72, 3, v1
v_mul_u32_u24 v73, 1280, v72
v_and_b32 v74, 7, v1
v_lshl_add_u32 v25, v74, 4, v73
v_lshrrev_b32 v73, 5, v1
v_mul_u32_u24 v73, 20, v73
v_and_b32 v75, 3, v72
v_add_u32 v73, v73, v75
v_mul_u32_u24 v73, 1280, v73
v_lshl_add_u32 v24, v74, 4, v73
v_lshrrev_b32 v72, 4, v1
v_lshrrev_b32 v73, 1, v72
v_and_b32 v72, 1, v72
v_lshlrev_b32 v73, 4, v73
v_lshl_add_u32 v73, v72, 2, v73
v_bfe_u32 v72, v1, 2, 2
v_add_u32 v73, v73, v72
v_lshlrev_b32 v73, 7, v73
v_and_b32 v72, 3, v1
v_lshl_add_u32 v73, v72, 3, v73
v_add_u32 v62, s6, v73
v_lshlrev_b32 v63, 4, v1
s_add_u32 s87, s86, 320
s_mul_i32 s88, s87, 6554
s_lshr_b32 s88, s88, 16
s_mul_i32 s89, s88, 10
s_sub_u32 s89, s87, s89
s_mul_i32 s76, s88, 40960
s_lshl_b32 s68, s87, 12
s_lshl_b32 s89, s89, 7
s_add_u32 s76, s76, s89
s_add_u32 s68, s68, 10485760
s_cmp_lt_u32 s87, 540
s_cselect_b32 s76, s76, 1073741824
s_cselect_b32 s68, s68, 1073741824
s_add_u32 s77, s76, 9216
s_add_u32 s78, s76, 18432
s_add_u32 s79, s76, 27648
s_add_u32 m0, s6, 0
s_nop 0
BL v25,s[36:39],s76 offen lds
BL v25,s[36:39],s77 offen offset:1024 lds
BL v25,s[36:39],s78 offen offset:2048 lds
BL v25,s[36:39],s79 offen offset:3072 lds
s_add_u32 s87, s86, 0
s_mul_i32 s88, s87, 6554
s_lshr_b32 s88, s88, 16
s_mul_i32 s89, s88, 10
s_sub_u32 s89, s87, s89
s_mul_i32 s76, s88, 51200
s_lshr_b32 s77, s88, 2
s_add_u32 s77, s77, s88
s_add_u32 s77, s77, 54
s_mul_i32 s77, s77, 10
s_add_u32 s77, s77, s89
s_lshl_b32 s69, s77, 12
s_lshl_b32 s89, s89, 7
s_add_u32 s76, s76, s89
s_add_u32 s69, s69, 10485760
s_cmp_lt_u32 s87, 160
s_cselect_b32 s76, s76, 1073741824
s_cselect_b32 s69, s69, 1073741824
s_add_u32 s77, s76, 9216
s_add_u32 s78, s76, 23552
s_add_u32 s79, s76, 32768
s_add_u32 m0, s6, 4096
s_nop 0
BL v25,s[64:67],s76 offen lds
BL v25,s[64:67],s77 offen offset:1024 lds
BL v25,s[64:67],s78 offen offset:2048 lds
BL v25,s[64:67],s79 offen offset:3072 lds
s_sub_u32 s87, 255, s86
s_mul_i32 s88, s87, 6554
s_lshr_b32 s88, s88, 16
s_mul_i32 s89, s88, 10
s_sub_u32 s89, s87, s89
s_mul_i32 s76, s88, 204800
s_add_u32 s76, s76, 20480
s_mul_i32 s77, s88, 50
s_add_u32 s77, s77, 580
s_add_u32 s77, s77, s89
s_lshl_b32 s70, s77, 12
s_lshl_b32 s89, s89, 7
s_add_u32 s76, s76, s89
s_add_u32 s70, s70, 10485760
s_cmp_lt_u32 s87, 40
s_cselect_b32 s76, s76, 1073741824
s_cselect_b32 s70, s70, 1073741824
s_add_u32 s77, s76, 50176
s_add_u32 s78, s76, 100352
s_add_u32 s79, s76, 150528
s_add_u32 m0, s6, 8192
s_nop 0
BL v24,s[64:67],s76 offen lds
BL v24,s[64:67],s77 offen offset:1024 lds
BL v24,s[64:67],s78 offen offset:2048 lds
BL v24,s[64:67],s79 offen offset:3072 lds
v_and_b32 v56, 31, v1
v_lshrrev_b32 v57, 5, v1
v_bfe_u32 v58, v1, 1, 3
v_lshlrev_b32 v59, 7, v56
v_add_u32 v59, s6, v59
s_mov_b32 s49, 0x3f803f80
v_add_u32 v60, 0, v57
v_xor_b32 v60, v60, v58
v_lshl_add_u32 v34, v60, 4, v59
v_add_u32 v60, 2, v57
v_xor_b32 v60, v60, v58
v_lshl_add_u32 v35, v60, 4, v59
v_add_u32 v60, 4, v57
v_xor_b32 v60, v60, v58
v_lshl_add_u32 v36, v60, 4, v59
v_add_u32 v60, 6, v57
v_xor_b32 v60, v60, v58
v_lshl_add_u32 v37, v60, 4, v59
v_mov_b32 v48, 0
v_mov_b32 v49, 0
v_mov_b32 v50, 0
v_mov_b32 v51, 0
v_mov_b32 v52, 0
v_mov_b32 v53, 0
v_mov_b32 v54, 0
v_mov_b32 v55, 0
s_mov_b32 s54, 0xffff
s_mov_b32 s55, 0xffff
v_add_u32 v40, 0, v1
v_mul_u32_u24 v41, 3277, v40
v_lshrrev_b32 v41, 16, v41
v_mul_u32_u24 v42, 20, v41
v_sub_u32 v42, v40, v42
v_mul_u32_u24 v41, 3840, v41
v_add_u32 v41, 3072, v41
v_lshl_add_u32 v10, v42, 4, v41
v_cmp_lt_u32 vcc, 9, v42
v_mov_b32 v43, 1280
v_mov_b32 v44, 2400
v_cndmask_b32 v43, v43, v44, vcc
s_waitcnt vmcnt(24)
ds_read_b128 v[96:99], v34 offset:12288
ds_read_b128 v[100:103], v35 offset:12288
ds_read_b128 v[104:107], v36 offset:12288
ds_read_b128 v[108:111], v37 offset:12288
s_bfe_u32 s44, s58, 0x40010
s_mul_i32 s44, s44, 128
s_add_u32 s44, s44, s43
s_add_u32 s61, s44, 20480
s_add_u32 m0, s6, 28672
s_nop 0
BL v30,s[8:11],s44 offen lds
v_add_u32 v10, v10, v43
v_add_u32 v40, 64, v1
v_mul_u32_u24 v41, 3277, v40
v_lshrrev_b32 v41, 16, v41
v_mul_u32_u24 v42, 20, v41
v_sub_u32 v42, v40, v42
s_add_u32 m0, s6, 29696
s_nop 0
BL v31,s[8:11],s44 offen lds
v_mul_u32_u24 v41, 3840, v41
v_add_u32 v41, 2048, v41
v_lshl_add_u32 v11, v42, 4, v41
v_cmp_lt_u32 vcc, 9, v42
v_mov_b32 v43, 1280
v_mov_b32 v44, 2400
s_add_u32 m0, s6, 30720
s_nop 0
BL v30,s[8:11],s61 offen lds
v_cndmask_b32 v43, v43, v44, vcc
v_add_u32 v11, v11, v43
v_add_u32 v40, 128, v1
v_mul_u32_u24 v41, 3277, v40
v_lshrrev_b32 v41, 16, v41
v_mul_u32_u24 v42, 20, v41
s_add_u32 m0, s6, 31744
s_nop 0
BL v31,s[8:11],s61 offen lds
v_sub_u32 v42, v40, v42
v_mul_u32_u24 v41, 3840, v41
v_add_u32 v41, 1024, v41
v_lshl_add_u32 v12, v42, 4, v41
v_cmp_lt_u32 vcc, 9, v42
v_mov_b32 v43, 1280
s_waitcnt vmcnt(24)
ds_read_b128 v[112:115], v34 offset:16384
ds_read_b128 v[116:119], v35 offset:16384
ds_read_b128 v[120:123], v36 offset:16384
ds_read_b128 v[124:127], v37 offset:16384
s_waitcnt lgkmcnt(4)
s_bfe_u32 s44, s58, 0x40014
s_mul_i32 s44, s44, 128
s_add_u32 s44, s44, s43
s_add_u32 s61, s44, 20480
s_add_u32 m0, s6, 32768
s_nop 0
BL v30,s[8:11],s44 offen lds
D2 v48,v96,s49,v48
D2 v52,v96,v96,v52
D2 v49,v97,s49,v49
D2 v53,v97,v97,v53
D2 v50,v98,s49,v50
D2 v54,v98,v98,v54
D2 v51,v99,s49,v51
D2 v55,v99,v99,v55
v_mov_b32 v44, 2400
v_cndmask_b32 v43, v43, v44, vcc
v_add_u32 v12, v12, v43
v_add_u32 v40, 192, v1
v_mul_u32_u24 v41, 3277, v40
v_lshrrev_b32 v41, 16, v41
s_add_u32 m0, s6, 33792
s_nop 0
BL v31,s[8:11],s44 offen lds
D2 v48,v100,s49,v48
D2 v52,v100,v100,v52
D2 v49,v101,s49,v49
D2 v53,v101,v101,v53
D2 v50,v102,s49,v50
D2 v54,v102,v102,v54
D2 v51,v103,s49,v51
D2 v55,v103,v103,v55
v_mul_u32_u24 v42, 20, v41
v_sub_u32 v42, v40, v42
v_mul_u32_u24 v41, 3840, v41
v_add_u32 v41, 0, v41
v_lshl_add_u32 v13, v42, 4, v41
v_cmp_lt_u32 vcc, 9, v42
s_add_u32 m0, s6, 34816
s_nop 0
BL v30,s[8:11],s61 offen lds
D2 v48,v104,s49,v48
D2 v52,v104,v104,v52
D2 v49,v105,s49,v49
D2 v53,v105,v105,v53
D2 v50,v106,s49,v50
D2 v54,v106,v106,v54
D2 v51,v107,s49,v51
D2 v55,v107,v107,v55
v_mov_b32 v43, 1280
v_mov_b32 v44, 2400
v_cndmask_b32 v43, v43, v44, vcc
v_add_u32 v13, v13, v43
v_add_u32 v40, 256, v1
v_mul_u32_u24 v41, 3277, v40
s_add_u32 m0, s6, 35840
s_nop 0
BL v31,s[8:11],s61 offen lds
D2 v48,v108,s49,v48
D2 v52,v108,v108,v52
D2 v49,v109,s49,v49
D2 v53,v109,v109,v53
D2 v50,v110,s49,v50
D2 v54,v110,v110,v54
D2 v51,v111,s49,v51
D2 v55,v111,v111,v55
v_lshrrev_b32 v41, 16, v41
v_mul_u32_u24 v42, 20, v41
v_sub_u32 v42, v40, v42
v_mul_u32_u24 v41, 3840, v41
v_add_u32 v41, 3072, v41
v_lshl_add_u32 v14, v42, 4, v41
s_waitcnt vmcnt(24)
ds_read_b128 v[128:131], v34 offset:20480
ds_read_b128 v[132:135], v35 offset:20480
ds_read_b128 v[136:139], v36 offset:20480
ds_read_b128 v[140:143], v37 offset:20480
s_waitcnt vmcnt(16)
TR v[64:65],v62
TR v[66:67],v62 offset:1024
TR v[68:69],v62 offset:32
TR v[70:71],v62 offset:1056
TR v[72:73],v62 offset:64
TR v[74:75],v62 offset:1088
TR v[76:77],v62 offset:96
TR v[78:79],v62 offset:1120
s_waitcnt lgkmcnt(6)
buffer_store_dwordx4 v[64:67], v63, s[24:27], s68 offen sc1
s_waitcnt lgkmcnt(4)
buffer_store_dwordx4 v[68:71], v63, s[24:27], s68 offen offset:1024 sc1
s_waitcnt lgkmcnt(2)
buffer_store_dwordx4 v[72:75], v63, s[24:27], s68 offen offset:2048 sc1
s_waitcnt lgkmcnt(0)
buffer_store_dwordx4 v[76:79], v63, s[24:27], s68 offen offset:3072 sc1
s_waitcnt vmcnt(16)
TR v[80:81],v62 offset:4096
TR v[82:83],v62 offset:5120
TR v[84:85],v62 offset:4128
TR v[86:87],v62 offset:5152
TR v[88:89],v62 offset:4160
TR v[90:91],v62 offset:5184
TR v[92:93],v62 offset:4192
TR v[94:95],v62 offset:5216
s_waitcnt lgkmcnt(6)
buffer_store_dwordx4 v[80:83], v63, s[24:27], s69 offen sc1
s_waitcnt lgkmcnt(4)
buffer_store_dwordx4 v[84:87], v63, s[24:27], s69 offen offset:1024 sc1
s_waitcnt lgkmcnt(2)
buffer_store_dwordx4 v[88:91], v63, s[24:27], s69 offen offset:2048 sc1
s_waitcnt lgkmcnt(0)
buffer_store_dwordx4 v[92:95], v63, s[24:27], s69 offen offset:3072 sc1
s_waitcnt vmcnt(16)
TR v[64:65],v62 offset:8192
TR v[66:67],v62 offset:9216
TR v[68:69],v62 offset:8224
TR v[70:71],v62 offset:9248
TR v[72:73],v62 offset:8256
TR v[74:75],v62 offset:9280
TR v[76:77],v62 offset:8288
TR v[78:79],v62 offset:9312
s_waitcnt lgkmcnt(6)
buffer_store_dwordx4 v[64:67], v63, s[24:27], s70 offen sc1
s_waitcnt lgkmcnt(4)
buffer_store_dwordx4 v[68:71], v63, s[24:27], s70 offen offset:1024 sc1
s_waitcnt lgkmcnt(2)
buffer_store_dwordx4 v[72:75], v63, s[24:27], s70 offen offset:2048 sc1
s_waitcnt lgkmcnt(0)
buffer_store_dwordx4 v[76:79], v63, s[24:27], s70 offen offset:3072 sc1
buffer_load_dword v26, v27, s[28:31], 0 offen sc1
s_bfe_u32 s44, s58, 0x40018
s_mul_i32 s44, s44, 128
s_add_u32 s44, s44, s43
s_add_u32 s61, s44, 20480
s_add_u32 m0, s6, 36864
s_nop 0
BL v30,s[8:11],s44 offen lds
D2 v48,v112,s49,v48
D2 v52,v112,v112,v52
D2 v49,v113,s49,v49
D2 v53,v113,v113,v53
D2 v50,v114,s49,v50
D2 v54,v114,v114,v54
D2 v51,v115,s49,v51
D2 v55,v115,v115,v55
v_cmp_lt_u32 vcc, 9, v42
v_mov_b32 v43, 1280
v_mov_b32 v44, 2400
v_cndmask_b32 v43, v43, v44, vcc
v_add_u32 v14, v14, v43
s_mul_i32 s40, s3, 61440
s_add_u32 m0, s6, 37888
s_nop 0
BL v31,s[8:11],s44 offen lds
D2 v48,v116,s49,v48
D2 v52,v116,v116,v52
D2 v49,v117,s49,v49
D2 v53,v117,v117,v53
D2 v50,v118,s49,v50
D2 v54,v118,v118,v54
D2 v51,v119,s49,v51
D2 v55,v119,v119,v55
s_mul_i32 s7, s5, 160
s_add_u32 s40, s40, s7
v_lshrrev_b32 v40, 4, v1
v_and_b32 v41, 1, v40
v_lshrrev_b32 v40, 1, v40
v_bfe_u32 v42, v1, 2, 2
s_add_u32 m0, s6, 38912
s_nop 0
BL v30,s[8:11],s61 offen lds
D2 v48,v120,s49,v48
D2 v52,v120,v120,v52
D2 v49,v121,s49,v49
D2 v53,v121,v121,v53
D2 v50,v122,s49,v50
D2 v54,v122,v122,v54
D2 v51,v123,s49,v51
D2 v55,v123,v123,v55
v_and_b32 v43, 3, v1
v_lshl_add_u32 v44, v40, 3, v42
v_mul_u32_u24 v44, 320, v44
v_mul_u32_u24 v45, 40, v41
v_lshl_add_u32 v45, v43, 3, v45
v_add_u32 v2, v44, v45
s_add_u32 m0, s6, 39936
s_nop 0
BL v31,s[8:11],s61 offen lds
D2 v48,v124,s49,v48
D2 v52,v124,v124,v52
D2 v49,v125,s49,v49
D2 v53,v125,v125,v53
D2 v50,v126,s49,v50
D2 v54,v126,v126,v54
D2 v51,v127,s49,v51
D2 v55,v127,v127,v55
v_add_u32 v3, 81920, v2
v_lshl_add_u32 v45, v41, 2, v43
v_mul_u32_u24 v45, 40, v45
v_add3_u32 v4, v44, v45, 32
v_add_u32 v5, 81920, v4
s_lshl_b32 s7, s5, 2
ds_read_b128 v[144:147], v34 offset:24576
ds_read_b128 v[148:151], v35 offset:24576
ds_read_b128 v[152:155], v36 offset:24576
ds_read_b128 v[156:159], v37 offset:24576
s_bfe_u32 s44, s58, 0x4001c
s_mul_i32 s44, s44, 128
s_add_u32 s44, s44, s43
s_add_u32 s61, s44, 20480
s_add_u32 m0, s6, 12288
s_nop 0
BL v30,s[8:11],s44 offen lds
D2 v48,v128,s49,v48
D2 v52,v128,v128,v52
D2 v49,v129,s49,v49
D2 v53,v129,v129,v53
D2 v50,v130,s49,v50
D2 v54,v130,v130,v54
D2 v51,v131,s49,v51
D2 v55,v131,v131,v55
s_add_u32 s62, s7, s3
s_mul_i32 s62, s62, 40960
s_mul_i32 s63, s4, 2560
s_add_u32 s62, s62, s63
s_add_u32 s62, s62, 16777216
s_sub_u32 s84, s5, 4
s_add_u32 m0, s6, 13312
s_nop 0
BL v31,s[8:11],s44 offen lds
D2 v48,v132,s49,v48
D2 v52,v132,v132,v52
D2 v49,v133,s49,v49
D2 v53,v133,v133,v53
D2 v50,v134,s49,v50
D2 v54,v134,v134,v54
D2 v51,v135,s49,v51
D2 v55,v135,v135,v55
s_lshl_b32 s84, s84, 4
s_add_u32 s84, s84, s4
s_lshl_b32 s84, s84, 2
s_add_u32 s84, s84, s3
s_min_u32 s85, s84, 159
s_mul_i32 s63, s85, 205
s_add_u32 m0, s6, 14336
s_nop 0
BL v30,s[8:11],s61 offen lds
D2 v48,v136,s49,v48
D2 v52,v136,v136,v52
D2 v49,v137,s49,v49
D2 v53,v137,v137,v53
D2 v50,v138,s49,v50
D2 v54,v138,v138,v54
D2 v51,v139,s49,v51
D2 v55,v139,v139,v55
s_lshr_b32 s63, s63, 10
s_mov_b32 s7, s63
s_mul_i32 s63, s63, 5
s_sub_u32 s85, s85, s63
s_mul_i32 s63, s7, 40960
s_lshl_b32 s64, s85, 7
s_add_u32 m0, s6, 15360
s_nop 0
BL v31,s[8:11],s61 offen lds
D2 v48,v140,s49,v48
D2 v52,v140,v140,v52
D2 v49,v141,s49,v49
D2 v53,v141,v141,v53
D2 v50,v142,s49,v50
D2 v54,v142,v142,v54
D2 v51,v143,s49,v51
D2 v55,v143,v143,v55
s_add_u32 s63, s63, s64
s_add_u32 s63, s63, 16777216
s_mul_i32 s64, s7, 1920
s_mul_i32 s85, s85, 384
s_add_u32 s64, s64, s85
s_add_u32 s64, s64, 18874368
s_waitcnt vmcnt(25)
ds_read_b128 v[160:163], v34 offset:28672
ds_read_b128 v[164:167], v35 offset:28672
ds_read_b128 v[168:171], v36 offset:28672
ds_read_b128 v[172:175], v37 offset:28672
s_waitcnt lgkmcnt(4)
s_bfe_u32 s44, s59, 0x40000
s_mul_i32 s44, s44, 128
s_add_u32 s44, s44, s43
s_add_u32 s61, s44, 20480
s_add_u32 m0, s6, 16384
s_nop 0
BL v30,s[8:11],s44 offen lds
D2 v48,v144,s49,v48
D2 v52,v144,v144,v52
D2 v49,v145,s49,v49
D2 v53,v145,v145,v53
D2 v50,v146,s49,v50
D2 v54,v146,v146,v54
D2 v51,v147,s49,v51
D2 v55,v147,v147,v55
s_cmp_lt_u32 s84, 160
s_cselect_b32 s64, s64, 1073741824
v_lshrrev_b32 v40, 3, v1
v_mul_u32_u24 v41, 3456, v40
v_and_b32 v42, 7, v1
v_and_b32 v40, 2, v40
s_add_u32 m0, s6, 17408
s_nop 0
BL v31,s[8:11],s44 offen lds
D2 v48,v148,s49,v48
D2 v52,v148,v148,v52
D2 v49,v149,s49,v49
D2 v53,v149,v149,v53
D2 v50,v150,s49,v50
D2 v54,v150,v150,v54
D2 v51,v151,s49,v51
D2 v55,v151,v151,v55
v_xor_b32 v42, v42, v40
v_lshl_add_u32 v42, v42, 4, v41
v_xor_b32 v43, 64, v42
v_add_u32 v15, 3072, v42
v_add_u32 v16, 29696, v42
v_add_u32 v17, 1024, v43
s_add_u32 m0, s6, 18432
s_nop 0
BL v30,s[8:11],s61 offen lds
D2 v48,v152,s49,v48
D2 v52,v152,v152,v52
D2 v49,v153,s49,v49
D2 v53,v153,v153,v53
D2 v50,v154,s49,v50
D2 v54,v154,v154,v54
D2 v51,v155,s49,v51
D2 v55,v155,v155,v55
v_add_u32 v18, 27648, v43
s_sub_u32 s7, s5, 4
s_cmp_eq_u32 s7, 3
s_cselect_b32 s41, 3, 4
s_mul_i32 s7, s7, 7
s_add_u32 s7, s7, s41
s_add_u32 m0, s6, 19456
s_nop 0
BL v31,s[8:11],s61 offen lds
D2 v48,v156,s49,v48
D2 v52,v156,v156,v52
D2 v49,v157,s49,v49
D2 v53,v157,v157,v53
D2 v50,v158,s49,v50
D2 v54,v158,v158,v54
D2 v51,v159,s49,v51
D2 v55,v159,v159,v55
s_mul_i32 s41, s3, 55296
s_lshl_b32 s47, s7, 7
s_add_u32 s41, s41, s47
s_lshl_b32 s47, s7, 13
v_lshrrev_b32 v40, 4, v1
v_and_b32 v41, 1, v40
s_waitcnt vmcnt(25)
ds_read_b128 v[176:179], v34 offset:32768
ds_read_b128 v[180:183], v35 offset:32768
ds_read_b128 v[184:187], v36 offset:32768
ds_read_b128 v[188:191], v37 offset:32768
s_waitcnt lgkmcnt(4)
s_bfe_u32 s44, s59, 0x40004
s_mul_i32 s44, s44, 128
s_add_u32 s44, s44, s43
s_add_u32 s61, s44, 20480
s_add_u32 m0, s6, 20480
s_nop 0
BL v30,s[8:11],s44 offen lds
D2 v48,v160,s49,v48
D2 v52,v160,v160,v52
D2 v49,v161,s49,v49
D2 v53,v161,v161,v53
D2 v50,v162,s49,v50
D2 v54,v162,v162,v54
D2 v51,v163,s49,v51
D2 v55,v163,v163,v55
v_lshrrev_b32 v40, 1, v40
v_bfe_u32 v42, v1, 2, 2
v_and_b32 v43, 3, v1
v_lshl_add_u32 v44, v40, 3, v42
v_lshlrev_b32 v44, 7, v44
v_lshl_add_u32 v44, v41, 11, v44
s_add_u32 m0, s6, 21504
s_nop 0
BL v31,s[8:11],s44 offen lds
D2 v48,v164,s49,v48
D2 v52,v164,v164,v52
D2 v49,v165,s49,v49
D2 v53,v165,v165,v53
D2 v50,v166,s49,v50
D2 v54,v166,v166,v54
D2 v51,v167,s49,v51
D2 v55,v167,v167,v55
v_and_b32 v45, 1, v43
v_lshl_add_u32 v44, v45, 3, v44
v_and_b32 v45, 2, v42
v_lshl_add_u32 v45, v41, 2, v45
v_lshrrev_b32 v43, 1, v43
v_xor_b32 v46, 0, v45
s_add_u32 m0, s6, 22528
s_nop 0
BL v30,s[8:11],s61 offen lds
D2 v48,v168,s49,v48
D2 v52,v168,v168,v52
D2 v49,v169,s49,v49
D2 v53,v169,v169,v53
D2 v50,v170,s49,v50
D2 v54,v170,v170,v54
D2 v51,v171,s49,v51
D2 v55,v171,v171,v55
v_add_u32 v46, v46, v43
v_lshl_add_u32 v6, v46, 4, v44
v_add_u32 v7, 81920, v6
v_xor_b32 v46, 2, v45
v_add_u32 v46, v46, v43
v_lshl_add_u32 v8, v46, 4, v44
s_add_u32 m0, s6, 23552
s_nop 0
BL v31,s[8:11],s61 offen lds
D2 v48,v172,s49,v48
D2 v52,v172,v172,v52
D2 v49,v173,s49,v49
D2 v53,v173,v173,v53
D2 v50,v174,s49,v50
D2 v54,v174,v174,v54
D2 v51,v175,s49,v51
D2 v55,v175,v175,v55
v_add_u32 v9, 81920, v8
v_xor_b32 v46, 4, v45
v_add_u32 v46, v46, v43
v_lshl_add_u32 v19, v46, 4, v44
v_add_u32 v22, 81920, v19
v_xor_b32 v46, 6, v45
s_waitcnt vmcnt(12)
ds_read_b128 v[192:195], v34 offset:36864
ds_read_b128 v[196:199], v35 offset:36864
ds_read_b128 v[200:203], v36 offset:36864
ds_read_b128 v[204:207], v37 offset:36864
v_add_u32 v46, v46, v43
v_lshl_add_u32 v23, v46, 4, v44
v_add_u32 v24, 81920, v23
s_lshl_b32 s7, s4, 1
s_lshr_b32 s45, s3, 1
s_add_u32 s7, s7, s45
s_mul_i32 s45, s7, 303104
s_and_b32 s7, s3, 1
s_lshl_b32 s7, s7, 11
s_add_u32 s45, s45, s7
v_bfe_u32 v40, v1, 4, 1
v_lshlrev_b32 v40, 10, v40
v_lshrrev_b32 v41, 5, v1
v_lshl_add_u32 v40, v41, 8, v40
v_and_b32 v41, 15, v1
v_lshl_add_u32 v28, v41, 4, v40
v_add_u32 v29, 4096, v28
s_mov_b32 s50, 0xbfb8aa3b
s_mov_b32 s51, 0x3fb8aa3b
s_mov_b32 s52, 0xffff0000
s_mov_b32 s53, 0x358637bd
s_add_u32 s47, s47, s45
s_and_b32 s7, s5, 7
s_mul_i32 s32, s3, 112
s_add_u32 s7, s7, s32
s_mul_i32 s7, s7, 5120
s_sub_u32 s34, 3031040, s7
s_add_u32 s7, s7, 10485760
s_add_u32 s32, s82, s7
s_addc_u32 s33, s83, 0
s_mov_b32 s35, 0x20000
s_and_b32 s7, s5, 7
s_add_u32 s7, s7, s4
s_and_b32 s7, s7, 3
s_mul_i32 s7, s7, 0
s_mov_b32 s84, 0x03020100
s_mov_b32 s85, s84
s_lshr_b64 s[84:85], s[84:85], s7
s_mov_b32 s87, s84
s_add_u32 s89, s84, 0x0a0a0a0a
s_sub_u32 s70, s89, 0x02020202
s_cmp_eq_u32 s3, 3
s_cselect_b32 s89, s70, s89
s_mov_b32 s70, 0x0908
s_cselect_b32 s70, 0x0706, s70
s_mov_b32 s84, 0x07060504
s_cselect_b32 s84, 0xffff0504, s84
s_mul_i32 s71, s3, 9
s_sub_u32 s71, 54, s71
s_add_u32 s85, s71, 4
s_lshl_b32 s85, s85, 16
s_or_b32 s70, s70, s85
s_mul_i32 s71, s71, 0x01010101
s_add_u32 s71, s71, s87
s_mov_b32 s85, s84
s_lshr_b64 s[84:85], s[84:85], s7
s_mov_b32 s88, s84
s_lshl_b32 s96, s4, 12
s_lshr_b32 s7, s3, 1
s_lshl_b32 s7, s7, 11
s_add_u32 s96, s96, s7
s_lshl_b32 s7, s5, 7
s_add_u32 s96, s96, s7
s_and_b32 s7, s3, 1
s_lshl_b32 s7, s7, 2
s_add_u32 s96, s96, s7
s_add_u32 s96, s96, 15466496
s_lshl_b32 s97, s4, 12
s_lshr_b32 s7, s5, 3
s_lshl_b32 s7, s7, 11
s_add_u32 s97, s97, s7
s_add_u32 s97, s97, 15466496
s_waitcnt lgkmcnt(4)
D2 v48,v176,s49,v48
D2 v52,v176,v176,v52
D2 v49,v177,s49,v49
D2 v53,v177,v177,v53
D2 v50,v178,s49,v50
D2 v54,v178,v178,v54
D2 v51,v179,s49,v51
D2 v55,v179,v179,v55
D2 v48,v180,s49,v48
D2 v52,v180,v180,v52
D2 v49,v181,s49,v49
D2 v53,v181,v181,v53
D2 v50,v182,s49,v50
D2 v54,v182,v182,v54
D2 v51,v183,s49,v51
D2 v55,v183,v183,v55
D2 v48,v184,s49,v48
D2 v52,v184,v184,v52
D2 v49,v185,s49,v49
D2 v53,v185,v185,v53
D2 v50,v186,s49,v50
D2 v54,v186,v186,v54
D2 v51,v187,s49,v51
D2 v55,v187,v187,v55
D2 v48,v188,s49,v48
D2 v52,v188,v188,v52
D2 v49,v189,s49,v49
D2 v53,v189,v189,v53
D2 v50,v190,s49,v50
D2 v54,v190,v190,v54
D2 v51,v191,s49,v51
D2 v55,v191,v191,v55
s_waitcnt vmcnt(8)
ds_read_b128 v[208:211], v34 offset:12288
ds_read_b128 v[212:215], v35 offset:12288
ds_read_b128 v[216:219], v36 offset:12288
ds_read_b128 v[220:223], v37 offset:12288
s_waitcnt lgkmcnt(4)
s_add_u32 m0, s6, 0
s_bfe_u32 s60, s58, 0x40000
s_mul_i32 s60, s60, 245760
s_add_u32 s60, s60, s40
BL v10,s[20:23],s60 offen lds
D2 v48,v192,s49,v48
D2 v52,v192,v192,v52
D2 v49,v193,s49,v49
D2 v53,v193,v193,v53
D2 v50,v194,s49,v50
D2 v54,v194,v194,v54
D2 v51,v195,s49,v51
BL v11,s[20:23],s60 offen offset:1024 lds
D2 v55,v195,v195,v55
D2 v48,v196,s49,v48
D2 v52,v196,v196,v52
D2 v49,v197,s49,v49
D2 v53,v197,v197,v53
D2 v50,v198,s49,v50
D2 v54,v198,v198,v54
BL v12,s[20:23],s60 offen offset:2048 lds
D2 v51,v199,s49,v51
D2 v55,v199,v199,v55
D2 v48,v200,s49,v48
D2 v52,v200,v200,v52
D2 v49,v201,s49,v49
D2 v53,v201,v201,v53
BL v13,s[20:23],s60 offen offset:3072 lds
D2 v50,v202,s49,v50
D2 v54,v202,v202,v54
D2 v51,v203,s49,v51
D2 v55,v203,v203,v55
D2 v48,v204,s49,v48
D2 v52,v204,v204,v52
s_add_u32 m0, s6, 4096
s_nop 0
BL v14,s[20:23],s60 offen lds
D2 v49,v205,s49,v49
D2 v53,v205,v205,v53
D2 v50,v206,s49,v50
D2 v54,v206,v206,v54
D2 v51,v207,s49,v51
D2 v55,v207,v207,v55
s_waitcnt vmcnt(9)
ds_read_b128 v[224:227], v34 offset:16384
ds_read_b128 v[228:231], v35 offset:16384
ds_read_b128 v[232:235], v36 offset:16384
ds_read_b128 v[236:239], v37 offset:16384
s_waitcnt lgkmcnt(4)
D2 v48,v208,s49,v48
D2 v52,v208,v208,v52
D2 v49,v209,s49,v49
D2 v53,v209,v209,v53
D2 v50,v210,s49,v50
D2 v54,v210,v210,v54
D2 v51,v211,s49,v51
D2 v55,v211,v211,v55
D2 v48,v212,s49,v48
D2 v52,v212,v212,v52
D2 v49,v213,s49,v49
D2 v53,v213,v213,v53
D2 v50,v214,s49,v50
D2 v54,v214,v214,v54
D2 v51,v215,s49,v51
D2 v55,v215,v215,v55
D2 v48,v216,s49,v48
D2 v52,v216,v216,v52
D2 v49,v217,s49,v49
D2 v53,v217,v217,v53
D2 v50,v218,s49,v50
D2 v54,v218,v218,v54
D2 v51,v219,s49,v51
D2 v55,v219,v219,v55
D2 v48,v220,s49,v48
D2 v52,v220,v220,v52
D2 v49,v221,s49,v49
D2 v53,v221,v221,v53
D2 v50,v222,s49,v50
D2 v54,v222,v222,v54
D2 v51,v223,s49,v51
D2 v55,v223,v223,v55
s_waitcnt vmcnt(5)
ds_read_b128 v[240:243], v34 offset:20480
ds_read_b128 v[244:247], v35 offset:20480
ds_read_b128 v[248:251], v36 offset:20480
ds_read_b128 v[252:255], v37 offset:20480
s_waitcnt lgkmcnt(4)
s_add_u32 m0, s6, 5120
s_bfe_u32 s60, s58, 0x40004
s_mul_i32 s60, s60, 245760
s_add_u32 s60, s60, s40
BL v10,s[20:23],s60 offen lds
D2 v48,v224,s49,v48
D2 v52,v224,v224,v52
D2 v49,v225,s49,v49
D2 v53,v225,v225,v53
D2 v50,v226,s49,v50
D2 v54,v226,v226,v54
D2 v51,v227,s49,v51
BL v11,s[20:23],s60 offen offset:1024 lds
D2 v55,v227,v227,v55
D2 v48,v228,s49,v48
D2 v52,v228,v228,v52
D2 v49,v229,s49,v49
D2 v53,v229,v229,v53
D2 v50,v230,s49,v50
D2 v54,v230,v230,v54
BL v12,s[20:23],s60 offen offset:2048 lds
D2 v51,v231,s49,v51
D2 v55,v231,v231,v55
D2 v48,v232,s49,v48
D2 v52,v232,v232,v52
D2 v49,v233,s49,v49
D2 v53,v233,v233,v53
BL v13,s[20:23],s60 offen offset:3072 lds
D2 v50,v234,s49,v50
D2 v54,v234,v234,v54
D2 v51,v235,s49,v51
D2 v55,v235,v235,v55
D2 v48,v236,s49,v48
D2 v52,v236,v236,v52
s_add_u32 m0, s6, 9216
s_nop 0
BL v14,s[20:23],s60 offen lds
D2 v49,v237,s49,v49
D2 v53,v237,v237,v53
D2 v50,v238,s49,v50
D2 v54,v238,v238,v54
D2 v51,v239,s49,v51
D2 v55,v239,v239,v55
s_waitcnt lgkmcnt(0)
D2 v48,v240,s49,v48
D2 v52,v240,v240,v52
D2 v49,v241,s49,v49
D2 v53,v241,v241,v53
D2 v50,v242,s49,v50
D2 v54,v242,v242,v54
D2 v51,v243,s49,v51
D2 v55,v243,v243,v55
D2 v48,v244,s49,v48
D2 v52,v244,v244,v52
D2 v49,v245,s49,v49
D2 v53,v245,v245,v53
D2 v50,v246,s49,v50
D2 v54,v246,v246,v54
D2 v51,v247,s49,v51
D2 v55,v247,v247,v55
D2 v48,v248,s49,v48
D2 v52,v248,v248,v52
D2 v49,v249,s49,v49
D2 v53,v249,v249,v53
D2 v50,v250,s49,v50
D2 v54,v250,v250,v54
D2 v51,v251,s49,v51
D2 v55,v251,v251,v55
D2 v48,v252,s49,v48
D2 v52,v252,v252,v52
D2 v49,v253,s49,v49
D2 v53,v253,v253,v53
D2 v50,v254,s49,v50
D2 v54,v254,v254,v54
D2 v51,v255,s49,v51
D2 v55,v255,v255,v55
s_nop 2
v_add_f32 v48, v48, v49
v_add_f32 v50, v50, v51
v_add_f32 v52, v52, v53
v_add_f32 v54, v54, v55
v_add_f32 v48, v48, v50
v_add_f32 v52, v52, v54
v_mov_b32 v49, v48
v_mov_b32 v53, v52
s_nop 0
v_permlane32_swap_b32 v48, v49
v_permlane32_swap_b32 v52, v53
v_add_f32 v48, v48, v49
v_add_f32 v52, v52, v53
v_mul_f32 v48, 0x3acccccd, v48
v_mul_f32 v52, 0x3acccccd, v52
v_fma_f32 v52, -v48, v48, v52
v_max_f32 v52, 0, v52
CV v50,v48,v52
v_and_b32 v52, s52, v50
v_lshlrev_b32 v48, 16, v50
v_add_f32 v52, 0x3727c5ac, v52
CV v52,v52,v52
v_and_b32 v52, s52, v52
v_sqrt_f32 v52, v52
s_nop 0
CV v52,v52,v52
v_and_b32 v52, s52, v52
v_rcp_f32 v32, v52
s_nop 0
v_mul_f32 v33, v48, v32
v_sub_f32 v33, 0, v33
K1_KVGU_N_chk:
v_cmp_eq_u32 vcc, 0, v26
s_nop 0
s_cmp_eq_u64 vcc, 0
s_cbranch_scc1 K1_KVGU_N_ok
s_cmp_eq_u32 s101, 0
s_cbranch_scc1 K1_KVGU_N_ok
s_sub_u32 s101, s101, 1
s_sleep 10
buffer_load_dword v26, v27, s[28:31], 0 offen sc1
s_waitcnt vmcnt(0)
s_branch K1_KVGU_N_chk
K1_KVGU_N_ok:
s_lshl_b32 s7, s86, 2
s_add_u32 s7, s7, 15532288
buffer_store_dword v26, v20, s[24:27], s7 offen sc1
s_waitcnt vmcnt(6)
s_barrier
TR a[224:225],v2
TR a[226:227],v2 offset:1280
TR a[228:229],v2 offset:80
TR a[230:231],v2 offset:1360
TR a[232:233],v2 offset:160
TR a[234:235],v2 offset:1440
TR a[236:237],v2 offset:240
TR a[238:239],v2 offset:1520
TR a[240:241],v4
TR a[242:243],v4 offset:1280
TR a[244:245],v2 offset:40960
TR a[246:247],v2 offset:42240
TR a[248:249],v2 offset:41040
TR a[250:251],v2 offset:42320
v_lshlrev_b32 v34, 16, v96
v_and_b32 v35, s52, v96
v_lshlrev_b32 v36, 16, v97
v_and_b32 v37, s52, v97
v_lshlrev_b32 v38, 16, v98
v_and_b32 v39, s52, v98
v_lshlrev_b32 v88, 16, v99
v_and_b32 v89, s52, v99
v_fma_f32 v34, v34, v32, v33
v_fma_f32 v35, v35, v32, v33
v_fma_f32 v36, v36, v32, v33
v_fma_f32 v37, v37, v32, v33
v_fma_f32 v38, v38, v32, v33
v_fma_f32 v39, v39, v32, v33
v_fma_f32 v88, v88, v32, v33
v_fma_f32 v89, v89, v32, v33
CV v96,v34,v35
CV v97,v36,v37
CV v98,v38,v39
CV v99,v88,v89
v_lshlrev_b32 v34, 16, v100
v_and_b32 v35, s52, v100
v_lshlrev_b32 v36, 16, v101
v_and_b32 v37, s52, v101
s_waitcnt lgkmcnt(6)
M3 a[0:15],v[96:99],a[224:227],0
TR a[252:253],v2 offset:41120
TR a[254:255],v2 offset:42400
v_lshlrev_b32 v38, 16, v102
v_and_b32 v39, s52, v102
v_lshlrev_b32 v88, 16, v103
v_and_b32 v89, s52, v103
s_add_u32 m0, s6, 10240
s_bfe_u32 s60, s58, 0x40008
s_mul_i32 s60, s60, 245760
s_add_u32 s60, s60, s40
BL v10,s[20:23],s60 offen lds
M3 a[16:31],v[96:99],a[228:231],0
TR a[224:225],v2 offset:41200
TR a[226:227],v2 offset:42480
v_fma_f32 v34, v34, v32, v33
v_fma_f32 v35, v35, v32, v33
v_fma_f32 v36, v36, v32, v33
v_fma_f32 v37, v37, v32, v33
M3 a[32:47],v[96:99],a[232:235],0
TR a[228:229],v4 offset:40960
TR a[230:231],v4 offset:42240
v_fma_f32 v38, v38, v32, v33
v_fma_f32 v39, v39, v32, v33
v_fma_f32 v88, v88, v32, v33
v_fma_f32 v89, v89, v32, v33
BL v11,s[20:23],s60 offen offset:1024 lds
M3 a[48:63],v[96:99],a[236:239],0
TR a[232:233],v3
TR a[234:235],v3 offset:1280
CV v100,v34,v35
CV v101,v36,v37
CV v102,v38,v39
CV v103,v88,v89
s_waitcnt lgkmcnt(6)
M3 a[64:79],v[96:99],a[240:243],0
TR a[236:237],v3 offset:80
TR a[238:239],v3 offset:1360
v_lshlrev_b32 v34, 16, v104
v_and_b32 v35, s52, v104
v_lshlrev_b32 v36, 16, v105
v_and_b32 v37, s52, v105
BL v12,s[20:23],s60 offen offset:2048 lds
M3 a[0:15],v[100:103],a[244:247],a[0:15]
TR a[240:241],v3 offset:160
TR a[242:243],v3 offset:1440
v_lshlrev_b32 v38, 16, v106
v_and_b32 v39, s52, v106
v_lshlrev_b32 v88, 16, v107
v_and_b32 v89, s52, v107
M3 a[16:31],v[100:103],a[248:251],a[16:31]
TR a[244:245],v3 offset:240
TR a[246:247],v3 offset:1520
v_fma_f32 v34, v34, v32, v33
v_fma_f32 v35, v35, v32, v33
v_fma_f32 v36, v36, v32, v33
v_fma_f32 v37, v37, v32, v33
BL v13,s[20:23],s60 offen offset:3072 lds
M3 a[32:47],v[100:103],a[252:255],a[32:47]
TR a[248:249],v5
TR a[250:251],v5 offset:1280
v_fma_f32 v38, v38, v32, v33
v_fma_f32 v39, v39, v32, v33
v_fma_f32 v88, v88, v32, v33
v_fma_f32 v89, v89, v32, v33
s_waitcnt lgkmcnt(6)
M3 a[48:63],v[100:103],a[224:227],a[48:63]
TR a[252:253],v3 offset:40960
TR a[254:255],v3 offset:42240
CV v104,v34,v35
CV v105,v36,v37
CV v106,v38,v39
CV v107,v88,v89
s_add_u32 m0, s6, 14336
s_nop 0
BL v14,s[20:23],s60 offen lds
M3 a[64:79],v[100:103],a[228:231],a[64:79]
TR a[224:225],v3 offset:41040
TR a[226:227],v3 offset:42320
v_lshlrev_b32 v34, 16, v108
v_and_b32 v35, s52, v108
v_lshlrev_b32 v36, 16, v109
v_and_b32 v37, s52, v109
M3 a[0:15],v[104:107],a[232:235],a[0:15]
TR a[228:229],v3 offset:41120
TR a[230:231],v3 offset:42400
v_lshlrev_b32 v38, 16, v110
v_and_b32 v39, s52, v110
v_lshlrev_b32 v88, 16, v111
v_and_b32 v89, s52, v111
s_add_u32 m0, s6, 15360
s_bfe_u32 s60, s58, 0x4000c
s_mul_i32 s60, s60, 245760
s_add_u32 s60, s60, s40
BL v10,s[20:23],s60 offen lds
M3 a[16:31],v[104:107],a[236:239],a[16:31]
TR a[232:233],v3 offset:41200
TR a[234:235],v3 offset:42480
v_fma_f32 v34, v34, v32, v33
v_fma_f32 v35, v35, v32, v33
v_fma_f32 v36, v36, v32, v33
v_fma_f32 v37, v37, v32, v33
s_waitcnt lgkmcnt(6)
M3 a[32:47],v[104:107],a[240:243],a[32:47]
TR a[236:237],v5 offset:40960
TR a[238:239],v5 offset:42240
v_fma_f32 v38, v38, v32, v33
v_fma_f32 v39, v39, v32, v33
v_fma_f32 v88, v88, v32, v33
v_fma_f32 v89, v89, v32, v33
BL v11,s[20:23],s60 offen offset:1024 lds
M3 a[48:63],v[104:107],a[244:247],a[48:63]
CV v108,v34,v35
CV v109,v36,v37
CV v110,v38,v39
CV v111,v88,v89
M3 a[64:79],v[104:107],a[248:251],a[64:79]
v_lshlrev_b32 v34, 16, v112
v_and_b32 v35, s52, v112
v_lshlrev_b32 v36, 16, v113
v_and_b32 v37, s52, v113
BL v12,s[20:23],s60 offen offset:2048 lds
M3 a[0:15],v[108:111],a[252:255],a[0:15]
s_waitcnt vmcnt(9) lgkmcnt(0)
s_barrier
TR a[240:241],v2 offset:5120
TR a[242:243],v2 offset:6400
TR a[244:245],v2 offset:5200
TR a[246:247],v2 offset:6480
v_lshlrev_b32 v38, 16, v114
v_and_b32 v39, s52, v114
v_lshlrev_b32 v88, 16, v115
v_and_b32 v89, s52, v115
M3 a[16:31],v[108:111],a[224:227],a[16:31]
TR a[248:249],v2 offset:5280
TR a[250:251],v2 offset:6560
TR a[252:253],v2 offset:5360
TR a[254:255],v2 offset:6640
v_fma_f32 v34, v34, v32, v33
v_fma_f32 v35, v35, v32, v33
v_fma_f32 v36, v36, v32, v33
v_fma_f32 v37, v37, v32, v33
BL v13,s[20:23],s60 offen offset:3072 lds
M3 a[32:47],v[108:111],a[228:231],a[32:47]
TR a[224:225],v4 offset:5120
TR a[226:227],v4 offset:6400
v_fma_f32 v38, v38, v32, v33
v_fma_f32 v39, v39, v32, v33
v_fma_f32 v88, v88, v32, v33
v_fma_f32 v89, v89, v32, v33
M3 a[48:63],v[108:111],a[232:235],a[48:63]
TR a[228:229],v2 offset:46080
TR a[230:231],v2 offset:47360
CV v112,v34,v35
CV v113,v36,v37
CV v114,v38,v39
CV v115,v88,v89
s_add_u32 m0, s6, 19456
s_nop 0
BL v14,s[20:23],s60 offen lds
M3 a[64:79],v[108:111],a[236:239],a[64:79]
TR a[232:233],v2 offset:46160
TR a[234:235],v2 offset:47440
v_lshlrev_b32 v34, 16, v116
v_and_b32 v35, s52, v116
v_lshlrev_b32 v36, 16, v117
v_and_b32 v37, s52, v117
s_waitcnt lgkmcnt(6)
M3 a[0:15],v[112:115],a[240:243],a[0:15]
TR a[236:237],v2 offset:46240
TR a[238:239],v2 offset:47520
v_lshlrev_b32 v38, 16, v118
v_and_b32 v39, s52, v118
v_lshlrev_b32 v88, 16, v119
v_and_b32 v89, s52, v119
s_add_u32 m0, s6, 20480
s_bfe_u32 s60, s58, 0x40010
s_mul_i32 s60, s60, 245760
s_add_u32 s60, s60, s40
BL v10,s[20:23],s60 offen lds
M3 a[16:31],v[112:115],a[244:247],a[16:31]
TR a[240:241],v2 offset:46320
TR a[242:243],v2 offset:47600
v_fma_f32 v34, v34, v32, v33
v_fma_f32 v35, v35, v32, v33
v_fma_f32 v36, v36, v32, v33
v_fma_f32 v37, v37, v32, v33
M3 a[32:47],v[112:115],a[248:251],a[32:47]
TR a[244:245],v4 offset:46080
TR a[246:247],v4 offset:47360
v_fma_f32 v38, v38, v32, v33
v_fma_f32 v39, v39, v32, v33
v_fma_f32 v88, v88, v32, v33
v_fma_f32 v89, v89, v32, v33
BL v11,s[20:23],s60 offen offset:1024 lds
M3 a[48:63],v[112:115],a[252:255],a[48:63]
TR a[248:249],v3 offset:5120
TR a[250:251],v3 offset:6400
CV v116,v34,v35
CV v117,v36,v37
CV v118,v38,v39
CV v119,v88,v89
s_waitcnt lgkmcnt(6)
M3 a[64:79],v[112:115],a[224:227],a[64:79]
TR a[252:253],v3 offset:5200
TR a[254:255],v3 offset:6480
v_lshlrev_b32 v34, 16, v120
v_and_b32 v35, s52, v120
v_lshlrev_b32 v36, 16, v121
v_and_b32 v37, s52, v121
BL v12,s[20:23],s60 offen offset:2048 lds
M3 a[0:15],v[116:119],a[228:231],a[0:15]
TR a[224:225],v3 offset:5280
TR a[226:227],v3 offset:6560
v_lshlrev_b32 v38, 16, v122
v_and_b32 v39, s52, v122
v_lshlrev_b32 v88, 16, v123
v_and_b32 v89, s52, v123
M3 a[16:31],v[116:119],a[232:235],a[16:31]
TR a[228:229],v3 offset:5360
TR a[230:231],v3 offset:6640
v_fma_f32 v34, v34, v32, v33
v_fma_f32 v35, v35, v32, v33
v_fma_f32 v36, v36, v32, v33
v_fma_f32 v37, v37, v32, v33
BL v13,s[20:23],s60 offen offset:3072 lds
M3 a[32:47],v[116:119],a[236:239],a[32:47]
TR a[232:233],v5 offset:5120
TR a[234:235],v5 offset:6400
v_fma_f32 v38, v38, v32, v33
v_fma_f32 v39, v39, v32, v33
v_fma_f32 v88, v88, v32, v33
v_fma_f32 v89, v89, v32, v33
s_waitcnt lgkmcnt(6)
M3 a[48:63],v[116:119],a[240:243],a[48:63]
TR a[236:237],v3 offset:46080
TR a[238:239],v3 offset:47360
CV v120,v34,v35
CV v121,v36,v37
CV v122,v38,v39
CV v123,v88,v89
s_add_u32 m0, s6, 24576
s_nop 0
BL v14,s[20:23],s60 offen lds
M3 a[64:79],v[116:119],a[244:247],a[64:79]
TR a[240:241],v3 offset:46160
TR a[242:243],v3 offset:47440
v_lshlrev_b32 v34, 16, v124
v_and_b32 v35, s52, v124
v_lshlrev_b32 v36, 16, v125
v_and_b32 v37, s52, v125
M3 a[0:15],v[120:123],a[248:251],a[0:15]
TR a[244:245],v3 offset:46240
TR a[246:247],v3 offset:47520
v_lshlrev_b32 v38, 16, v126
v_and_b32 v39, s52, v126
v_lshlrev_b32 v88, 16, v127
v_and_b32 v89, s52, v127
s_add_u32 m0, s6, 0
s_bfe_u32 s60, s58, 0x40014
s_mul_i32 s60, s60, 245760
s_add_u32 s60, s60, s40
BL v10,s[20:23],s60 offen lds
M3 a[16:31],v[120:123],a[252:255],a[16:31]
TR a[248:249],v3 offset:46320
TR a[250:251],v3 offset:47600
v_fma_f32 v34, v34, v32, v33
v_fma_f32 v35, v35, v32, v33
v_fma_f32 v36, v36, v32, v33
v_fma_f32 v37, v37, v32, v33
s_waitcnt lgkmcnt(6)
M3 a[32:47],v[120:123],a[224:227],a[32:47]
TR a[252:253],v5 offset:46080
TR a[254:255],v5 offset:47360
v_fma_f32 v38, v38, v32, v33
v_fma_f32 v39, v39, v32, v33
v_fma_f32 v88, v88, v32, v33
v_fma_f32 v89, v89, v32, v33
BL v11,s[20:23],s60 offen offset:1024 lds
M3 a[48:63],v[120:123],a[228:231],a[48:63]
CV v124,v34,v35
CV v125,v36,v37
CV v126,v38,v39
CV v127,v88,v89
M3 a[64:79],v[120:123],a[232:235],a[64:79]
v_lshlrev_b32 v34, 16, v128
v_and_b32 v35, s52, v128
v_lshlrev_b32 v36, 16, v129
v_and_b32 v37, s52, v129
BL v12,s[20:23],s60 offen offset:2048 lds
M3 a[0:15],v[124:127],a[236:239],a[0:15]
s_waitcnt vmcnt(13) lgkmcnt(0)
s_barrier
TR a[224:225],v2 offset:10240
TR a[226:227],v2 offset:11520
TR a[228:229],v2 offset:10320
TR a[230:231],v2 offset:11600
v_lshlrev_b32 v38, 16, v130
v_and_b32 v39, s52, v130
v_lshlrev_b32 v88, 16, v131
v_and_b32 v89, s52, v131
M3 a[16:31],v[124:127],a[240:243],a[16:31]
TR a[232:233],v2 offset:10400
TR a[234:235],v2 offset:11680
TR a[236:237],v2 offset:10480
TR a[238:239],v2 offset:11760
v_fma_f32 v34, v34, v32, v33
v_fma_f32 v35, v35, v32, v33
v_fma_f32 v36, v36, v32, v33
v_fma_f32 v37, v37, v32, v33
BL v13,s[20:23],s60 offen offset:3072 lds
M3 a[32:47],v[124:127],a[244:247],a[32:47]
TR a[240:241],v4 offset:10240
TR a[242:243],v4 offset:11520
v_fma_f32 v38, v38, v32, v33
v_fma_f32 v39, v39, v32, v33
v_fma_f32 v88, v88, v32, v33
v_fma_f32 v89, v89, v32, v33
M3 a[48:63],v[124:127],a[248:251],a[48:63]
TR a[244:245],v2 offset:51200
TR a[246:247],v2 offset:52480
CV v128,v34,v35
CV v129,v36,v37
CV v130,v38,v39
CV v131,v88,v89
s_add_u32 m0, s6, 4096
s_nop 0
BL v14,s[20:23],s60 offen lds
M3 a[64:79],v[124:127],a[252:255],a[64:79]
TR a[248:249],v2 offset:51280
TR a[250:251],v2 offset:52560
v_lshlrev_b32 v34, 16, v132
v_and_b32 v35, s52, v132
v_lshlrev_b32 v36, 16, v133
v_and_b32 v37, s52, v133
s_waitcnt lgkmcnt(6)
M3 a[0:15],v[128:131],a[224:227],a[0:15]
TR a[252:253],v2 offset:51360
TR a[254:255],v2 offset:52640
v_lshlrev_b32 v38, 16, v134
v_and_b32 v39, s52, v134
v_lshlrev_b32 v88, 16, v135
v_and_b32 v89, s52, v135
s_add_u32 m0, s6, 5120
s_bfe_u32 s60, s58, 0x40018
s_mul_i32 s60, s60, 245760
s_add_u32 s60, s60, s40
BL v10,s[20:23],s60 offen lds
M3 a[16:31],v[128:131],a[228:231],a[16:31]
TR a[224:225],v2 offset:51440
TR a[226:227],v2 offset:52720
v_fma_f32 v34, v34, v32, v33
v_fma_f32 v35, v35, v32, v33
v_fma_f32 v36, v36, v32, v33
v_fma_f32 v37, v37, v32, v33
M3 a[32:47],v[128:131],a[232:235],a[32:47]
TR a[228:229],v4 offset:51200
TR a[230:231],v4 offset:52480
v_fma_f32 v38, v38, v32, v33
v_fma_f32 v39, v39, v32, v33
v_fma_f32 v88, v88, v32, v33
v_fma_f32 v89, v89, v32, v33
BL v11,s[20:23],s60 offen offset:1024 lds
M3 a[48:63],v[128:131],a[236:239],a[48:63]
TR a[232:233],v3 offset:10240
TR a[234:235],v3 offset:11520
CV v132,v34,v35
CV v133,v36,v37
CV v134,v38,v39
CV v135,v88,v89
s_waitcnt lgkmcnt(6)
M3 a[64:79],v[128:131],a[240:243],a[64:79]
TR a[236:237],v3 offset:10320
TR a[238:239],v3 offset:11600
v_lshlrev_b32 v34, 16, v136
v_and_b32 v35, s52, v136
v_lshlrev_b32 v36, 16, v137
v_and_b32 v37, s52, v137
BL v12,s[20:23],s60 offen offset:2048 lds
M3 a[0:15],v[132:135],a[244:247],a[0:15]
TR a[240:241],v3 offset:10400
TR a[242:243],v3 offset:11680
v_lshlrev_b32 v38, 16, v138
v_and_b32 v39, s52, v138
v_lshlrev_b32 v88, 16, v139
v_and_b32 v89, s52, v139
M3 a[16:31],v[132:135],a[248:251],a[16:31]
TR a[244:245],v3 offset:10480
TR a[246:247],v3 offset:11760
v_fma_f32 v34, v34, v32, v33
v_fma_f32 v35, v35, v32, v33
v_fma_f32 v36, v36, v32, v33
v_fma_f32 v37, v37, v32, v33
BL v13,s[20:23],s60 offen offset:3072 lds
M3 a[32:47],v[132:135],a[252:255],a[32:47]
TR a[248:249],v5 offset:10240
TR a[250:251],v5 offset:11520
v_fma_f32 v38, v38, v32, v33
v_fma_f32 v39, v39, v32, v33
v_fma_f32 v88, v88, v32, v33
v_fma_f32 v89, v89, v32, v33
s_waitcnt lgkmcnt(6)
M3 a[48:63],v[132:135],a[224:227],a[48:63]
TR a[252:253],v3 offset:51200
TR a[254:255],v3 offset:52480
CV v136,v34,v35
CV v137,v36,v37
CV v138,v38,v39
CV v139,v88,v89
s_add_u32 m0, s6, 9216
s_nop 0
BL v14,s[20:23],s60 offen lds
M3 a[64:79],v[132:135],a[228:231],a[64:79]
TR a[224:225],v3 offset:51280
TR a[226:227],v3 offset:52560
v_lshlrev_b32 v34, 16, v140
v_and_b32 v35, s52, v140
v_lshlrev_b32 v36, 16, v141
v_and_b32 v37, s52, v141
M3 a[0:15],v[136:139],a[232:235],a[0:15]
TR a[228:229],v3 offset:51360
TR a[230:231],v3 offset:52640
v_lshlrev_b32 v38, 16, v142
v_and_b32 v39, s52, v142
v_lshlrev_b32 v88, 16, v143
v_and_b32 v89, s52, v143
M3 a[16:31],v[136:139],a[236:239],a[16:31]
TR a[232:233],v3 offset:51440
TR a[234:235],v3 offset:52720
v_fma_f32 v34, v34, v32, v33
v_fma_f32 v35, v35, v32, v33
v_fma_f32 v36, v36, v32, v33
v_fma_f32 v37, v37, v32, v33
s_waitcnt lgkmcnt(6)
M3 a[32:47],v[136:139],a[240:243],a[32:47]
TR a[236:237],v5 offset:51200
TR a[238:239],v5 offset:52480
v_fma_f32 v38, v38, v32, v33
v_fma_f32 v39, v39, v32, v33
v_fma_f32 v88, v88, v32, v33
v_fma_f32 v89, v89, v32, v33
M3 a[48:63],v[136:139],a[244:247],a[48:63]
CV v140,v34,v35
CV v141,v36,v37
CV v142,v38,v39
CV v143,v88,v89
M3 a[64:79],v[136:139],a[248:251],a[64:79]
v_lshlrev_b32 v34, 16, v144
v_and_b32 v35, s52, v144
v_lshlrev_b32 v36, 16, v145
v_and_b32 v37, s52, v145
M3 a[0:15],v[140:143],a[252:255],a[0:15]
s_waitcnt vmcnt(15) lgkmcnt(0)
s_barrier
TR a[240:241],v2 offset:15360
TR a[242:243],v2 offset:16640
TR a[244:245],v2 offset:15440
TR a[246:247],v2 offset:16720
v_lshlrev_b32 v38, 16, v146
v_and_b32 v39, s52, v146
v_lshlrev_b32 v88, 16, v147
v_and_b32 v89, s52, v147
M3 a[16:31],v[140:143],a[224:227],a[16:31]
TR a[248:249],v2 offset:15520
TR a[250:251],v2 offset:16800
TR a[252:253],v2 offset:15600
TR a[254:255],v2 offset:16880
v_fma_f32 v34, v34, v32, v33
v_fma_f32 v35, v35, v32, v33
v_fma_f32 v36, v36, v32, v33
v_fma_f32 v37, v37, v32, v33
s_add_u32 m0, s6, 10240
s_bfe_u32 s60, s58, 0x4001c
s_mul_i32 s60, s60, 245760
s_add_u32 s60, s60, s40
BL v10,s[20:23],s60 offen lds
M3 a[32:47],v[140:143],a[228:231],a[32:47]
TR a[224:225],v4 offset:15360
TR a[226:227],v4 offset:16640
v_fma_f32 v38, v38, v32, v33
v_fma_f32 v39, v39, v32, v33
v_fma_f32 v88, v88, v32, v33
v_fma_f32 v89, v89, v32, v33
M3 a[48:63],v[140:143],a[232:235],a[48:63]
TR a[228:229],v2 offset:56320
TR a[230:231],v2 offset:57600
CV v144,v34,v35
CV v145,v36,v37
CV v146,v38,v39
CV v147,v88,v89
BL v11,s[20:23],s60 offen offset:1024 lds
M3 a[64:79],v[140:143],a[236:239],a[64:79]
TR a[232:233],v2 offset:56400
TR a[234:235],v2 offset:57680
v_lshlrev_b32 v34, 16, v148
v_and_b32 v35, s52, v148
v_lshlrev_b32 v36, 16, v149
v_and_b32 v37, s52, v149
s_waitcnt lgkmcnt(6)
M3 a[0:15],v[144:147],a[240:243],a[0:15]
TR a[236:237],v2 offset:56480
TR a[238:239],v2 offset:57760
v_lshlrev_b32 v38, 16, v150
v_and_b32 v39, s52, v150
v_lshlrev_b32 v88, 16, v151
v_and_b32 v89, s52, v151
BL v12,s[20:23],s60 offen offset:2048 lds
M3 a[16:31],v[144:147],a[244:247],a[16:31]
TR a[240:241],v2 offset:56560
TR a[242:243],v2 offset:57840
v_fma_f32 v34, v34, v32, v33
v_fma_f32 v35, v35, v32, v33
v_fma_f32 v36, v36, v32, v33
v_fma_f32 v37, v37, v32, v33
M3 a[32:47],v[144:147],a[248:251],a[32:47]
TR a[244:245],v4 offset:56320
TR a[246:247],v4 offset:57600
v_fma_f32 v38, v38, v32, v33
v_fma_f32 v39, v39, v32, v33
v_fma_f32 v88, v88, v32, v33
v_fma_f32 v89, v89, v32, v33
BL v13,s[20:23],s60 offen offset:3072 lds
M3 a[48:63],v[144:147],a[252:255],a[48:63]
TR a[248:249],v3 offset:15360
TR a[250:251],v3 offset:16640
CV v148,v34,v35
CV v149,v36,v37
CV v150,v38,v39
CV v151,v88,v89
s_waitcnt lgkmcnt(6)
M3 a[64:79],v[144:147],a[224:227],a[64:79]
TR a[252:253],v3 offset:15440
TR a[254:255],v3 offset:16720
v_lshlrev_b32 v34, 16, v152
v_and_b32 v35, s52, v152
v_lshlrev_b32 v36, 16, v153
v_and_b32 v37, s52, v153
s_add_u32 m0, s6, 14336
s_nop 0
BL v14,s[20:23],s60 offen lds
M3 a[0:15],v[148:151],a[228:231],a[0:15]
TR a[224:225],v3 offset:15520
TR a[226:227],v3 offset:16800
v_lshlrev_b32 v38, 16, v154
v_and_b32 v39, s52, v154
v_lshlrev_b32 v88, 16, v155
v_and_b32 v89, s52, v155
M3 a[16:31],v[148:151],a[232:235],a[16:31]
TR a[228:229],v3 offset:15600
TR a[230:231],v3 offset:16880
v_fma_f32 v34, v34, v32, v33
v_fma_f32 v35, v35, v32, v33
v_fma_f32 v36, v36, v32, v33
v_fma_f32 v37, v37, v32, v33
M3 a[32:47],v[148:151],a[236:239],a[32:47]
TR a[232:233],v5 offset:15360
TR a[234:235],v5 offset:16640
v_fma_f32 v38, v38, v32, v33
v_fma_f32 v39, v39, v32, v33
v_fma_f32 v88, v88, v32, v33
v_fma_f32 v89, v89, v32, v33
s_waitcnt lgkmcnt(6)
M3 a[48:63],v[148:151],a[240:243],a[48:63]
TR a[236:237],v3 offset:56320
TR a[238:239],v3 offset:57600
CV v152,v34,v35
CV v153,v36,v37
CV v154,v38,v39
CV v155,v88,v89
M3 a[64:79],v[148:151],a[244:247],a[64:79]
TR a[240:241],v3 offset:56400
TR a[242:243],v3 offset:57680
v_lshlrev_b32 v34, 16, v156
v_and_b32 v35, s52, v156
v_lshlrev_b32 v36, 16, v157
v_and_b32 v37, s52, v157
M3 a[0:15],v[152:155],a[248:251],a[0:15]
TR a[244:245],v3 offset:56480
TR a[246:247],v3 offset:57760
v_lshlrev_b32 v38, 16, v158
v_and_b32 v39, s52, v158
v_lshlrev_b32 v88, 16, v159
v_and_b32 v89, s52, v159
M3 a[16:31],v[152:155],a[252:255],a[16:31]
TR a[248:249],v3 offset:56560
TR a[250:251],v3 offset:57840
v_fma_f32 v34, v34, v32, v33
v_fma_f32 v35, v35, v32, v33
v_fma_f32 v36, v36, v32, v33
v_fma_f32 v37, v37, v32, v33
s_waitcnt lgkmcnt(6)
M3 a[32:47],v[152:155],a[224:227],a[32:47]
TR a[252:253],v5 offset:56320
TR a[254:255],v5 offset:57600
v_fma_f32 v38, v38, v32, v33
v_fma_f32 v39, v39, v32, v33
v_fma_f32 v88, v88, v32, v33
v_fma_f32 v89, v89, v32, v33
M3 a[48:63],v[152:155],a[228:231],a[48:63]
CV v156,v34,v35
CV v157,v36,v37
CV v158,v38,v39
CV v159,v88,v89
M3 a[64:79],v[152:155],a[232:235],a[64:79]
v_lshlrev_b32 v34, 16, v160
v_and_b32 v35, s52, v160
v_lshlrev_b32 v36, 16, v161
v_and_b32 v37, s52, v161
M3 a[0:15],v[156:159],a[236:239],a[0:15]
s_waitcnt vmcnt(15) lgkmcnt(0)
s_barrier
TR a[224:225],v2 offset:20480
TR a[226:227],v2 offset:21760
TR a[228:229],v2 offset:20560
TR a[230:231],v2 offset:21840
v_lshlrev_b32 v38, 16, v162
v_and_b32 v39, s52, v162
v_lshlrev_b32 v88, 16, v163
v_and_b32 v89, s52, v163
M3 a[16:31],v[156:159],a[240:243],a[16:31]
TR a[232:233],v2 offset:20640
TR a[234:235],v2 offset:21920
TR a[236:237],v2 offset:20720
TR a[238:239],v2 offset:22000
v_fma_f32 v34, v34, v32, v33
v_fma_f32 v35, v35, v32, v33
v_fma_f32 v36, v36, v32, v33
v_fma_f32 v37, v37, v32, v33
s_add_u32 m0, s6, 15360
s_bfe_u32 s60, s59, 0x40000
s_mul_i32 s60, s60, 245760
s_add_u32 s60, s60, s40
BL v10,s[20:23],s60 offen lds
M3 a[32:47],v[156:159],a[244:247],a[32:47]
TR a[240:241],v4 offset:20480
TR a[242:243],v4 offset:21760
v_fma_f32 v38, v38, v32, v33
v_fma_f32 v39, v39, v32, v33
v_fma_f32 v88, v88, v32, v33
v_fma_f32 v89, v89, v32, v33
M3 a[48:63],v[156:159],a[248:251],a[48:63]
TR a[244:245],v2 offset:61440
TR a[246:247],v2 offset:62720
CV v160,v34,v35
CV v161,v36,v37
CV v162,v38,v39
CV v163,v88,v89
BL v11,s[20:23],s60 offen offset:1024 lds
M3 a[64:79],v[156:159],a[252:255],a[64:79]
TR a[248:249],v2 offset:61520
TR a[250:251],v2 offset:62800
v_lshlrev_b32 v34, 16, v164
v_and_b32 v35, s52, v164
v_lshlrev_b32 v36, 16, v165
v_and_b32 v37, s52, v165
s_waitcnt lgkmcnt(6)
M3 a[0:15],v[160:163],a[224:227],a[0:15]
TR a[252:253],v2 offset:61600
TR a[254:255],v2 offset:62880
v_lshlrev_b32 v38, 16, v166
v_and_b32 v39, s52, v166
v_lshlrev_b32 v88, 16, v167
v_and_b32 v89, s52, v167
BL v12,s[20:23],s60 offen offset:2048 lds
M3 a[16:31],v[160:163],a[228:231],a[16:31]
TR a[224:225],v2 offset:61680
TR a[226:227],v2 offset:62960
v_fma_f32 v34, v34, v32, v33
v_fma_f32 v35, v35, v32, v33
v_fma_f32 v36, v36, v32, v33
v_fma_f32 v37, v37, v32, v33
M3 a[32:47],v[160:163],a[232:235],a[32:47]
TR a[228:229],v4 offset:61440
TR a[230:231],v4 offset:62720
v_fma_f32 v38, v38, v32, v33
v_fma_f32 v39, v39, v32, v33
v_fma_f32 v88, v88, v32, v33
v_fma_f32 v89, v89, v32, v33
BL v13,s[20:23],s60 offen offset:3072 lds
M3 a[48:63],v[160:163],a[236:239],a[48:63]
TR a[232:233],v3 offset:20480
TR a[234:235],v3 offset:21760
CV v164,v34,v35
CV v165,v36,v37
CV v166,v38,v39
CV v167,v88,v89
s_waitcnt lgkmcnt(6)
M3 a[64:79],v[160:163],a[240:243],a[64:79]
TR a[236:237],v3 offset:20560
TR a[238:239],v3 offset:21840
v_lshlrev_b32 v34, 16, v168
v_and_b32 v35, s52, v168
v_lshlrev_b32 v36, 16, v169
v_and_b32 v37, s52, v169
s_add_u32 m0, s6, 19456
s_nop 0
BL v14,s[20:23],s60 offen lds
M3 a[0:15],v[164:167],a[244:247],a[0:15]
TR a[240:241],v3 offset:20640
TR a[242:243],v3 offset:21920
v_lshlrev_b32 v38, 16, v170
v_and_b32 v39, s52, v170
v_lshlrev_b32 v88, 16, v171
v_and_b32 v89, s52, v171
M3 a[16:31],v[164:167],a[248:251],a[16:31]
TR a[244:245],v3 offset:20720
TR a[246:247],v3 offset:22000
v_fma_f32 v34, v34, v32, v33
v_fma_f32 v35, v35, v32, v33
v_fma_f32 v36, v36, v32, v33
v_fma_f32 v37, v37, v32, v33
M3 a[32:47],v[164:167],a[252:255],a[32:47]
TR a[248:249],v5 offset:20480
TR a[250:251],v5 offset:21760
v_fma_f32 v38, v38, v32, v33
v_fma_f32 v39, v39, v32, v33
v_fma_f32 v88, v88, v32, v33
v_fma_f32 v89, v89, v32, v33
s_waitcnt lgkmcnt(6)
M3 a[48:63],v[164:167],a[224:227],a[48:63]
TR a[252:253],v3 offset:61440
TR a[254:255],v3 offset:62720
CV v168,v34,v35
CV v169,v36,v37
CV v170,v38,v39
CV v171,v88,v89
M3 a[64:79],v[164:167],a[228:231],a[64:79]
TR a[224:225],v3 offset:61520
TR a[226:227],v3 offset:62800
v_lshlrev_b32 v34, 16, v172
v_and_b32 v35, s52, v172
v_lshlrev_b32 v36, 16, v173
v_and_b32 v37, s52, v173
M3 a[0:15],v[168:171],a[232:235],a[0:15]
TR a[228:229],v3 offset:61600
TR a[230:231],v3 offset:62880
v_lshlrev_b32 v38, 16, v174
v_and_b32 v39, s52, v174
v_lshlrev_b32 v88, 16, v175
v_and_b32 v89, s52, v175
M3 a[16:31],v[168:171],a[236:239],a[16:31]
TR a[232:233],v3 offset:61680
TR a[234:235],v3 offset:62960
v_fma_f32 v34, v34, v32, v33
v_fma_f32 v35, v35, v32, v33
v_fma_f32 v36, v36, v32, v33
v_fma_f32 v37, v37, v32, v33
s_waitcnt lgkmcnt(6)
M3 a[32:47],v[168:171],a[240:243],a[32:47]
TR a[236:237],v5 offset:61440
TR a[238:239],v5 offset:62720
v_fma_f32 v38, v38, v32, v33
v_fma_f32 v39, v39, v32, v33
v_fma_f32 v88, v88, v32, v33
v_fma_f32 v89, v89, v32, v33
M3 a[48:63],v[168:171],a[244:247],a[48:63]
CV v172,v34,v35
CV v173,v36,v37
CV v174,v38,v39
CV v175,v88,v89
M3 a[64:79],v[168:171],a[248:251],a[64:79]
v_lshlrev_b32 v34, 16, v176
v_and_b32 v35, s52, v176
v_lshlrev_b32 v36, 16, v177
v_and_b32 v37, s52, v177
M3 a[0:15],v[172:175],a[252:255],a[0:15]
s_waitcnt vmcnt(15) lgkmcnt(0)
s_barrier
TR a[240:241],v2
TR a[242:243],v2 offset:1280
TR a[244:245],v2 offset:80
TR a[246:247],v2 offset:1360
v_lshlrev_b32 v38, 16, v178
v_and_b32 v39, s52, v178
v_lshlrev_b32 v88, 16, v179
v_and_b32 v89, s52, v179
M3 a[16:31],v[172:175],a[224:227],a[16:31]
TR a[248:249],v2 offset:160
TR a[250:251],v2 offset:1440
TR a[252:253],v2 offset:240
TR a[254:255],v2 offset:1520
v_fma_f32 v34, v34, v32, v33
v_fma_f32 v35, v35, v32, v33
v_fma_f32 v36, v36, v32, v33
v_fma_f32 v37, v37, v32, v33
s_add_u32 m0, s6, 20480
s_bfe_u32 s60, s59, 0x40004
s_mul_i32 s60, s60, 245760
s_add_u32 s60, s60, s40
BL v10,s[20:23],s60 offen lds
M3 a[32:47],v[172:175],a[228:231],a[32:47]
TR a[224:225],v4
TR a[226:227],v4 offset:1280
v_fma_f32 v38, v38, v32, v33
v_fma_f32 v39, v39, v32, v33
v_fma_f32 v88, v88, v32, v33
v_fma_f32 v89, v89, v32, v33
M3 a[48:63],v[172:175],a[232:235],a[48:63]
TR a[228:229],v2 offset:40960
TR a[230:231],v2 offset:42240
CV v176,v34,v35
CV v177,v36,v37
CV v178,v38,v39
CV v179,v88,v89
BL v11,s[20:23],s60 offen offset:1024 lds
M3 a[64:79],v[172:175],a[236:239],a[64:79]
TR a[232:233],v2 offset:41040
TR a[234:235],v2 offset:42320
v_lshlrev_b32 v34, 16, v180
v_and_b32 v35, s52, v180
v_lshlrev_b32 v36, 16, v181
v_and_b32 v37, s52, v181
s_waitcnt lgkmcnt(6)
M3 a[0:15],v[176:179],a[240:243],a[0:15]
TR a[236:237],v2 offset:41120
TR a[238:239],v2 offset:42400
v_lshlrev_b32 v38, 16, v182
v_and_b32 v39, s52, v182
v_lshlrev_b32 v88, 16, v183
v_and_b32 v89, s52, v183
BL v12,s[20:23],s60 offen offset:2048 lds
M3 a[16:31],v[176:179],a[244:247],a[16:31]
TR a[240:241],v2 offset:41200
TR a[242:243],v2 offset:42480
v_fma_f32 v34, v34, v32, v33
v_fma_f32 v35, v35, v32, v33
v_fma_f32 v36, v36, v32, v33
v_fma_f32 v37, v37, v32, v33
M3 a[32:47],v[176:179],a[248:251],a[32:47]
TR a[244:245],v4 offset:40960
TR a[246:247],v4 offset:42240
v_fma_f32 v38, v38, v32, v33
v_fma_f32 v39, v39, v32, v33
v_fma_f32 v88, v88, v32, v33
v_fma_f32 v89, v89, v32, v33
BL v13,s[20:23],s60 offen offset:3072 lds
M3 a[48:63],v[176:179],a[252:255],a[48:63]
TR a[248:249],v3
TR a[250:251],v3 offset:1280
CV v180,v34,v35
CV v181,v36,v37
CV v182,v38,v39
CV v183,v88,v89
s_waitcnt lgkmcnt(6)
M3 a[64:79],v[176:179],a[224:227],a[64:79]
TR a[252:253],v3 offset:80
TR a[254:255],v3 offset:1360
v_lshlrev_b32 v34, 16, v184
v_and_b32 v35, s52, v184
v_lshlrev_b32 v36, 16, v185
v_and_b32 v37, s52, v185
s_add_u32 m0, s6, 24576
s_nop 0
BL v14,s[20:23],s60 offen lds
M3 a[0:15],v[180:183],a[228:231],a[0:15]
TR a[224:225],v3 offset:160
TR a[226:227],v3 offset:1440
v_lshlrev_b32 v38, 16, v186
v_and_b32 v39, s52, v186
v_lshlrev_b32 v88, 16, v187
v_and_b32 v89, s52, v187
M3 a[16:31],v[180:183],a[232:235],a[16:31]
TR a[228:229],v3 offset:240
TR a[230:231],v3 offset:1520
v_fma_f32 v34, v34, v32, v33
v_fma_f32 v35, v35, v32, v33
v_fma_f32 v36, v36, v32, v33
v_fma_f32 v37, v37, v32, v33
M3 a[32:47],v[180:183],a[236:239],a[32:47]
TR a[232:233],v5
TR a[234:235],v5 offset:1280
v_fma_f32 v38, v38, v32, v33
v_fma_f32 v39, v39, v32, v33
v_fma_f32 v88, v88, v32, v33
v_fma_f32 v89, v89, v32, v33
s_waitcnt lgkmcnt(6)
M3 a[48:63],v[180:183],a[240:243],a[48:63]
TR a[236:237],v3 offset:40960
TR a[238:239],v3 offset:42240
CV v184,v34,v35
CV v185,v36,v37
CV v186,v38,v39
CV v187,v88,v89
M3 a[64:79],v[180:183],a[244:247],a[64:79]
TR a[240:241],v3 offset:41040
TR a[242:243],v3 offset:42320
v_lshlrev_b32 v34, 16, v188
v_and_b32 v35, s52, v188
v_lshlrev_b32 v36, 16, v189
v_and_b32 v37, s52, v189
M3 a[0:15],v[184:187],a[248:251],a[0:15]
TR a[244:245],v3 offset:41120
TR a[246:247],v3 offset:42400
v_lshlrev_b32 v38, 16, v190
v_and_b32 v39, s52, v190
v_lshlrev_b32 v88, 16, v191
v_and_b32 v89, s52, v191
M3 a[16:31],v[184:187],a[252:255],a[16:31]
TR a[248:249],v3 offset:41200
TR a[250:251],v3 offset:42480
v_fma_f32 v34, v34, v32, v33
v_fma_f32 v35, v35, v32, v33
v_fma_f32 v36, v36, v32, v33
v_fma_f32 v37, v37, v32, v33
s_waitcnt lgkmcnt(6)
M3 a[32:47],v[184:187],a[224:227],a[32:47]
TR a[252:253],v5 offset:40960
TR a[254:255],v5 offset:42240
v_fma_f32 v38, v38, v32, v33
v_fma_f32 v39, v39, v32, v33
v_fma_f32 v88, v88, v32, v33
v_fma_f32 v89, v89, v32, v33
M3 a[48:63],v[184:187],a[228:231],a[48:63]
CV v188,v34,v35
CV v189,v36,v37
CV v190,v38,v39
CV v191,v88,v89
M3 a[64:79],v[184:187],a[232:235],a[64:79]
v_lshlrev_b32 v34, 16, v192
v_and_b32 v35, s52, v192
v_lshlrev_b32 v36, 16, v193
v_and_b32 v37, s52, v193
M3 a[0:15],v[188:191],a[236:239],a[0:15]
s_waitcnt vmcnt(15) lgkmcnt(0)
s_barrier
TR a[224:225],v2 offset:5120
TR a[226:227],v2 offset:6400
TR a[228:229],v2 offset:5200
TR a[230:231],v2 offset:6480
v_lshlrev_b32 v38, 16, v194
v_and_b32 v39, s52, v194
v_lshlrev_b32 v88, 16, v195
v_and_b32 v89, s52, v195
M3 a[16:31],v[188:191],a[240:243],a[16:31]
TR a[232:233],v2 offset:5280
TR a[234:235],v2 offset:6560
TR a[236:237],v2 offset:5360
TR a[238:239],v2 offset:6640
v_fma_f32 v34, v34, v32, v33
v_fma_f32 v35, v35, v32, v33
v_fma_f32 v36, v36, v32, v33
v_fma_f32 v37, v37, v32, v33
s_add_u32 m0, s6, 0
s_bfe_u32 s60, s58, 0x40000
s_mul_i32 s60, s60, 221184
s_add_u32 s60, s60, s41
BL v15,s[12:15],s60 offen lds
M3 a[32:47],v[188:191],a[244:247],a[32:47]
TR a[240:241],v4 offset:5120
TR a[242:243],v4 offset:6400
v_fma_f32 v38, v38, v32, v33
v_fma_f32 v39, v39, v32, v33
v_fma_f32 v88, v88, v32, v33
v_fma_f32 v89, v89, v32, v33
M3 a[48:63],v[188:191],a[248:251],a[48:63]
TR a[244:245],v2 offset:46080
TR a[246:247],v2 offset:47360
CV v192,v34,v35
CV v193,v36,v37
CV v194,v38,v39
CV v195,v88,v89
BL v16,s[12:15],s60 offen offset:1024 lds
M3 a[64:79],v[188:191],a[252:255],a[64:79]
TR a[248:249],v2 offset:46160
TR a[250:251],v2 offset:47440
v_lshlrev_b32 v34, 16, v196
v_and_b32 v35, s52, v196
v_lshlrev_b32 v36, 16, v197
v_and_b32 v37, s52, v197
s_waitcnt lgkmcnt(6)
M3 a[0:15],v[192:195],a[224:227],a[0:15]
TR a[252:253],v2 offset:46240
TR a[254:255],v2 offset:47520
v_lshlrev_b32 v38, 16, v198
v_and_b32 v39, s52, v198
v_lshlrev_b32 v88, 16, v199
v_and_b32 v89, s52, v199
BL v17,s[16:19],s60 offen offset:2048 lds
M3 a[16:31],v[192:195],a[228:231],a[16:31]
TR a[224:225],v2 offset:46320
TR a[226:227],v2 offset:47600
v_fma_f32 v34, v34, v32, v33
v_fma_f32 v35, v35, v32, v33
v_fma_f32 v36, v36, v32, v33
v_fma_f32 v37, v37, v32, v33
M3 a[32:47],v[192:195],a[232:235],a[32:47]
TR a[228:229],v4 offset:46080
TR a[230:231],v4 offset:47360
v_fma_f32 v38, v38, v32, v33
v_fma_f32 v39, v39, v32, v33
v_fma_f32 v88, v88, v32, v33
v_fma_f32 v89, v89, v32, v33
BL v18,s[16:19],s60 offen offset:3072 lds
M3 a[48:63],v[192:195],a[236:239],a[48:63]
TR a[232:233],v3 offset:5120
TR a[234:235],v3 offset:6400
CV v196,v34,v35
CV v197,v36,v37
CV v198,v38,v39
CV v199,v88,v89
s_waitcnt lgkmcnt(6)
M3 a[64:79],v[192:195],a[240:243],a[64:79]
TR a[236:237],v3 offset:5200
TR a[238:239],v3 offset:6480
v_lshlrev_b32 v34, 16, v200
v_and_b32 v35, s52, v200
v_lshlrev_b32 v36, 16, v201
v_and_b32 v37, s52, v201
M3 a[0:15],v[196:199],a[244:247],a[0:15]
TR a[240:241],v3 offset:5280
TR a[242:243],v3 offset:6560
v_lshlrev_b32 v38, 16, v202
v_and_b32 v39, s52, v202
v_lshlrev_b32 v88, 16, v203
v_and_b32 v89, s52, v203
M3 a[16:31],v[196:199],a[248:251],a[16:31]
TR a[244:245],v3 offset:5360
TR a[246:247],v3 offset:6640
v_fma_f32 v34, v34, v32, v33
v_fma_f32 v35, v35, v32, v33
v_fma_f32 v36, v36, v32, v33
v_fma_f32 v37, v37, v32, v33
M3 a[32:47],v[196:199],a[252:255],a[32:47]
TR a[248:249],v5 offset:5120
TR a[250:251],v5 offset:6400
v_fma_f32 v38, v38, v32, v33
v_fma_f32 v39, v39, v32, v33
v_fma_f32 v88, v88, v32, v33
v_fma_f32 v89, v89, v32, v33
s_waitcnt lgkmcnt(6)
M3 a[48:63],v[196:199],a[224:227],a[48:63]
TR a[252:253],v3 offset:46080
TR a[254:255],v3 offset:47360
CV v200,v34,v35
CV v201,v36,v37
CV v202,v38,v39
CV v203,v88,v89
M3 a[64:79],v[196:199],a[228:231],a[64:79]
TR a[224:225],v3 offset:46160
TR a[226:227],v3 offset:47440
v_lshlrev_b32 v34, 16, v204
v_and_b32 v35, s52, v204
v_lshlrev_b32 v36, 16, v205
v_and_b32 v37, s52, v205
M3 a[0:15],v[200:203],a[232:235],a[0:15]
TR a[228:229],v3 offset:46240
TR a[230:231],v3 offset:47520
v_lshlrev_b32 v38, 16, v206
v_and_b32 v39, s52, v206
v_lshlrev_b32 v88, 16, v207
v_and_b32 v89, s52, v207
M3 a[16:31],v[200:203],a[236:239],a[16:31]
TR a[232:233],v3 offset:46320
TR a[234:235],v3 offset:47600
v_fma_f32 v34, v34, v32, v33
v_fma_f32 v35, v35, v32, v33
v_fma_f32 v36, v36, v32, v33
v_fma_f32 v37, v37, v32, v33
s_waitcnt lgkmcnt(6)
M3 a[32:47],v[200:203],a[240:243],a[32:47]
TR a[236:237],v5 offset:46080
TR a[238:239],v5 offset:47360
v_fma_f32 v38, v38, v32, v33
v_fma_f32 v39, v39, v32, v33
v_fma_f32 v88, v88, v32, v33
v_fma_f32 v89, v89, v32, v33
M3 a[48:63],v[200:203],a[244:247],a[48:63]
CV v204,v34,v35
CV v205,v36,v37
CV v206,v38,v39
CV v207,v88,v89
M3 a[64:79],v[200:203],a[248:251],a[64:79]
v_lshlrev_b32 v34, 16, v208
v_and_b32 v35, s52, v208
v_lshlrev_b32 v36, 16, v209
v_and_b32 v37, s52, v209
M3 a[0:15],v[204:207],a[252:255],a[0:15]
s_waitcnt vmcnt(14) lgkmcnt(0)
s_barrier
TR a[240:241],v2 offset:10240
TR a[242:243],v2 offset:11520
TR a[244:245],v2 offset:10320
TR a[246:247],v2 offset:11600
v_lshlrev_b32 v38, 16, v210
v_and_b32 v39, s52, v210
v_lshlrev_b32 v88, 16, v211
v_and_b32 v89, s52, v211
M3 a[16:31],v[204:207],a[224:227],a[16:31]
TR a[248:249],v2 offset:10400
TR a[250:251],v2 offset:11680
TR a[252:253],v2 offset:10480
TR a[254:255],v2 offset:11760
v_fma_f32 v34, v34, v32, v33
v_fma_f32 v35, v35, v32, v33
v_fma_f32 v36, v36, v32, v33
v_fma_f32 v37, v37, v32, v33
s_add_u32 m0, s6, 5120
s_bfe_u32 s60, s58, 0x40004
s_mul_i32 s60, s60, 221184
s_add_u32 s60, s60, s41
BL v15,s[12:15],s60 offen lds
M3 a[32:47],v[204:207],a[228:231],a[32:47]
TR a[224:225],v4 offset:10240
TR a[226:227],v4 offset:11520
v_fma_f32 v38, v38, v32, v33
v_fma_f32 v39, v39, v32, v33
v_fma_f32 v88, v88, v32, v33
v_fma_f32 v89, v89, v32, v33
M3 a[48:63],v[204:207],a[232:235],a[48:63]
TR a[228:229],v2 offset:51200
TR a[230:231],v2 offset:52480
CV v208,v34,v35
CV v209,v36,v37
CV v210,v38,v39
CV v211,v88,v89
BL v16,s[12:15],s60 offen offset:1024 lds
M3 a[64:79],v[204:207],a[236:239],a[64:79]
TR a[232:233],v2 offset:51280
TR a[234:235],v2 offset:52560
v_lshlrev_b32 v34, 16, v212
v_and_b32 v35, s52, v212
v_lshlrev_b32 v36, 16, v213
v_and_b32 v37, s52, v213
s_waitcnt lgkmcnt(6)
M3 a[0:15],v[208:211],a[240:243],a[0:15]
TR a[236:237],v2 offset:51360
TR a[238:239],v2 offset:52640
v_lshlrev_b32 v38, 16, v214
v_and_b32 v39, s52, v214
v_lshlrev_b32 v88, 16, v215
v_and_b32 v89, s52, v215
BL v17,s[16:19],s60 offen offset:2048 lds
M3 a[16:31],v[208:211],a[244:247],a[16:31]
TR a[240:241],v2 offset:51440
TR a[242:243],v2 offset:52720
v_fma_f32 v34, v34, v32, v33
v_fma_f32 v35, v35, v32, v33
v_fma_f32 v36, v36, v32, v33
v_fma_f32 v37, v37, v32, v33
M3 a[32:47],v[208:211],a[248:251],a[32:47]
TR a[244:245],v4 offset:51200
TR a[246:247],v4 offset:52480
v_fma_f32 v38, v38, v32, v33
v_fma_f32 v39, v39, v32, v33
v_fma_f32 v88, v88, v32, v33
v_fma_f32 v89, v89, v32, v33
BL v18,s[16:19],s60 offen offset:3072 lds
M3 a[48:63],v[208:211],a[252:255],a[48:63]
TR a[248:249],v3 offset:10240
TR a[250:251],v3 offset:11520
CV v212,v34,v35
CV v213,v36,v37
CV v214,v38,v39
CV v215,v88,v89
s_waitcnt lgkmcnt(6)
M3 a[64:79],v[208:211],a[224:227],a[64:79]
TR a[252:253],v3 offset:10320
TR a[254:255],v3 offset:11600
v_lshlrev_b32 v34, 16, v216
v_and_b32 v35, s52, v216
v_lshlrev_b32 v36, 16, v217
v_and_b32 v37, s52, v217
M3 a[0:15],v[212:215],a[228:231],a[0:15]
TR a[224:225],v3 offset:10400
TR a[226:227],v3 offset:11680
v_lshlrev_b32 v38, 16, v218
v_and_b32 v39, s52, v218
v_lshlrev_b32 v88, 16, v219
v_and_b32 v89, s52, v219
M3 a[16:31],v[212:215],a[232:235],a[16:31]
TR a[228:229],v3 offset:10480
TR a[230:231],v3 offset:11760
v_fma_f32 v34, v34, v32, v33
v_fma_f32 v35, v35, v32, v33
v_fma_f32 v36, v36, v32, v33
v_fma_f32 v37, v37, v32, v33
M3 a[32:47],v[212:215],a[236:239],a[32:47]
TR a[232:233],v5 offset:10240
TR a[234:235],v5 offset:11520
v_fma_f32 v38, v38, v32, v33
v_fma_f32 v39, v39, v32, v33
v_fma_f32 v88, v88, v32, v33
v_fma_f32 v89, v89, v32, v33
s_waitcnt lgkmcnt(6)
M3 a[48:63],v[212:215],a[240:243],a[48:63]
TR a[236:237],v3 offset:51200
TR a[238:239],v3 offset:52480
CV v216,v34,v35
CV v217,v36,v37
CV v218,v38,v39
CV v219,v88,v89
M3 a[64:79],v[212:215],a[244:247],a[64:79]
TR a[240:241],v3 offset:51280
TR a[242:243],v3 offset:52560
v_lshlrev_b32 v34, 16, v220
v_and_b32 v35, s52, v220
v_lshlrev_b32 v36, 16, v221
v_and_b32 v37, s52, v221
M3 a[0:15],v[216:219],a[248:251],a[0:15]
TR a[244:245],v3 offset:51360
TR a[246:247],v3 offset:52640
v_lshlrev_b32 v38, 16, v222
v_and_b32 v39, s52, v222
v_lshlrev_b32 v88, 16, v223
v_and_b32 v89, s52, v223
M3 a[16:31],v[216:219],a[252:255],a[16:31]
TR a[248:249],v3 offset:51440
TR a[250:251],v3 offset:52720
v_fma_f32 v34, v34, v32, v33
v_fma_f32 v35, v35, v32, v33
v_fma_f32 v36, v36, v32, v33
v_fma_f32 v37, v37, v32, v33
s_waitcnt lgkmcnt(6)
M3 a[32:47],v[216:219],a[224:227],a[32:47]
TR a[252:253],v5 offset:51200
TR a[254:255],v5 offset:52480
v_fma_f32 v38, v38, v32, v33
v_fma_f32 v39, v39, v32, v33
v_fma_f32 v88, v88, v32, v33
v_fma_f32 v89, v89, v32, v33
M3 a[48:63],v[216:219],a[228:231],a[48:63]
CV v220,v34,v35
CV v221,v36,v37
CV v222,v38,v39
CV v223,v88,v89
M3 a[64:79],v[216:219],a[232:235],a[64:79]
v_lshlrev_b32 v34, 16, v224
v_and_b32 v35, s52, v224
v_lshlrev_b32 v36, 16, v225
v_and_b32 v37, s52, v225
M3 a[0:15],v[220:223],a[236:239],a[0:15]
s_waitcnt vmcnt(13) lgkmcnt(0)
s_barrier
TR a[224:225],v2 offset:15360
TR a[226:227],v2 offset:16640
TR a[228:229],v2 offset:15440
TR a[230:231],v2 offset:16720
v_lshlrev_b32 v38, 16, v226
v_and_b32 v39, s52, v226
v_lshlrev_b32 v88, 16, v227
v_and_b32 v89, s52, v227
M3 a[16:31],v[220:223],a[240:243],a[16:31]
TR a[232:233],v2 offset:15520
TR a[234:235],v2 offset:16800
TR a[236:237],v2 offset:15600
TR a[238:239],v2 offset:16880
v_fma_f32 v34, v34, v32, v33
v_fma_f32 v35, v35, v32, v33
v_fma_f32 v36, v36, v32, v33
v_fma_f32 v37, v37, v32, v33
s_add_u32 m0, s6, 10240
s_bfe_u32 s60, s58, 0x40008
s_mul_i32 s60, s60, 221184
s_add_u32 s60, s60, s41
BL v15,s[12:15],s60 offen lds
M3 a[32:47],v[220:223],a[244:247],a[32:47]
TR a[240:241],v4 offset:15360
TR a[242:243],v4 offset:16640
v_fma_f32 v38, v38, v32, v33
v_fma_f32 v39, v39, v32, v33
v_fma_f32 v88, v88, v32, v33
v_fma_f32 v89, v89, v32, v33
M3 a[48:63],v[220:223],a[248:251],a[48:63]
TR a[244:245],v2 offset:56320
TR a[246:247],v2 offset:57600
CV v224,v34,v35
CV v225,v36,v37
CV v226,v38,v39
CV v227,v88,v89
BL v16,s[12:15],s60 offen offset:1024 lds
M3 a[64:79],v[220:223],a[252:255],a[64:79]
TR a[248:249],v2 offset:56400
TR a[250:251],v2 offset:57680
v_lshlrev_b32 v34, 16, v228
v_and_b32 v35, s52, v228
v_lshlrev_b32 v36, 16, v229
v_and_b32 v37, s52, v229
s_waitcnt lgkmcnt(6)
M3 a[0:15],v[224:227],a[224:227],a[0:15]
TR a[252:253],v2 offset:56480
TR a[254:255],v2 offset:57760
v_lshlrev_b32 v38, 16, v230
v_and_b32 v39, s52, v230
v_lshlrev_b32 v88, 16, v231
v_and_b32 v89, s52, v231
BL v17,s[16:19],s60 offen offset:2048 lds
M3 a[16:31],v[224:227],a[228:231],a[16:31]
TR a[224:225],v2 offset:56560
TR a[226:227],v2 offset:57840
v_fma_f32 v34, v34, v32, v33
v_fma_f32 v35, v35, v32, v33
v_fma_f32 v36, v36, v32, v33
v_fma_f32 v37, v37, v32, v33
M3 a[32:47],v[224:227],a[232:235],a[32:47]
TR a[228:229],v4 offset:56320
TR a[230:231],v4 offset:57600
v_fma_f32 v38, v38, v32, v33
v_fma_f32 v39, v39, v32, v33
v_fma_f32 v88, v88, v32, v33
v_fma_f32 v89, v89, v32, v33
BL v18,s[16:19],s60 offen offset:3072 lds
M3 a[48:63],v[224:227],a[236:239],a[48:63]
TR a[232:233],v3 offset:15360
TR a[234:235],v3 offset:16640
CV v228,v34,v35
CV v229,v36,v37
CV v230,v38,v39
CV v231,v88,v89
s_waitcnt lgkmcnt(6)
M3 a[64:79],v[224:227],a[240:243],a[64:79]
TR a[236:237],v3 offset:15440
TR a[238:239],v3 offset:16720
v_lshlrev_b32 v34, 16, v232
v_and_b32 v35, s52, v232
v_lshlrev_b32 v36, 16, v233
v_and_b32 v37, s52, v233
M3 a[0:15],v[228:231],a[244:247],a[0:15]
TR a[240:241],v3 offset:15520
TR a[242:243],v3 offset:16800
v_lshlrev_b32 v38, 16, v234
v_and_b32 v39, s52, v234
v_lshlrev_b32 v88, 16, v235
v_and_b32 v89, s52, v235
M3 a[16:31],v[228:231],a[248:251],a[16:31]
TR a[244:245],v3 offset:15600
TR a[246:247],v3 offset:16880
v_fma_f32 v34, v34, v32, v33
v_fma_f32 v35, v35, v32, v33
v_fma_f32 v36, v36, v32, v33
v_fma_f32 v37, v37, v32, v33
M3 a[32:47],v[228:231],a[252:255],a[32:47]
TR a[248:249],v5 offset:15360
TR a[250:251],v5 offset:16640
v_fma_f32 v38, v38, v32, v33
v_fma_f32 v39, v39, v32, v33
v_fma_f32 v88, v88, v32, v33
v_fma_f32 v89, v89, v32, v33
s_waitcnt lgkmcnt(6)
M3 a[48:63],v[228:231],a[224:227],a[48:63]
TR a[252:253],v3 offset:56320
TR a[254:255],v3 offset:57600
CV v232,v34,v35
CV v233,v36,v37
CV v234,v38,v39
CV v235,v88,v89
M3 a[64:79],v[228:231],a[228:231],a[64:79]
TR a[224:225],v3 offset:56400
TR a[226:227],v3 offset:57680
v_lshlrev_b32 v34, 16, v236
v_and_b32 v35, s52, v236
v_lshlrev_b32 v36, 16, v237
v_and_b32 v37, s52, v237
M3 a[0:15],v[232:235],a[232:235],a[0:15]
TR a[228:229],v3 offset:56480
TR a[230:231],v3 offset:57760
v_lshlrev_b32 v38, 16, v238
v_and_b32 v39, s52, v238
v_lshlrev_b32 v88, 16, v239
v_and_b32 v89, s52, v239
M3 a[16:31],v[232:235],a[236:239],a[16:31]
TR a[232:233],v3 offset:56560
TR a[234:235],v3 offset:57840
v_fma_f32 v34, v34, v32, v33
v_fma_f32 v35, v35, v32, v33
v_fma_f32 v36, v36, v32, v33
v_fma_f32 v37, v37, v32, v33
s_waitcnt lgkmcnt(6)
M3 a[32:47],v[232:235],a[240:243],a[32:47]
TR a[236:237],v5 offset:56320
TR a[238:239],v5 offset:57600
v_fma_f32 v38, v38, v32, v33
v_fma_f32 v39, v39, v32, v33
v_fma_f32 v88, v88, v32, v33
v_fma_f32 v89, v89, v32, v33
M3 a[48:63],v[232:235],a[244:247],a[48:63]
CV v236,v34,v35
CV v237,v36,v37
CV v238,v38,v39
CV v239,v88,v89
M3 a[64:79],v[232:235],a[248:251],a[64:79]
v_lshlrev_b32 v34, 16, v240
v_and_b32 v35, s52, v240
v_lshlrev_b32 v36, 16, v241
v_and_b32 v37, s52, v241
M3 a[0:15],v[236:239],a[252:255],a[0:15]
s_waitcnt vmcnt(12) lgkmcnt(0)
s_barrier
TR a[240:241],v2 offset:20480
TR a[242:243],v2 offset:21760
TR a[244:245],v2 offset:20560
TR a[246:247],v2 offset:21840
v_lshlrev_b32 v38, 16, v242
v_and_b32 v39, s52, v242
v_lshlrev_b32 v88, 16, v243
v_and_b32 v89, s52, v243
M3 a[16:31],v[236:239],a[224:227],a[16:31]
TR a[248:249],v2 offset:20640
TR a[250:251],v2 offset:21920
TR a[252:253],v2 offset:20720
TR a[254:255],v2 offset:22000
v_fma_f32 v34, v34, v32, v33
v_fma_f32 v35, v35, v32, v33
v_fma_f32 v36, v36, v32, v33
v_fma_f32 v37, v37, v32, v33
s_add_u32 m0, s6, 15360
s_bfe_u32 s60, s58, 0x4000c
s_mul_i32 s60, s60, 221184
s_add_u32 s60, s60, s41
BL v15,s[12:15],s60 offen lds
M3 a[32:47],v[236:239],a[228:231],a[32:47]
TR a[224:225],v4 offset:20480
TR a[226:227],v4 offset:21760
v_fma_f32 v38, v38, v32, v33
v_fma_f32 v39, v39, v32, v33
v_fma_f32 v88, v88, v32, v33
v_fma_f32 v89, v89, v32, v33
M3 a[48:63],v[236:239],a[232:235],a[48:63]
TR a[228:229],v2 offset:61440
TR a[230:231],v2 offset:62720
CV v240,v34,v35
CV v241,v36,v37
CV v242,v38,v39
CV v243,v88,v89
BL v16,s[12:15],s60 offen offset:1024 lds
M3 a[64:79],v[236:239],a[236:239],a[64:79]
TR a[232:233],v2 offset:61520
TR a[234:235],v2 offset:62800
v_lshlrev_b32 v34, 16, v244
v_and_b32 v35, s52, v244
v_lshlrev_b32 v36, 16, v245
v_and_b32 v37, s52, v245
s_waitcnt lgkmcnt(6)
M3 a[0:15],v[240:243],a[240:243],a[0:15]
TR a[236:237],v2 offset:61600
TR a[238:239],v2 offset:62880
v_lshlrev_b32 v38, 16, v246
v_and_b32 v39, s52, v246
v_lshlrev_b32 v88, 16, v247
v_and_b32 v89, s52, v247
BL v17,s[16:19],s60 offen offset:2048 lds
M3 a[16:31],v[240:243],a[244:247],a[16:31]
TR a[240:241],v2 offset:61680
TR a[242:243],v2 offset:62960
v_fma_f32 v34, v34, v32, v33
v_fma_f32 v35, v35, v32, v33
v_fma_f32 v36, v36, v32, v33
v_fma_f32 v37, v37, v32, v33
M3 a[32:47],v[240:243],a[248:251],a[32:47]
TR a[244:245],v4 offset:61440
TR a[246:247],v4 offset:62720
v_fma_f32 v38, v38, v32, v33
v_fma_f32 v39, v39, v32, v33
v_fma_f32 v88, v88, v32, v33
v_fma_f32 v89, v89, v32, v33
BL v18,s[16:19],s60 offen offset:3072 lds
M3 a[48:63],v[240:243],a[252:255],a[48:63]
TR a[248:249],v3 offset:20480
TR a[250:251],v3 offset:21760
CV v244,v34,v35
CV v245,v36,v37
CV v246,v38,v39
CV v247,v88,v89
s_waitcnt lgkmcnt(6)
M3 a[64:79],v[240:243],a[224:227],a[64:79]
TR a[252:253],v3 offset:20560
TR a[254:255],v3 offset:21840
v_lshlrev_b32 v34, 16, v248
v_and_b32 v35, s52, v248
v_lshlrev_b32 v36, 16, v249
v_and_b32 v37, s52, v249
M3 a[0:15],v[244:247],a[228:231],a[0:15]
TR a[224:225],v3 offset:20640
TR a[226:227],v3 offset:21920
v_lshlrev_b32 v38, 16, v250
v_and_b32 v39, s52, v250
v_lshlrev_b32 v88, 16, v251
v_and_b32 v89, s52, v251
M3 a[16:31],v[244:247],a[232:235],a[16:31]
TR a[228:229],v3 offset:20720
TR a[230:231],v3 offset:22000
v_fma_f32 v34, v34, v32, v33
v_fma_f32 v35, v35, v32, v33
v_fma_f32 v36, v36, v32, v33
v_fma_f32 v37, v37, v32, v33
M3 a[32:47],v[244:247],a[236:239],a[32:47]
TR a[232:233],v5 offset:20480
TR a[234:235],v5 offset:21760
v_fma_f32 v38, v38, v32, v33
v_fma_f32 v39, v39, v32, v33
v_fma_f32 v88, v88, v32, v33
v_fma_f32 v89, v89, v32, v33
s_waitcnt lgkmcnt(6)
M3 a[48:63],v[244:247],a[240:243],a[48:63]
TR a[236:237],v3 offset:61440
TR a[238:239],v3 offset:62720
CV v248,v34,v35
CV v249,v36,v37
CV v250,v38,v39
CV v251,v88,v89
M3 a[64:79],v[244:247],a[244:247],a[64:79]
TR a[240:241],v3 offset:61520
TR a[242:243],v3 offset:62800
v_lshlrev_b32 v34, 16, v252
v_and_b32 v35, s52, v252
v_lshlrev_b32 v36, 16, v253
v_and_b32 v37, s52, v253
M3 a[0:15],v[248:251],a[248:251],a[0:15]
TR a[244:245],v3 offset:61600
TR a[246:247],v3 offset:62880
v_lshlrev_b32 v38, 16, v254
v_and_b32 v39, s52, v254
v_lshlrev_b32 v88, 16, v255
v_and_b32 v89, s52, v255
M3 a[16:31],v[248:251],a[252:255],a[16:31]
TR a[248:249],v3 offset:61680
TR a[250:251],v3 offset:62960
v_fma_f32 v34, v34, v32, v33
v_fma_f32 v35, v35, v32, v33
v_fma_f32 v36, v36, v32, v33
v_fma_f32 v37, v37, v32, v33
s_waitcnt lgkmcnt(6)
M3 a[32:47],v[248:251],a[224:227],a[32:47]
TR a[252:253],v5 offset:61440
TR a[254:255],v5 offset:62720
v_fma_f32 v38, v38, v32, v33
v_fma_f32 v39, v39, v32, v33
v_fma_f32 v88, v88, v32, v33
v_fma_f32 v89, v89, v32, v33
M3 a[48:63],v[248:251],a[228:231],a[48:63]
CV v252,v34,v35
CV v253,v36,v37
CV v254,v38,v39
CV v255,v88,v89
M3 a[64:79],v[248:251],a[232:235],a[64:79]
s_nop 0
M3 a[0:15],v[252:255],a[236:239],a[0:15]
s_waitcnt vmcnt(12) lgkmcnt(0)
s_barrier
TR a[224:225],v6
TR a[226:227],v6 offset:512
TR a[228:229],v8
TR a[230:231],v8 offset:512
M3 a[16:31],v[252:255],a[240:243],a[16:31]
TR a[232:233],v19
TR a[234:235],v19 offset:512
TR a[236:237],v23
TR a[238:239],v23 offset:512
s_add_u32 m0, s6, 20480
s_bfe_u32 s60, s58, 0x40010
s_mul_i32 s60, s60, 221184
s_add_u32 s60, s60, s41
BL v15,s[12:15],s60 offen lds
M3 a[32:47],v[252:255],a[244:247],a[32:47]
TR a[240:241],v6 offset:40960
TR a[242:243],v6 offset:41472
M3 a[48:63],v[252:255],a[248:251],a[48:63]
TR a[244:245],v8 offset:40960
TR a[246:247],v8 offset:41472
BL v16,s[12:15],s60 offen offset:1024 lds
M3 a[64:79],v[252:255],a[252:255],a[64:79]
TR a[248:249],v19 offset:40960
TR a[250:251],v19 offset:41472
v_lshlrev_b32 v34, 4, v1
v_add_u32 v34, s6, v34
AR v88,a0
AR v89,a1
AR v90,a2
AR v91,a3
v_pk_mul_f32 v[92:93], v[88:89], s[50:51] op_sel:[0,1] op_sel_hi:[1,1]
v_pk_mul_f32 v[94:95], v[90:91], s[50:51] op_sel:[0,1] op_sel_hi:[1,1]
v_exp_f32_e64 v92, v92 clamp
v_max_f32 v88, s53, v88
v_exp_f32_e64 v93, v93 clamp
v_max_f32 v89, s53, v89
v_exp_f32_e64 v94, v94 clamp
v_max_f32 v90, s53, v90
v_exp_f32_e64 v95, v95 clamp
v_max_f32 v91, s53, v91
v_pk_add_f32 v[88:89], v[88:89], v[92:93]
v_pk_add_f32 v[90:91], v[90:91], v[94:95]
CV v40,v88,v89
CV v41,v90,v91
AR v88,a4
AR v89,a5
AR v90,a6
AR v91,a7
v_pk_mul_f32 v[92:93], v[88:89], s[50:51] op_sel:[0,1] op_sel_hi:[1,1]
v_pk_mul_f32 v[94:95], v[90:91], s[50:51] op_sel:[0,1] op_sel_hi:[1,1]
v_exp_f32_e64 v92, v92 clamp
v_max_f32 v88, s53, v88
v_exp_f32_e64 v93, v93 clamp
v_max_f32 v89, s53, v89
v_exp_f32_e64 v94, v94 clamp
v_max_f32 v90, s53, v90
v_exp_f32_e64 v95, v95 clamp
v_max_f32 v91, s53, v91
v_pk_add_f32 v[88:89], v[88:89], v[92:93]
v_pk_add_f32 v[90:91], v[90:91], v[94:95]
CV v42,v88,v89
CV v43,v90,v91
AR v88,a8
AR v89,a9
AR v90,a10
AR v91,a11
v_pk_mul_f32 v[92:93], v[88:89], s[50:51] op_sel:[0,1] op_sel_hi:[1,1]
v_pk_mul_f32 v[94:95], v[90:91], s[50:51] op_sel:[0,1] op_sel_hi:[1,1]
v_exp_f32_e64 v92, v92 clamp
v_max_f32 v88, s53, v88
v_exp_f32_e64 v93, v93 clamp
v_max_f32 v89, s53, v89
v_exp_f32_e64 v94, v94 clamp
v_max_f32 v90, s53, v90
v_exp_f32_e64 v95, v95 clamp
v_max_f32 v91, s53, v91
v_pk_add_f32 v[88:89], v[88:89], v[92:93]
v_pk_add_f32 v[90:91], v[90:91], v[94:95]
CV v44,v88,v89
CV v45,v90,v91
AR v88,a12
AR v89,a13
AR v90,a14
AR v91,a15
v_pk_mul_f32 v[92:93], v[88:89], s[50:51] op_sel:[0,1] op_sel_hi:[1,1]
v_pk_mul_f32 v[94:95], v[90:91], s[50:51] op_sel:[0,1] op_sel_hi:[1,1]
v_exp_f32_e64 v92, v92 clamp
v_max_f32 v88, s53, v88
v_exp_f32_e64 v93, v93 clamp
v_max_f32 v89, s53, v89
v_exp_f32_e64 v94, v94 clamp
v_max_f32 v90, s53, v90
v_exp_f32_e64 v95, v95 clamp
v_max_f32 v91, s53, v91
v_pk_add_f32 v[88:89], v[88:89], v[92:93]
v_pk_add_f32 v[90:91], v[90:91], v[94:95]
CV v46,v88,v89
CV v47,v90,v91
ds_write_b128 v34, v[40:43] offset:25600
ds_write_b128 v34, v[44:47] offset:31744
AR v88,a16
AR v89,a17
AR v90,a18
AR v91,a19
v_pk_mul_f32 v[92:93], v[88:89], s[50:51] op_sel:[0,1] op_sel_hi:[1,1]
v_pk_mul_f32 v[94:95], v[90:91], s[50:51] op_sel:[0,1] op_sel_hi:[1,1]
v_exp_f32_e64 v92, v92 clamp
v_max_f32 v88, s53, v88
v_exp_f32_e64 v93, v93 clamp
v_max_f32 v89, s53, v89
v_exp_f32_e64 v94, v94 clamp
v_max_f32 v90, s53, v90
v_exp_f32_e64 v95, v95 clamp
v_max_f32 v91, s53, v91
v_pk_add_f32 v[88:89], v[88:89], v[92:93]
v_pk_add_f32 v[90:91], v[90:91], v[94:95]
CV v48,v88,v89
CV v49,v90,v91
AR v88,a20
AR v89,a21
AR v90,a22
AR v91,a23
v_pk_mul_f32 v[92:93], v[88:89], s[50:51] op_sel:[0,1] op_sel_hi:[1,1]
v_pk_mul_f32 v[94:95], v[90:91], s[50:51] op_sel:[0,1] op_sel_hi:[1,1]
v_exp_f32_e64 v92, v92 clamp
v_max_f32 v88, s53, v88
v_exp_f32_e64 v93, v93 clamp
v_max_f32 v89, s53, v89
v_exp_f32_e64 v94, v94 clamp
v_max_f32 v90, s53, v90
v_exp_f32_e64 v95, v95 clamp
v_max_f32 v91, s53, v91
v_pk_add_f32 v[88:89], v[88:89], v[92:93]
v_pk_add_f32 v[90:91], v[90:91], v[94:95]
CV v50,v88,v89
CV v51,v90,v91
AR v88,a24
AR v89,a25
AR v90,a26
AR v91,a27
v_pk_mul_f32 v[92:93], v[88:89], s[50:51] op_sel:[0,1] op_sel_hi:[1,1]
v_pk_mul_f32 v[94:95], v[90:91], s[50:51] op_sel:[0,1] op_sel_hi:[1,1]
v_exp_f32_e64 v92, v92 clamp
v_max_f32 v88, s53, v88
v_exp_f32_e64 v93, v93 clamp
v_max_f32 v89, s53, v89
v_exp_f32_e64 v94, v94 clamp
v_max_f32 v90, s53, v90
v_exp_f32_e64 v95, v95 clamp
v_max_f32 v91, s53, v91
v_pk_add_f32 v[88:89], v[88:89], v[92:93]
v_pk_add_f32 v[90:91], v[90:91], v[94:95]
CV v52,v88,v89
CV v53,v90,v91
AR v88,a28
AR v89,a29
AR v90,a30
AR v91,a31
v_pk_mul_f32 v[92:93], v[88:89], s[50:51] op_sel:[0,1] op_sel_hi:[1,1]
v_pk_mul_f32 v[94:95], v[90:91], s[50:51] op_sel:[0,1] op_sel_hi:[1,1]
v_exp_f32_e64 v92, v92 clamp
v_max_f32 v88, s53, v88
v_exp_f32_e64 v93, v93 clamp
v_max_f32 v89, s53, v89
v_exp_f32_e64 v94, v94 clamp
v_max_f32 v90, s53, v90
v_exp_f32_e64 v95, v95 clamp
v_max_f32 v91, s53, v91
v_pk_add_f32 v[88:89], v[88:89], v[92:93]
v_pk_add_f32 v[90:91], v[90:91], v[94:95]
CV v54,v88,v89
CV v55,v90,v91
ds_write_b128 v34, v[48:51] offset:26624
ds_write_b128 v34, v[52:55] offset:32768
AR v88,a32
AR v89,a33
AR v90,a34
AR v91,a35
CV v56,v88,v89
CV v57,v90,v91
AR v88,a36
AR v89,a37
AR v90,a38
AR v91,a39
CV v58,v88,v89
CV v59,v90,v91
AR v88,a40
AR v89,a41
AR v90,a42
AR v91,a43
CV v60,v88,v89
CV v61,v90,v91
AR v88,a44
AR v89,a45
AR v90,a46
AR v91,a47
CV v62,v88,v89
CV v63,v90,v91
ds_write_b128 v34, v[56:59] offset:27648
ds_write_b128 v34, v[60:63] offset:33792
AR v88,a48
AR v89,a49
AR v90,a50
AR v91,a51
CV v64,v88,v89
CV v65,v90,v91
AR v88,a52
AR v89,a53
AR v90,a54
AR v91,a55
CV v66,v88,v89
CV v67,v90,v91
AR v88,a56
AR v89,a57
AR v90,a58
AR v91,a59
CV v68,v88,v89
CV v69,v90,v91
AR v88,a60
AR v89,a61
AR v90,a62
AR v91,a63
CV v70,v88,v89
CV v71,v90,v91
ds_write_b128 v34, v[64:67] offset:28672
ds_write_b128 v34, v[68:71] offset:34816
AR v88,a64
AR v89,a65
AR v90,a66
AR v91,a67
CV v80,v88,v89
CV v81,v90,v91
v_pk_mul_f32 v[92:93], v[88:89], s[50:51] op_sel:[0,1] op_sel_hi:[1,1]
v_pk_mul_f32 v[94:95], v[90:91], s[50:51] op_sel:[0,1] op_sel_hi:[1,1]
v_exp_f32_e64 v92, v92 clamp
v_max_f32 v88, s53, v88
v_exp_f32_e64 v93, v93 clamp
v_max_f32 v89, s53, v89
v_exp_f32_e64 v94, v94 clamp
v_max_f32 v90, s53, v90
v_exp_f32_e64 v95, v95 clamp
v_max_f32 v91, s53, v91
v_pk_add_f32 v[88:89], v[88:89], v[92:93]
v_pk_add_f32 v[90:91], v[90:91], v[94:95]
CV v72,v88,v89
CV v73,v90,v91
AR v88,a68
AR v89,a69
AR v90,a70
AR v91,a71
CV v82,v88,v89
CV v83,v90,v91
v_pk_mul_f32 v[92:93], v[88:89], s[50:51] op_sel:[0,1] op_sel_hi:[1,1]
v_pk_mul_f32 v[94:95], v[90:91], s[50:51] op_sel:[0,1] op_sel_hi:[1,1]
v_exp_f32_e64 v92, v92 clamp
v_max_f32 v88, s53, v88
v_exp_f32_e64 v93, v93 clamp
v_max_f32 v89, s53, v89
v_exp_f32_e64 v94, v94 clamp
v_max_f32 v90, s53, v90
v_exp_f32_e64 v95, v95 clamp
v_max_f32 v91, s53, v91
v_pk_add_f32 v[88:89], v[88:89], v[92:93]
v_pk_add_f32 v[90:91], v[90:91], v[94:95]
CV v74,v88,v89
CV v75,v90,v91
AR v88,a72
AR v89,a73
AR v90,a74
AR v91,a75
CV v84,v88,v89
CV v85,v90,v91
v_pk_mul_f32 v[92:93], v[88:89], s[50:51] op_sel:[0,1] op_sel_hi:[1,1]
v_pk_mul_f32 v[94:95], v[90:91], s[50:51] op_sel:[0,1] op_sel_hi:[1,1]
v_exp_f32_e64 v92, v92 clamp
v_max_f32 v88, s53, v88
v_exp_f32_e64 v93, v93 clamp
v_max_f32 v89, s53, v89
v_exp_f32_e64 v94, v94 clamp
v_max_f32 v90, s53, v90
v_exp_f32_e64 v95, v95 clamp
v_max_f32 v91, s53, v91
v_pk_add_f32 v[88:89], v[88:89], v[92:93]
v_pk_add_f32 v[90:91], v[90:91], v[94:95]
CV v76,v88,v89
CV v77,v90,v91
AR v88,a76
AR v89,a77
AR v90,a78
AR v91,a79
CV v86,v88,v89
CV v87,v90,v91
v_pk_mul_f32 v[92:93], v[88:89], s[50:51] op_sel:[0,1] op_sel_hi:[1,1]
v_pk_mul_f32 v[94:95], v[90:91], s[50:51] op_sel:[0,1] op_sel_hi:[1,1]
v_exp_f32_e64 v92, v92 clamp
v_max_f32 v88, s53, v88
v_exp_f32_e64 v93, v93 clamp
v_max_f32 v89, s53, v89
v_exp_f32_e64 v94, v94 clamp
v_max_f32 v90, s53, v90
v_exp_f32_e64 v95, v95 clamp
v_max_f32 v91, s53, v91
v_pk_add_f32 v[88:89], v[88:89], v[92:93]
v_pk_add_f32 v[90:91], v[90:91], v[94:95]
CV v78,v88,v89
CV v79,v90,v91
ds_write_b128 v34, v[72:75] offset:29696
ds_write_b128 v34, v[76:79] offset:35840
v_mov_b32 v88, 0x3f803f80
v_cndmask_b32 v80, v80, v88, s[54:55]
v_cndmask_b32 v81, v81, v88, s[54:55]
v_cndmask_b32 v82, v82, v88, s[54:55]
v_cndmask_b32 v83, v83, v88, s[54:55]
v_cndmask_b32 v84, v84, v88, s[54:55]
v_cndmask_b32 v85, v85, v88, s[54:55]
v_cndmask_b32 v86, v86, v88, s[54:55]
v_cndmask_b32 v87, v87, v88, s[54:55]
ds_write_b128 v34, v[80:83] offset:30720
ds_write_b128 v34, v[84:87] offset:36864
v_and_b32 v88, 31, v1
v_lshrrev_b32 v89, 5, v1
s_and_b32 s7, s3, 1
s_lshl_b32 s7, s7, 4
s_lshr_b32 s84, s3, 1
s_lshl_b32 s84, s84, 6
s_add_u32 s7, s7, s84
s_lshl_b32 s85, s3, 2
v_add_u32 v90, s7, v88
v_add_u32 v91, s85, v88
v_add_u32 v92, 128, v90
v_add_u32 v93, 320, v91
v_cmp_gt_u32 vcc, 20, v88
v_mov_b32 v94, 320
s_nop 0
v_cndmask_b32 v93, v94, v93, vcc
v_min_u32 v94, 19, v88
v_add_u32 v94, s85, v94
v_add_u32 v94, 240, v94
v_cmp_gt_u32 vcc, 16, v88
s_nop 1
v_cndmask_b32 v92, v93, v92, vcc
v_cndmask_b32 v90, v94, v90, vcc
v_lshl_add_u32 v92, v89, 5, v92
v_lshl_add_u32 v90, v89, 5, v90
v_lshlrev_b32 v92, 4, v92
v_lshlrev_b32 v90, 4, v90
v_add_u32 v35, 25600, v92
v_add_u32 v36, 107520, v92
v_add_u32 v37, 25600, v90
v_add_u32 v38, 107520, v90
v_mul_u32_u24 v89, 20, v89
v_add_u32 v89, v89, v88
v_lshlrev_b32 v89, 4, v89
v_mov_b32 v94, 1073741824
v_cmp_gt_u32 vcc, 20, v88
s_nop 1
v_cndmask_b32 v39, v94, v89, vcc
s_waitcnt lgkmcnt(0)
s_barrier
ds_read_b128 a[0:3], v35
ds_read_b128 a[4:7], v37
ds_read_b128 a[8:11], v35 offset:6144
ds_read_b128 a[12:15], v37 offset:6144
ds_read_b128 a[16:19], v35 offset:40960
ds_read_b128 a[20:23], v37 offset:40960
M3 a[80:95],a[224:227],v[96:99],0
TR a[252:253],v23 offset:40960
TR a[254:255],v23 offset:41472
BL v17,s[16:19],s60 offen offset:2048 lds
s_mov_b32 s57, 15532032
v_lshlrev_b32 v27, 4, v1
v_lshlrev_b32 v95, 2, v1
v_add_u32 v25, 4096, v27
BL v[30:33],v27,s[24:27],s57 offen sc1
buffer_load_dword v94, v95, s[24:27], s57 offen offset:1024 sc1
ds_read_b128 a[24:27], v35 offset:47104
ds_read_b128 a[28:31], v37 offset:47104
M3 a[96:111],a[228:231],v[96:99],0
TR a[224:225],v7
TR a[226:227],v7 offset:512
ds_read_b128 a[32:35], v36
ds_read_b128 a[36:39], v38
ds_read_b128 a[40:43], v36 offset:6144
ds_read_b128 a[44:47], v38 offset:6144
M3 a[112:127],a[232:235],v[96:99],0
TR a[228:229],v9
TR a[230:231],v9 offset:512
BL v18,s[16:19],s60 offen offset:3072 lds
ds_read_b128 a[48:51], v36 offset:40960
ds_read_b128 a[52:55], v38 offset:40960
M3 a[128:143],a[236:239],v[96:99],0
TR a[232:233],v22
TR a[234:235],v22 offset:512
ds_read_b128 a[56:59], v36 offset:47104
ds_read_b128 a[60:63], v38 offset:47104
s_waitcnt lgkmcnt(15)
M3 a[208:223],a[0:3],a[4:7],0
M3 a[80:95],a[240:243],v[100:103],a[80:95]
TR a[236:237],v24
TR a[238:239],v24 offset:512
M3 a[96:111],a[244:247],v[100:103],a[96:111]
TR a[240:241],v7 offset:40960
TR a[242:243],v7 offset:41472
M3 a[208:223],a[8:11],a[12:15],a[208:223]
M3 a[112:127],a[248:251],v[100:103],a[112:127]
TR a[244:245],v9 offset:40960
TR a[246:247],v9 offset:41472
M3 a[128:143],a[252:255],v[100:103],a[128:143]
TR a[248:249],v22 offset:40960
TR a[250:251],v22 offset:41472
M3 a[208:223],a[16:19],a[20:23],a[208:223]
s_waitcnt lgkmcnt(6)
M3 a[80:95],a[224:227],v[104:107],a[80:95]
TR a[252:253],v24 offset:40960
TR a[254:255],v24 offset:41472
M3 a[96:111],a[228:231],v[104:107],a[96:111]
M3 a[208:223],a[24:27],a[28:31],a[208:223]
M3 a[112:127],a[232:235],v[104:107],a[112:127]
M3 a[208:223],a[32:35],a[36:39],a[208:223]
M3 a[128:143],a[236:239],v[104:107],a[128:143]
s_waitcnt vmcnt(14) lgkmcnt(0)
s_barrier
TR a[224:225],v6 offset:5120
TR a[226:227],v6 offset:5632
TR a[228:229],v8 offset:5120
TR a[230:231],v8 offset:5632
M3 a[80:95],a[240:243],v[108:111],a[80:95]
TR a[232:233],v19 offset:5120
TR a[234:235],v19 offset:5632
TR a[236:237],v23 offset:5120
TR a[238:239],v23 offset:5632
s_add_u32 m0, s6, 0
s_bfe_u32 s60, s58, 0x40014
s_mul_i32 s60, s60, 221184
s_add_u32 s60, s60, s41
BL v15,s[12:15],s60 offen lds
M3 a[96:111],a[244:247],v[108:111],a[96:111]
TR a[240:241],v6 offset:46080
TR a[242:243],v6 offset:46592
M3 a[112:127],a[248:251],v[108:111],a[112:127]
TR a[244:245],v8 offset:46080
TR a[246:247],v8 offset:46592
BL v16,s[12:15],s60 offen offset:1024 lds
M3 a[128:143],a[252:255],v[108:111],a[128:143]
TR a[248:249],v19 offset:46080
TR a[250:251],v19 offset:46592
M3 a[208:223],a[40:43],a[44:47],a[208:223]
s_waitcnt lgkmcnt(6)
M3 a[80:95],a[224:227],v[112:115],a[80:95]
TR a[252:253],v23 offset:46080
TR a[254:255],v23 offset:46592
BL v17,s[16:19],s60 offen offset:2048 lds
s_waitcnt vmcnt(4)
K1_KVGU_W_chk:
v_cmp_ne_u32 vcc, v30, v26
v_cmp_ne_u32 s[84:85], v31, v26
s_nop 0
s_or_b64 vcc, vcc, s[84:85]
v_cmp_ne_u32 s[84:85], v32, v26
s_nop 0
s_or_b64 vcc, vcc, s[84:85]
v_cmp_ne_u32 s[84:85], v33, v26
s_nop 0
s_or_b64 vcc, vcc, s[84:85]
v_cmp_ne_u32 s[84:85], v94, v26
s_nop 0
s_or_b64 vcc, vcc, s[84:85]
s_cmp_eq_u64 vcc, 0
s_cbranch_scc1 K1_KVGU_W_ok
s_cmp_eq_u32 s101, 0
s_cbranch_scc1 K1_KVGU_W_ok
s_sub_u32 s101, s101, 1
s_sleep 10
BL v[30:33],v27,s[24:27],s57 offen sc1
buffer_load_dword v94, v95, s[24:27], s57 offen offset:1024 sc1
s_waitcnt vmcnt(0)
s_branch K1_KVGU_W_chk
K1_KVGU_W_ok:
M3 a[96:111],a[228:231],v[112:115],a[96:111]
TR a[224:225],v7 offset:5120
TR a[226:227],v7 offset:5632
M3 a[112:127],a[232:235],v[112:115],a[112:127]
TR a[228:229],v9 offset:5120
TR a[230:231],v9 offset:5632
BL v18,s[16:19],s60 offen offset:3072 lds
M3 a[128:143],a[236:239],v[112:115],a[128:143]
TR a[232:233],v22 offset:5120
TR a[234:235],v22 offset:5632
M3 a[208:223],a[48:51],a[52:55],a[208:223]
s_waitcnt lgkmcnt(6)
M3 a[80:95],a[240:243],v[116:119],a[80:95]
TR a[236:237],v24 offset:5120
TR a[238:239],v24 offset:5632
s_bfe_u32 s65, s87, 0x80000
s_mul_i32 s65, s65, 40960
BL a[160:163],v27,s[32:35],s65 offen sc1
M3 a[96:111],a[244:247],v[116:119],a[96:111]
TR a[240:241],v7 offset:46080
TR a[242:243],v7 offset:46592
M3 a[112:127],a[248:251],v[116:119],a[112:127]
TR a[244:245],v9 offset:46080
TR a[246:247],v9 offset:46592
BL a[164:167],v27,s[32:35],s65 offen offset:1024 sc1
M3 a[208:223],a[56:59],a[60:63],a[208:223]
M3 a[128:143],a[252:255],v[116:119],a[128:143]
TR a[248:249],v22 offset:46080
TR a[250:251],v22 offset:46592
s_waitcnt lgkmcnt(6)
M3 a[80:95],a[224:227],v[120:123],a[80:95]
TR a[252:253],v24 offset:46080
TR a[254:255],v24 offset:46592
BL a[168:171],v27,s[32:35],s65 offen offset:2048 sc1
M3 a[96:111],a[228:231],v[120:123],a[96:111]
v_mov_b32 v43, v26
v_mov_b32 v47, v26
v_mov_b32 v51, v26
v_mov_b32 v55, v26
v_and_b32 v92, 7, v1
v_lshrrev_b32 v91, 3, v1
M3 a[112:127],a[232:235],v[120:123],a[112:127]
BL a[172:175],v27,s[32:35],s65 offen offset:3072 sc1
v_mul_u32_u24 v93, 2560, v91
v_lshl_add_u32 v88, v92, 4, v93
v_add_u32 v89, 20480, v88
v_mul_u32_u24 v93, 48, v92
M3 a[128:143],a[236:239],v[120:123],a[128:143]
s_waitcnt lgkmcnt(0)
s_barrier
TR a[224:225],v6 offset:10240
TR a[226:227],v6 offset:10752
TR a[228:229],v8 offset:10240
TR a[230:231],v8 offset:10752
M3 a[80:95],a[240:243],v[124:127],a[80:95]
TR a[232:233],v19 offset:10240
TR a[234:235],v19 offset:10752
TR a[236:237],v23 offset:10240
TR a[238:239],v23 offset:10752
s_add_u32 m0, s6, 5120
s_bfe_u32 s60, s58, 0x40018
s_mul_i32 s60, s60, 221184
s_add_u32 s60, s60, s41
BL v15,s[12:15],s60 offen lds
M3 a[96:111],a[244:247],v[124:127],a[96:111]
TR a[240:241],v6 offset:51200
TR a[242:243],v6 offset:51712
M3 a[112:127],a[248:251],v[124:127],a[112:127]
TR a[244:245],v8 offset:51200
TR a[246:247],v8 offset:51712
BL v16,s[12:15],s60 offen offset:1024 lds
v_lshl_add_u32 v93, v91, 4, v93
v_mov_b32 v92, 1073741824
M3 a[128:143],a[252:255],v[124:127],a[128:143]
TR a[248:249],v19 offset:51200
TR a[250:251],v19 offset:51712
v_cmp_gt_u32 vcc, 3, v91
s_nop 1
v_cndmask_b32 v90, v92, v93, vcc
AR v40,a208
AR v41,a209
s_waitcnt lgkmcnt(6)
M3 a[80:95],a[224:227],v[128:131],a[80:95]
TR a[252:253],v23 offset:51200
TR a[254:255],v23 offset:51712
BL v17,s[16:19],s60 offen offset:2048 lds
AR v42,a210
AR v52,a211
M3 a[96:111],a[228:231],v[128:131],a[96:111]
TR a[224:225],v7 offset:10240
TR a[226:227],v7 offset:10752
AR v44,a212
AR v45,a213
AR v46,a214
AR v53,a215
M3 a[112:127],a[232:235],v[128:131],a[112:127]
TR a[228:229],v9 offset:10240
TR a[230:231],v9 offset:10752
BL v18,s[16:19],s60 offen offset:3072 lds
AR v48,a216
AR v49,a217
M3 a[128:143],a[236:239],v[128:131],a[128:143]
TR a[232:233],v22 offset:10240
TR a[234:235],v22 offset:10752
AR v50,a218
AR v54,a219
buffer_store_dwordx4 v[40:43], v39, s[24:27], s62 offen sc1
s_waitcnt lgkmcnt(6)
M3 a[80:95],a[240:243],v[132:135],a[80:95]
TR a[236:237],v24 offset:10240
TR a[238:239],v24 offset:10752
BL a[176:179],v25,s[32:35],s65 offen sc1
buffer_store_dwordx4 v[44:47], v39, s[24:27], s62 offen offset:640 sc1
M3 a[96:111],a[244:247],v[132:135],a[96:111]
TR a[240:241],v7 offset:51200
TR a[242:243],v7 offset:51712
buffer_store_dwordx4 v[48:51], v39, s[24:27], s62 offen offset:1280 sc1
buffer_store_dwordx4 v[52:55], v39, s[24:27], s62 offen offset:1920 sc1
M3 a[112:127],a[248:251],v[132:135],a[112:127]
TR a[244:245],v9 offset:51200
TR a[246:247],v9 offset:51712
s_bfe_u32 s65, s87, 0x80008
s_mul_i32 s65, s65, 40960
BL a[180:183],v27,s[32:35],s65 offen sc1
M3 a[128:143],a[252:255],v[132:135],a[128:143]
TR a[248:249],v22 offset:51200
TR a[250:251],v22 offset:51712
s_waitcnt lgkmcnt(6)
M3 a[80:95],a[224:227],v[136:139],a[80:95]
TR a[252:253],v24 offset:51200
TR a[254:255],v24 offset:51712
BL a[184:187],v27,s[32:35],s65 offen offset:1024 sc1
M3 a[96:111],a[228:231],v[136:139],a[96:111]
M3 a[112:127],a[232:235],v[136:139],a[112:127]
BL a[188:191],v27,s[32:35],s65 offen offset:2048 sc1
M3 a[128:143],a[236:239],v[136:139],a[128:143]
s_waitcnt lgkmcnt(0)
s_barrier
TR a[224:225],v6 offset:15360
TR a[226:227],v6 offset:15872
TR a[228:229],v8 offset:15360
TR a[230:231],v8 offset:15872
M3 a[80:95],a[240:243],v[140:143],a[80:95]
TR a[232:233],v19 offset:15360
TR a[234:235],v19 offset:15872
TR a[236:237],v23 offset:15360
TR a[238:239],v23 offset:15872
s_add_u32 m0, s6, 10240
s_bfe_u32 s60, s58, 0x4001c
s_mul_i32 s60, s60, 221184
s_add_u32 s60, s60, s41
BL v15,s[12:15],s60 offen lds
M3 a[96:111],a[244:247],v[140:143],a[96:111]
TR a[240:241],v6 offset:56320
TR a[242:243],v6 offset:56832
M3 a[112:127],a[248:251],v[140:143],a[112:127]
TR a[244:245],v8 offset:56320
TR a[246:247],v8 offset:56832
BL v16,s[12:15],s60 offen offset:1024 lds
M3 a[128:143],a[252:255],v[140:143],a[128:143]
TR a[248:249],v19 offset:56320
TR a[250:251],v19 offset:56832
s_waitcnt lgkmcnt(6)
M3 a[80:95],a[224:227],v[144:147],a[80:95]
TR a[252:253],v23 offset:56320
TR a[254:255],v23 offset:56832
BL v17,s[16:19],s60 offen offset:2048 lds
M3 a[96:111],a[228:231],v[144:147],a[96:111]
TR a[224:225],v7 offset:15360
TR a[226:227],v7 offset:15872
M3 a[112:127],a[232:235],v[144:147],a[112:127]
TR a[228:229],v9 offset:15360
TR a[230:231],v9 offset:15872
BL v18,s[16:19],s60 offen offset:3072 lds
M3 a[128:143],a[236:239],v[144:147],a[128:143]
TR a[232:233],v22 offset:15360
TR a[234:235],v22 offset:15872
s_waitcnt lgkmcnt(6)
M3 a[80:95],a[240:243],v[148:151],a[80:95]
TR a[236:237],v24 offset:15360
TR a[238:239],v24 offset:15872
BL a[192:195],v27,s[32:35],s65 offen offset:3072 sc1
M3 a[96:111],a[244:247],v[148:151],a[96:111]
TR a[240:241],v7 offset:56320
TR a[242:243],v7 offset:56832
M3 a[112:127],a[248:251],v[148:151],a[112:127]
TR a[244:245],v9 offset:56320
TR a[246:247],v9 offset:56832
BL a[196:199],v25,s[32:35],s65 offen sc1
M3 a[128:143],a[252:255],v[148:151],a[128:143]
TR a[248:249],v22 offset:56320
TR a[250:251],v22 offset:56832
s_waitcnt lgkmcnt(6)
M3 a[80:95],a[224:227],v[152:155],a[80:95]
TR a[252:253],v24 offset:56320
TR a[254:255],v24 offset:56832
s_bfe_u32 s65, s87, 0x80010
s_mul_i32 s65, s65, 40960
BL a[200:203],v27,s[32:35],s65 offen sc1
M3 a[96:111],a[228:231],v[152:155],a[96:111]
M3 a[112:127],a[232:235],v[152:155],a[112:127]
BL a[204:207],v27,s[32:35],s65 offen offset:1024 sc1
M3 a[128:143],a[236:239],v[152:155],a[128:143]
s_waitcnt vmcnt(28) lgkmcnt(0)
s_barrier
TR a[224:225],v6 offset:20480
TR a[226:227],v6 offset:20992
TR a[228:229],v8 offset:20480
TR a[230:231],v8 offset:20992
M3 a[80:95],a[240:243],v[156:159],a[80:95]
TR a[232:233],v19 offset:20480
TR a[234:235],v19 offset:20992
TR a[236:237],v23 offset:20480
TR a[238:239],v23 offset:20992
s_add_u32 m0, s6, 15360
s_bfe_u32 s60, s59, 0x40000
s_mul_i32 s60, s60, 221184
s_add_u32 s60, s60, s41
BL v15,s[12:15],s60 offen lds
M3 a[96:111],a[244:247],v[156:159],a[96:111]
TR a[240:241],v6 offset:61440
TR a[242:243],v6 offset:61952
M3 a[112:127],a[248:251],v[156:159],a[112:127]
TR a[244:245],v8 offset:61440
TR a[246:247],v8 offset:61952
BL v16,s[12:15],s60 offen offset:1024 lds
BL v[40:43],v88,s[24:27],s63 offen sc1
M3 a[128:143],a[252:255],v[156:159],a[128:143]
TR a[248:249],v19 offset:61440
TR a[250:251],v19 offset:61952
BL v[44:47],v88,s[24:27],s63 offen offset:640 sc1
BL v[48:51],v88,s[24:27],s63 offen offset:1280 sc1
s_waitcnt lgkmcnt(6)
M3 a[80:95],a[224:227],v[160:163],a[80:95]
TR a[252:253],v23 offset:61440
TR a[254:255],v23 offset:61952
BL v17,s[16:19],s60 offen offset:2048 lds
BL v[52:55],v88,s[24:27],s63 offen offset:1920 sc1
M3 a[96:111],a[228:231],v[160:163],a[96:111]
TR a[224:225],v7 offset:20480
TR a[226:227],v7 offset:20992
BL v[56:59],v89,s[24:27],s63 offen sc1
BL v[60:63],v89,s[24:27],s63 offen offset:640 sc1
M3 a[112:127],a[232:235],v[160:163],a[112:127]
TR a[228:229],v9 offset:20480
TR a[230:231],v9 offset:20992
BL v18,s[16:19],s60 offen offset:3072 lds
BL v[64:67],v89,s[24:27],s63 offen offset:1280 sc1
M3 a[128:143],a[236:239],v[160:163],a[128:143]
TR a[232:233],v22 offset:20480
TR a[234:235],v22 offset:20992
BL v[68:71],v89,s[24:27],s63 offen offset:1920 sc1
s_waitcnt lgkmcnt(6)
M3 a[80:95],a[240:243],v[164:167],a[80:95]
TR a[236:237],v24 offset:20480
TR a[238:239],v24 offset:20992
BL a[208:211],v27,s[32:35],s65 offen offset:2048 sc1
M3 a[96:111],a[244:247],v[164:167],a[96:111]
TR a[240:241],v7 offset:61440
TR a[242:243],v7 offset:61952
M3 a[112:127],a[248:251],v[164:167],a[112:127]
TR a[244:245],v9 offset:61440
TR a[246:247],v9 offset:61952
BL a[212:215],v27,s[32:35],s65 offen offset:3072 sc1
M3 a[128:143],a[252:255],v[164:167],a[128:143]
TR a[248:249],v22 offset:61440
TR a[250:251],v22 offset:61952
s_waitcnt lgkmcnt(6)
M3 a[80:95],a[224:227],v[168:171],a[80:95]
TR a[252:253],v24 offset:61440
TR a[254:255],v24 offset:61952
BL a[216:219],v25,s[32:35],s65 offen sc1
M3 a[96:111],a[228:231],v[168:171],a[96:111]
M3 a[112:127],a[232:235],v[168:171],a[112:127]
s_bfe_u32 s65, s87, 0x80018
s_mul_i32 s65, s65, 40960
BL a[220:223],v27,s[32:35],s65 offen sc1
M3 a[128:143],a[236:239],v[168:171],a[128:143]
s_waitcnt vmcnt(40) lgkmcnt(0)
s_barrier
TR a[224:225],v6
TR a[226:227],v6 offset:512
TR a[228:229],v8
TR a[230:231],v8 offset:512
M3 a[80:95],a[240:243],v[172:175],a[80:95]
TR a[232:233],v19
TR a[234:235],v19 offset:512
TR a[236:237],v23
TR a[238:239],v23 offset:512
s_add_u32 m0, s6, 20480
s_bfe_u32 s60, s59, 0x40004
s_mul_i32 s60, s60, 221184
s_add_u32 s60, s60, s41
BL v15,s[12:15],s60 offen lds
M3 a[96:111],a[244:247],v[172:175],a[96:111]
TR a[240:241],v6 offset:40960
TR a[242:243],v6 offset:41472
M3 a[112:127],a[248:251],v[172:175],a[112:127]
TR a[244:245],v8 offset:40960
TR a[246:247],v8 offset:41472
BL v16,s[12:15],s60 offen offset:1024 lds
M3 a[128:143],a[252:255],v[172:175],a[128:143]
TR a[248:249],v19 offset:40960
TR a[250:251],v19 offset:41472
s_waitcnt lgkmcnt(6)
M3 a[80:95],a[224:227],v[176:179],a[80:95]
TR a[252:253],v23 offset:40960
TR a[254:255],v23 offset:41472
BL v17,s[16:19],s60 offen offset:2048 lds
M3 a[96:111],a[228:231],v[176:179],a[96:111]
TR a[224:225],v7
TR a[226:227],v7 offset:512
M3 a[112:127],a[232:235],v[176:179],a[112:127]
TR a[228:229],v9
TR a[230:231],v9 offset:512
BL v18,s[16:19],s60 offen offset:3072 lds
M3 a[128:143],a[236:239],v[176:179],a[128:143]
TR a[232:233],v22
TR a[234:235],v22 offset:512
s_waitcnt lgkmcnt(6)
M3 a[80:95],a[240:243],v[180:183],a[80:95]
TR a[236:237],v24
TR a[238:239],v24 offset:512
s_add_u32 m0, s6, 32768
s_nop 0
BL v27,s[32:35],s65 offen offset:1024 sc1 lds
M3 a[96:111],a[244:247],v[180:183],a[96:111]
TR a[240:241],v7 offset:40960
TR a[242:243],v7 offset:41472
M3 a[112:127],a[248:251],v[180:183],a[112:127]
TR a[244:245],v9 offset:40960
TR a[246:247],v9 offset:41472
BL v27,s[32:35],s65 offen offset:2048 sc1 lds
s_waitcnt vmcnt(10)
K1_KVGU_Z_chk:
v_cmp_ne_u32 vcc, v43, v26
v_cmp_ne_u32 s[84:85], v47, v26
s_nop 0
s_or_b64 vcc, vcc, s[84:85]
v_cmp_ne_u32 s[84:85], v51, v26
s_nop 0
s_or_b64 vcc, vcc, s[84:85]
v_cmp_ne_u32 s[84:85], v55, v26
s_nop 0
s_or_b64 vcc, vcc, s[84:85]
v_cmp_ne_u32 s[84:85], v59, v26
s_nop 0
s_or_b64 vcc, vcc, s[84:85]
v_cmp_ne_u32 s[84:85], v63, v26
s_nop 0
s_or_b64 vcc, vcc, s[84:85]
v_cmp_ne_u32 s[84:85], v67, v26
s_nop 0
s_or_b64 vcc, vcc, s[84:85]
v_cmp_ne_u32 s[84:85], v71, v26
s_nop 0
s_or_b64 vcc, vcc, s[84:85]
s_cmp_eq_u64 vcc, 0
s_cbranch_scc1 K1_KVGU_Z_ok
s_cmp_eq_u32 s101, 0
s_cbranch_scc1 K1_KVGU_Z_ok
s_sub_u32 s101, s101, 1
s_sleep 2
BL v[40:43],v88,s[24:27],s63 offen sc1
BL v[44:47],v88,s[24:27],s63 offen offset:640 sc1
BL v[48:51],v88,s[24:27],s63 offen offset:1280 sc1
BL v[52:55],v88,s[24:27],s63 offen offset:1920 sc1
BL v[56:59],v89,s[24:27],s63 offen sc1
BL v[60:63],v89,s[24:27],s63 offen offset:640 sc1
BL v[64:67],v89,s[24:27],s63 offen offset:1280 sc1
BL v[68:71],v89,s[24:27],s63 offen offset:1920 sc1
s_waitcnt vmcnt(0)
s_branch K1_KVGU_Z_chk
K1_KVGU_Z_ok:
M3 a[128:143],a[252:255],v[180:183],a[128:143]
TR a[248:249],v22 offset:40960
TR a[250:251],v22 offset:41472
s_waitcnt lgkmcnt(6)
M3 a[80:95],a[224:227],v[184:187],a[80:95]
TR a[252:253],v24 offset:40960
TR a[254:255],v24 offset:41472
BL v27,s[32:35],s65 offen offset:3072 sc1 lds
M3 a[96:111],a[228:231],v[184:187],a[96:111]
v_add_f32 v40, v40, v56
v_add_f32 v41, v41, v57
v_add_f32 v42, v42, v58
v_add_f32 v44, v44, v60
v_add_f32 v45, v45, v61
v_add_f32 v46, v46, v62
M3 a[112:127],a[232:235],v[184:187],a[112:127]
s_add_u32 m0, s6, 36864
s_nop 0
BL v25,s[32:35],s65 offen sc1 lds
v_add_f32 v48, v48, v64
v_add_f32 v49, v49, v65
v_add_f32 v50, v50, v66
M3 a[128:143],a[236:239],v[184:187],a[128:143]
s_waitcnt lgkmcnt(0)
s_barrier
TR a[224:225],v6 offset:5120
TR a[226:227],v6 offset:5632
TR a[228:229],v8 offset:5120
TR a[230:231],v8 offset:5632
M3 a[80:95],a[240:243],v[188:191],a[80:95]
TR a[232:233],v19 offset:5120
TR a[234:235],v19 offset:5632
TR a[236:237],v23 offset:5120
TR a[238:239],v23 offset:5632
s_add_u32 m0, s6, 37888
s_bfe_u32 s65, s88, 0x80000
s_mul_i32 s65, s65, 40960
BL v27,s[32:35],s65 offen sc1 lds
M3 a[96:111],a[244:247],v[188:191],a[96:111]
TR a[240:241],v6 offset:46080
TR a[242:243],v6 offset:46592
v_add_f32 v52, v52, v68
M3 a[112:127],a[248:251],v[188:191],a[112:127]
TR a[244:245],v8 offset:46080
TR a[246:247],v8 offset:46592
BL v27,s[32:35],s65 offen offset:1024 sc1 lds
v_add_f32 v53, v53, v69
v_add_f32 v54, v54, v70
M3 a[128:143],a[252:255],v[188:191],a[128:143]
TR a[248:249],v19 offset:46080
TR a[250:251],v19 offset:46592
v_add_f32_dpp v40, v40, v40 row_ror:8 row_mask:0xf bank_mask:0xf
v_add_f32_dpp v41, v41, v41 row_ror:8 row_mask:0xf bank_mask:0xf
v_add_f32_dpp v42, v42, v42 row_ror:8 row_mask:0xf bank_mask:0xf
v_add_f32_dpp v44, v44, v44 row_ror:8 row_mask:0xf bank_mask:0xf
s_waitcnt lgkmcnt(6)
M3 a[80:95],a[224:227],v[192:195],a[80:95]
TR a[252:253],v23 offset:46080
TR a[254:255],v23 offset:46592
BL v27,s[32:35],s65 offen offset:2048 sc1 lds
v_add_f32_dpp v45, v45, v45 row_ror:8 row_mask:0xf bank_mask:0xf
v_add_f32_dpp v46, v46, v46 row_ror:8 row_mask:0xf bank_mask:0xf
M3 a[96:111],a[228:231],v[192:195],a[96:111]
TR a[224:225],v7 offset:5120
TR a[226:227],v7 offset:5632
v_add_f32_dpp v48, v48, v48 row_ror:8 row_mask:0xf bank_mask:0xf
v_add_f32_dpp v49, v49, v49 row_ror:8 row_mask:0xf bank_mask:0xf
v_add_f32_dpp v50, v50, v50 row_ror:8 row_mask:0xf bank_mask:0xf
v_add_f32_dpp v52, v52, v52 row_ror:8 row_mask:0xf bank_mask:0xf
M3 a[112:127],a[232:235],v[192:195],a[112:127]
TR a[228:229],v9 offset:5120
TR a[230:231],v9 offset:5632
BL a[64:67],v27,s[32:35],s65 offen offset:3072 sc1
v_add_f32_dpp v53, v53, v53 row_ror:8 row_mask:0xf bank_mask:0xf
v_add_f32_dpp v54, v54, v54 row_ror:8 row_mask:0xf bank_mask:0xf
M3 a[128:143],a[236:239],v[192:195],a[128:143]
TR a[232:233],v22 offset:5120
TR a[234:235],v22 offset:5632
v_mov_b32 v56, v40
v_mov_b32 v57, v41
v_mov_b32 v58, v42
v_mov_b32 v60, v44
s_waitcnt lgkmcnt(6)
M3 a[80:95],a[240:243],v[196:199],a[80:95]
TR a[236:237],v24 offset:5120
TR a[238:239],v24 offset:5632
BL a[68:71],v25,s[32:35],s65 offen sc1
v_mov_b32 v61, v45
v_mov_b32 v62, v46
M3 a[96:111],a[244:247],v[196:199],a[96:111]
TR a[240:241],v7 offset:46080
TR a[242:243],v7 offset:46592
v_mov_b32 v64, v48
v_mov_b32 v65, v49
v_mov_b32 v66, v50
v_mov_b32 v68, v52
M3 a[112:127],a[248:251],v[196:199],a[112:127]
TR a[244:245],v9 offset:46080
TR a[246:247],v9 offset:46592
s_bfe_u32 s65, s88, 0x80008
s_mul_i32 s65, s65, 40960
BL a[72:75],v27,s[32:35],s65 offen sc1
M3 a[128:143],a[252:255],v[196:199],a[128:143]
TR a[248:249],v22 offset:46080
TR a[250:251],v22 offset:46592
v_mov_b32 v69, v53
v_mov_b32 v70, v54
v_permlane16_swap_b32 v40, v56
v_permlane16_swap_b32 v41, v57
s_waitcnt lgkmcnt(6)
M3 a[80:95],a[224:227],v[200:203],a[80:95]
TR a[252:253],v24 offset:46080
TR a[254:255],v24 offset:46592
s_lshr_b32 s7, s5, 3
s_lshl_b32 s98, s4, 1
s_add_u32 s98, s98, s7
s_mul_i32 s99, s98, 74
s_mul_i32 s61, s3, 14
s_add_u32 s99, s99, s61
s_lshl_b32 s99, s99, 12
s_add_u32 s99, s99, 0
s_add_u32 s36, s82, s99
s_addc_u32 s37, s83, 0
s_sub_u32 s38, 74, s61
s_lshl_b32 s38, s38, 12
s_mov_b32 s39, 0x20000
v_and_b32 v30, 1, v1
v_lshlrev_b32 v30, 2, v30
v_and_b32 v31, 2, v1
v_lshl_add_u32 v30, v31, 6, v30
s_lshl_b32 s7, s3, 8
s_add_u32 s7, s7, 1024
v_add_u32 v30, s7, v30
s_add_u32 s98, s97, 4294836224
s_add_u32 s99, s97, 4294901760
buffer_load_dword v31, v30, s[24:27], s98 offen sc1
BL a[76:79],v27,s[32:35],s65 offen offset:1024 sc1
v_permlane16_swap_b32 v42, v58
v_permlane16_swap_b32 v44, v60
M3 a[96:111],a[228:231],v[200:203],a[96:111]
v_permlane16_swap_b32 v45, v61
v_permlane16_swap_b32 v46, v62
v_permlane16_swap_b32 v48, v64
v_permlane16_swap_b32 v49, v65
v_permlane16_swap_b32 v50, v66
v_permlane16_swap_b32 v52, v68
M3 a[112:127],a[232:235],v[200:203],a[112:127]
s_add_u32 m0, s6, 23552
s_nop 0
BL v27,s[32:35],s65 offen offset:2048 sc1 lds
v_permlane16_swap_b32 v53, v69
v_permlane16_swap_b32 v54, v70
v_add_f32 v40, v40, v56
M3 a[128:143],a[236:239],v[200:203],a[128:143]
s_waitcnt lgkmcnt(0)
s_barrier
TR a[224:225],v6 offset:10240
TR a[226:227],v6 offset:10752
TR a[228:229],v8 offset:10240
TR a[230:231],v8 offset:10752
M3 a[80:95],a[240:243],v[204:207],a[80:95]
TR a[232:233],v19 offset:10240
TR a[234:235],v19 offset:10752
TR a[236:237],v23 offset:10240
TR a[238:239],v23 offset:10752
BL v27,s[32:35],s65 offen offset:3072 sc1 lds
M3 a[96:111],a[244:247],v[204:207],a[96:111]
TR a[240:241],v6 offset:51200
TR a[242:243],v6 offset:51712
v_add_f32 v41, v41, v57
v_add_f32 v42, v42, v58
v_add_f32 v44, v44, v60
v_add_f32 v45, v45, v61
M3 a[112:127],a[248:251],v[204:207],a[112:127]
TR a[244:245],v8 offset:51200
TR a[246:247],v8 offset:51712
s_add_u32 m0, s6, 27648
s_nop 0
BL v25,s[32:35],s65 offen sc1 lds
v_add_f32 v46, v46, v62
M3 a[128:143],a[252:255],v[204:207],a[128:143]
TR a[248:249],v19 offset:51200
TR a[250:251],v19 offset:51712
v_add_f32 v48, v48, v64
v_add_f32 v49, v49, v65
v_add_f32 v50, v50, v66
v_add_f32 v52, v52, v68
s_waitcnt lgkmcnt(6)
M3 a[80:95],a[224:227],v[208:211],a[80:95]
TR a[252:253],v23 offset:51200
TR a[254:255],v23 offset:51712
s_add_u32 m0, s6, 28672
s_bfe_u32 s65, s88, 0x80010
s_mul_i32 s65, s65, 40960
BL v27,s[32:35],s65 offen sc1 lds
M3 a[96:111],a[228:231],v[208:211],a[96:111]
TR a[224:225],v7 offset:10240
TR a[226:227],v7 offset:10752
v_add_f32 v53, v53, v69
v_add_f32 v54, v54, v70
v_mov_b32 v56, v40
M3 a[112:127],a[232:235],v[208:211],a[112:127]
TR a[228:229],v9 offset:10240
TR a[230:231],v9 offset:10752
BL v27,s[32:35],s65 offen offset:1024 sc1 lds
v_mov_b32 v57, v41
v_mov_b32 v58, v42
M3 a[128:143],a[236:239],v[208:211],a[128:143]
TR a[232:233],v22 offset:10240
TR a[234:235],v22 offset:10752
v_mov_b32 v60, v44
v_mov_b32 v61, v45
v_mov_b32 v62, v46
v_mov_b32 v64, v48
s_waitcnt lgkmcnt(6)
M3 a[80:95],a[240:243],v[212:215],a[80:95]
TR a[236:237],v24 offset:10240
TR a[238:239],v24 offset:10752
BL v27,s[32:35],s65 offen offset:2048 sc1 lds
v_mov_b32 v65, v49
v_mov_b32 v66, v50
M3 a[96:111],a[244:247],v[212:215],a[96:111]
TR a[240:241],v7 offset:51200
TR a[242:243],v7 offset:51712
v_mov_b32 v68, v52
v_mov_b32 v69, v53
v_mov_b32 v70, v54
v_permlane32_swap_b32 v40, v56
M3 a[112:127],a[248:251],v[212:215],a[112:127]
TR a[244:245],v9 offset:51200
TR a[246:247],v9 offset:51712
BL v27,s[32:35],s65 offen offset:3072 sc1 lds
v_permlane32_swap_b32 v41, v57
v_permlane32_swap_b32 v42, v58
M3 a[128:143],a[252:255],v[212:215],a[128:143]
TR a[248:249],v22 offset:51200
TR a[250:251],v22 offset:51712
v_permlane32_swap_b32 v44, v60
v_permlane32_swap_b32 v45, v61
v_permlane32_swap_b32 v46, v62
v_permlane32_swap_b32 v48, v64
s_waitcnt lgkmcnt(6)
M3 a[80:95],a[224:227],v[216:219],a[80:95]
TR a[252:253],v24 offset:51200
TR a[254:255],v24 offset:51712
s_add_u32 m0, s6, 32768
s_nop 0
BL v25,s[32:35],s65 offen sc1 lds
v_permlane32_swap_b32 v49, v65
M3 a[96:111],a[228:231],v[216:219],a[96:111]
v_permlane32_swap_b32 v50, v66
v_permlane32_swap_b32 v52, v68
v_permlane32_swap_b32 v53, v69
v_permlane32_swap_b32 v54, v70
v_add_f32 v40, v40, v56
v_add_f32 v41, v41, v57
M3 a[112:127],a[232:235],v[216:219],a[112:127]
s_bfe_u32 s65, s88, 0x80018
s_mul_i32 s65, s65, 40960
BL a[0:3],v27,s[32:35],s65 offen sc1
v_add_f32 v42, v42, v58
v_add_f32 v44, v44, v60
M3 a[128:143],a[236:239],v[216:219],a[128:143]
s_waitcnt lgkmcnt(0)
s_barrier
TR a[224:225],v6 offset:15360
TR a[226:227],v6 offset:15872
TR a[228:229],v8 offset:15360
TR a[230:231],v8 offset:15872
M3 a[80:95],a[240:243],v[220:223],a[80:95]
TR a[232:233],v19 offset:15360
TR a[234:235],v19 offset:15872
TR a[236:237],v23 offset:15360
TR a[238:239],v23 offset:15872
BL a[4:7],v27,s[32:35],s65 offen offset:1024 sc1
M3 a[96:111],a[244:247],v[220:223],a[96:111]
TR a[240:241],v6 offset:56320
TR a[242:243],v6 offset:56832
v_add_f32 v45, v45, v61
v_add_f32 v46, v46, v62
v_add_f32 v48, v48, v64
v_add_f32 v49, v49, v65
M3 a[112:127],a[248:251],v[220:223],a[112:127]
TR a[244:245],v8 offset:56320
TR a[246:247],v8 offset:56832
BL a[8:11],v27,s[32:35],s65 offen offset:2048 sc1
v_add_f32 v50, v50, v66
v_add_f32 v52, v52, v68
M3 a[128:143],a[252:255],v[220:223],a[128:143]
TR a[248:249],v19 offset:56320
TR a[250:251],v19 offset:56832
v_add_f32 v53, v53, v69
v_add_f32 v54, v54, v70
CV v72,v40,v41
CV v73,v42,v52
s_waitcnt lgkmcnt(6)
M3 a[80:95],a[224:227],v[224:227],a[80:95]
TR a[252:253],v23 offset:56320
TR a[254:255],v23 offset:56832
s_waitcnt vmcnt(12)
K1_KVGU_E_chk:
v_cmp_ne_u32 vcc, v31, v26
s_nop 0
s_cmp_eq_u64 vcc, 0
s_cbranch_scc1 K1_KVGU_E_ok
s_cmp_eq_u32 s101, 0
s_cbranch_scc1 K1_KVGU_E_ok
s_sub_u32 s101, s101, 1
s_sleep 10
buffer_load_dword v31, v30, s[24:27], s98 offen sc1
s_waitcnt vmcnt(0)
s_branch K1_KVGU_E_chk
K1_KVGU_E_ok:
s_bfe_u32 s61, s87, 0x80000
s_mul_i32 s61, s61, 4096
BL v[96:99],v27,s[36:39],s61 offen sc1
M3 a[96:111],a[228:231],v[224:227],a[96:111]
TR a[224:225],v7 offset:15360
TR a[226:227],v7 offset:15872
CV v76,v44,v45
CV v77,v46,v53
CV v80,v48,v49
CV v81,v50,v54
M3 a[112:127],a[232:235],v[224:227],a[112:127]
TR a[228:229],v9 offset:15360
TR a[230:231],v9 offset:15872
s_bfe_u32 s61, s87, 0x80000
s_mul_i32 s61, s61, 4096
BL v[100:103],v27,s[36:39],s61 offen offset:1024 sc1
M3 a[128:143],a[236:239],v[224:227],a[128:143]
TR a[232:233],v22 offset:15360
TR a[234:235],v22 offset:15872
v_cmp_eq_u32 vcc, 1, v91
s_nop 1
v_cndmask_b32 v72, v72, v76, vcc
v_cndmask_b32 v73, v73, v77, vcc
v_cmp_eq_u32 vcc, 2, v91
s_nop 1
v_cndmask_b32 v72, v72, v80, vcc
v_cndmask_b32 v73, v73, v81, vcc
s_waitcnt lgkmcnt(6)
M3 a[80:95],a[240:243],v[228:231],a[80:95]
TR a[236:237],v24 offset:15360
TR a[238:239],v24 offset:15872
s_bfe_u32 s61, s87, 0x80000
s_mul_i32 s61, s61, 4096
BL v[104:107],v27,s[36:39],s61 offen offset:2048 sc1
M3 a[96:111],a[244:247],v[228:231],a[96:111]
TR a[240:241],v7 offset:56320
TR a[242:243],v7 offset:56832
v_mov_b32 v74, v26
v_mov_b32 v75, v26
M3 a[112:127],a[248:251],v[228:231],a[112:127]
TR a[244:245],v9 offset:56320
TR a[246:247],v9 offset:56832
s_bfe_u32 s61, s87, 0x80000
s_mul_i32 s61, s61, 4096
BL v[108:111],v27,s[36:39],s61 offen offset:3072 sc1
M3 a[128:143],a[252:255],v[228:231],a[128:143]
TR a[248:249],v22 offset:56320
TR a[250:251],v22 offset:56832
buffer_store_dwordx4 v[72:75], v90, s[24:27], s64 offen sc1
s_waitcnt lgkmcnt(6)
M3 a[80:95],a[224:227],v[232:235],a[80:95]
TR a[252:253],v24 offset:56320
TR a[254:255],v24 offset:56832
s_bfe_u32 s61, s87, 0x80008
s_mul_i32 s61, s61, 4096
BL v[112:115],v27,s[36:39],s61 offen sc1
M3 a[96:111],a[228:231],v[232:235],a[96:111]
M3 a[112:127],a[232:235],v[232:235],a[112:127]
s_bfe_u32 s61, s87, 0x80008
s_mul_i32 s61, s61, 4096
BL v[116:119],v27,s[36:39],s61 offen offset:1024 sc1
M3 a[128:143],a[236:239],v[232:235],a[128:143]
s_waitcnt lgkmcnt(0)
s_barrier
TR a[224:225],v6 offset:20480
TR a[226:227],v6 offset:20992
TR a[228:229],v8 offset:20480
TR a[230:231],v8 offset:20992
M3 a[80:95],a[240:243],v[236:239],a[80:95]
TR a[232:233],v19 offset:20480
TR a[234:235],v19 offset:20992
TR a[236:237],v23 offset:20480
TR a[238:239],v23 offset:20992
s_bfe_u32 s61, s87, 0x80008
s_mul_i32 s61, s61, 4096
BL v[120:123],v27,s[36:39],s61 offen offset:2048 sc1
M3 a[96:111],a[244:247],v[236:239],a[96:111]
TR a[240:241],v6 offset:61440
TR a[242:243],v6 offset:61952
M3 a[112:127],a[248:251],v[236:239],a[112:127]
TR a[244:245],v8 offset:61440
TR a[246:247],v8 offset:61952
s_bfe_u32 s61, s87, 0x80008
s_mul_i32 s61, s61, 4096
BL v[124:127],v27,s[36:39],s61 offen offset:3072 sc1
M3 a[128:143],a[252:255],v[236:239],a[128:143]
TR a[248:249],v19 offset:61440
TR a[250:251],v19 offset:61952
s_waitcnt lgkmcnt(6)
M3 a[80:95],a[224:227],v[240:243],a[80:95]
TR a[252:253],v23 offset:61440
TR a[254:255],v23 offset:61952
s_bfe_u32 s61, s87, 0x80010
s_mul_i32 s61, s61, 4096
BL v[128:131],v27,s[36:39],s61 offen sc1
M3 a[96:111],a[228:231],v[240:243],a[96:111]
TR a[224:225],v7 offset:20480
TR a[226:227],v7 offset:20992
M3 a[112:127],a[232:235],v[240:243],a[112:127]
TR a[228:229],v9 offset:20480
TR a[230:231],v9 offset:20992
s_bfe_u32 s61, s87, 0x80010
s_mul_i32 s61, s61, 4096
BL v[132:135],v27,s[36:39],s61 offen offset:1024 sc1
M3 a[128:143],a[236:239],v[240:243],a[128:143]
TR a[232:233],v22 offset:20480
TR a[234:235],v22 offset:20992
s_waitcnt lgkmcnt(6)
M3 a[80:95],a[240:243],v[244:247],a[80:95]
TR a[236:237],v24 offset:20480
TR a[238:239],v24 offset:20992
s_bfe_u32 s61, s87, 0x80010
s_mul_i32 s61, s61, 4096
BL v[136:139],v27,s[36:39],s61 offen offset:2048 sc1
M3 a[96:111],a[244:247],v[244:247],a[96:111]
TR a[240:241],v7 offset:61440
TR a[242:243],v7 offset:61952
M3 a[112:127],a[248:251],v[244:247],a[112:127]
TR a[244:245],v9 offset:61440
TR a[246:247],v9 offset:61952
s_bfe_u32 s61, s87, 0x80010
s_mul_i32 s61, s61, 4096
BL v[140:143],v27,s[36:39],s61 offen offset:3072 sc1
M3 a[128:143],a[252:255],v[244:247],a[128:143]
TR a[248:249],v22 offset:61440
TR a[250:251],v22 offset:61952
s_waitcnt lgkmcnt(6)
M3 a[80:95],a[224:227],v[248:251],a[80:95]
TR a[252:253],v24 offset:61440
TR a[254:255],v24 offset:61952
s_bfe_u32 s61, s87, 0x80018
s_mul_i32 s61, s61, 4096
BL v[144:147],v27,s[36:39],s61 offen sc1
M3 a[96:111],a[228:231],v[248:251],a[96:111]
M3 a[112:127],a[232:235],v[248:251],a[112:127]
s_bfe_u32 s61, s87, 0x80018
s_mul_i32 s61, s61, 4096
BL v[148:151],v27,s[36:39],s61 offen offset:1024 sc1
M3 a[128:143],a[236:239],v[248:251],a[128:143]
s_waitcnt lgkmcnt(0)
M3 a[80:95],a[240:243],v[252:255],a[80:95]
s_bfe_u32 s61, s87, 0x80018
s_mul_i32 s61, s61, 4096
BL v[152:155],v27,s[36:39],s61 offen offset:2048 sc1
M3 a[96:111],a[244:247],v[252:255],a[96:111]
M3 a[112:127],a[248:251],v[252:255],a[112:127]
s_bfe_u32 s61, s87, 0x80018
s_mul_i32 s61, s61, 4096
BL v[156:159],v27,s[36:39],s61 offen offset:3072 sc1
M3 a[128:143],a[252:255],v[252:255],a[128:143]
s_barrier
s_nop 1
AR v40,a80
AR v41,a81
AR v42,a82
AR v43,a83
AR v44,a88
AR v45,a89
AR v46,a90
AR v47,a91
v_pk_mul_f32 v[48:49], v[40:41], s[50:51] op_sel_hi:[1,0]
v_pk_mul_f32 v[50:51], v[42:43], s[50:51] op_sel_hi:[1,0]
v_exp_f32 v48, v48
v_exp_f32 v49, v49
v_exp_f32 v50, v50
v_exp_f32 v51, v51
v_pk_mul_f32 v[40:41], v[40:41], v[44:45]
v_pk_mul_f32 v[42:43], v[42:43], v[46:47]
v_pk_add_f32 v[48:49], v[48:49], 1.0 op_sel_hi:[1,0]
v_pk_add_f32 v[50:51], v[50:51], 1.0 op_sel_hi:[1,0]
v_rcp_f32 v48, v48
v_rcp_f32 v49, v49
v_rcp_f32 v50, v50
v_rcp_f32 v51, v51
v_pk_mul_f32 v[56:57], v[40:41], v[48:49]
v_pk_mul_f32 v[58:59], v[42:43], v[50:51]
AR v40,a84
AR v41,a85
AR v42,a86
AR v43,a87
AR v44,a92
AR v45,a93
AR v46,a94
AR v47,a95
v_pk_mul_f32 v[48:49], v[40:41], s[50:51] op_sel_hi:[1,0]
v_pk_mul_f32 v[50:51], v[42:43], s[50:51] op_sel_hi:[1,0]
v_exp_f32 v48, v48
v_exp_f32 v49, v49
v_exp_f32 v50, v50
v_exp_f32 v51, v51
v_pk_mul_f32 v[40:41], v[40:41], v[44:45]
v_pk_mul_f32 v[42:43], v[42:43], v[46:47]
v_pk_add_f32 v[48:49], v[48:49], 1.0 op_sel_hi:[1,0]
v_pk_add_f32 v[50:51], v[50:51], 1.0 op_sel_hi:[1,0]
v_rcp_f32 v48, v48
v_rcp_f32 v49, v49
v_rcp_f32 v50, v50
v_rcp_f32 v51, v51
v_pk_mul_f32 v[60:61], v[40:41], v[48:49]
v_pk_mul_f32 v[62:63], v[42:43], v[50:51]
CV v64,v56,v57
CV v65,v58,v59
CV v66,v60,v61
CV v67,v62,v63
buffer_store_dwordx4 v[64:67], v28, s[24:27], s47 offen sc1
AR v40,a96
AR v41,a97
AR v42,a98
AR v43,a99
AR v44,a104
AR v45,a105
AR v46,a106
AR v47,a107
v_pk_mul_f32 v[48:49], v[40:41], s[50:51] op_sel_hi:[1,0]
v_pk_mul_f32 v[50:51], v[42:43], s[50:51] op_sel_hi:[1,0]
v_exp_f32 v48, v48
v_exp_f32 v49, v49
v_exp_f32 v50, v50
v_exp_f32 v51, v51
v_pk_mul_f32 v[40:41], v[40:41], v[44:45]
v_pk_mul_f32 v[42:43], v[42:43], v[46:47]
v_pk_add_f32 v[48:49], v[48:49], 1.0 op_sel_hi:[1,0]
v_pk_add_f32 v[50:51], v[50:51], 1.0 op_sel_hi:[1,0]
v_rcp_f32 v48, v48
v_rcp_f32 v49, v49
v_rcp_f32 v50, v50
v_rcp_f32 v51, v51
v_pk_mul_f32 v[56:57], v[40:41], v[48:49]
v_pk_mul_f32 v[58:59], v[42:43], v[50:51]
AR v40,a100
AR v41,a101
AR v42,a102
AR v43,a103
AR v44,a108
AR v45,a109
AR v46,a110
AR v47,a111
v_pk_mul_f32 v[48:49], v[40:41], s[50:51] op_sel_hi:[1,0]
v_pk_mul_f32 v[50:51], v[42:43], s[50:51] op_sel_hi:[1,0]
v_exp_f32 v48, v48
v_exp_f32 v49, v49
v_exp_f32 v50, v50
v_exp_f32 v51, v51
v_pk_mul_f32 v[40:41], v[40:41], v[44:45]
v_pk_mul_f32 v[42:43], v[42:43], v[46:47]
v_pk_add_f32 v[48:49], v[48:49], 1.0 op_sel_hi:[1,0]
v_pk_add_f32 v[50:51], v[50:51], 1.0 op_sel_hi:[1,0]
v_rcp_f32 v48, v48
v_rcp_f32 v49, v49
v_rcp_f32 v50, v50
v_rcp_f32 v51, v51
v_pk_mul_f32 v[60:61], v[40:41], v[48:49]
v_pk_mul_f32 v[62:63], v[42:43], v[50:51]
CV v68,v56,v57
CV v69,v58,v59
CV v70,v60,v61
CV v71,v62,v63
buffer_store_dwordx4 v[68:71], v28, s[24:27], s47 offen offset:512 sc1
AR v40,a112
AR v41,a113
AR v42,a114
AR v43,a115
AR v44,a120
AR v45,a121
AR v46,a122
AR v47,a123
v_pk_mul_f32 v[48:49], v[40:41], s[50:51] op_sel_hi:[1,0]
v_pk_mul_f32 v[50:51], v[42:43], s[50:51] op_sel_hi:[1,0]
v_exp_f32 v48, v48
v_exp_f32 v49, v49
v_exp_f32 v50, v50
v_exp_f32 v51, v51
v_pk_mul_f32 v[40:41], v[40:41], v[44:45]
v_pk_mul_f32 v[42:43], v[42:43], v[46:47]
v_pk_add_f32 v[48:49], v[48:49], 1.0 op_sel_hi:[1,0]
v_pk_add_f32 v[50:51], v[50:51], 1.0 op_sel_hi:[1,0]
v_rcp_f32 v48, v48
v_rcp_f32 v49, v49
v_rcp_f32 v50, v50
v_rcp_f32 v51, v51
v_pk_mul_f32 v[56:57], v[40:41], v[48:49]
v_pk_mul_f32 v[58:59], v[42:43], v[50:51]
AR v40,a116
AR v41,a117
AR v42,a118
AR v43,a119
AR v44,a124
AR v45,a125
AR v46,a126
AR v47,a127
v_pk_mul_f32 v[48:49], v[40:41], s[50:51] op_sel_hi:[1,0]
v_pk_mul_f32 v[50:51], v[42:43], s[50:51] op_sel_hi:[1,0]
v_exp_f32 v48, v48
v_exp_f32 v49, v49
v_exp_f32 v50, v50
v_exp_f32 v51, v51
v_pk_mul_f32 v[40:41], v[40:41], v[44:45]
v_pk_mul_f32 v[42:43], v[42:43], v[46:47]
v_pk_add_f32 v[48:49], v[48:49], 1.0 op_sel_hi:[1,0]
v_pk_add_f32 v[50:51], v[50:51], 1.0 op_sel_hi:[1,0]
v_rcp_f32 v48, v48
v_rcp_f32 v49, v49
v_rcp_f32 v50, v50
v_rcp_f32 v51, v51
v_pk_mul_f32 v[60:61], v[40:41], v[48:49]
v_pk_mul_f32 v[62:63], v[42:43], v[50:51]
CV v64,v56,v57
CV v65,v58,v59
CV v66,v60,v61
CV v67,v62,v63
buffer_store_dwordx4 v[64:67], v29, s[24:27], s47 offen sc1
AR v40,a128
AR v41,a129
AR v42,a130
AR v43,a131
AR v44,a136
AR v45,a137
AR v46,a138
AR v47,a139
v_pk_mul_f32 v[48:49], v[40:41], s[50:51] op_sel_hi:[1,0]
v_pk_mul_f32 v[50:51], v[42:43], s[50:51] op_sel_hi:[1,0]
v_exp_f32 v48, v48
v_exp_f32 v49, v49
v_exp_f32 v50, v50
v_exp_f32 v51, v51
v_pk_mul_f32 v[40:41], v[40:41], v[44:45]
v_pk_mul_f32 v[42:43], v[42:43], v[46:47]
v_pk_add_f32 v[48:49], v[48:49], 1.0 op_sel_hi:[1,0]
v_pk_add_f32 v[50:51], v[50:51], 1.0 op_sel_hi:[1,0]
v_rcp_f32 v48, v48
v_rcp_f32 v49, v49
v_rcp_f32 v50, v50
v_rcp_f32 v51, v51
v_pk_mul_f32 v[56:57], v[40:41], v[48:49]
v_pk_mul_f32 v[58:59], v[42:43], v[50:51]
AR v40,a132
AR v41,a133
AR v42,a134
AR v43,a135
AR v44,a140
AR v45,a141
AR v46,a142
AR v47,a143
v_pk_mul_f32 v[48:49], v[40:41], s[50:51] op_sel_hi:[1,0]
v_pk_mul_f32 v[50:51], v[42:43], s[50:51] op_sel_hi:[1,0]
v_exp_f32 v48, v48
v_exp_f32 v49, v49
v_exp_f32 v50, v50
v_exp_f32 v51, v51
v_pk_mul_f32 v[40:41], v[40:41], v[44:45]
v_pk_mul_f32 v[42:43], v[42:43], v[46:47]
v_pk_add_f32 v[48:49], v[48:49], 1.0 op_sel_hi:[1,0]
v_pk_add_f32 v[50:51], v[50:51], 1.0 op_sel_hi:[1,0]
v_rcp_f32 v48, v48
v_rcp_f32 v49, v49
v_rcp_f32 v50, v50
v_rcp_f32 v51, v51
v_pk_mul_f32 v[60:61], v[40:41], v[48:49]
v_pk_mul_f32 v[62:63], v[42:43], v[50:51]
CV v68,v56,v57
CV v69,v58,v59
CV v70,v60,v61
CV v71,v62,v63
buffer_store_dwordx4 v[68:71], v29, s[24:27], s47 offen offset:512 sc1
s_waitcnt vmcnt(0)
buffer_store_dword v26, v20, s[24:27], s96 offen sc1
v_and_b32 v2, 1, v1
v_lshlrev_b32 v2, 2, v2
v_and_b32 v7, 2, v1
v_lshl_add_u32 v2, v7, 6, v2
s_lshl_b32 s7, s3, 8
s_add_u32 s7, s7, 1024
v_add_u32 v2, s7, v2
v_and_b32 v3, 1, v1
v_lshlrev_b32 v3, 2, v3
s_lshl_b32 s7, s3, 7
v_add_u32 v3, s7, v3
v_add_u32 v19, 512, v3
buffer_load_dword v6, v2, s[24:27], s99 offen sc1
buffer_load_dword v7, v19, s[24:27], s97 offen sc1
s_load_dwordx2 s[48:49], s[0:1], 56
s_and_b32 s7, s5, 7
s_lshl_b32 s40, s4, 1
s_lshr_b32 s7, s5, 3
s_add_u32 s40, s40, s7
s_and_b32 s7, s5, 7
s_mul_i32 s47, s40, 81920
s_mul_i32 s7, s7, 160
s_add_u32 s47, s47, s7
v_add_u32 v88, 0, v0
v_mul_u32_u24 v89, 6554, v88
v_lshrrev_b32 v89, 16, v89
v_mul_u32_u24 v90, 10, v89
v_sub_u32 v90, v88, v90
v_mul_u32_u24 v91, 1280, v89
v_lshl_add_u32 v10, v90, 4, v91
v_bfe_u32 v91, v89, 1, 2
v_lshlrev_b32 v90, 1, v90
v_xor_b32 v90, v90, v91
v_mul_u32_u24 v91, 320, v89
v_lshl_add_u32 v28, v90, 4, v91
v_xor_b32 v29, 16, v28
v_add_u32 v30, 81920, v28
v_add_u32 v31, 81920, v29
v_add_u32 v88, 256, v0
v_mul_u32_u24 v89, 6554, v88
v_lshrrev_b32 v89, 16, v89
v_mul_u32_u24 v90, 10, v89
v_sub_u32 v90, v88, v90
v_mul_u32_u24 v91, 1280, v89
v_lshl_add_u32 v11, v90, 4, v91
v_bfe_u32 v91, v89, 1, 2
v_lshlrev_b32 v90, 1, v90
v_xor_b32 v90, v90, v91
v_mul_u32_u24 v91, 320, v89
v_lshl_add_u32 v32, v90, 4, v91
v_xor_b32 v33, 16, v32
v_add_u32 v34, 81920, v32
v_add_u32 v35, 81920, v33
v_add_u32 v88, 512, v0
v_mul_u32_u24 v89, 6554, v88
v_lshrrev_b32 v89, 16, v89
v_mul_u32_u24 v90, 10, v89
v_sub_u32 v90, v88, v90
v_mul_u32_u24 v91, 1280, v89
v_lshl_add_u32 v12, v90, 4, v91
v_bfe_u32 v91, v89, 1, 2
v_lshlrev_b32 v90, 1, v90
v_xor_b32 v90, v90, v91
v_mul_u32_u24 v91, 320, v89
v_lshl_add_u32 v36, v90, 4, v91
v_xor_b32 v37, 16, v36
v_add_u32 v38, 81920, v36
v_add_u32 v39, 81920, v37
v_mov_b32 v91, 1073741824
v_cmp_gt_u32 vcc, 128, v0
s_nop 1
v_cndmask_b32 v12, v91, v12, vcc
v_and_b32 v88, 15, v1
v_bfe_u32 v90, v1, 1, 2
v_mul_u32_u24 v88, 320, v88
v_lshrrev_b32 v89, 4, v1
v_xor_b32 v89, v89, v90
v_lshl_add_u32 v88, v89, 4, v88
v_add_u32 v9, s6, v88
v_add_u32 v8, s6, v27
s_waitcnt lgkmcnt(0)
s_mov_b32 s12, s48
s_mov_b32 s13, s49
s_mov_b32 s14, 2621440
s_mov_b32 s15, 0x20000
M1 v[176:179],a[160:163],v[96:99],0
M1 v[192:195],a[164:167],v[96:99],0
BL a[12:15],v27,s[32:35],s65 offen offset:3072 sc1
M1 v[208:211],a[168:171],v[96:99],0
M1 v[224:227],a[172:175],v[96:99],0
BL a[16:19],v25,s[32:35],s65 offen sc1
M1 v[240:243],a[176:179],v[96:99],0
M1 v[180:183],a[160:163],v[100:103],0
M1 v[196:199],a[164:167],v[100:103],0
s_bfe_u32 s65, s70, 0x80000
s_mul_i32 s65, s65, 40960
BL a[20:23],v27,s[32:35],s65 offen sc1
M1 v[212:215],a[168:171],v[100:103],0
M1 v[228:231],a[172:175],v[100:103],0
BL a[24:27],v27,s[32:35],s65 offen offset:1024 sc1
M1 v[244:247],a[176:179],v[100:103],0
M1 v[184:187],a[160:163],v[104:107],0
M1 v[200:203],a[164:167],v[104:107],0
BL a[28:31],v27,s[32:35],s65 offen offset:2048 sc1
M1 v[216:219],a[168:171],v[104:107],0
M1 v[232:235],a[172:175],v[104:107],0
M1 v[248:251],a[176:179],v[104:107],0
M1 v[188:191],a[160:163],v[108:111],0
M1 v[204:207],a[164:167],v[108:111],0
M1 v[220:223],a[168:171],v[108:111],0
M1 v[236:239],a[172:175],v[108:111],0
M1 v[252:255],a[176:179],v[108:111],0
s_waitcnt vmcnt(6)
P2_KVGU_E_chk:
v_cmp_ne_u32 vcc, v6, v26
s_nop 0
s_cmp_eq_u64 vcc, 0
s_cbranch_scc1 P2_KVGU_E_ok
s_cmp_eq_u32 s101, 0
s_cbranch_scc1 P2_KVGU_E_ok
s_sub_u32 s101, s101, 1
s_sleep 10
buffer_load_dword v6, v2, s[24:27], s99 offen sc1
s_waitcnt vmcnt(0)
s_branch P2_KVGU_E_chk
P2_KVGU_E_ok:
M1 v[176:179],a[180:183],v[112:115],v[176:179]
M1 v[192:195],a[184:187],v[112:115],v[192:195]
s_bfe_u32 s41, s88, 0x80000
s_mul_i32 s41, s41, 4096
BL a[80:83],v27,s[36:39],s41 offen sc1
M1 v[208:211],a[188:191],v[112:115],v[208:211]
M1 v[224:227],a[192:195],v[112:115],v[224:227]
BL a[84:87],v27,s[36:39],s41 offen offset:1024 sc1
M1 v[240:243],a[196:199],v[112:115],v[240:243]
M1 v[180:183],a[180:183],v[116:119],v[180:183]
M1 v[196:199],a[184:187],v[116:119],v[196:199]
BL a[88:91],v27,s[36:39],s41 offen offset:2048 sc1
M1 v[212:215],a[188:191],v[116:119],v[212:215]
M1 v[228:231],a[192:195],v[116:119],v[228:231]
BL a[92:95],v27,s[36:39],s41 offen offset:3072 sc1
M1 v[244:247],a[196:199],v[116:119],v[244:247]
M1 v[184:187],a[180:183],v[120:123],v[184:187]
M1 v[200:203],a[184:187],v[120:123],v[200:203]
s_bfe_u32 s41, s88, 0x80008
s_mul_i32 s41, s41, 4096
BL a[96:99],v27,s[36:39],s41 offen sc1
M1 v[216:219],a[188:191],v[120:123],v[216:219]
M1 v[232:235],a[192:195],v[120:123],v[232:235]
BL a[100:103],v27,s[36:39],s41 offen offset:1024 sc1
M1 v[248:251],a[196:199],v[120:123],v[248:251]
M1 v[188:191],a[180:183],v[124:127],v[188:191]
M1 v[204:207],a[184:187],v[124:127],v[204:207]
BL a[104:107],v27,s[36:39],s41 offen offset:2048 sc1
M1 v[220:223],a[188:191],v[124:127],v[220:223]
M1 v[236:239],a[192:195],v[124:127],v[236:239]
BL a[108:111],v27,s[36:39],s41 offen offset:3072 sc1
M1 v[252:255],a[196:199],v[124:127],v[252:255]
s_bfe_u32 s41, s88, 0x80010
s_mul_i32 s41, s41, 4096
BL a[112:115],v27,s[36:39],s41 offen sc1
BL a[116:119],v27,s[36:39],s41 offen offset:1024 sc1
BL a[120:123],v27,s[36:39],s41 offen offset:2048 sc1
BL a[124:127],v27,s[36:39],s41 offen offset:3072 sc1
s_bfe_u32 s41, s88, 0x80018
s_mul_i32 s41, s41, 4096
BL a[128:131],v27,s[36:39],s41 offen sc1
BL a[132:135],v27,s[36:39],s41 offen offset:1024 sc1
BL a[136:139],v27,s[36:39],s41 offen offset:2048 sc1
BL a[140:143],v27,s[36:39],s41 offen offset:3072 sc1
BL a[32:35],v27,s[32:35],s65 offen offset:3072 sc1
BL a[36:39],v25,s[32:35],s65 offen sc1
s_bfe_u32 s65, s70, 0x80008
s_mul_i32 s65, s65, 40960
BL a[40:43],v27,s[32:35],s65 offen sc1
BL a[44:47],v27,s[32:35],s65 offen offset:1024 sc1
BL a[48:51],v27,s[32:35],s65 offen offset:2048 sc1
s_waitcnt vmcnt(26)
P2_KVGU_K_chk:
v_cmp_ne_u32 vcc, v7, v26
s_nop 0
s_cmp_eq_u64 vcc, 0
s_cbranch_scc1 P2_KVGU_K_ok
s_cmp_eq_u32 s101, 0
s_cbranch_scc1 P2_KVGU_K_ok
s_sub_u32 s101, s101, 1
s_sleep 10
buffer_load_dword v7, v19, s[24:27], s97 offen sc1
s_waitcnt vmcnt(0)
s_branch P2_KVGU_K_chk
P2_KVGU_K_ok:
M1 v[176:179],a[200:203],v[128:131],v[176:179]
M1 v[192:195],a[204:207],v[128:131],v[192:195]
ds_read_b128 v[64:67], v8 offset:33792
M1 v[208:211],a[208:211],v[128:131],v[208:211]
M1 v[224:227],a[212:215],v[128:131],v[224:227]
ds_read_b128 v[68:71], v8 offset:34816
M1 v[240:243],a[216:219],v[128:131],v[240:243]
M1 v[180:183],a[200:203],v[132:135],v[180:183]
M1 v[196:199],a[204:207],v[132:135],v[196:199]
ds_read_b128 v[72:75], v8 offset:35840
M1 v[212:215],a[208:211],v[132:135],v[212:215]
M1 v[228:231],a[212:215],v[132:135],v[228:231]
ds_read_b128 v[76:79], v8 offset:36864
M1 v[244:247],a[216:219],v[132:135],v[244:247]
M1 v[184:187],a[200:203],v[136:139],v[184:187]
M1 v[200:203],a[204:207],v[136:139],v[200:203]
s_bfe_u32 s41, s70, 0x80000
s_mul_i32 s41, s41, 4096
BL a[160:163],v27,s[36:39],s41 offen sc1
M1 v[216:219],a[208:211],v[136:139],v[216:219]
M1 v[232:235],a[212:215],v[136:139],v[232:235]
BL a[164:167],v27,s[36:39],s41 offen offset:1024 sc1
M1 v[248:251],a[216:219],v[136:139],v[248:251]
M1 v[188:191],a[200:203],v[140:143],v[188:191]
M1 v[204:207],a[204:207],v[140:143],v[204:207]
BL a[168:171],v27,s[36:39],s41 offen offset:2048 sc1
M1 v[220:223],a[208:211],v[140:143],v[220:223]
M1 v[236:239],a[212:215],v[140:143],v[236:239]
BL a[172:175],v27,s[36:39],s41 offen offset:3072 sc1
M1 v[252:255],a[216:219],v[140:143],v[252:255]
s_bfe_u32 s41, s70, 0x80008
s_mul_i32 s41, s41, 4096
BL a[176:179],v27,s[36:39],s41 offen sc1
BL a[180:183],v27,s[36:39],s41 offen offset:1024 sc1
BL a[184:187],v27,s[36:39],s41 offen offset:2048 sc1
BL a[188:191],v27,s[36:39],s41 offen offset:3072 sc1
buffer_load_dword v4, v2, s[24:27], s97 offen sc1
BL a[52:55],v27,s[32:35],s65 offen offset:3072 sc1
BL a[56:59],v25,s[32:35],s65 offen sc1
s_add_u32 m0, s6, 0
s_bfe_u32 s65, s89, 0x80000
s_mul_i32 s65, s65, 40960
BL v27,s[32:35],s65 offen sc1 lds
BL v27,s[32:35],s65 offen offset:1024 sc1 lds
BL v27,s[32:35],s65 offen offset:2048 sc1 lds
M1 v[176:179],a[220:223],v[144:147],v[176:179]
s_waitcnt lgkmcnt(3)
M1 v[192:195],v[64:67],v[144:147],v[192:195]
ds_read_b128 v[40:43], v8 offset:37888
s_waitcnt lgkmcnt(3)
M1 v[208:211],v[68:71],v[144:147],v[208:211]
s_waitcnt lgkmcnt(2)
M1 v[224:227],v[72:75],v[144:147],v[224:227]
ds_read_b128 v[44:47], v8 offset:38912
s_waitcnt lgkmcnt(2)
M1 v[240:243],v[76:79],v[144:147],v[240:243]
M1 v[180:183],a[220:223],v[148:151],v[180:183]
M1 v[196:199],v[64:67],v[148:151],v[196:199]
ds_read_b128 v[48:51], v8 offset:39936
M1 v[212:215],v[68:71],v[148:151],v[212:215]
M1 v[228:231],v[72:75],v[148:151],v[228:231]
BL v27,s[32:35],s65 offen offset:3072 sc1 lds
M1 v[244:247],v[76:79],v[148:151],v[244:247]
M1 v[184:187],a[220:223],v[152:155],v[184:187]
M1 v[200:203],v[64:67],v[152:155],v[200:203]
s_add_u32 m0, s6, 4096
s_nop 0
BL v25,s[32:35],s65 offen sc1 lds
M1 v[216:219],v[68:71],v[152:155],v[216:219]
M1 v[232:235],v[72:75],v[152:155],v[232:235]
s_add_u32 m0, s6, 5120
s_bfe_u32 s65, s89, 0x80008
s_mul_i32 s65, s65, 40960
BL v27,s[32:35],s65 offen sc1 lds
M1 v[248:251],v[76:79],v[152:155],v[248:251]
M1 v[188:191],a[220:223],v[156:159],v[188:191]
M1 v[204:207],v[64:67],v[156:159],v[204:207]
BL v27,s[32:35],s65 offen offset:1024 sc1 lds
M1 v[220:223],v[68:71],v[156:159],v[220:223]
M1 v[236:239],v[72:75],v[156:159],v[236:239]
BL v27,s[32:35],s65 offen offset:2048 sc1 lds
M1 v[252:255],v[76:79],v[156:159],v[252:255]
s_waitcnt vmcnt(10)
P2_KVGU_L_chk:
v_cmp_ne_u32 vcc, v4, v26
s_nop 0
s_cmp_eq_u64 vcc, 0
s_cbranch_scc1 P2_KVGU_L_ok
s_cmp_eq_u32 s101, 0
s_cbranch_scc1 P2_KVGU_L_ok
s_sub_u32 s101, s101, 1
s_sleep 10
buffer_load_dword v4, v2, s[24:27], s97 offen sc1
s_waitcnt vmcnt(0)
s_branch P2_KVGU_L_chk
P2_KVGU_L_ok:
s_waitcnt lgkmcnt(2)
M1 v[176:179],v[40:43],a[80:83],v[176:179]
s_waitcnt lgkmcnt(1)
M1 v[192:195],v[44:47],a[80:83],v[192:195]
ds_read_b128 v[68:71], v8 offset:25600
s_waitcnt lgkmcnt(1)
M1 v[208:211],v[48:51],a[80:83],v[208:211]
M1 v[224:227],a[64:67],a[80:83],v[224:227]
ds_read_b128 v[72:75], v8 offset:26624
M1 v[240:243],a[68:71],a[80:83],v[240:243]
M1 v[180:183],v[40:43],a[84:87],v[180:183]
M1 v[196:199],v[44:47],a[84:87],v[196:199]
ds_read_b128 v[76:79], v8 offset:27648
M1 v[212:215],v[48:51],a[84:87],v[212:215]
M1 v[228:231],a[64:67],a[84:87],v[228:231]
s_bfe_u32 s41, s89, 0x80000
s_mul_i32 s41, s41, 4096
BL v[96:99],v27,s[36:39],s41 offen sc1
M1 v[244:247],a[68:71],a[84:87],v[244:247]
M1 v[184:187],v[40:43],a[88:91],v[184:187]
M1 v[200:203],v[44:47],a[88:91],v[200:203]
BL v[100:103],v27,s[36:39],s41 offen offset:1024 sc1
M1 v[216:219],v[48:51],a[88:91],v[216:219]
M1 v[232:235],a[64:67],a[88:91],v[232:235]
BL v[104:107],v27,s[36:39],s41 offen offset:2048 sc1
M1 v[248:251],a[68:71],a[88:91],v[248:251]
M1 v[188:191],v[40:43],a[92:95],v[188:191]
M1 v[204:207],v[44:47],a[92:95],v[204:207]
BL v[108:111],v27,s[36:39],s41 offen offset:3072 sc1
M1 v[220:223],v[48:51],a[92:95],v[220:223]
M1 v[236:239],a[64:67],a[92:95],v[236:239]
s_bfe_u32 s41, s89, 0x80008
s_mul_i32 s41, s41, 4096
BL v[112:115],v27,s[36:39],s41 offen sc1
M1 v[252:255],a[68:71],a[92:95],v[252:255]
BL v[116:119],v27,s[36:39],s41 offen offset:1024 sc1
BL v[120:123],v27,s[36:39],s41 offen offset:2048 sc1
BL v[124:127],v27,s[36:39],s41 offen offset:3072 sc1
s_bfe_u32 s41, s89, 0x80010
s_mul_i32 s41, s41, 4096
BL v[128:131],v27,s[36:39],s41 offen sc1
BL v[132:135],v27,s[36:39],s41 offen offset:1024 sc1
BL v[136:139],v27,s[36:39],s41 offen offset:2048 sc1
BL v[140:143],v27,s[36:39],s41 offen offset:3072 sc1
s_bfe_u32 s41, s89, 0x80018
s_mul_i32 s41, s41, 4096
BL v[144:147],v27,s[36:39],s41 offen sc1
BL v[148:151],v27,s[36:39],s41 offen offset:1024 sc1
BL v[152:155],v27,s[36:39],s41 offen offset:2048 sc1
BL v[156:159],v27,s[36:39],s41 offen offset:3072 sc1
BL v27,s[32:35],s65 offen offset:3072 sc1 lds
s_add_u32 m0, s6, 9216
s_nop 0
BL v25,s[32:35],s65 offen sc1 lds
s_add_u32 m0, s6, 10240
s_bfe_u32 s65, s89, 0x80010
s_mul_i32 s65, s65, 40960
BL v27,s[32:35],s65 offen sc1 lds
BL v27,s[32:35],s65 offen offset:1024 sc1 lds
BL v27,s[32:35],s65 offen offset:2048 sc1 lds
M1 v[176:179],a[72:75],a[96:99],v[176:179]
M1 v[192:195],a[76:79],a[96:99],v[192:195]
ds_read_b128 v[40:43], v8 offset:28672
s_waitcnt lgkmcnt(3)
M1 v[208:211],v[68:71],a[96:99],v[208:211]
s_waitcnt lgkmcnt(2)
M1 v[224:227],v[72:75],a[96:99],v[224:227]
ds_read_b128 v[44:47], v8 offset:29696
s_waitcnt lgkmcnt(2)
M1 v[240:243],v[76:79],a[96:99],v[240:243]
M1 v[180:183],a[72:75],a[100:103],v[180:183]
M1 v[196:199],a[76:79],a[100:103],v[196:199]
ds_read_b128 v[48:51], v8 offset:30720
M1 v[212:215],v[68:71],a[100:103],v[212:215]
M1 v[228:231],v[72:75],a[100:103],v[228:231]
ds_read_b128 v[52:55], v8 offset:31744
M1 v[244:247],v[76:79],a[100:103],v[244:247]
M1 v[184:187],a[72:75],a[104:107],v[184:187]
M1 v[200:203],a[76:79],a[104:107],v[200:203]
ds_read_b128 v[56:59], v8 offset:32768
M1 v[216:219],v[68:71],a[104:107],v[216:219]
M1 v[232:235],v[72:75],a[104:107],v[232:235]
BL v27,s[32:35],s65 offen offset:3072 sc1 lds
M1 v[248:251],v[76:79],a[104:107],v[248:251]
M1 v[188:191],a[72:75],a[108:111],v[188:191]
M1 v[204:207],a[76:79],a[108:111],v[204:207]
s_add_u32 m0, s6, 14336
s_nop 0
BL v25,s[32:35],s65 offen sc1 lds
M1 v[220:223],v[68:71],a[108:111],v[220:223]
M1 v[236:239],v[72:75],a[108:111],v[236:239]
s_add_u32 m0, s6, 15360
s_bfe_u32 s65, s89, 0x80018
s_mul_i32 s65, s65, 40960
BL v27,s[32:35],s65 offen sc1 lds
M1 v[252:255],v[76:79],a[108:111],v[252:255]
BL v27,s[32:35],s65 offen offset:1024 sc1 lds
BL v27,s[32:35],s65 offen offset:2048 sc1 lds
s_waitcnt lgkmcnt(4)
M1 v[176:179],v[40:43],a[112:115],v[176:179]
s_waitcnt lgkmcnt(3)
M1 v[192:195],v[44:47],a[112:115],v[192:195]
BL v27,s[32:35],s65 offen offset:3072 sc1 lds
s_waitcnt lgkmcnt(2)
M1 v[208:211],v[48:51],a[112:115],v[208:211]
s_waitcnt lgkmcnt(1)
M1 v[224:227],v[52:55],a[112:115],v[224:227]
s_add_u32 m0, s6, 19456
s_nop 0
BL v25,s[32:35],s65 offen sc1 lds
s_waitcnt lgkmcnt(0)
M1 v[240:243],v[56:59],a[112:115],v[240:243]
M1 v[180:183],v[40:43],a[116:119],v[180:183]
M1 v[196:199],v[44:47],a[116:119],v[196:199]
s_add_u32 m0, s6, 20480
s_bfe_u32 s65, s71, 0x80000
s_mul_i32 s65, s65, 40960
BL v27,s[32:35],s65 offen sc1 lds
M1 v[212:215],v[48:51],a[116:119],v[212:215]
M1 v[228:231],v[52:55],a[116:119],v[228:231]
BL v27,s[32:35],s65 offen offset:1024 sc1 lds
M1 v[244:247],v[56:59],a[116:119],v[244:247]
M1 v[184:187],v[40:43],a[120:123],v[184:187]
M1 v[200:203],v[44:47],a[120:123],v[200:203]
BL v27,s[32:35],s65 offen offset:2048 sc1 lds
M1 v[216:219],v[48:51],a[120:123],v[216:219]
M1 v[232:235],v[52:55],a[120:123],v[232:235]
M1 v[248:251],v[56:59],a[120:123],v[248:251]
M1 v[188:191],v[40:43],a[124:127],v[188:191]
M1 v[204:207],v[44:47],a[124:127],v[204:207]
M1 v[220:223],v[48:51],a[124:127],v[220:223]
M1 v[236:239],v[52:55],a[124:127],v[236:239]
M1 v[252:255],v[56:59],a[124:127],v[252:255]
M1 v[176:179],a[0:3],a[128:131],v[176:179]
M1 v[192:195],a[4:7],a[128:131],v[192:195]
BL v27,s[32:35],s65 offen offset:3072 sc1 lds
M1 v[208:211],a[8:11],a[128:131],v[208:211]
M1 v[224:227],a[12:15],a[128:131],v[224:227]
s_add_u32 m0, s6, 24576
s_nop 0
BL v25,s[32:35],s65 offen sc1 lds
M1 v[240:243],a[16:19],a[128:131],v[240:243]
M1 v[180:183],a[0:3],a[132:135],v[180:183]
M1 v[196:199],a[4:7],a[132:135],v[196:199]
s_bfe_u32 s65, s71, 0x80008
s_mul_i32 s65, s65, 40960
BL a[224:227],v27,s[32:35],s65 offen sc1
M1 v[212:215],a[8:11],a[132:135],v[212:215]
M1 v[228:231],a[12:15],a[132:135],v[228:231]
BL a[228:231],v27,s[32:35],s65 offen offset:1024 sc1
M1 v[244:247],a[16:19],a[132:135],v[244:247]
M1 v[184:187],a[0:3],a[136:139],v[184:187]
M1 v[200:203],a[4:7],a[136:139],v[200:203]
BL a[232:235],v27,s[32:35],s65 offen offset:2048 sc1
M1 v[216:219],a[8:11],a[136:139],v[216:219]
M1 v[232:235],a[12:15],a[136:139],v[232:235]
M1 v[248:251],a[16:19],a[136:139],v[248:251]
M1 v[188:191],a[0:3],a[140:143],v[188:191]
M1 v[204:207],a[4:7],a[140:143],v[204:207]
M1 v[220:223],a[8:11],a[140:143],v[220:223]
M1 v[236:239],a[12:15],a[140:143],v[236:239]
M1 v[252:255],a[16:19],a[140:143],v[252:255]
M1 v[176:179],a[20:23],a[160:163],v[176:179]
M1 v[192:195],a[24:27],a[160:163],v[192:195]
BL a[236:239],v27,s[32:35],s65 offen offset:3072 sc1
M1 v[208:211],a[28:31],a[160:163],v[208:211]
M1 v[224:227],a[32:35],a[160:163],v[224:227]
BL a[240:243],v25,s[32:35],s65 offen sc1
M1 v[240:243],a[36:39],a[160:163],v[240:243]
M1 v[180:183],a[20:23],a[164:167],v[180:183]
M1 v[196:199],a[24:27],a[164:167],v[196:199]
s_bfe_u32 s65, s71, 0x80010
s_mul_i32 s65, s65, 40960
BL a[244:247],v27,s[32:35],s65 offen sc1
M1 v[212:215],a[28:31],a[164:167],v[212:215]
M1 v[228:231],a[32:35],a[164:167],v[228:231]
BL a[248:251],v27,s[32:35],s65 offen offset:1024 sc1
M1 v[244:247],a[36:39],a[164:167],v[244:247]
M1 v[184:187],a[20:23],a[168:171],v[184:187]
M1 v[200:203],a[24:27],a[168:171],v[200:203]
BL a[252:255],v27,s[32:35],s65 offen offset:2048 sc1
M1 v[216:219],a[28:31],a[168:171],v[216:219]
M1 v[232:235],a[32:35],a[168:171],v[232:235]
M1 v[248:251],a[36:39],a[168:171],v[248:251]
M1 v[188:191],a[20:23],a[172:175],v[188:191]
M1 v[204:207],a[24:27],a[172:175],v[204:207]
M1 v[220:223],a[28:31],a[172:175],v[220:223]
M1 v[236:239],a[32:35],a[172:175],v[236:239]
M1 v[252:255],a[36:39],a[172:175],v[252:255]
M1 v[176:179],a[40:43],a[176:179],v[176:179]
M1 v[192:195],a[44:47],a[176:179],v[192:195]
s_waitcnt vmcnt(48)
ds_read_b128 v[40:43], v8
M1 v[208:211],a[48:51],a[176:179],v[208:211]
M1 v[224:227],a[52:55],a[176:179],v[224:227]
s_waitcnt vmcnt(47)
ds_read_b128 v[44:47], v8 offset:1024
M1 v[240:243],a[56:59],a[176:179],v[240:243]
M1 v[180:183],a[40:43],a[180:183],v[180:183]
M1 v[196:199],a[44:47],a[180:183],v[196:199]
s_waitcnt vmcnt(46)
ds_read_b128 v[48:51], v8 offset:2048
M1 v[212:215],a[48:51],a[180:183],v[212:215]
M1 v[228:231],a[52:55],a[180:183],v[228:231]
s_waitcnt vmcnt(45)
ds_read_b128 v[52:55], v8 offset:3072
M1 v[244:247],a[56:59],a[180:183],v[244:247]
M1 v[184:187],a[40:43],a[184:187],v[184:187]
M1 v[200:203],a[44:47],a[184:187],v[200:203]
s_waitcnt vmcnt(44)
ds_read_b128 v[56:59], v8 offset:4096
M1 v[216:219],a[48:51],a[184:187],v[216:219]
M1 v[232:235],a[52:55],a[184:187],v[232:235]
BL v[160:163],v27,s[32:35],s65 offen offset:3072 sc1
M1 v[248:251],a[56:59],a[184:187],v[248:251]
M1 v[188:191],a[40:43],a[188:191],v[188:191]
M1 v[204:207],a[44:47],a[188:191],v[204:207]
BL v[164:167],v25,s[32:35],s65 offen sc1
M1 v[220:223],a[48:51],a[188:191],v[220:223]
M1 v[236:239],a[52:55],a[188:191],v[236:239]
s_bfe_u32 s65, s71, 0x80018
s_mul_i32 s65, s65, 40960
BL v[168:171],v27,s[32:35],s65 offen sc1
M1 v[252:255],a[56:59],a[188:191],v[252:255]
BL v[172:175],v27,s[32:35],s65 offen offset:1024 sc1
BL a[144:147],v27,s[32:35],s65 offen offset:2048 sc1
s_waitcnt vmcnt(45)
s_waitcnt lgkmcnt(4)
M1 v[176:179],v[40:43],v[96:99],v[176:179]
s_waitcnt lgkmcnt(3)
M1 v[192:195],v[44:47],v[96:99],v[192:195]
ds_read_b128 v[60:63], v8 offset:5120
s_waitcnt lgkmcnt(3)
M1 v[208:211],v[48:51],v[96:99],v[208:211]
s_waitcnt lgkmcnt(2)
M1 v[224:227],v[52:55],v[96:99],v[224:227]
ds_read_b128 v[64:67], v8 offset:6144
s_waitcnt lgkmcnt(2)
M1 v[240:243],v[56:59],v[96:99],v[240:243]
s_waitcnt vmcnt(44)
M1 v[180:183],v[40:43],v[100:103],v[180:183]
M1 v[196:199],v[44:47],v[100:103],v[196:199]
ds_read_b128 v[68:71], v8 offset:7168
M1 v[212:215],v[48:51],v[100:103],v[212:215]
M1 v[228:231],v[52:55],v[100:103],v[228:231]
s_waitcnt vmcnt(29)
ds_read_b128 v[72:75], v8 offset:8192
M1 v[244:247],v[56:59],v[100:103],v[244:247]
M1 v[184:187],v[40:43],v[104:107],v[184:187]
M1 v[200:203],v[44:47],v[104:107],v[200:203]
s_waitcnt vmcnt(28)
ds_read_b128 v[76:79], v8 offset:9216
M1 v[216:219],v[48:51],v[104:107],v[216:219]
M1 v[232:235],v[52:55],v[104:107],v[232:235]
BL v[80:83],v10,s[8:11],s47 offen
M1 v[248:251],v[56:59],v[104:107],v[248:251]
M1 v[188:191],v[40:43],v[108:111],v[188:191]
M1 v[204:207],v[44:47],v[108:111],v[204:207]
BL v[84:87],v11,s[8:11],s47 offen
M1 v[220:223],v[48:51],v[108:111],v[220:223]
M1 v[236:239],v[52:55],v[108:111],v[236:239]
BL v[88:91],v12,s[8:11],s47 offen
M1 v[252:255],v[56:59],v[108:111],v[252:255]
buffer_load_dword v5, v3, s[24:27], s97 offen sc1
BL a[148:151],v27,s[32:35],s65 offen offset:3072 sc1
BL a[152:155],v25,s[32:35],s65 offen sc1
s_bfe_u32 s65, s70, 0x80010
s_mul_i32 s65, s65, 40960
BL a[156:159],v27,s[32:35],s65 offen sc1
BL a[208:211],v27,s[32:35],s65 offen offset:1024 sc1
BL a[212:215],v27,s[32:35],s65 offen offset:2048 sc1
s_waitcnt lgkmcnt(4)
M1 v[176:179],v[60:63],v[112:115],v[176:179]
s_waitcnt lgkmcnt(3)
M1 v[192:195],v[64:67],v[112:115],v[192:195]
s_waitcnt vmcnt(36)
ds_read_b128 v[40:43], v8 offset:10240
s_waitcnt lgkmcnt(3)
M1 v[208:211],v[68:71],v[112:115],v[208:211]
s_waitcnt lgkmcnt(2)
M1 v[224:227],v[72:75],v[112:115],v[224:227]
s_waitcnt vmcnt(35)
ds_read_b128 v[44:47], v8 offset:11264
s_waitcnt lgkmcnt(2)
M1 v[240:243],v[76:79],v[112:115],v[240:243]
M1 v[180:183],v[60:63],v[116:119],v[180:183]
M1 v[196:199],v[64:67],v[116:119],v[196:199]
s_waitcnt vmcnt(34)
ds_read_b128 v[48:51], v8 offset:12288
M1 v[212:215],v[68:71],v[116:119],v[212:215]
M1 v[228:231],v[72:75],v[116:119],v[228:231]
s_waitcnt vmcnt(33)
ds_read_b128 v[52:55], v8 offset:13312
M1 v[244:247],v[76:79],v[116:119],v[244:247]
M1 v[184:187],v[60:63],v[120:123],v[184:187]
M1 v[200:203],v[64:67],v[120:123],v[200:203]
s_waitcnt vmcnt(32)
ds_read_b128 v[56:59], v8 offset:14336
M1 v[216:219],v[68:71],v[120:123],v[216:219]
M1 v[232:235],v[72:75],v[120:123],v[232:235]
BL a[216:219],v27,s[32:35],s65 offen offset:3072 sc1
M1 v[248:251],v[76:79],v[120:123],v[248:251]
M1 v[188:191],v[60:63],v[124:127],v[188:191]
M1 v[204:207],v[64:67],v[124:127],v[204:207]
BL a[220:223],v25,s[32:35],s65 offen sc1
M1 v[220:223],v[68:71],v[124:127],v[220:223]
M1 v[236:239],v[72:75],v[124:127],v[236:239]
M1 v[252:255],v[76:79],v[124:127],v[252:255]
s_waitcnt vmcnt(7)
P2_KVGU_O_chk:
v_cmp_ne_u32 vcc, v5, v26
s_nop 0
s_cmp_eq_u64 vcc, 0
s_cbranch_scc1 P2_KVGU_O_ok
s_cmp_eq_u32 s101, 0
s_cbranch_scc1 P2_KVGU_O_ok
s_sub_u32 s101, s101, 1
s_sleep 4
buffer_load_dword v5, v3, s[24:27], s97 offen sc1
s_waitcnt vmcnt(0)
s_branch P2_KVGU_O_chk
P2_KVGU_O_ok:
s_waitcnt lgkmcnt(4)
M1 v[176:179],v[40:43],v[128:131],v[176:179]
s_waitcnt lgkmcnt(3)
M1 v[192:195],v[44:47],v[128:131],v[192:195]
ds_read_b128 v[60:63], v8 offset:15360
s_waitcnt lgkmcnt(3)
M1 v[208:211],v[48:51],v[128:131],v[208:211]
s_waitcnt lgkmcnt(2)
M1 v[224:227],v[52:55],v[128:131],v[224:227]
ds_read_b128 v[64:67], v8 offset:16384
s_waitcnt lgkmcnt(2)
M1 v[240:243],v[56:59],v[128:131],v[240:243]
M1 v[180:183],v[40:43],v[132:135],v[180:183]
M1 v[196:199],v[44:47],v[132:135],v[196:199]
ds_read_b128 v[68:71], v8 offset:17408
M1 v[212:215],v[48:51],v[132:135],v[212:215]
M1 v[228:231],v[52:55],v[132:135],v[228:231]
ds_read_b128 v[72:75], v8 offset:18432
M1 v[244:247],v[56:59],v[132:135],v[244:247]
M1 v[184:187],v[40:43],v[136:139],v[184:187]
M1 v[200:203],v[44:47],v[136:139],v[200:203]
ds_read_b128 v[76:79], v8 offset:19456
M1 v[216:219],v[48:51],v[136:139],v[216:219]
M1 v[232:235],v[52:55],v[136:139],v[232:235]
s_bfe_u32 s41, s71, 0x80000
s_mul_i32 s41, s41, 4096
BL a[80:83],v27,s[36:39],s41 offen sc1
M1 v[248:251],v[56:59],v[136:139],v[248:251]
M1 v[188:191],v[40:43],v[140:143],v[188:191]
M1 v[204:207],v[44:47],v[140:143],v[204:207]
BL a[84:87],v27,s[36:39],s41 offen offset:1024 sc1
M1 v[220:223],v[48:51],v[140:143],v[220:223]
M1 v[236:239],v[52:55],v[140:143],v[236:239]
BL a[88:91],v27,s[36:39],s41 offen offset:2048 sc1
M1 v[252:255],v[56:59],v[140:143],v[252:255]
BL a[92:95],v27,s[36:39],s41 offen offset:3072 sc1
s_bfe_u32 s41, s71, 0x80008
s_mul_i32 s41, s41, 4096
BL a[96:99],v27,s[36:39],s41 offen sc1
BL a[100:103],v27,s[36:39],s41 offen offset:1024 sc1
BL a[104:107],v27,s[36:39],s41 offen offset:2048 sc1
BL a[108:111],v27,s[36:39],s41 offen offset:3072 sc1
s_bfe_u32 s41, s71, 0x80010
s_mul_i32 s41, s41, 4096
BL a[112:115],v27,s[36:39],s41 offen sc1
BL a[116:119],v27,s[36:39],s41 offen offset:1024 sc1
BL a[120:123],v27,s[36:39],s41 offen offset:2048 sc1
BL a[124:127],v27,s[36:39],s41 offen offset:3072 sc1
s_bfe_u32 s41, s71, 0x80018
s_mul_i32 s41, s41, 4096
BL a[128:131],v27,s[36:39],s41 offen sc1
BL a[132:135],v27,s[36:39],s41 offen offset:1024 sc1
BL a[136:139],v27,s[36:39],s41 offen offset:2048 sc1
BL a[140:143],v27,s[36:39],s41 offen offset:3072 sc1
s_bfe_u32 s41, s70, 0x80010
s_mul_i32 s41, s41, 4096
BL a[192:195],v27,s[36:39],s41 offen sc1
BL a[196:199],v27,s[36:39],s41 offen offset:1024 sc1
BL a[200:203],v27,s[36:39],s41 offen offset:2048 sc1
BL a[204:207],v27,s[36:39],s41 offen offset:3072 sc1
s_waitcnt lgkmcnt(4)
M1 v[176:179],v[60:63],v[144:147],v[176:179]
s_waitcnt lgkmcnt(3)
M1 v[192:195],v[64:67],v[144:147],v[192:195]
ds_read_b128 v[40:43], v8 offset:20480
s_waitcnt lgkmcnt(3)
M1 v[208:211],v[68:71],v[144:147],v[208:211]
s_waitcnt lgkmcnt(2)
M1 v[224:227],v[72:75],v[144:147],v[224:227]
ds_read_b128 v[44:47], v8 offset:21504
s_waitcnt lgkmcnt(2)
M1 v[240:243],v[76:79],v[144:147],v[240:243]
M1 v[180:183],v[60:63],v[148:151],v[180:183]
M1 v[196:199],v[64:67],v[148:151],v[196:199]
ds_read_b128 v[48:51], v8 offset:22528
M1 v[212:215],v[68:71],v[148:151],v[212:215]
M1 v[228:231],v[72:75],v[148:151],v[228:231]
ds_read_b128 v[52:55], v8 offset:23552
M1 v[244:247],v[76:79],v[148:151],v[244:247]
M1 v[184:187],v[60:63],v[152:155],v[184:187]
M1 v[200:203],v[64:67],v[152:155],v[200:203]
ds_read_b128 v[56:59], v8 offset:24576
M1 v[216:219],v[68:71],v[152:155],v[216:219]
M1 v[232:235],v[72:75],v[152:155],v[232:235]
M1 v[248:251],v[76:79],v[152:155],v[248:251]
M1 v[188:191],v[60:63],v[156:159],v[188:191]
M1 v[204:207],v[64:67],v[156:159],v[204:207]
M1 v[220:223],v[68:71],v[156:159],v[220:223]
M1 v[236:239],v[72:75],v[156:159],v[236:239]
M1 v[252:255],v[76:79],v[156:159],v[252:255]
s_waitcnt vmcnt(19)
s_waitcnt lgkmcnt(4)
M1 a[0:3],v[40:43],a[80:83],0
s_waitcnt lgkmcnt(3)
M1 a[16:19],v[44:47],a[80:83],0
s_waitcnt lgkmcnt(2)
M1 a[32:35],v[48:51],a[80:83],0
s_waitcnt lgkmcnt(1)
M1 a[48:51],v[52:55],a[80:83],0
s_waitcnt lgkmcnt(0)
M1 a[64:67],v[56:59],a[80:83],0
s_waitcnt vmcnt(18)
M1 a[4:7],v[40:43],a[84:87],0
M1 a[20:23],v[44:47],a[84:87],0
M1 a[36:39],v[48:51],a[84:87],0
M1 a[52:55],v[52:55],a[84:87],0
M1 a[68:71],v[56:59],a[84:87],0
s_waitcnt vmcnt(17)
M1 a[8:11],v[40:43],a[88:91],0
M1 a[24:27],v[44:47],a[88:91],0
ds_write_b128 v9, v[176:179]
M1 a[40:43],v[48:51],a[88:91],0
M1 a[56:59],v[52:55],a[88:91],0
ds_write_b128 v9, v[180:183] offset:5120
M1 a[72:75],v[56:59],a[88:91],0
s_waitcnt vmcnt(16)
M1 a[12:15],v[40:43],a[92:95],0
M1 a[28:31],v[44:47],a[92:95],0
ds_write_b128 v9, v[184:187] offset:10240
M1 a[44:47],v[48:51],a[92:95],0
M1 a[60:63],v[52:55],a[92:95],0
ds_write_b128 v9, v[188:191] offset:15360
M1 a[76:79],v[56:59],a[92:95],0
s_waitcnt vmcnt(15)
M1 a[0:3],a[224:227],a[96:99],a[0:3]
M1 a[16:19],a[228:231],a[96:99],a[16:19]
ds_write_b128 v9, v[192:195] offset:64
M1 a[32:35],a[232:235],a[96:99],a[32:35]
M1 a[48:51],a[236:239],a[96:99],a[48:51]
ds_write_b128 v9, v[196:199] offset:5184
M1 a[64:67],a[240:243],a[96:99],a[64:67]
s_waitcnt vmcnt(14)
M1 a[4:7],a[224:227],a[100:103],a[4:7]
M1 a[20:23],a[228:231],a[100:103],a[20:23]
ds_write_b128 v9, v[200:203] offset:10304
M1 a[36:39],a[232:235],a[100:103],a[36:39]
M1 a[52:55],a[236:239],a[100:103],a[52:55]
ds_write_b128 v9, v[204:207] offset:15424
M1 a[68:71],a[240:243],a[100:103],a[68:71]
s_waitcnt vmcnt(13)
M1 a[8:11],a[224:227],a[104:107],a[8:11]
M1 a[24:27],a[228:231],a[104:107],a[24:27]
ds_write_b128 v9, v[208:211] offset:128
M1 a[40:43],a[232:235],a[104:107],a[40:43]
M1 a[56:59],a[236:239],a[104:107],a[56:59]
ds_write_b128 v9, v[212:215] offset:5248
M1 a[72:75],a[240:243],a[104:107],a[72:75]
s_waitcnt vmcnt(12)
M1 a[12:15],a[224:227],a[108:111],a[12:15]
M1 a[28:31],a[228:231],a[108:111],a[28:31]
ds_write_b128 v9, v[216:219] offset:10368
M1 a[44:47],a[232:235],a[108:111],a[44:47]
M1 a[60:63],a[236:239],a[108:111],a[60:63]
ds_write_b128 v9, v[220:223] offset:15488
M1 a[76:79],a[240:243],a[108:111],a[76:79]
s_waitcnt vmcnt(11)
M1 a[0:3],a[244:247],a[112:115],a[0:3]
M1 a[16:19],a[248:251],a[112:115],a[16:19]
ds_write_b128 v9, v[224:227] offset:192
M1 a[32:35],a[252:255],a[112:115],a[32:35]
M1 a[48:51],v[160:163],a[112:115],a[48:51]
ds_write_b128 v9, v[228:231] offset:5312
M1 a[64:67],v[164:167],a[112:115],a[64:67]
s_waitcnt vmcnt(10)
M1 a[4:7],a[244:247],a[116:119],a[4:7]
M1 a[20:23],a[248:251],a[116:119],a[20:23]
ds_write_b128 v9, v[232:235] offset:10432
M1 a[36:39],a[252:255],a[116:119],a[36:39]
M1 a[52:55],v[160:163],a[116:119],a[52:55]
ds_write_b128 v9, v[236:239] offset:15552
M1 a[68:71],v[164:167],a[116:119],a[68:71]
s_waitcnt vmcnt(9)
M1 a[8:11],a[244:247],a[120:123],a[8:11]
M1 a[24:27],a[248:251],a[120:123],a[24:27]
ds_write_b128 v9, v[240:243] offset:256
M1 a[40:43],a[252:255],a[120:123],a[40:43]
M1 a[56:59],v[160:163],a[120:123],a[56:59]
ds_write_b128 v9, v[244:247] offset:5376
M1 a[72:75],v[164:167],a[120:123],a[72:75]
s_waitcnt vmcnt(8)
M1 a[12:15],a[244:247],a[124:127],a[12:15]
M1 a[28:31],a[248:251],a[124:127],a[28:31]
ds_write_b128 v9, v[248:251] offset:10496
M1 a[44:47],a[252:255],a[124:127],a[44:47]
M1 a[60:63],v[160:163],a[124:127],a[60:63]
ds_write_b128 v9, v[252:255] offset:15616
M1 a[76:79],v[164:167],a[124:127],a[76:79]
s_waitcnt vmcnt(7)
M1 a[0:3],v[168:171],a[128:131],a[0:3]
M1 a[16:19],v[172:175],a[128:131],a[16:19]
M1 a[32:35],a[144:147],a[128:131],a[32:35]
M1 a[48:51],a[148:151],a[128:131],a[48:51]
M1 a[64:67],a[152:155],a[128:131],a[64:67]
s_waitcnt vmcnt(6)
M1 a[4:7],v[168:171],a[132:135],a[4:7]
M1 a[20:23],v[172:175],a[132:135],a[20:23]
M1 a[36:39],a[144:147],a[132:135],a[36:39]
M1 a[52:55],a[148:151],a[132:135],a[52:55]
M1 a[68:71],a[152:155],a[132:135],a[68:71]
s_waitcnt vmcnt(5)
M1 a[8:11],v[168:171],a[136:139],a[8:11]
M1 a[24:27],v[172:175],a[136:139],a[24:27]
M1 a[40:43],a[144:147],a[136:139],a[40:43]
M1 a[56:59],a[148:151],a[136:139],a[56:59]
M1 a[72:75],a[152:155],a[136:139],a[72:75]
s_waitcnt vmcnt(4)
M1 a[12:15],v[168:171],a[140:143],a[12:15]
M1 a[28:31],v[172:175],a[140:143],a[28:31]
M1 a[44:47],a[144:147],a[140:143],a[44:47]
M1 a[60:63],a[148:151],a[140:143],a[60:63]
M1 a[76:79],a[152:155],a[140:143],a[76:79]
s_waitcnt lgkmcnt(0)
s_barrier
s_waitcnt vmcnt(3)
M1 a[0:3],a[156:159],a[192:195],a[0:3]
M1 a[16:19],a[208:211],a[192:195],a[16:19]
ds_read_b128 v[96:99], v28
ds_read_b128 v[100:103], v29
ds_read_b128 v[104:107], v28 offset:40960
M1 a[32:35],a[212:215],a[192:195],a[32:35]
M1 a[48:51],a[216:219],a[192:195],a[48:51]
ds_read_b128 v[108:111], v29 offset:40960
ds_read_b128 v[112:115], v30
ds_read_b128 v[116:119], v31
M1 a[64:67],a[220:223],a[192:195],a[64:67]
s_waitcnt vmcnt(2)
M1 a[4:7],a[156:159],a[196:199],a[4:7]
M1 a[20:23],a[208:211],a[196:199],a[20:23]
ds_read_b128 v[120:123], v30 offset:40960
ds_read_b128 v[124:127], v31 offset:40960
ds_read_b128 v[160:163], v32
M1 a[36:39],a[212:215],a[196:199],a[36:39]
M1 a[52:55],a[216:219],a[196:199],a[52:55]
ds_read_b128 v[164:167], v33
ds_read_b128 v[168:171], v32 offset:40960
ds_read_b128 v[172:175], v33 offset:40960
M1 a[68:71],a[220:223],a[196:199],a[68:71]
s_waitcnt vmcnt(1)
M1 a[8:11],a[156:159],a[200:203],a[8:11]
M1 a[24:27],a[208:211],a[200:203],a[24:27]
ds_read_b128 v[176:179], v34
ds_read_b128 v[180:183], v35
ds_read_b128 v[184:187], v34 offset:40960
M1 a[40:43],a[212:215],a[200:203],a[40:43]
M1 a[56:59],a[216:219],a[200:203],a[56:59]
ds_read_b128 v[188:191], v35 offset:40960
ds_read_b128 v[224:227], v36
ds_read_b128 v[228:231], v37
M1 a[72:75],a[220:223],a[200:203],a[72:75]
s_waitcnt vmcnt(0)
M1 a[12:15],a[156:159],a[204:207],a[12:15]
M1 a[28:31],a[208:211],a[204:207],a[28:31]
ds_read_b128 v[232:235], v36 offset:40960
ds_read_b128 v[236:239], v37 offset:40960
ds_read_b128 v[240:243], v38
M1 a[44:47],a[212:215],a[204:207],a[44:47]
M1 a[60:63],a[216:219],a[204:207],a[60:63]
ds_read_b128 v[244:247], v39
ds_read_b128 v[248:251], v38 offset:40960
ds_read_b128 v[252:255], v39 offset:40960
M1 a[76:79],a[220:223],a[204:207],a[76:79]
ds_write_b128 v9, a[0:3] offset:20480
s_waitcnt lgkmcnt(15)
v_pk_add_f32 v[96:97], v[96:97], v[104:105]
v_pk_add_f32 v[98:99], v[98:99], v[106:107]
v_pk_add_f32 v[100:101], v[100:101], v[108:109]
v_pk_add_f32 v[102:103], v[102:103], v[110:111]
v_pk_add_f32 v[112:113], v[112:113], v[120:121]
v_pk_add_f32 v[114:115], v[114:115], v[122:123]
ds_write_b128 v9, a[4:7] offset:25600
v_pk_add_f32 v[116:117], v[116:117], v[124:125]
v_pk_add_f32 v[118:119], v[118:119], v[126:127]
v_pk_add_f32 v[96:97], v[96:97], v[112:113]
v_pk_add_f32 v[98:99], v[98:99], v[114:115]
v_pk_add_f32 v[100:101], v[100:101], v[116:117]
v_pk_add_f32 v[102:103], v[102:103], v[118:119]
v_pk_mul_f32 v[104:105], v[96:97], s[50:51] op_sel_hi:[1,0]
ds_write_b128 v9, a[8:11] offset:30720
v_pk_mul_f32 v[106:107], v[98:99], s[50:51] op_sel_hi:[1,0]
v_pk_mul_f32 v[108:109], v[100:101], s[50:51] op_sel_hi:[1,0]
v_pk_mul_f32 v[110:111], v[102:103], s[50:51] op_sel_hi:[1,0]
v_exp_f32 v104, v104
v_lshlrev_b32 v112, 16, v80
v_exp_f32 v105, v105
v_and_b32 v113, s52, v80
ds_write_b128 v9, a[12:15] offset:35840
v_exp_f32 v106, v106
v_lshlrev_b32 v114, 16, v81
v_exp_f32 v107, v107
v_and_b32 v115, s52, v81
v_exp_f32 v108, v108
v_lshlrev_b32 v116, 16, v82
v_exp_f32 v109, v109
ds_write_b128 v9, a[16:19] offset:20544
v_and_b32 v117, s52, v82
v_exp_f32 v110, v110
v_lshlrev_b32 v118, 16, v83
v_exp_f32 v111, v111
v_and_b32 v119, s52, v83
v_pk_add_f32 v[104:105], v[104:105], 1.0 op_sel_hi:[1,0]
v_pk_add_f32 v[106:107], v[106:107], 1.0 op_sel_hi:[1,0]
ds_write_b128 v9, a[20:23] offset:25664
v_pk_add_f32 v[108:109], v[108:109], 1.0 op_sel_hi:[1,0]
v_pk_add_f32 v[110:111], v[110:111], 1.0 op_sel_hi:[1,0]
v_rcp_f32 v104, v104
v_rcp_f32 v105, v105
v_rcp_f32 v106, v106
v_rcp_f32 v107, v107
v_rcp_f32 v108, v108
ds_write_b128 v9, a[24:27] offset:30784
v_rcp_f32 v109, v109
v_rcp_f32 v110, v110
v_rcp_f32 v111, v111
v_pk_mul_f32 v[96:97], v[96:97], v[104:105]
v_pk_mul_f32 v[98:99], v[98:99], v[106:107]
v_pk_mul_f32 v[100:101], v[100:101], v[108:109]
v_pk_mul_f32 v[102:103], v[102:103], v[110:111]
ds_write_b128 v9, a[28:31] offset:35904
s_waitcnt lgkmcnt(15)
v_pk_add_f32 v[160:161], v[160:161], v[168:169]
v_pk_add_f32 v[162:163], v[162:163], v[170:171]
v_pk_add_f32 v[164:165], v[164:165], v[172:173]
v_pk_add_f32 v[166:167], v[166:167], v[174:175]
v_pk_add_f32 v[176:177], v[176:177], v[184:185]
v_pk_add_f32 v[178:179], v[178:179], v[186:187]
ds_write_b128 v9, a[32:35] offset:20608
v_pk_add_f32 v[180:181], v[180:181], v[188:189]
v_pk_add_f32 v[182:183], v[182:183], v[190:191]
v_pk_add_f32 v[160:161], v[160:161], v[176:177]
v_pk_add_f32 v[162:163], v[162:163], v[178:179]
v_pk_add_f32 v[164:165], v[164:165], v[180:181]
v_pk_add_f32 v[166:167], v[166:167], v[182:183]
v_pk_mul_f32 v[168:169], v[160:161], s[50:51] op_sel_hi:[1,0]
ds_write_b128 v9, a[36:39] offset:25728
v_pk_mul_f32 v[170:171], v[162:163], s[50:51] op_sel_hi:[1,0]
v_pk_mul_f32 v[172:173], v[164:165], s[50:51] op_sel_hi:[1,0]
v_pk_mul_f32 v[174:175], v[166:167], s[50:51] op_sel_hi:[1,0]
v_exp_f32 v168, v168
v_lshlrev_b32 v176, 16, v84
v_exp_f32 v169, v169
v_and_b32 v177, s52, v84
ds_write_b128 v9, a[40:43] offset:30848
v_exp_f32 v170, v170
v_lshlrev_b32 v178, 16, v85
v_exp_f32 v171, v171
v_and_b32 v179, s52, v85
v_exp_f32 v172, v172
v_lshlrev_b32 v180, 16, v86
v_exp_f32 v173, v173
ds_write_b128 v9, a[44:47] offset:35968
v_and_b32 v181, s52, v86
v_exp_f32 v174, v174
v_lshlrev_b32 v182, 16, v87
v_exp_f32 v175, v175
v_and_b32 v183, s52, v87
v_pk_add_f32 v[168:169], v[168:169], 1.0 op_sel_hi:[1,0]
v_pk_add_f32 v[170:171], v[170:171], 1.0 op_sel_hi:[1,0]
ds_write_b128 v9, a[48:51] offset:20672
v_pk_add_f32 v[172:173], v[172:173], 1.0 op_sel_hi:[1,0]
v_pk_add_f32 v[174:175], v[174:175], 1.0 op_sel_hi:[1,0]
v_rcp_f32 v168, v168
v_rcp_f32 v169, v169
v_rcp_f32 v170, v170
v_rcp_f32 v171, v171
v_rcp_f32 v172, v172
ds_write_b128 v9, a[52:55] offset:25792
v_rcp_f32 v173, v173
v_rcp_f32 v174, v174
v_rcp_f32 v175, v175
v_pk_mul_f32 v[160:161], v[160:161], v[168:169]
v_pk_mul_f32 v[162:163], v[162:163], v[170:171]
v_pk_mul_f32 v[164:165], v[164:165], v[172:173]
v_pk_mul_f32 v[166:167], v[166:167], v[174:175]
ds_write_b128 v9, a[56:59] offset:30912
s_waitcnt lgkmcnt(15)
v_pk_add_f32 v[224:225], v[224:225], v[232:233]
v_pk_add_f32 v[226:227], v[226:227], v[234:235]
v_pk_add_f32 v[228:229], v[228:229], v[236:237]
v_pk_add_f32 v[230:231], v[230:231], v[238:239]
v_pk_add_f32 v[240:241], v[240:241], v[248:249]
v_pk_add_f32 v[242:243], v[242:243], v[250:251]
ds_write_b128 v9, a[60:63] offset:36032
v_pk_add_f32 v[244:245], v[244:245], v[252:253]
v_pk_add_f32 v[246:247], v[246:247], v[254:255]
v_pk_add_f32 v[224:225], v[224:225], v[240:241]
v_pk_add_f32 v[226:227], v[226:227], v[242:243]
v_pk_add_f32 v[228:229], v[228:229], v[244:245]
v_pk_add_f32 v[230:231], v[230:231], v[246:247]
v_pk_mul_f32 v[232:233], v[224:225], s[50:51] op_sel_hi:[1,0]
ds_write_b128 v9, a[64:67] offset:20736
v_pk_mul_f32 v[234:235], v[226:227], s[50:51] op_sel_hi:[1,0]
v_pk_mul_f32 v[236:237], v[228:229], s[50:51] op_sel_hi:[1,0]
v_pk_mul_f32 v[238:239], v[230:231], s[50:51] op_sel_hi:[1,0]
v_exp_f32 v232, v232
v_lshlrev_b32 v240, 16, v88
v_exp_f32 v233, v233
v_and_b32 v241, s52, v88
ds_write_b128 v9, a[68:71] offset:25856
v_exp_f32 v234, v234
v_lshlrev_b32 v242, 16, v89
v_exp_f32 v235, v235
v_and_b32 v243, s52, v89
v_exp_f32 v236, v236
v_lshlrev_b32 v244, 16, v90
v_exp_f32 v237, v237
ds_write_b128 v9, a[72:75] offset:30976
v_and_b32 v245, s52, v90
v_exp_f32 v238, v238
v_lshlrev_b32 v246, 16, v91
v_exp_f32 v239, v239
v_and_b32 v247, s52, v91
v_pk_add_f32 v[232:233], v[232:233], 1.0 op_sel_hi:[1,0]
v_pk_add_f32 v[234:235], v[234:235], 1.0 op_sel_hi:[1,0]
ds_write_b128 v9, a[76:79] offset:36096
v_pk_add_f32 v[236:237], v[236:237], 1.0 op_sel_hi:[1,0]
v_pk_add_f32 v[238:239], v[238:239], 1.0 op_sel_hi:[1,0]
v_rcp_f32 v232, v232
v_rcp_f32 v233, v233
v_rcp_f32 v234, v234
v_rcp_f32 v235, v235
v_rcp_f32 v236, v236
v_rcp_f32 v237, v237
v_rcp_f32 v238, v238
v_rcp_f32 v239, v239
v_pk_mul_f32 v[224:225], v[224:225], v[232:233]
v_pk_mul_f32 v[226:227], v[226:227], v[234:235]
v_pk_mul_f32 v[228:229], v[228:229], v[236:237]
v_pk_mul_f32 v[230:231], v[230:231], v[238:239]
s_waitcnt lgkmcnt(0)
s_barrier
ds_read_b128 v[128:131], v28 offset:20480
ds_read_b128 v[132:135], v29 offset:20480
ds_read_b128 v[136:139], v28 offset:61440
ds_read_b128 v[140:143], v29 offset:61440
ds_read_b128 v[144:147], v30 offset:20480
ds_read_b128 v[148:151], v31 offset:20480
ds_read_b128 v[152:155], v30 offset:61440
ds_read_b128 v[156:159], v31 offset:61440
ds_read_b128 v[192:195], v32 offset:20480
ds_read_b128 v[196:199], v33 offset:20480
ds_read_b128 v[200:203], v32 offset:61440
ds_read_b128 v[204:207], v33 offset:61440
ds_read_b128 v[208:211], v34 offset:20480
ds_read_b128 v[212:215], v35 offset:20480
ds_read_b128 v[216:219], v34 offset:61440
ds_read_b128 v[220:223], v35 offset:61440
ds_read_b128 v[40:43], v36 offset:20480
ds_read_b128 v[44:47], v37 offset:20480
ds_read_b128 v[48:51], v36 offset:61440
ds_read_b128 v[52:55], v37 offset:61440
ds_read_b128 v[56:59], v38 offset:20480
ds_read_b128 v[60:63], v39 offset:20480
ds_read_b128 v[64:67], v38 offset:61440
ds_read_b128 v[68:71], v39 offset:61440
s_waitcnt lgkmcnt(15)
v_pk_add_f32 v[128:129], v[128:129], v[136:137]
v_pk_add_f32 v[130:131], v[130:131], v[138:139]
v_pk_add_f32 v[132:133], v[132:133], v[140:141]
v_pk_add_f32 v[134:135], v[134:135], v[142:143]
v_pk_add_f32 v[144:145], v[144:145], v[152:153]
v_pk_add_f32 v[146:147], v[146:147], v[154:155]
v_pk_add_f32 v[148:149], v[148:149], v[156:157]
v_pk_add_f32 v[150:151], v[150:151], v[158:159]
v_pk_add_f32 v[128:129], v[128:129], v[144:145]
v_pk_add_f32 v[130:131], v[130:131], v[146:147]
v_pk_add_f32 v[132:133], v[132:133], v[148:149]
v_pk_add_f32 v[134:135], v[134:135], v[150:151]
v_pk_fma_f32 v[96:97], v[96:97], v[128:129], v[112:113]
v_pk_fma_f32 v[98:99], v[98:99], v[130:131], v[114:115]
v_pk_fma_f32 v[100:101], v[100:101], v[132:133], v[116:117]
v_pk_fma_f32 v[102:103], v[102:103], v[134:135], v[118:119]
CV v104,v96,v97
CV v105,v98,v99
CV v106,v100,v101
CV v107,v102,v103
buffer_store_dwordx4 v[104:107], v10, s[12:15], s47 offen sc1
s_waitcnt lgkmcnt(8)
v_pk_add_f32 v[192:193], v[192:193], v[200:201]
v_pk_add_f32 v[194:195], v[194:195], v[202:203]
v_pk_add_f32 v[196:197], v[196:197], v[204:205]
v_pk_add_f32 v[198:199], v[198:199], v[206:207]
v_pk_add_f32 v[208:209], v[208:209], v[216:217]
v_pk_add_f32 v[210:211], v[210:211], v[218:219]
v_pk_add_f32 v[212:213], v[212:213], v[220:221]
v_pk_add_f32 v[214:215], v[214:215], v[222:223]
v_pk_add_f32 v[192:193], v[192:193], v[208:209]
v_pk_add_f32 v[194:195], v[194:195], v[210:211]
v_pk_add_f32 v[196:197], v[196:197], v[212:213]
v_pk_add_f32 v[198:199], v[198:199], v[214:215]
v_pk_fma_f32 v[160:161], v[160:161], v[192:193], v[176:177]
v_pk_fma_f32 v[162:163], v[162:163], v[194:195], v[178:179]
v_pk_fma_f32 v[164:165], v[164:165], v[196:197], v[180:181]
v_pk_fma_f32 v[166:167], v[166:167], v[198:199], v[182:183]
CV v168,v160,v161
CV v169,v162,v163
CV v170,v164,v165
CV v171,v166,v167
buffer_store_dwordx4 v[168:171], v11, s[12:15], s47 offen sc1
s_waitcnt lgkmcnt(0)
v_pk_add_f32 v[40:41], v[40:41], v[48:49]
v_pk_add_f32 v[42:43], v[42:43], v[50:51]
v_pk_add_f32 v[44:45], v[44:45], v[52:53]
v_pk_add_f32 v[46:47], v[46:47], v[54:55]
v_pk_add_f32 v[56:57], v[56:57], v[64:65]
v_pk_add_f32 v[58:59], v[58:59], v[66:67]
v_pk_add_f32 v[60:61], v[60:61], v[68:69]
v_pk_add_f32 v[62:63], v[62:63], v[70:71]
v_pk_add_f32 v[40:41], v[40:41], v[56:57]
v_pk_add_f32 v[42:43], v[42:43], v[58:59]
v_pk_add_f32 v[44:45], v[44:45], v[60:61]
v_pk_add_f32 v[46:47], v[46:47], v[62:63]
v_pk_fma_f32 v[224:225], v[224:225], v[40:41], v[240:241]
v_pk_fma_f32 v[226:227], v[226:227], v[42:43], v[242:243]
v_pk_fma_f32 v[228:229], v[228:229], v[44:45], v[244:245]
v_pk_fma_f32 v[230:231], v[230:231], v[46:47], v[246:247]
CV v232,v224,v225
CV v233,v226,v227
CV v234,v228,v229
CV v235,v230,v231
buffer_store_dwordx4 v[232:235], v12, s[12:15], s47 offen sc1
s_endpgm
.p2align 6
K1_GU2:
K1_GU2B:
s_getpc_b64 s[98:99]
K1_G_pc:
s_and_b32 s7, s4, 3
s_lshl_b32 s84, s3, 2
s_add_u32 s7, s7, s84
s_cmp_ge_u32 s7, 5
s_cbranch_scc1 K1_G_nopf
s_lshl_b32 s7, s7, 13
s_mov_b32 s84, K1_G_pc-K1_G_pc
s_add_u32 s7, s7, s84
v_lshl_add_u32 v94, v1, 7, s7
v_min_u32 v94, K1_END-K1_G_pc, v94
global_load_dword v255, v94, s[98:99]
K1_G_nopf:
s_waitcnt lgkmcnt(0)
s_or_b32 s100, s100, 1
s_mov_b32 s101, 0x40000
s_mov_b32 s93, 0
v_mov_b32 v20, 1073741824
v_cmp_eq_u32 vcc, 0, v1
s_nop 1
v_cndmask_b32 v20, v20, 0, vcc
s_mov_b32 s24, s82
s_mov_b32 s25, s83
s_mov_b32 s26, 20971520
s_mov_b32 s27, 0x20000
s_mov_b32 s28, s80
s_mov_b32 s29, s81
s_mov_b32 s30, 256
s_mov_b32 s31, 0x20000
s_sub_u32 s12, s76, 3072
s_subb_u32 s13, s77, 0
s_mov_b32 s14, 2214912
s_mov_b32 s15, 0x20000
s_sub_u32 s16, s78, 3072
s_subb_u32 s17, s79, 0
s_mov_b32 s18, 2214912
s_mov_b32 s19, 0x20000
s_sub_u32 s20, s70, 3072
s_subb_u32 s21, s71, 0
s_mov_b32 s22, 2460672
s_mov_b32 s23, 0x20000
s_or_b32 s7, s2, s3
s_cmp_eq_u32 s7, 0
s_cselect_b32 s7, 240, 1073741824
v_mov_b32 v26, s100
v_mov_b32 v27, 240
buffer_store_dword v26, v20, s[28:31], s7 offen sc1
s_lshl_b32 s86, s4, 2
s_add_u32 s86, s86, s3
s_mov_b32 s36, s74
s_mov_b32 s37, s75
s_mov_b32 s38, 2211840
s_mov_b32 s39, 0x20000
s_mov_b32 s64, s72
s_mov_b32 s65, s73
s_mov_b32 s66, 819200
s_mov_b32 s67, 0x20000
v_lshrrev_b32 v72, 3, v1
v_mul_u32_u24 v73, 1280, v72
v_and_b32 v74, 7, v1
v_lshl_add_u32 v25, v74, 4, v73
v_lshrrev_b32 v73, 5, v1
v_mul_u32_u24 v73, 20, v73
v_and_b32 v75, 3, v72
v_add_u32 v73, v73, v75
v_mul_u32_u24 v73, 1280, v73
v_lshl_add_u32 v24, v74, 4, v73
v_lshrrev_b32 v72, 4, v1
v_lshrrev_b32 v73, 1, v72
v_and_b32 v72, 1, v72
v_lshlrev_b32 v73, 4, v73
v_lshl_add_u32 v73, v72, 2, v73
v_bfe_u32 v72, v1, 2, 2
v_add_u32 v73, v73, v72
v_lshlrev_b32 v73, 7, v73
v_and_b32 v72, 3, v1
v_lshl_add_u32 v73, v72, 3, v73
v_add_u32 v62, s6, v73
v_lshlrev_b32 v63, 4, v1
s_add_u32 s87, s86, 0
s_mul_i32 s88, s87, 6554
s_lshr_b32 s88, s88, 16
s_mul_i32 s89, s88, 10
s_sub_u32 s89, s87, s89
s_mul_i32 s76, s88, 40960
s_lshl_b32 s40, s87, 12
s_lshl_b32 s89, s89, 7
s_add_u32 s76, s76, s89
s_add_u32 s40, s40, 10485760
s_cmp_lt_u32 s87, 540
s_cselect_b32 s76, s76, 1073741824
s_cselect_b32 s40, s40, 1073741824
s_add_u32 s77, s76, 9216
s_add_u32 s78, s76, 18432
s_add_u32 s79, s76, 27648
s_add_u32 m0, s6, 0
s_nop 0
BL v25,s[36:39],s76 offen lds
BL v25,s[36:39],s77 offen offset:1024 lds
BL v25,s[36:39],s78 offen offset:2048 lds
BL v25,s[36:39],s79 offen offset:3072 lds
s_add_u32 s87, s86, 64
s_mul_i32 s88, s87, 6554
s_lshr_b32 s88, s88, 16
s_mul_i32 s89, s88, 10
s_sub_u32 s89, s87, s89
s_mul_i32 s76, s88, 40960
s_lshl_b32 s41, s87, 12
s_lshl_b32 s89, s89, 7
s_add_u32 s76, s76, s89
s_add_u32 s41, s41, 10485760
s_cmp_lt_u32 s87, 540
s_cselect_b32 s76, s76, 1073741824
s_cselect_b32 s41, s41, 1073741824
s_add_u32 s77, s76, 9216
s_add_u32 s78, s76, 18432
s_add_u32 s79, s76, 27648
s_add_u32 m0, s6, 4096
s_nop 0
BL v25,s[36:39],s76 offen lds
BL v25,s[36:39],s77 offen offset:1024 lds
BL v25,s[36:39],s78 offen offset:2048 lds
BL v25,s[36:39],s79 offen offset:3072 lds
s_add_u32 s87, s86, 128
s_mul_i32 s88, s87, 6554
s_lshr_b32 s88, s88, 16
s_mul_i32 s89, s88, 10
s_sub_u32 s89, s87, s89
s_mul_i32 s76, s88, 40960
s_lshl_b32 s42, s87, 12
s_lshl_b32 s89, s89, 7
s_add_u32 s76, s76, s89
s_add_u32 s42, s42, 10485760
s_cmp_lt_u32 s87, 540
s_cselect_b32 s76, s76, 1073741824
s_cselect_b32 s42, s42, 1073741824
s_add_u32 s77, s76, 9216
s_add_u32 s78, s76, 18432
s_add_u32 s79, s76, 27648
s_add_u32 m0, s6, 8192
s_nop 0
BL v25,s[36:39],s76 offen lds
BL v25,s[36:39],s77 offen offset:1024 lds
BL v25,s[36:39],s78 offen offset:2048 lds
BL v25,s[36:39],s79 offen offset:3072 lds
s_add_u32 s87, s86, 192
s_mul_i32 s88, s87, 6554
s_lshr_b32 s88, s88, 16
s_mul_i32 s89, s88, 10
s_sub_u32 s89, s87, s89
s_mul_i32 s76, s88, 40960
s_lshl_b32 s43, s87, 12
s_lshl_b32 s89, s89, 7
s_add_u32 s76, s76, s89
s_add_u32 s43, s43, 10485760
s_cmp_lt_u32 s87, 540
s_cselect_b32 s76, s76, 1073741824
s_cselect_b32 s43, s43, 1073741824
s_add_u32 s77, s76, 9216
s_add_u32 s78, s76, 18432
s_add_u32 s79, s76, 27648
s_add_u32 m0, s6, 12288
s_nop 0
BL v25,s[36:39],s76 offen lds
BL v25,s[36:39],s77 offen offset:1024 lds
BL v25,s[36:39],s78 offen offset:2048 lds
BL v25,s[36:39],s79 offen offset:3072 lds
s_add_u32 s87, s86, 256
s_mul_i32 s88, s87, 6554
s_lshr_b32 s88, s88, 16
s_mul_i32 s89, s88, 10
s_sub_u32 s89, s87, s89
s_mul_i32 s76, s88, 40960
s_lshl_b32 s44, s87, 12
s_lshl_b32 s89, s89, 7
s_add_u32 s76, s76, s89
s_add_u32 s44, s44, 10485760
s_cmp_lt_u32 s87, 540
s_cselect_b32 s76, s76, 1073741824
s_cselect_b32 s44, s44, 1073741824
s_add_u32 s77, s76, 9216
s_add_u32 s78, s76, 18432
s_add_u32 s79, s76, 27648
s_add_u32 m0, s6, 16384
s_nop 0
BL v25,s[36:39],s76 offen lds
BL v25,s[36:39],s77 offen offset:1024 lds
BL v25,s[36:39],s78 offen offset:2048 lds
BL v25,s[36:39],s79 offen offset:3072 lds
s_waitcnt vmcnt(16)
TR v[64:65],v62
TR v[66:67],v62 offset:1024
TR v[68:69],v62 offset:32
TR v[70:71],v62 offset:1056
TR v[72:73],v62 offset:64
TR v[74:75],v62 offset:1088
TR v[76:77],v62 offset:96
TR v[78:79],v62 offset:1120
s_waitcnt lgkmcnt(6)
buffer_store_dwordx4 v[64:67], v63, s[24:27], s40 offen sc1
s_waitcnt lgkmcnt(4)
buffer_store_dwordx4 v[68:71], v63, s[24:27], s40 offen offset:1024 sc1
s_waitcnt lgkmcnt(2)
buffer_store_dwordx4 v[72:75], v63, s[24:27], s40 offen offset:2048 sc1
s_waitcnt lgkmcnt(0)
buffer_store_dwordx4 v[76:79], v63, s[24:27], s40 offen offset:3072 sc1
s_waitcnt vmcnt(16)
TR v[80:81],v62 offset:4096
TR v[82:83],v62 offset:5120
TR v[84:85],v62 offset:4128
TR v[86:87],v62 offset:5152
TR v[88:89],v62 offset:4160
TR v[90:91],v62 offset:5184
TR v[92:93],v62 offset:4192
TR v[94:95],v62 offset:5216
s_waitcnt lgkmcnt(6)
buffer_store_dwordx4 v[80:83], v63, s[24:27], s41 offen sc1
s_waitcnt lgkmcnt(4)
buffer_store_dwordx4 v[84:87], v63, s[24:27], s41 offen offset:1024 sc1
s_waitcnt lgkmcnt(2)
buffer_store_dwordx4 v[88:91], v63, s[24:27], s41 offen offset:2048 sc1
s_waitcnt lgkmcnt(0)
buffer_store_dwordx4 v[92:95], v63, s[24:27], s41 offen offset:3072 sc1
s_waitcnt vmcnt(16)
TR v[64:65],v62 offset:8192
TR v[66:67],v62 offset:9216
TR v[68:69],v62 offset:8224
TR v[70:71],v62 offset:9248
TR v[72:73],v62 offset:8256
TR v[74:75],v62 offset:9280
TR v[76:77],v62 offset:8288
TR v[78:79],v62 offset:9312
s_waitcnt lgkmcnt(6)
buffer_store_dwordx4 v[64:67], v63, s[24:27], s42 offen sc1
s_waitcnt lgkmcnt(4)
buffer_store_dwordx4 v[68:71], v63, s[24:27], s42 offen offset:1024 sc1
s_waitcnt lgkmcnt(2)
buffer_store_dwordx4 v[72:75], v63, s[24:27], s42 offen offset:2048 sc1
s_waitcnt lgkmcnt(0)
buffer_store_dwordx4 v[76:79], v63, s[24:27], s42 offen offset:3072 sc1
s_waitcnt vmcnt(16)
TR v[80:81],v62 offset:12288
TR v[82:83],v62 offset:13312
TR v[84:85],v62 offset:12320
TR v[86:87],v62 offset:13344
TR v[88:89],v62 offset:12352
TR v[90:91],v62 offset:13376
TR v[92:93],v62 offset:12384
TR v[94:95],v62 offset:13408
s_waitcnt lgkmcnt(6)
buffer_store_dwordx4 v[80:83], v63, s[24:27], s43 offen sc1
s_waitcnt lgkmcnt(4)
buffer_store_dwordx4 v[84:87], v63, s[24:27], s43 offen offset:1024 sc1
s_waitcnt lgkmcnt(2)
buffer_store_dwordx4 v[88:91], v63, s[24:27], s43 offen offset:2048 sc1
s_waitcnt lgkmcnt(0)
buffer_store_dwordx4 v[92:95], v63, s[24:27], s43 offen offset:3072 sc1
buffer_load_dword v26, v27, s[28:31], 0 offen sc1
s_waitcnt vmcnt(17)
TR v[64:65],v62 offset:16384
TR v[66:67],v62 offset:17408
TR v[68:69],v62 offset:16416
TR v[70:71],v62 offset:17440
TR v[72:73],v62 offset:16448
TR v[74:75],v62 offset:17472
TR v[76:77],v62 offset:16480
TR v[78:79],v62 offset:17504
s_waitcnt lgkmcnt(6)
buffer_store_dwordx4 v[64:67], v63, s[24:27], s44 offen sc1
s_waitcnt lgkmcnt(4)
buffer_store_dwordx4 v[68:71], v63, s[24:27], s44 offen offset:1024 sc1
s_waitcnt lgkmcnt(2)
buffer_store_dwordx4 v[72:75], v63, s[24:27], s44 offen offset:2048 sc1
s_waitcnt lgkmcnt(0)
buffer_store_dwordx4 v[76:79], v63, s[24:27], s44 offen offset:3072 sc1
v_lshrrev_b32 v40, 3, v1
v_mul_u32_u24 v41, 1280, v40
v_lshrrev_b32 v42, 4, v1
v_and_b32 v43, 7, v1
v_xor_b32 v43, v43, v42
v_lshl_add_u32 v30, v43, 4, v41
v_xor_b32 v31, 64, v30
v_add_u32 v31, 10240, v31
s_mul_i32 s43, s4, 163840
s_add_u32 s43, s43, s6
s_bfe_u32 s44, s58, 0x40000
s_mul_i32 s44, s44, 128
s_add_u32 s44, s44, s43
s_add_u32 s61, s44, 20480
s_add_u32 m0, s6, 12288
s_nop 0
BL v30,s[8:11],s44 offen lds
s_add_u32 m0, s6, 13312
s_nop 0
BL v31,s[8:11],s44 offen lds
s_add_u32 m0, s6, 14336
s_nop 0
BL v30,s[8:11],s61 offen lds
s_add_u32 m0, s6, 15360
s_nop 0
BL v31,s[8:11],s61 offen lds
s_bfe_u32 s44, s58, 0x40004
s_mul_i32 s44, s44, 128
s_add_u32 s44, s44, s43
s_add_u32 s61, s44, 20480
s_add_u32 m0, s6, 16384
s_nop 0
BL v30,s[8:11],s44 offen lds
s_add_u32 m0, s6, 17408
s_nop 0
BL v31,s[8:11],s44 offen lds
s_add_u32 m0, s6, 18432
s_nop 0
BL v30,s[8:11],s61 offen lds
s_add_u32 m0, s6, 19456
s_nop 0
BL v31,s[8:11],s61 offen lds
s_bfe_u32 s44, s58, 0x40008
s_mul_i32 s44, s44, 128
s_add_u32 s44, s44, s43
s_add_u32 s61, s44, 20480
s_add_u32 m0, s6, 20480
s_nop 0
BL v30,s[8:11],s44 offen lds
s_add_u32 m0, s6, 21504
s_nop 0
BL v31,s[8:11],s44 offen lds
s_add_u32 m0, s6, 22528
s_nop 0
BL v30,s[8:11],s61 offen lds
s_add_u32 m0, s6, 23552
s_nop 0
BL v31,s[8:11],s61 offen lds
s_bfe_u32 s44, s58, 0x4000c
s_mul_i32 s44, s44, 128
s_add_u32 s44, s44, s43
s_add_u32 s61, s44, 20480
s_add_u32 m0, s6, 24576
s_nop 0
BL v30,s[8:11],s44 offen lds
s_add_u32 m0, s6, 25600
s_nop 0
BL v31,s[8:11],s44 offen lds
s_add_u32 m0, s6, 26624
s_nop 0
BL v30,s[8:11],s61 offen lds
s_add_u32 m0, s6, 27648
s_nop 0
BL v31,s[8:11],s61 offen lds
s_waitcnt vmcnt(16)
K1_GU2_N_chk:
v_cmp_eq_u32 vcc, 0, v26
s_nop 0
s_cmp_eq_u64 vcc, 0
s_cbranch_scc1 K1_GU2_N_ok
s_cmp_eq_u32 s101, 0
s_cbranch_scc1 K1_GU2_N_ok
s_sub_u32 s101, s101, 1
s_sleep 10
buffer_load_dword v26, v27, s[28:31], 0 offen sc1
s_waitcnt vmcnt(0)
s_branch K1_GU2_N_chk
K1_GU2_N_ok:
s_lshl_b32 s7, s86, 2
s_add_u32 s7, s7, 15532032
buffer_store_dword v26, v20, s[24:27], s7 offen sc1
v_and_b32 v56, 31, v1
v_lshrrev_b32 v57, 5, v1
v_bfe_u32 v58, v1, 1, 3
v_lshlrev_b32 v59, 7, v56
v_add_u32 v59, s6, v59
s_mov_b32 s49, 0x3f803f80
v_add_u32 v60, 0, v57
v_xor_b32 v60, v60, v58
v_lshl_add_u32 v34, v60, 4, v59
v_add_u32 v60, 2, v57
v_xor_b32 v60, v60, v58
v_lshl_add_u32 v35, v60, 4, v59
v_add_u32 v60, 4, v57
v_xor_b32 v60, v60, v58
v_lshl_add_u32 v36, v60, 4, v59
v_add_u32 v60, 6, v57
v_xor_b32 v60, v60, v58
v_lshl_add_u32 v37, v60, 4, v59
v_mov_b32 v48, 0
v_mov_b32 v49, 0
v_mov_b32 v50, 0
v_mov_b32 v51, 0
v_mov_b32 v52, 0
v_mov_b32 v53, 0
v_mov_b32 v54, 0
v_mov_b32 v55, 0
v_lshrrev_b32 v40, 3, v1
v_mul_u32_u24 v41, 3456, v40
v_and_b32 v42, 7, v1
v_and_b32 v40, 2, v40
v_xor_b32 v42, v42, v40
v_lshl_add_u32 v42, v42, 4, v41
v_xor_b32 v43, 64, v42
v_add_u32 v10, 3072, v42
v_add_u32 v11, 29696, v42
v_add_u32 v12, 1024, v43
v_add_u32 v13, 27648, v43
s_sub_u32 s7, s5, 8
s_lshr_b32 s46, s7, 1
s_and_b32 s7, s7, 1
s_waitcnt vmcnt(13)
ds_read_b128 v[96:99], v34 offset:12288
ds_read_b128 v[100:103], v35 offset:12288
ds_read_b128 v[104:107], v36 offset:12288
ds_read_b128 v[108:111], v37 offset:12288
s_bfe_u32 s44, s58, 0x40010
s_mul_i32 s44, s44, 128
s_add_u32 s44, s44, s43
s_add_u32 s61, s44, 20480
s_add_u32 m0, s6, 28672
s_nop 0
BL v30,s[8:11],s44 offen lds
s_mul_i32 s47, s46, 7
s_add_u32 s47, s47, s7
s_add_u32 s48, s47, 5
s_cmp_eq_u32 s46, 3
s_cselect_b32 s42, 1, 0
s_sub_u32 s48, s48, s42
s_add_u32 m0, s6, 29696
s_nop 0
BL v31,s[8:11],s44 offen lds
s_mul_i32 s41, s3, 55296
s_lshl_b32 s42, s47, 7
s_add_u32 s40, s41, s42
s_lshl_b32 s42, s48, 7
s_add_u32 s42, s41, s42
s_add_u32 s41, s40, 256
s_add_u32 m0, s6, 30720
s_nop 0
BL v30,s[8:11],s61 offen lds
s_lshl_b32 s46, s47, 13
s_lshl_b32 s48, s48, 13
s_mov_b32 s41, s42
v_lshrrev_b32 v40, 4, v1
v_and_b32 v41, 1, v40
v_lshrrev_b32 v40, 1, v40
s_add_u32 m0, s6, 31744
s_nop 0
BL v31,s[8:11],s61 offen lds
v_bfe_u32 v42, v1, 2, 2
v_and_b32 v43, 3, v1
v_lshl_add_u32 v44, v40, 3, v42
v_lshlrev_b32 v44, 7, v44
v_lshl_add_u32 v44, v41, 11, v44
v_and_b32 v45, 1, v43
s_waitcnt vmcnt(13)
ds_read_b128 v[112:115], v34 offset:16384
ds_read_b128 v[116:119], v35 offset:16384
ds_read_b128 v[120:123], v36 offset:16384
ds_read_b128 v[124:127], v37 offset:16384
s_waitcnt lgkmcnt(4)
s_bfe_u32 s44, s58, 0x40014
s_mul_i32 s44, s44, 128
s_add_u32 s44, s44, s43
s_add_u32 s61, s44, 20480
s_add_u32 m0, s6, 32768
s_nop 0
BL v30,s[8:11],s44 offen lds
D2 v48,v96,s49,v48
D2 v52,v96,v96,v52
D2 v49,v97,s49,v49
D2 v53,v97,v97,v53
D2 v50,v98,s49,v50
D2 v54,v98,v98,v54
D2 v51,v99,s49,v51
D2 v55,v99,v99,v55
v_lshl_add_u32 v44, v45, 3, v44
v_and_b32 v45, 2, v42
v_lshl_add_u32 v45, v41, 2, v45
v_lshrrev_b32 v43, 1, v43
v_xor_b32 v46, 0, v45
v_add_u32 v46, v46, v43
s_add_u32 m0, s6, 33792
s_nop 0
BL v31,s[8:11],s44 offen lds
D2 v48,v100,s49,v48
D2 v52,v100,v100,v52
D2 v49,v101,s49,v49
D2 v53,v101,v101,v53
D2 v50,v102,s49,v50
D2 v54,v102,v102,v54
D2 v51,v103,s49,v51
D2 v55,v103,v103,v55
v_lshl_add_u32 v2, v46, 4, v44
v_add_u32 v3, 81920, v2
v_xor_b32 v46, 2, v45
v_add_u32 v46, v46, v43
v_lshl_add_u32 v4, v46, 4, v44
v_add_u32 v5, 81920, v4
s_add_u32 m0, s6, 34816
s_nop 0
BL v30,s[8:11],s61 offen lds
D2 v48,v104,s49,v48
D2 v52,v104,v104,v52
D2 v49,v105,s49,v49
D2 v53,v105,v105,v53
D2 v50,v106,s49,v50
D2 v54,v106,v106,v54
D2 v51,v107,s49,v51
D2 v55,v107,v107,v55
v_xor_b32 v46, 4, v45
v_add_u32 v46, v46, v43
v_lshl_add_u32 v6, v46, 4, v44
v_add_u32 v7, 81920, v6
v_xor_b32 v46, 6, v45
v_add_u32 v46, v46, v43
s_add_u32 m0, s6, 35840
s_nop 0
BL v31,s[8:11],s61 offen lds
D2 v48,v108,s49,v48
D2 v52,v108,v108,v52
D2 v49,v109,s49,v49
D2 v53,v109,v109,v53
D2 v50,v110,s49,v50
D2 v54,v110,v110,v54
D2 v51,v111,s49,v51
D2 v55,v111,v111,v55
v_lshl_add_u32 v8, v46, 4, v44
v_add_u32 v9, 81920, v8
s_lshl_b32 s7, s4, 1
s_lshr_b32 s45, s3, 1
s_add_u32 s7, s7, s45
s_mul_i32 s45, s7, 303104
s_waitcnt vmcnt(13)
ds_read_b128 v[128:131], v34 offset:20480
ds_read_b128 v[132:135], v35 offset:20480
ds_read_b128 v[136:139], v36 offset:20480
ds_read_b128 v[140:143], v37 offset:20480
s_waitcnt lgkmcnt(4)
s_bfe_u32 s44, s58, 0x40018
s_mul_i32 s44, s44, 128
s_add_u32 s44, s44, s43
s_add_u32 s61, s44, 20480
s_add_u32 m0, s6, 36864
s_nop 0
BL v30,s[8:11],s44 offen lds
D2 v48,v112,s49,v48
D2 v52,v112,v112,v52
D2 v49,v113,s49,v49
D2 v53,v113,v113,v53
D2 v50,v114,s49,v50
D2 v54,v114,v114,v54
D2 v51,v115,s49,v51
D2 v55,v115,v115,v55
s_and_b32 s7, s3, 1
s_lshl_b32 s7, s7, 11
s_add_u32 s45, s45, s7
v_bfe_u32 v40, v1, 4, 1
v_lshlrev_b32 v40, 10, v40
v_lshrrev_b32 v41, 5, v1
s_add_u32 m0, s6, 37888
s_nop 0
BL v31,s[8:11],s44 offen lds
D2 v48,v116,s49,v48
D2 v52,v116,v116,v52
D2 v49,v117,s49,v49
D2 v53,v117,v117,v53
D2 v50,v118,s49,v50
D2 v54,v118,v118,v54
D2 v51,v119,s49,v51
D2 v55,v119,v119,v55
v_lshl_add_u32 v40, v41, 8, v40
v_and_b32 v41, 15, v1
v_lshl_add_u32 v28, v41, 4, v40
v_add_u32 v29, 4096, v28
s_mov_b32 s50, 0xbfb8aa3b
s_mov_b32 s51, 0x3fb8aa3b
s_add_u32 m0, s6, 38912
s_nop 0
BL v30,s[8:11],s61 offen lds
D2 v48,v120,s49,v48
D2 v52,v120,v120,v52
D2 v49,v121,s49,v49
D2 v53,v121,v121,v53
D2 v50,v122,s49,v50
D2 v54,v122,v122,v54
D2 v51,v123,s49,v51
D2 v55,v123,v123,v55
s_mov_b32 s52, 0xffff0000
s_mov_b32 s53, 0x358637bd
s_add_u32 s46, s46, s45
s_add_u32 s47, s46, 16384
s_add_u32 s48, s48, s45
s_mov_b32 s47, s48
s_add_u32 m0, s6, 39936
s_nop 0
BL v31,s[8:11],s61 offen lds
D2 v48,v124,s49,v48
D2 v52,v124,v124,v52
D2 v49,v125,s49,v49
D2 v53,v125,v125,v53
D2 v50,v126,s49,v50
D2 v54,v126,v126,v54
D2 v51,v127,s49,v51
D2 v55,v127,v127,v55
s_and_b32 s7, s5, 7
s_mul_i32 s32, s3, 112
s_add_u32 s7, s7, s32
s_mul_i32 s7, s7, 5120
s_sub_u32 s34, 3031040, s7
s_add_u32 s7, s7, 10485760
s_waitcnt vmcnt(13)
ds_read_b128 v[144:147], v34 offset:24576
ds_read_b128 v[148:151], v35 offset:24576
ds_read_b128 v[152:155], v36 offset:24576
ds_read_b128 v[156:159], v37 offset:24576
s_waitcnt lgkmcnt(4)
s_bfe_u32 s44, s58, 0x4001c
s_mul_i32 s44, s44, 128
s_add_u32 s44, s44, s43
s_add_u32 s61, s44, 20480
s_add_u32 m0, s6, 12288
s_nop 0
BL v30,s[8:11],s44 offen lds
D2 v48,v128,s49,v48
D2 v52,v128,v128,v52
D2 v49,v129,s49,v49
D2 v53,v129,v129,v53
D2 v50,v130,s49,v50
D2 v54,v130,v130,v54
D2 v51,v131,s49,v51
D2 v55,v131,v131,v55
s_add_u32 s32, s82, s7
s_addc_u32 s33, s83, 0
s_mov_b32 s35, 0x20000
s_and_b32 s7, s5, 7
s_add_u32 s7, s7, s4
s_and_b32 s7, s7, 3
s_mul_i32 s7, s7, 0
s_add_u32 m0, s6, 13312
s_nop 0
BL v31,s[8:11],s44 offen lds
D2 v48,v132,s49,v48
D2 v52,v132,v132,v52
D2 v49,v133,s49,v49
D2 v53,v133,v133,v53
D2 v50,v134,s49,v50
D2 v54,v134,v134,v54
D2 v51,v135,s49,v51
D2 v55,v135,v135,v55
s_mov_b32 s84, 0x03020100
s_mov_b32 s85, s84
s_lshr_b64 s[84:85], s[84:85], s7
s_mov_b32 s87, s84
s_add_u32 s89, s84, 0x0a0a0a0a
s_sub_u32 s70, s89, 0x02020202
s_add_u32 m0, s6, 14336
s_nop 0
BL v30,s[8:11],s61 offen lds
D2 v48,v136,s49,v48
D2 v52,v136,v136,v52
D2 v49,v137,s49,v49
D2 v53,v137,v137,v53
D2 v50,v138,s49,v50
D2 v54,v138,v138,v54
D2 v51,v139,s49,v51
D2 v55,v139,v139,v55
s_cmp_eq_u32 s3, 3
s_cselect_b32 s89, s70, s89
s_mov_b32 s70, 0x0908
s_cselect_b32 s70, 0x0706, s70
s_mov_b32 s84, 0x07060504
s_cselect_b32 s84, 0xffff0504, s84
s_add_u32 m0, s6, 15360
s_nop 0
BL v31,s[8:11],s61 offen lds
D2 v48,v140,s49,v48
D2 v52,v140,v140,v52
D2 v49,v141,s49,v49
D2 v53,v141,v141,v53
D2 v50,v142,s49,v50
D2 v54,v142,v142,v54
D2 v51,v143,s49,v51
D2 v55,v143,v143,v55
s_mul_i32 s71, s3, 9
s_sub_u32 s71, 54, s71
s_add_u32 s85, s71, 4
s_lshl_b32 s85, s85, 16
s_or_b32 s70, s70, s85
s_mul_i32 s71, s71, 0x01010101
s_waitcnt vmcnt(12)
ds_read_b128 v[160:163], v34 offset:28672
ds_read_b128 v[164:167], v35 offset:28672
ds_read_b128 v[168:171], v36 offset:28672
ds_read_b128 v[172:175], v37 offset:28672
s_waitcnt lgkmcnt(4)
s_bfe_u32 s44, s59, 0x40000
s_mul_i32 s44, s44, 128
s_add_u32 s44, s44, s43
s_add_u32 s61, s44, 20480
s_add_u32 m0, s6, 16384
s_nop 0
BL v30,s[8:11],s44 offen lds
D2 v48,v144,s49,v48
D2 v52,v144,v144,v52
D2 v49,v145,s49,v49
D2 v53,v145,v145,v53
D2 v50,v146,s49,v50
D2 v54,v146,v146,v54
D2 v51,v147,s49,v51
D2 v55,v147,v147,v55
s_add_u32 s71, s71, s87
s_mov_b32 s85, s84
s_lshr_b64 s[84:85], s[84:85], s7
s_mov_b32 s88, s84
s_lshl_b32 s96, s4, 12
s_lshr_b32 s7, s3, 1
s_add_u32 m0, s6, 17408
s_nop 0
BL v31,s[8:11],s44 offen lds
D2 v48,v148,s49,v48
D2 v52,v148,v148,v52
D2 v49,v149,s49,v49
D2 v53,v149,v149,v53
D2 v50,v150,s49,v50
D2 v54,v150,v150,v54
D2 v51,v151,s49,v51
D2 v55,v151,v151,v55
s_lshl_b32 s7, s7, 11
s_add_u32 s96, s96, s7
s_lshl_b32 s7, s5, 7
s_add_u32 s96, s96, s7
s_and_b32 s7, s3, 1
s_lshl_b32 s7, s7, 2
s_add_u32 m0, s6, 18432
s_nop 0
BL v30,s[8:11],s61 offen lds
D2 v48,v152,s49,v48
D2 v52,v152,v152,v52
D2 v49,v153,s49,v49
D2 v53,v153,v153,v53
D2 v50,v154,s49,v50
D2 v54,v154,v154,v54
D2 v51,v155,s49,v51
D2 v55,v155,v155,v55
s_add_u32 s96, s96, s7
s_add_u32 s96, s96, 15466496
s_lshl_b32 s97, s4, 12
s_lshr_b32 s7, s5, 3
s_lshl_b32 s7, s7, 11
s_add_u32 s97, s97, s7
s_add_u32 m0, s6, 19456
s_nop 0
BL v31,s[8:11],s61 offen lds
D2 v48,v156,s49,v48
D2 v52,v156,v156,v52
D2 v49,v157,s49,v49
D2 v53,v157,v157,v53
D2 v50,v158,s49,v50
D2 v54,v158,v158,v54
D2 v51,v159,s49,v51
D2 v55,v159,v159,v55
s_add_u32 s97, s97, 15466496
s_waitcnt vmcnt(12)
ds_read_b128 v[176:179], v34 offset:32768
ds_read_b128 v[180:183], v35 offset:32768
ds_read_b128 v[184:187], v36 offset:32768
ds_read_b128 v[188:191], v37 offset:32768
s_waitcnt lgkmcnt(4)
s_bfe_u32 s44, s59, 0x40004
s_mul_i32 s44, s44, 128
s_add_u32 s44, s44, s43
s_add_u32 s61, s44, 20480
s_add_u32 m0, s6, 20480
s_nop 0
BL v30,s[8:11],s44 offen lds
D2 v48,v160,s49,v48
D2 v52,v160,v160,v52
D2 v49,v161,s49,v49
D2 v53,v161,v161,v53
D2 v50,v162,s49,v50
D2 v54,v162,v162,v54
D2 v51,v163,s49,v51
D2 v55,v163,v163,v55
s_add_u32 m0, s6, 21504
s_nop 0
BL v31,s[8:11],s44 offen lds
D2 v48,v164,s49,v48
D2 v52,v164,v164,v52
D2 v49,v165,s49,v49
D2 v53,v165,v165,v53
D2 v50,v166,s49,v50
D2 v54,v166,v166,v54
D2 v51,v167,s49,v51
D2 v55,v167,v167,v55
s_add_u32 m0, s6, 22528
s_nop 0
BL v30,s[8:11],s61 offen lds
D2 v48,v168,s49,v48
D2 v52,v168,v168,v52
D2 v49,v169,s49,v49
D2 v53,v169,v169,v53
D2 v50,v170,s49,v50
D2 v54,v170,v170,v54
D2 v51,v171,s49,v51
D2 v55,v171,v171,v55
s_add_u32 m0, s6, 23552
s_nop 0
BL v31,s[8:11],s61 offen lds
D2 v48,v172,s49,v48
D2 v52,v172,v172,v52
D2 v49,v173,s49,v49
D2 v53,v173,v173,v53
D2 v50,v174,s49,v50
D2 v54,v174,v174,v54
D2 v51,v175,s49,v51
D2 v55,v175,v175,v55
s_waitcnt vmcnt(12)
ds_read_b128 v[192:195], v34 offset:36864
ds_read_b128 v[196:199], v35 offset:36864
ds_read_b128 v[200:203], v36 offset:36864
ds_read_b128 v[204:207], v37 offset:36864
s_waitcnt lgkmcnt(4)
D2 v48,v176,s49,v48
D2 v52,v176,v176,v52
D2 v49,v177,s49,v49
D2 v53,v177,v177,v53
D2 v50,v178,s49,v50
D2 v54,v178,v178,v54
D2 v51,v179,s49,v51
D2 v55,v179,v179,v55
D2 v48,v180,s49,v48
D2 v52,v180,v180,v52
D2 v49,v181,s49,v49
D2 v53,v181,v181,v53
D2 v50,v182,s49,v50
D2 v54,v182,v182,v54
D2 v51,v183,s49,v51
D2 v55,v183,v183,v55
D2 v48,v184,s49,v48
D2 v52,v184,v184,v52
D2 v49,v185,s49,v49
D2 v53,v185,v185,v53
D2 v50,v186,s49,v50
D2 v54,v186,v186,v54
D2 v51,v187,s49,v51
D2 v55,v187,v187,v55
D2 v48,v188,s49,v48
D2 v52,v188,v188,v52
D2 v49,v189,s49,v49
D2 v53,v189,v189,v53
D2 v50,v190,s49,v50
D2 v54,v190,v190,v54
D2 v51,v191,s49,v51
D2 v55,v191,v191,v55
s_waitcnt vmcnt(8)
ds_read_b128 v[208:211], v34 offset:12288
ds_read_b128 v[212:215], v35 offset:12288
ds_read_b128 v[216:219], v36 offset:12288
ds_read_b128 v[220:223], v37 offset:12288
s_waitcnt lgkmcnt(4)
s_add_u32 m0, s6, 0
s_bfe_u32 s60, s58, 0x40000
s_mul_i32 s60, s60, 221184
s_add_u32 s60, s60, s40
BL v10,s[12:15],s60 offen lds
D2 v48,v192,s49,v48
D2 v52,v192,v192,v52
D2 v49,v193,s49,v49
D2 v53,v193,v193,v53
D2 v50,v194,s49,v50
D2 v54,v194,v194,v54
D2 v51,v195,s49,v51
D2 v55,v195,v195,v55
BL v11,s[12:15],s60 offen offset:1024 lds
D2 v48,v196,s49,v48
D2 v52,v196,v196,v52
D2 v49,v197,s49,v49
D2 v53,v197,v197,v53
D2 v50,v198,s49,v50
D2 v54,v198,v198,v54
D2 v51,v199,s49,v51
D2 v55,v199,v199,v55
BL v12,s[16:19],s60 offen offset:2048 lds
D2 v48,v200,s49,v48
D2 v52,v200,v200,v52
D2 v49,v201,s49,v49
D2 v53,v201,v201,v53
D2 v50,v202,s49,v50
D2 v54,v202,v202,v54
D2 v51,v203,s49,v51
D2 v55,v203,v203,v55
BL v13,s[16:19],s60 offen offset:3072 lds
D2 v48,v204,s49,v48
D2 v52,v204,v204,v52
D2 v49,v205,s49,v49
D2 v53,v205,v205,v53
D2 v50,v206,s49,v50
D2 v54,v206,v206,v54
D2 v51,v207,s49,v51
D2 v55,v207,v207,v55
s_waitcnt vmcnt(8)
ds_read_b128 v[224:227], v34 offset:16384
ds_read_b128 v[228:231], v35 offset:16384
ds_read_b128 v[232:235], v36 offset:16384
ds_read_b128 v[236:239], v37 offset:16384
s_waitcnt lgkmcnt(4)
D2 v48,v208,s49,v48
D2 v52,v208,v208,v52
D2 v49,v209,s49,v49
D2 v53,v209,v209,v53
D2 v50,v210,s49,v50
D2 v54,v210,v210,v54
D2 v51,v211,s49,v51
D2 v55,v211,v211,v55
D2 v48,v212,s49,v48
D2 v52,v212,v212,v52
D2 v49,v213,s49,v49
D2 v53,v213,v213,v53
D2 v50,v214,s49,v50
D2 v54,v214,v214,v54
D2 v51,v215,s49,v51
D2 v55,v215,v215,v55
D2 v48,v216,s49,v48
D2 v52,v216,v216,v52
D2 v49,v217,s49,v49
D2 v53,v217,v217,v53
D2 v50,v218,s49,v50
D2 v54,v218,v218,v54
D2 v51,v219,s49,v51
D2 v55,v219,v219,v55
D2 v48,v220,s49,v48
D2 v52,v220,v220,v52
D2 v49,v221,s49,v49
D2 v53,v221,v221,v53
D2 v50,v222,s49,v50
D2 v54,v222,v222,v54
D2 v51,v223,s49,v51
D2 v55,v223,v223,v55
s_waitcnt vmcnt(4)
ds_read_b128 v[240:243], v34 offset:20480
ds_read_b128 v[244:247], v35 offset:20480
ds_read_b128 v[248:251], v36 offset:20480
ds_read_b128 v[252:255], v37 offset:20480
s_waitcnt lgkmcnt(4)
s_add_u32 m0, s6, 5120
s_bfe_u32 s60, s58, 0x40004
s_mul_i32 s60, s60, 221184
s_add_u32 s60, s60, s40
BL v10,s[12:15],s60 offen lds
D2 v48,v224,s49,v48
D2 v52,v224,v224,v52
D2 v49,v225,s49,v49
D2 v53,v225,v225,v53
D2 v50,v226,s49,v50
D2 v54,v226,v226,v54
D2 v51,v227,s49,v51
D2 v55,v227,v227,v55
BL v11,s[12:15],s60 offen offset:1024 lds
D2 v48,v228,s49,v48
D2 v52,v228,v228,v52
D2 v49,v229,s49,v49
D2 v53,v229,v229,v53
D2 v50,v230,s49,v50
D2 v54,v230,v230,v54
D2 v51,v231,s49,v51
D2 v55,v231,v231,v55
BL v12,s[16:19],s60 offen offset:2048 lds
D2 v48,v232,s49,v48
D2 v52,v232,v232,v52
D2 v49,v233,s49,v49
D2 v53,v233,v233,v53
D2 v50,v234,s49,v50
D2 v54,v234,v234,v54
D2 v51,v235,s49,v51
D2 v55,v235,v235,v55
BL v13,s[16:19],s60 offen offset:3072 lds
D2 v48,v236,s49,v48
D2 v52,v236,v236,v52
D2 v49,v237,s49,v49
D2 v53,v237,v237,v53
D2 v50,v238,s49,v50
D2 v54,v238,v238,v54
D2 v51,v239,s49,v51
D2 v55,v239,v239,v55
s_waitcnt lgkmcnt(0)
D2 v48,v240,s49,v48
D2 v52,v240,v240,v52
D2 v49,v241,s49,v49
D2 v53,v241,v241,v53
D2 v50,v242,s49,v50
D2 v54,v242,v242,v54
D2 v51,v243,s49,v51
D2 v55,v243,v243,v55
D2 v48,v244,s49,v48
D2 v52,v244,v244,v52
D2 v49,v245,s49,v49
D2 v53,v245,v245,v53
D2 v50,v246,s49,v50
D2 v54,v246,v246,v54
D2 v51,v247,s49,v51
D2 v55,v247,v247,v55
D2 v48,v248,s49,v48
D2 v52,v248,v248,v52
D2 v49,v249,s49,v49
D2 v53,v249,v249,v53
D2 v50,v250,s49,v50
D2 v54,v250,v250,v54
D2 v51,v251,s49,v51
D2 v55,v251,v251,v55
D2 v48,v252,s49,v48
D2 v52,v252,v252,v52
D2 v49,v253,s49,v49
D2 v53,v253,v253,v53
D2 v50,v254,s49,v50
D2 v54,v254,v254,v54
D2 v51,v255,s49,v51
D2 v55,v255,v255,v55
s_nop 2
v_add_f32 v48, v48, v49
v_add_f32 v50, v50, v51
v_add_f32 v52, v52, v53
v_add_f32 v54, v54, v55
v_add_f32 v48, v48, v50
v_add_f32 v52, v52, v54
v_mov_b32 v49, v48
v_mov_b32 v53, v52
s_nop 0
v_permlane32_swap_b32 v48, v49
v_permlane32_swap_b32 v52, v53
v_add_f32 v48, v48, v49
v_add_f32 v52, v52, v53
v_mul_f32 v48, 0x3acccccd, v48
v_mul_f32 v52, 0x3acccccd, v52
v_fma_f32 v52, -v48, v48, v52
v_max_f32 v52, 0, v52
CV v50,v48,v52
v_and_b32 v52, s52, v50
v_lshlrev_b32 v48, 16, v50
v_add_f32 v52, 0x3727c5ac, v52
CV v52,v52,v52
v_and_b32 v52, s52, v52
v_sqrt_f32 v52, v52
s_nop 0
CV v52,v52,v52
v_and_b32 v52, s52, v52
v_rcp_f32 v32, v52
s_nop 0
v_mul_f32 v33, v48, v32
v_sub_f32 v33, 0, v33
s_waitcnt vmcnt(4)
s_barrier
TR a[224:225],v2
TR a[226:227],v2 offset:512
TR a[228:229],v4
TR a[230:231],v4 offset:512
TR a[232:233],v6
TR a[234:235],v6 offset:512
TR a[236:237],v8
TR a[238:239],v8 offset:512
TR a[240:241],v2 offset:40960
TR a[242:243],v2 offset:41472
TR a[244:245],v4 offset:40960
TR a[246:247],v4 offset:41472
TR a[248:249],v6 offset:40960
TR a[250:251],v6 offset:41472
v_lshlrev_b32 v34, 16, v96
v_and_b32 v35, s52, v96
v_lshlrev_b32 v36, 16, v97
v_and_b32 v37, s52, v97
v_lshlrev_b32 v38, 16, v98
v_and_b32 v39, s52, v98
v_lshlrev_b32 v88, 16, v99
v_and_b32 v89, s52, v99
v_fma_f32 v34, v34, v32, v33
v_fma_f32 v35, v35, v32, v33
v_fma_f32 v36, v36, v32, v33
v_fma_f32 v37, v37, v32, v33
v_fma_f32 v38, v38, v32, v33
v_fma_f32 v39, v39, v32, v33
v_fma_f32 v88, v88, v32, v33
v_fma_f32 v89, v89, v32, v33
CV v96,v34,v35
CV v97,v36,v37
CV v98,v38,v39
CV v99,v88,v89
v_lshlrev_b32 v34, 16, v100
v_and_b32 v35, s52, v100
v_lshlrev_b32 v36, 16, v101
v_and_b32 v37, s52, v101
s_waitcnt lgkmcnt(6)
M3 a[0:15],a[224:227],v[96:99],0
TR a[252:253],v8 offset:40960
TR a[254:255],v8 offset:41472
v_lshlrev_b32 v38, 16, v102
v_and_b32 v39, s52, v102
v_lshlrev_b32 v88, 16, v103
v_and_b32 v89, s52, v103
v_fma_f32 v34, v34, v32, v33
s_add_u32 m0, s6, 10240
s_bfe_u32 s60, s58, 0x40008
s_mul_i32 s60, s60, 221184
s_add_u32 s60, s60, s40
BL v10,s[12:15],s60 offen lds
M3 a[16:31],a[228:231],v[96:99],0
TR a[224:225],v3
TR a[226:227],v3 offset:512
v_fma_f32 v35, v35, v32, v33
v_fma_f32 v36, v36, v32, v33
v_fma_f32 v37, v37, v32, v33
v_fma_f32 v38, v38, v32, v33
v_fma_f32 v39, v39, v32, v33
M3 a[32:47],a[232:235],v[96:99],0
TR a[228:229],v5
TR a[230:231],v5 offset:512
v_fma_f32 v88, v88, v32, v33
v_fma_f32 v89, v89, v32, v33
CV v100,v34,v35
CV v101,v36,v37
CV v102,v38,v39
BL v11,s[12:15],s60 offen offset:1024 lds
M3 a[48:63],a[236:239],v[96:99],0
TR a[232:233],v7
TR a[234:235],v7 offset:512
CV v103,v88,v89
v_lshlrev_b32 v34, 16, v104
v_and_b32 v35, s52, v104
v_lshlrev_b32 v36, 16, v105
v_and_b32 v37, s52, v105
s_waitcnt lgkmcnt(6)
M3 a[0:15],a[240:243],v[100:103],a[0:15]
TR a[236:237],v9
TR a[238:239],v9 offset:512
v_lshlrev_b32 v38, 16, v106
v_and_b32 v39, s52, v106
v_lshlrev_b32 v88, 16, v107
v_and_b32 v89, s52, v107
v_fma_f32 v34, v34, v32, v33
BL v12,s[16:19],s60 offen offset:2048 lds
M3 a[16:31],a[244:247],v[100:103],a[16:31]
TR a[240:241],v3 offset:40960
TR a[242:243],v3 offset:41472
v_fma_f32 v35, v35, v32, v33
v_fma_f32 v36, v36, v32, v33
v_fma_f32 v37, v37, v32, v33
v_fma_f32 v38, v38, v32, v33
v_fma_f32 v39, v39, v32, v33
M3 a[32:47],a[248:251],v[100:103],a[32:47]
TR a[244:245],v5 offset:40960
TR a[246:247],v5 offset:41472
v_fma_f32 v88, v88, v32, v33
v_fma_f32 v89, v89, v32, v33
CV v104,v34,v35
CV v105,v36,v37
CV v106,v38,v39
BL v13,s[16:19],s60 offen offset:3072 lds
M3 a[48:63],a[252:255],v[100:103],a[48:63]
TR a[248:249],v7 offset:40960
TR a[250:251],v7 offset:41472
CV v107,v88,v89
v_lshlrev_b32 v34, 16, v108
v_and_b32 v35, s52, v108
v_lshlrev_b32 v36, 16, v109
v_and_b32 v37, s52, v109
s_waitcnt lgkmcnt(6)
M3 a[0:15],a[224:227],v[104:107],a[0:15]
TR a[252:253],v9 offset:40960
TR a[254:255],v9 offset:41472
v_lshlrev_b32 v38, 16, v110
v_and_b32 v39, s52, v110
v_lshlrev_b32 v88, 16, v111
v_and_b32 v89, s52, v111
v_fma_f32 v34, v34, v32, v33
s_add_u32 m0, s6, 15360
s_bfe_u32 s60, s58, 0x4000c
s_mul_i32 s60, s60, 221184
s_add_u32 s60, s60, s40
BL v10,s[12:15],s60 offen lds
M3 a[16:31],a[228:231],v[104:107],a[16:31]
v_fma_f32 v35, v35, v32, v33
v_fma_f32 v36, v36, v32, v33
v_fma_f32 v37, v37, v32, v33
v_fma_f32 v38, v38, v32, v33
v_fma_f32 v39, v39, v32, v33
M3 a[32:47],a[232:235],v[104:107],a[32:47]
v_fma_f32 v88, v88, v32, v33
v_fma_f32 v89, v89, v32, v33
CV v108,v34,v35
CV v109,v36,v37
CV v110,v38,v39
BL v11,s[12:15],s60 offen offset:1024 lds
M3 a[48:63],a[236:239],v[104:107],a[48:63]
s_waitcnt vmcnt(6) lgkmcnt(0)
s_barrier
TR a[224:225],v2 offset:5120
TR a[226:227],v2 offset:5632
TR a[228:229],v4 offset:5120
TR a[230:231],v4 offset:5632
CV v111,v88,v89
v_lshlrev_b32 v34, 16, v112
v_and_b32 v35, s52, v112
v_lshlrev_b32 v36, 16, v113
v_and_b32 v37, s52, v113
M3 a[0:15],a[240:243],v[108:111],a[0:15]
TR a[232:233],v6 offset:5120
TR a[234:235],v6 offset:5632
TR a[236:237],v8 offset:5120
TR a[238:239],v8 offset:5632
v_lshlrev_b32 v38, 16, v114
v_and_b32 v39, s52, v114
v_lshlrev_b32 v88, 16, v115
v_and_b32 v89, s52, v115
v_fma_f32 v34, v34, v32, v33
BL v12,s[16:19],s60 offen offset:2048 lds
M3 a[16:31],a[244:247],v[108:111],a[16:31]
TR a[240:241],v2 offset:46080
TR a[242:243],v2 offset:46592
v_fma_f32 v35, v35, v32, v33
v_fma_f32 v36, v36, v32, v33
v_fma_f32 v37, v37, v32, v33
v_fma_f32 v38, v38, v32, v33
v_fma_f32 v39, v39, v32, v33
M3 a[32:47],a[248:251],v[108:111],a[32:47]
TR a[244:245],v4 offset:46080
TR a[246:247],v4 offset:46592
v_fma_f32 v88, v88, v32, v33
v_fma_f32 v89, v89, v32, v33
CV v112,v34,v35
CV v113,v36,v37
CV v114,v38,v39
BL v13,s[16:19],s60 offen offset:3072 lds
M3 a[48:63],a[252:255],v[108:111],a[48:63]
TR a[248:249],v6 offset:46080
TR a[250:251],v6 offset:46592
CV v115,v88,v89
v_lshlrev_b32 v34, 16, v116
v_and_b32 v35, s52, v116
v_lshlrev_b32 v36, 16, v117
v_and_b32 v37, s52, v117
s_waitcnt lgkmcnt(6)
M3 a[0:15],a[224:227],v[112:115],a[0:15]
TR a[252:253],v8 offset:46080
TR a[254:255],v8 offset:46592
v_lshlrev_b32 v38, 16, v118
v_and_b32 v39, s52, v118
v_lshlrev_b32 v88, 16, v119
v_and_b32 v89, s52, v119
v_fma_f32 v34, v34, v32, v33
s_add_u32 m0, s6, 20480
s_bfe_u32 s60, s58, 0x40010
s_mul_i32 s60, s60, 221184
s_add_u32 s60, s60, s40
BL v10,s[12:15],s60 offen lds
M3 a[16:31],a[228:231],v[112:115],a[16:31]
TR a[224:225],v3 offset:5120
TR a[226:227],v3 offset:5632
v_fma_f32 v35, v35, v32, v33
v_fma_f32 v36, v36, v32, v33
v_fma_f32 v37, v37, v32, v33
v_fma_f32 v38, v38, v32, v33
v_fma_f32 v39, v39, v32, v33
M3 a[32:47],a[232:235],v[112:115],a[32:47]
TR a[228:229],v5 offset:5120
TR a[230:231],v5 offset:5632
v_fma_f32 v88, v88, v32, v33
v_fma_f32 v89, v89, v32, v33
CV v116,v34,v35
CV v117,v36,v37
CV v118,v38,v39
BL v11,s[12:15],s60 offen offset:1024 lds
M3 a[48:63],a[236:239],v[112:115],a[48:63]
TR a[232:233],v7 offset:5120
TR a[234:235],v7 offset:5632
CV v119,v88,v89
v_lshlrev_b32 v34, 16, v120
v_and_b32 v35, s52, v120
v_lshlrev_b32 v36, 16, v121
v_and_b32 v37, s52, v121
s_waitcnt lgkmcnt(6)
M3 a[0:15],a[240:243],v[116:119],a[0:15]
TR a[236:237],v9 offset:5120
TR a[238:239],v9 offset:5632
v_lshlrev_b32 v38, 16, v122
v_and_b32 v39, s52, v122
v_lshlrev_b32 v88, 16, v123
v_and_b32 v89, s52, v123
v_fma_f32 v34, v34, v32, v33
BL v12,s[16:19],s60 offen offset:2048 lds
M3 a[16:31],a[244:247],v[116:119],a[16:31]
TR a[240:241],v3 offset:46080
TR a[242:243],v3 offset:46592
v_fma_f32 v35, v35, v32, v33
v_fma_f32 v36, v36, v32, v33
v_fma_f32 v37, v37, v32, v33
v_fma_f32 v38, v38, v32, v33
v_fma_f32 v39, v39, v32, v33
M3 a[32:47],a[248:251],v[116:119],a[32:47]
TR a[244:245],v5 offset:46080
TR a[246:247],v5 offset:46592
v_fma_f32 v88, v88, v32, v33
v_fma_f32 v89, v89, v32, v33
CV v120,v34,v35
CV v121,v36,v37
CV v122,v38,v39
BL v13,s[16:19],s60 offen offset:3072 lds
M3 a[48:63],a[252:255],v[116:119],a[48:63]
TR a[248:249],v7 offset:46080
TR a[250:251],v7 offset:46592
CV v123,v88,v89
v_lshlrev_b32 v34, 16, v124
v_and_b32 v35, s52, v124
v_lshlrev_b32 v36, 16, v125
v_and_b32 v37, s52, v125
s_waitcnt lgkmcnt(6)
M3 a[0:15],a[224:227],v[120:123],a[0:15]
TR a[252:253],v9 offset:46080
TR a[254:255],v9 offset:46592
v_lshlrev_b32 v38, 16, v126
v_and_b32 v39, s52, v126
v_lshlrev_b32 v88, 16, v127
v_and_b32 v89, s52, v127
v_fma_f32 v34, v34, v32, v33
s_add_u32 m0, s6, 0
s_bfe_u32 s60, s58, 0x40014
s_mul_i32 s60, s60, 221184
s_add_u32 s60, s60, s40
BL v10,s[12:15],s60 offen lds
M3 a[16:31],a[228:231],v[120:123],a[16:31]
v_fma_f32 v35, v35, v32, v33
v_fma_f32 v36, v36, v32, v33
v_fma_f32 v37, v37, v32, v33
v_fma_f32 v38, v38, v32, v33
v_fma_f32 v39, v39, v32, v33
M3 a[32:47],a[232:235],v[120:123],a[32:47]
v_fma_f32 v88, v88, v32, v33
v_fma_f32 v89, v89, v32, v33
CV v124,v34,v35
CV v125,v36,v37
CV v126,v38,v39
BL v11,s[12:15],s60 offen offset:1024 lds
M3 a[48:63],a[236:239],v[120:123],a[48:63]
s_waitcnt vmcnt(10) lgkmcnt(0)
s_barrier
TR a[224:225],v2 offset:10240
TR a[226:227],v2 offset:10752
TR a[228:229],v4 offset:10240
TR a[230:231],v4 offset:10752
CV v127,v88,v89
v_lshlrev_b32 v34, 16, v128
v_and_b32 v35, s52, v128
v_lshlrev_b32 v36, 16, v129
v_and_b32 v37, s52, v129
M3 a[0:15],a[240:243],v[124:127],a[0:15]
TR a[232:233],v6 offset:10240
TR a[234:235],v6 offset:10752
TR a[236:237],v8 offset:10240
TR a[238:239],v8 offset:10752
v_lshlrev_b32 v38, 16, v130
v_and_b32 v39, s52, v130
v_lshlrev_b32 v88, 16, v131
v_and_b32 v89, s52, v131
v_fma_f32 v34, v34, v32, v33
BL v12,s[16:19],s60 offen offset:2048 lds
M3 a[16:31],a[244:247],v[124:127],a[16:31]
TR a[240:241],v2 offset:51200
TR a[242:243],v2 offset:51712
v_fma_f32 v35, v35, v32, v33
v_fma_f32 v36, v36, v32, v33
v_fma_f32 v37, v37, v32, v33
v_fma_f32 v38, v38, v32, v33
v_fma_f32 v39, v39, v32, v33
M3 a[32:47],a[248:251],v[124:127],a[32:47]
TR a[244:245],v4 offset:51200
TR a[246:247],v4 offset:51712
v_fma_f32 v88, v88, v32, v33
v_fma_f32 v89, v89, v32, v33
CV v128,v34,v35
CV v129,v36,v37
CV v130,v38,v39
BL v13,s[16:19],s60 offen offset:3072 lds
M3 a[48:63],a[252:255],v[124:127],a[48:63]
TR a[248:249],v6 offset:51200
TR a[250:251],v6 offset:51712
CV v131,v88,v89
v_lshlrev_b32 v34, 16, v132
v_and_b32 v35, s52, v132
v_lshlrev_b32 v36, 16, v133
v_and_b32 v37, s52, v133
s_waitcnt lgkmcnt(6)
M3 a[0:15],a[224:227],v[128:131],a[0:15]
TR a[252:253],v8 offset:51200
TR a[254:255],v8 offset:51712
v_lshlrev_b32 v38, 16, v134
v_and_b32 v39, s52, v134
v_lshlrev_b32 v88, 16, v135
v_and_b32 v89, s52, v135
v_fma_f32 v34, v34, v32, v33
s_add_u32 m0, s6, 5120
s_bfe_u32 s60, s58, 0x40018
s_mul_i32 s60, s60, 221184
s_add_u32 s60, s60, s40
BL v10,s[12:15],s60 offen lds
M3 a[16:31],a[228:231],v[128:131],a[16:31]
TR a[224:225],v3 offset:10240
TR a[226:227],v3 offset:10752
v_fma_f32 v35, v35, v32, v33
v_fma_f32 v36, v36, v32, v33
v_fma_f32 v37, v37, v32, v33
v_fma_f32 v38, v38, v32, v33
v_fma_f32 v39, v39, v32, v33
M3 a[32:47],a[232:235],v[128:131],a[32:47]
TR a[228:229],v5 offset:10240
TR a[230:231],v5 offset:10752
v_fma_f32 v88, v88, v32, v33
v_fma_f32 v89, v89, v32, v33
CV v132,v34,v35
CV v133,v36,v37
CV v134,v38,v39
BL v11,s[12:15],s60 offen offset:1024 lds
M3 a[48:63],a[236:239],v[128:131],a[48:63]
TR a[232:233],v7 offset:10240
TR a[234:235],v7 offset:10752
CV v135,v88,v89
v_lshlrev_b32 v34, 16, v136
v_and_b32 v35, s52, v136
v_lshlrev_b32 v36, 16, v137
v_and_b32 v37, s52, v137
s_waitcnt lgkmcnt(6)
M3 a[0:15],a[240:243],v[132:135],a[0:15]
TR a[236:237],v9 offset:10240
TR a[238:239],v9 offset:10752
v_lshlrev_b32 v38, 16, v138
v_and_b32 v39, s52, v138
v_lshlrev_b32 v88, 16, v139
v_and_b32 v89, s52, v139
v_fma_f32 v34, v34, v32, v33
BL v12,s[16:19],s60 offen offset:2048 lds
M3 a[16:31],a[244:247],v[132:135],a[16:31]
TR a[240:241],v3 offset:51200
TR a[242:243],v3 offset:51712
v_fma_f32 v35, v35, v32, v33
v_fma_f32 v36, v36, v32, v33
v_fma_f32 v37, v37, v32, v33
v_fma_f32 v38, v38, v32, v33
v_fma_f32 v39, v39, v32, v33
M3 a[32:47],a[248:251],v[132:135],a[32:47]
TR a[244:245],v5 offset:51200
TR a[246:247],v5 offset:51712
v_fma_f32 v88, v88, v32, v33
v_fma_f32 v89, v89, v32, v33
CV v136,v34,v35
CV v137,v36,v37
CV v138,v38,v39
BL v13,s[16:19],s60 offen offset:3072 lds
M3 a[48:63],a[252:255],v[132:135],a[48:63]
TR a[248:249],v7 offset:51200
TR a[250:251],v7 offset:51712
CV v139,v88,v89
v_lshlrev_b32 v34, 16, v140
v_and_b32 v35, s52, v140
v_lshlrev_b32 v36, 16, v141
v_and_b32 v37, s52, v141
s_waitcnt lgkmcnt(6)
M3 a[0:15],a[224:227],v[136:139],a[0:15]
TR a[252:253],v9 offset:51200
TR a[254:255],v9 offset:51712
v_lshlrev_b32 v38, 16, v142
v_and_b32 v39, s52, v142
v_lshlrev_b32 v88, 16, v143
v_and_b32 v89, s52, v143
v_fma_f32 v34, v34, v32, v33
M3 a[16:31],a[228:231],v[136:139],a[16:31]
v_fma_f32 v35, v35, v32, v33
v_fma_f32 v36, v36, v32, v33
v_fma_f32 v37, v37, v32, v33
v_fma_f32 v38, v38, v32, v33
v_fma_f32 v39, v39, v32, v33
M3 a[32:47],a[232:235],v[136:139],a[32:47]
v_fma_f32 v88, v88, v32, v33
v_fma_f32 v89, v89, v32, v33
CV v140,v34,v35
CV v141,v36,v37
CV v142,v38,v39
M3 a[48:63],a[236:239],v[136:139],a[48:63]
s_waitcnt vmcnt(12) lgkmcnt(0)
s_barrier
TR a[224:225],v2 offset:15360
TR a[226:227],v2 offset:15872
TR a[228:229],v4 offset:15360
TR a[230:231],v4 offset:15872
CV v143,v88,v89
v_lshlrev_b32 v34, 16, v144
v_and_b32 v35, s52, v144
v_lshlrev_b32 v36, 16, v145
v_and_b32 v37, s52, v145
M3 a[0:15],a[240:243],v[140:143],a[0:15]
TR a[232:233],v6 offset:15360
TR a[234:235],v6 offset:15872
TR a[236:237],v8 offset:15360
TR a[238:239],v8 offset:15872
v_lshlrev_b32 v38, 16, v146
v_and_b32 v39, s52, v146
v_lshlrev_b32 v88, 16, v147
v_and_b32 v89, s52, v147
v_fma_f32 v34, v34, v32, v33
s_add_u32 m0, s6, 10240
s_bfe_u32 s60, s58, 0x4001c
s_mul_i32 s60, s60, 221184
s_add_u32 s60, s60, s40
BL v10,s[12:15],s60 offen lds
M3 a[16:31],a[244:247],v[140:143],a[16:31]
TR a[240:241],v2 offset:56320
TR a[242:243],v2 offset:56832
v_fma_f32 v35, v35, v32, v33
v_fma_f32 v36, v36, v32, v33
v_fma_f32 v37, v37, v32, v33
v_fma_f32 v38, v38, v32, v33
v_fma_f32 v39, v39, v32, v33
M3 a[32:47],a[248:251],v[140:143],a[32:47]
TR a[244:245],v4 offset:56320
TR a[246:247],v4 offset:56832
v_fma_f32 v88, v88, v32, v33
v_fma_f32 v89, v89, v32, v33
CV v144,v34,v35
CV v145,v36,v37
CV v146,v38,v39
BL v11,s[12:15],s60 offen offset:1024 lds
M3 a[48:63],a[252:255],v[140:143],a[48:63]
TR a[248:249],v6 offset:56320
TR a[250:251],v6 offset:56832
CV v147,v88,v89
v_lshlrev_b32 v34, 16, v148
v_and_b32 v35, s52, v148
v_lshlrev_b32 v36, 16, v149
v_and_b32 v37, s52, v149
s_waitcnt lgkmcnt(6)
M3 a[0:15],a[224:227],v[144:147],a[0:15]
TR a[252:253],v8 offset:56320
TR a[254:255],v8 offset:56832
v_lshlrev_b32 v38, 16, v150
v_and_b32 v39, s52, v150
v_lshlrev_b32 v88, 16, v151
v_and_b32 v89, s52, v151
v_fma_f32 v34, v34, v32, v33
BL v12,s[16:19],s60 offen offset:2048 lds
M3 a[16:31],a[228:231],v[144:147],a[16:31]
TR a[224:225],v3 offset:15360
TR a[226:227],v3 offset:15872
v_fma_f32 v35, v35, v32, v33
v_fma_f32 v36, v36, v32, v33
v_fma_f32 v37, v37, v32, v33
v_fma_f32 v38, v38, v32, v33
v_fma_f32 v39, v39, v32, v33
M3 a[32:47],a[232:235],v[144:147],a[32:47]
TR a[228:229],v5 offset:15360
TR a[230:231],v5 offset:15872
v_fma_f32 v88, v88, v32, v33
v_fma_f32 v89, v89, v32, v33
CV v148,v34,v35
CV v149,v36,v37
CV v150,v38,v39
BL v13,s[16:19],s60 offen offset:3072 lds
M3 a[48:63],a[236:239],v[144:147],a[48:63]
TR a[232:233],v7 offset:15360
TR a[234:235],v7 offset:15872
CV v151,v88,v89
v_lshlrev_b32 v34, 16, v152
v_and_b32 v35, s52, v152
v_lshlrev_b32 v36, 16, v153
v_and_b32 v37, s52, v153
s_waitcnt lgkmcnt(6)
M3 a[0:15],a[240:243],v[148:151],a[0:15]
TR a[236:237],v9 offset:15360
TR a[238:239],v9 offset:15872
v_lshlrev_b32 v38, 16, v154
v_and_b32 v39, s52, v154
v_lshlrev_b32 v88, 16, v155
v_and_b32 v89, s52, v155
v_fma_f32 v34, v34, v32, v33
M3 a[16:31],a[244:247],v[148:151],a[16:31]
TR a[240:241],v3 offset:56320
TR a[242:243],v3 offset:56832
v_fma_f32 v35, v35, v32, v33
v_fma_f32 v36, v36, v32, v33
v_fma_f32 v37, v37, v32, v33
v_fma_f32 v38, v38, v32, v33
v_fma_f32 v39, v39, v32, v33
M3 a[32:47],a[248:251],v[148:151],a[32:47]
TR a[244:245],v5 offset:56320
TR a[246:247],v5 offset:56832
v_fma_f32 v88, v88, v32, v33
v_fma_f32 v89, v89, v32, v33
CV v152,v34,v35
CV v153,v36,v37
CV v154,v38,v39
M3 a[48:63],a[252:255],v[148:151],a[48:63]
TR a[248:249],v7 offset:56320
TR a[250:251],v7 offset:56832
CV v155,v88,v89
v_lshlrev_b32 v34, 16, v156
v_and_b32 v35, s52, v156
v_lshlrev_b32 v36, 16, v157
v_and_b32 v37, s52, v157
s_waitcnt lgkmcnt(6)
M3 a[0:15],a[224:227],v[152:155],a[0:15]
TR a[252:253],v9 offset:56320
TR a[254:255],v9 offset:56832
v_lshlrev_b32 v38, 16, v158
v_and_b32 v39, s52, v158
v_lshlrev_b32 v88, 16, v159
v_and_b32 v89, s52, v159
v_fma_f32 v34, v34, v32, v33
M3 a[16:31],a[228:231],v[152:155],a[16:31]
v_fma_f32 v35, v35, v32, v33
v_fma_f32 v36, v36, v32, v33
v_fma_f32 v37, v37, v32, v33
v_fma_f32 v38, v38, v32, v33
v_fma_f32 v39, v39, v32, v33
M3 a[32:47],a[232:235],v[152:155],a[32:47]
v_fma_f32 v88, v88, v32, v33
v_fma_f32 v89, v89, v32, v33
CV v156,v34,v35
CV v157,v36,v37
CV v158,v38,v39
M3 a[48:63],a[236:239],v[152:155],a[48:63]
s_waitcnt vmcnt(12) lgkmcnt(0)
s_barrier
TR a[224:225],v2 offset:20480
TR a[226:227],v2 offset:20992
TR a[228:229],v4 offset:20480
TR a[230:231],v4 offset:20992
CV v159,v88,v89
v_lshlrev_b32 v34, 16, v160
v_and_b32 v35, s52, v160
v_lshlrev_b32 v36, 16, v161
v_and_b32 v37, s52, v161
M3 a[0:15],a[240:243],v[156:159],a[0:15]
TR a[232:233],v6 offset:20480
TR a[234:235],v6 offset:20992
TR a[236:237],v8 offset:20480
TR a[238:239],v8 offset:20992
v_lshlrev_b32 v38, 16, v162
v_and_b32 v39, s52, v162
v_lshlrev_b32 v88, 16, v163
v_and_b32 v89, s52, v163
v_fma_f32 v34, v34, v32, v33
s_add_u32 m0, s6, 15360
s_bfe_u32 s60, s59, 0x40000
s_mul_i32 s60, s60, 221184
s_add_u32 s60, s60, s40
BL v10,s[12:15],s60 offen lds
M3 a[16:31],a[244:247],v[156:159],a[16:31]
TR a[240:241],v2 offset:61440
TR a[242:243],v2 offset:61952
v_fma_f32 v35, v35, v32, v33
v_fma_f32 v36, v36, v32, v33
v_fma_f32 v37, v37, v32, v33
v_fma_f32 v38, v38, v32, v33
v_fma_f32 v39, v39, v32, v33
M3 a[32:47],a[248:251],v[156:159],a[32:47]
TR a[244:245],v4 offset:61440
TR a[246:247],v4 offset:61952
v_fma_f32 v88, v88, v32, v33
v_fma_f32 v89, v89, v32, v33
CV v160,v34,v35
CV v161,v36,v37
CV v162,v38,v39
BL v11,s[12:15],s60 offen offset:1024 lds
M3 a[48:63],a[252:255],v[156:159],a[48:63]
TR a[248:249],v6 offset:61440
TR a[250:251],v6 offset:61952
CV v163,v88,v89
v_lshlrev_b32 v34, 16, v164
v_and_b32 v35, s52, v164
v_lshlrev_b32 v36, 16, v165
v_and_b32 v37, s52, v165
s_waitcnt lgkmcnt(6)
M3 a[0:15],a[224:227],v[160:163],a[0:15]
TR a[252:253],v8 offset:61440
TR a[254:255],v8 offset:61952
v_lshlrev_b32 v38, 16, v166
v_and_b32 v39, s52, v166
v_lshlrev_b32 v88, 16, v167
v_and_b32 v89, s52, v167
v_fma_f32 v34, v34, v32, v33
BL v12,s[16:19],s60 offen offset:2048 lds
M3 a[16:31],a[228:231],v[160:163],a[16:31]
TR a[224:225],v3 offset:20480
TR a[226:227],v3 offset:20992
v_fma_f32 v35, v35, v32, v33
v_fma_f32 v36, v36, v32, v33
v_fma_f32 v37, v37, v32, v33
v_fma_f32 v38, v38, v32, v33
v_fma_f32 v39, v39, v32, v33
M3 a[32:47],a[232:235],v[160:163],a[32:47]
TR a[228:229],v5 offset:20480
TR a[230:231],v5 offset:20992
v_fma_f32 v88, v88, v32, v33
v_fma_f32 v89, v89, v32, v33
CV v164,v34,v35
CV v165,v36,v37
CV v166,v38,v39
BL v13,s[16:19],s60 offen offset:3072 lds
M3 a[48:63],a[236:239],v[160:163],a[48:63]
TR a[232:233],v7 offset:20480
TR a[234:235],v7 offset:20992
CV v167,v88,v89
v_lshlrev_b32 v34, 16, v168
v_and_b32 v35, s52, v168
v_lshlrev_b32 v36, 16, v169
v_and_b32 v37, s52, v169
s_waitcnt lgkmcnt(6)
M3 a[0:15],a[240:243],v[164:167],a[0:15]
TR a[236:237],v9 offset:20480
TR a[238:239],v9 offset:20992
v_lshlrev_b32 v38, 16, v170
v_and_b32 v39, s52, v170
v_lshlrev_b32 v88, 16, v171
v_and_b32 v89, s52, v171
v_fma_f32 v34, v34, v32, v33
M3 a[16:31],a[244:247],v[164:167],a[16:31]
TR a[240:241],v3 offset:61440
TR a[242:243],v3 offset:61952
v_fma_f32 v35, v35, v32, v33
v_fma_f32 v36, v36, v32, v33
v_fma_f32 v37, v37, v32, v33
v_fma_f32 v38, v38, v32, v33
v_fma_f32 v39, v39, v32, v33
M3 a[32:47],a[248:251],v[164:167],a[32:47]
TR a[244:245],v5 offset:61440
TR a[246:247],v5 offset:61952
v_fma_f32 v88, v88, v32, v33
v_fma_f32 v89, v89, v32, v33
CV v168,v34,v35
CV v169,v36,v37
CV v170,v38,v39
M3 a[48:63],a[252:255],v[164:167],a[48:63]
TR a[248:249],v7 offset:61440
TR a[250:251],v7 offset:61952
CV v171,v88,v89
v_lshlrev_b32 v34, 16, v172
v_and_b32 v35, s52, v172
v_lshlrev_b32 v36, 16, v173
v_and_b32 v37, s52, v173
s_waitcnt lgkmcnt(6)
M3 a[0:15],a[224:227],v[168:171],a[0:15]
TR a[252:253],v9 offset:61440
TR a[254:255],v9 offset:61952
v_lshlrev_b32 v38, 16, v174
v_and_b32 v39, s52, v174
v_lshlrev_b32 v88, 16, v175
v_and_b32 v89, s52, v175
v_fma_f32 v34, v34, v32, v33
M3 a[16:31],a[228:231],v[168:171],a[16:31]
v_fma_f32 v35, v35, v32, v33
v_fma_f32 v36, v36, v32, v33
v_fma_f32 v37, v37, v32, v33
v_fma_f32 v38, v38, v32, v33
v_fma_f32 v39, v39, v32, v33
M3 a[32:47],a[232:235],v[168:171],a[32:47]
v_fma_f32 v88, v88, v32, v33
v_fma_f32 v89, v89, v32, v33
CV v172,v34,v35
CV v173,v36,v37
CV v174,v38,v39
M3 a[48:63],a[236:239],v[168:171],a[48:63]
s_waitcnt vmcnt(12) lgkmcnt(0)
s_barrier
TR a[224:225],v2
TR a[226:227],v2 offset:512
TR a[228:229],v4
TR a[230:231],v4 offset:512
CV v175,v88,v89
v_lshlrev_b32 v34, 16, v176
v_and_b32 v35, s52, v176
v_lshlrev_b32 v36, 16, v177
v_and_b32 v37, s52, v177
M3 a[0:15],a[240:243],v[172:175],a[0:15]
TR a[232:233],v6
TR a[234:235],v6 offset:512
TR a[236:237],v8
TR a[238:239],v8 offset:512
v_lshlrev_b32 v38, 16, v178
v_and_b32 v39, s52, v178
v_lshlrev_b32 v88, 16, v179
v_and_b32 v89, s52, v179
v_fma_f32 v34, v34, v32, v33
s_add_u32 m0, s6, 20480
s_bfe_u32 s60, s59, 0x40004
s_mul_i32 s60, s60, 221184
s_add_u32 s60, s60, s40
BL v10,s[12:15],s60 offen lds
M3 a[16:31],a[244:247],v[172:175],a[16:31]
TR a[240:241],v2 offset:40960
TR a[242:243],v2 offset:41472
v_fma_f32 v35, v35, v32, v33
v_fma_f32 v36, v36, v32, v33
v_fma_f32 v37, v37, v32, v33
v_fma_f32 v38, v38, v32, v33
v_fma_f32 v39, v39, v32, v33
M3 a[32:47],a[248:251],v[172:175],a[32:47]
TR a[244:245],v4 offset:40960
TR a[246:247],v4 offset:41472
v_fma_f32 v88, v88, v32, v33
v_fma_f32 v89, v89, v32, v33
CV v176,v34,v35
CV v177,v36,v37
CV v178,v38,v39
BL v11,s[12:15],s60 offen offset:1024 lds
M3 a[48:63],a[252:255],v[172:175],a[48:63]
TR a[248:249],v6 offset:40960
TR a[250:251],v6 offset:41472
CV v179,v88,v89
v_lshlrev_b32 v34, 16, v180
v_and_b32 v35, s52, v180
v_lshlrev_b32 v36, 16, v181
v_and_b32 v37, s52, v181
s_waitcnt lgkmcnt(6)
M3 a[0:15],a[224:227],v[176:179],a[0:15]
TR a[252:253],v8 offset:40960
TR a[254:255],v8 offset:41472
v_lshlrev_b32 v38, 16, v182
v_and_b32 v39, s52, v182
v_lshlrev_b32 v88, 16, v183
v_and_b32 v89, s52, v183
v_fma_f32 v34, v34, v32, v33
BL v12,s[16:19],s60 offen offset:2048 lds
M3 a[16:31],a[228:231],v[176:179],a[16:31]
TR a[224:225],v3
TR a[226:227],v3 offset:512
v_fma_f32 v35, v35, v32, v33
v_fma_f32 v36, v36, v32, v33
v_fma_f32 v37, v37, v32, v33
v_fma_f32 v38, v38, v32, v33
v_fma_f32 v39, v39, v32, v33
M3 a[32:47],a[232:235],v[176:179],a[32:47]
TR a[228:229],v5
TR a[230:231],v5 offset:512
v_fma_f32 v88, v88, v32, v33
v_fma_f32 v89, v89, v32, v33
CV v180,v34,v35
CV v181,v36,v37
CV v182,v38,v39
BL v13,s[16:19],s60 offen offset:3072 lds
M3 a[48:63],a[236:239],v[176:179],a[48:63]
TR a[232:233],v7
TR a[234:235],v7 offset:512
CV v183,v88,v89
v_lshlrev_b32 v34, 16, v184
v_and_b32 v35, s52, v184
v_lshlrev_b32 v36, 16, v185
v_and_b32 v37, s52, v185
s_waitcnt lgkmcnt(6)
M3 a[0:15],a[240:243],v[180:183],a[0:15]
TR a[236:237],v9
TR a[238:239],v9 offset:512
v_lshlrev_b32 v38, 16, v186
v_and_b32 v39, s52, v186
v_lshlrev_b32 v88, 16, v187
v_and_b32 v89, s52, v187
v_fma_f32 v34, v34, v32, v33
M3 a[16:31],a[244:247],v[180:183],a[16:31]
TR a[240:241],v3 offset:40960
TR a[242:243],v3 offset:41472
v_fma_f32 v35, v35, v32, v33
v_fma_f32 v36, v36, v32, v33
v_fma_f32 v37, v37, v32, v33
v_fma_f32 v38, v38, v32, v33
v_fma_f32 v39, v39, v32, v33
M3 a[32:47],a[248:251],v[180:183],a[32:47]
TR a[244:245],v5 offset:40960
TR a[246:247],v5 offset:41472
v_fma_f32 v88, v88, v32, v33
v_fma_f32 v89, v89, v32, v33
CV v184,v34,v35
CV v185,v36,v37
CV v186,v38,v39
M3 a[48:63],a[252:255],v[180:183],a[48:63]
TR a[248:249],v7 offset:40960
TR a[250:251],v7 offset:41472
CV v187,v88,v89
v_lshlrev_b32 v34, 16, v188
v_and_b32 v35, s52, v188
v_lshlrev_b32 v36, 16, v189
v_and_b32 v37, s52, v189
s_waitcnt lgkmcnt(6)
M3 a[0:15],a[224:227],v[184:187],a[0:15]
TR a[252:253],v9 offset:40960
TR a[254:255],v9 offset:41472
v_lshlrev_b32 v38, 16, v190
v_and_b32 v39, s52, v190
v_lshlrev_b32 v88, 16, v191
v_and_b32 v89, s52, v191
v_fma_f32 v34, v34, v32, v33
M3 a[16:31],a[228:231],v[184:187],a[16:31]
v_fma_f32 v35, v35, v32, v33
v_fma_f32 v36, v36, v32, v33
v_fma_f32 v37, v37, v32, v33
v_fma_f32 v38, v38, v32, v33
v_fma_f32 v39, v39, v32, v33
M3 a[32:47],a[232:235],v[184:187],a[32:47]
v_fma_f32 v88, v88, v32, v33
v_fma_f32 v89, v89, v32, v33
CV v188,v34,v35
CV v189,v36,v37
CV v190,v38,v39
M3 a[48:63],a[236:239],v[184:187],a[48:63]
s_waitcnt vmcnt(12) lgkmcnt(0)
s_barrier
TR a[224:225],v2 offset:5120
TR a[226:227],v2 offset:5632
TR a[228:229],v4 offset:5120
TR a[230:231],v4 offset:5632
CV v191,v88,v89
v_lshlrev_b32 v34, 16, v192
v_and_b32 v35, s52, v192
v_lshlrev_b32 v36, 16, v193
v_and_b32 v37, s52, v193
M3 a[0:15],a[240:243],v[188:191],a[0:15]
TR a[232:233],v6 offset:5120
TR a[234:235],v6 offset:5632
TR a[236:237],v8 offset:5120
TR a[238:239],v8 offset:5632
v_lshlrev_b32 v38, 16, v194
v_and_b32 v39, s52, v194
v_lshlrev_b32 v88, 16, v195
v_and_b32 v89, s52, v195
v_fma_f32 v34, v34, v32, v33
s_add_u32 m0, s6, 0
s_bfe_u32 s60, s58, 0x40000
s_mul_i32 s60, s60, 221184
s_add_u32 s60, s60, s41
BL v10,s[12:15],s60 offen lds
M3 a[16:31],a[244:247],v[188:191],a[16:31]
TR a[240:241],v2 offset:46080
TR a[242:243],v2 offset:46592
v_fma_f32 v35, v35, v32, v33
v_fma_f32 v36, v36, v32, v33
v_fma_f32 v37, v37, v32, v33
v_fma_f32 v38, v38, v32, v33
v_fma_f32 v39, v39, v32, v33
M3 a[32:47],a[248:251],v[188:191],a[32:47]
TR a[244:245],v4 offset:46080
TR a[246:247],v4 offset:46592
v_fma_f32 v88, v88, v32, v33
v_fma_f32 v89, v89, v32, v33
CV v192,v34,v35
CV v193,v36,v37
CV v194,v38,v39
BL v11,s[12:15],s60 offen offset:1024 lds
M3 a[48:63],a[252:255],v[188:191],a[48:63]
TR a[248:249],v6 offset:46080
TR a[250:251],v6 offset:46592
CV v195,v88,v89
v_lshlrev_b32 v34, 16, v196
v_and_b32 v35, s52, v196
v_lshlrev_b32 v36, 16, v197
v_and_b32 v37, s52, v197
s_waitcnt lgkmcnt(6)
M3 a[0:15],a[224:227],v[192:195],a[0:15]
TR a[252:253],v8 offset:46080
TR a[254:255],v8 offset:46592
v_lshlrev_b32 v38, 16, v198
v_and_b32 v39, s52, v198
v_lshlrev_b32 v88, 16, v199
v_and_b32 v89, s52, v199
v_fma_f32 v34, v34, v32, v33
BL v12,s[16:19],s60 offen offset:2048 lds
M3 a[16:31],a[228:231],v[192:195],a[16:31]
TR a[224:225],v3 offset:5120
TR a[226:227],v3 offset:5632
v_fma_f32 v35, v35, v32, v33
v_fma_f32 v36, v36, v32, v33
v_fma_f32 v37, v37, v32, v33
v_fma_f32 v38, v38, v32, v33
v_fma_f32 v39, v39, v32, v33
M3 a[32:47],a[232:235],v[192:195],a[32:47]
TR a[228:229],v5 offset:5120
TR a[230:231],v5 offset:5632
v_fma_f32 v88, v88, v32, v33
v_fma_f32 v89, v89, v32, v33
CV v196,v34,v35
CV v197,v36,v37
CV v198,v38,v39
BL v13,s[16:19],s60 offen offset:3072 lds
M3 a[48:63],a[236:239],v[192:195],a[48:63]
TR a[232:233],v7 offset:5120
TR a[234:235],v7 offset:5632
CV v199,v88,v89
v_lshlrev_b32 v34, 16, v200
v_and_b32 v35, s52, v200
v_lshlrev_b32 v36, 16, v201
v_and_b32 v37, s52, v201
s_waitcnt lgkmcnt(6)
M3 a[0:15],a[240:243],v[196:199],a[0:15]
TR a[236:237],v9 offset:5120
TR a[238:239],v9 offset:5632
v_lshlrev_b32 v38, 16, v202
v_and_b32 v39, s52, v202
v_lshlrev_b32 v88, 16, v203
v_and_b32 v89, s52, v203
v_fma_f32 v34, v34, v32, v33
M3 a[16:31],a[244:247],v[196:199],a[16:31]
TR a[240:241],v3 offset:46080
TR a[242:243],v3 offset:46592
v_fma_f32 v35, v35, v32, v33
v_fma_f32 v36, v36, v32, v33
v_fma_f32 v37, v37, v32, v33
v_fma_f32 v38, v38, v32, v33
v_fma_f32 v39, v39, v32, v33
M3 a[32:47],a[248:251],v[196:199],a[32:47]
TR a[244:245],v5 offset:46080
TR a[246:247],v5 offset:46592
v_fma_f32 v88, v88, v32, v33
v_fma_f32 v89, v89, v32, v33
CV v200,v34,v35
CV v201,v36,v37
CV v202,v38,v39
M3 a[48:63],a[252:255],v[196:199],a[48:63]
TR a[248:249],v7 offset:46080
TR a[250:251],v7 offset:46592
CV v203,v88,v89
v_lshlrev_b32 v34, 16, v204
v_and_b32 v35, s52, v204
v_lshlrev_b32 v36, 16, v205
v_and_b32 v37, s52, v205
s_waitcnt lgkmcnt(6)
M3 a[0:15],a[224:227],v[200:203],a[0:15]
TR a[252:253],v9 offset:46080
TR a[254:255],v9 offset:46592
v_lshlrev_b32 v38, 16, v206
v_and_b32 v39, s52, v206
v_lshlrev_b32 v88, 16, v207
v_and_b32 v89, s52, v207
v_fma_f32 v34, v34, v32, v33
M3 a[16:31],a[228:231],v[200:203],a[16:31]
v_fma_f32 v35, v35, v32, v33
v_fma_f32 v36, v36, v32, v33
v_fma_f32 v37, v37, v32, v33
v_fma_f32 v38, v38, v32, v33
v_fma_f32 v39, v39, v32, v33
M3 a[32:47],a[232:235],v[200:203],a[32:47]
v_fma_f32 v88, v88, v32, v33
v_fma_f32 v89, v89, v32, v33
CV v204,v34,v35
CV v205,v36,v37
CV v206,v38,v39
M3 a[48:63],a[236:239],v[200:203],a[48:63]
s_waitcnt vmcnt(12) lgkmcnt(0)
s_barrier
TR a[224:225],v2 offset:10240
TR a[226:227],v2 offset:10752
TR a[228:229],v4 offset:10240
TR a[230:231],v4 offset:10752
CV v207,v88,v89
v_lshlrev_b32 v34, 16, v208
v_and_b32 v35, s52, v208
v_lshlrev_b32 v36, 16, v209
v_and_b32 v37, s52, v209
M3 a[0:15],a[240:243],v[204:207],a[0:15]
TR a[232:233],v6 offset:10240
TR a[234:235],v6 offset:10752
TR a[236:237],v8 offset:10240
TR a[238:239],v8 offset:10752
v_lshlrev_b32 v38, 16, v210
v_and_b32 v39, s52, v210
v_lshlrev_b32 v88, 16, v211
v_and_b32 v89, s52, v211
v_fma_f32 v34, v34, v32, v33
s_add_u32 m0, s6, 5120
s_bfe_u32 s60, s58, 0x40004
s_mul_i32 s60, s60, 221184
s_add_u32 s60, s60, s41
BL v10,s[12:15],s60 offen lds
M3 a[16:31],a[244:247],v[204:207],a[16:31]
TR a[240:241],v2 offset:51200
TR a[242:243],v2 offset:51712
v_fma_f32 v35, v35, v32, v33
v_fma_f32 v36, v36, v32, v33
v_fma_f32 v37, v37, v32, v33
v_fma_f32 v38, v38, v32, v33
v_fma_f32 v39, v39, v32, v33
M3 a[32:47],a[248:251],v[204:207],a[32:47]
TR a[244:245],v4 offset:51200
TR a[246:247],v4 offset:51712
v_fma_f32 v88, v88, v32, v33
v_fma_f32 v89, v89, v32, v33
CV v208,v34,v35
CV v209,v36,v37
CV v210,v38,v39
BL v11,s[12:15],s60 offen offset:1024 lds
M3 a[48:63],a[252:255],v[204:207],a[48:63]
TR a[248:249],v6 offset:51200
TR a[250:251],v6 offset:51712
CV v211,v88,v89
v_lshlrev_b32 v34, 16, v212
v_and_b32 v35, s52, v212
v_lshlrev_b32 v36, 16, v213
v_and_b32 v37, s52, v213
s_waitcnt lgkmcnt(6)
M3 a[0:15],a[224:227],v[208:211],a[0:15]
TR a[252:253],v8 offset:51200
TR a[254:255],v8 offset:51712
v_lshlrev_b32 v38, 16, v214
v_and_b32 v39, s52, v214
v_lshlrev_b32 v88, 16, v215
v_and_b32 v89, s52, v215
v_fma_f32 v34, v34, v32, v33
BL v12,s[16:19],s60 offen offset:2048 lds
M3 a[16:31],a[228:231],v[208:211],a[16:31]
TR a[224:225],v3 offset:10240
TR a[226:227],v3 offset:10752
v_fma_f32 v35, v35, v32, v33
v_fma_f32 v36, v36, v32, v33
v_fma_f32 v37, v37, v32, v33
v_fma_f32 v38, v38, v32, v33
v_fma_f32 v39, v39, v32, v33
M3 a[32:47],a[232:235],v[208:211],a[32:47]
TR a[228:229],v5 offset:10240
TR a[230:231],v5 offset:10752
v_fma_f32 v88, v88, v32, v33
v_fma_f32 v89, v89, v32, v33
CV v212,v34,v35
CV v213,v36,v37
CV v214,v38,v39
BL v13,s[16:19],s60 offen offset:3072 lds
M3 a[48:63],a[236:239],v[208:211],a[48:63]
TR a[232:233],v7 offset:10240
TR a[234:235],v7 offset:10752
CV v215,v88,v89
v_lshlrev_b32 v34, 16, v216
v_and_b32 v35, s52, v216
v_lshlrev_b32 v36, 16, v217
v_and_b32 v37, s52, v217
s_waitcnt lgkmcnt(6)
M3 a[0:15],a[240:243],v[212:215],a[0:15]
TR a[236:237],v9 offset:10240
TR a[238:239],v9 offset:10752
v_lshlrev_b32 v38, 16, v218
v_and_b32 v39, s52, v218
v_lshlrev_b32 v88, 16, v219
v_and_b32 v89, s52, v219
v_fma_f32 v34, v34, v32, v33
M3 a[16:31],a[244:247],v[212:215],a[16:31]
TR a[240:241],v3 offset:51200
TR a[242:243],v3 offset:51712
v_fma_f32 v35, v35, v32, v33
v_fma_f32 v36, v36, v32, v33
v_fma_f32 v37, v37, v32, v33
v_fma_f32 v38, v38, v32, v33
v_fma_f32 v39, v39, v32, v33
M3 a[32:47],a[248:251],v[212:215],a[32:47]
TR a[244:245],v5 offset:51200
TR a[246:247],v5 offset:51712
v_fma_f32 v88, v88, v32, v33
v_fma_f32 v89, v89, v32, v33
CV v216,v34,v35
CV v217,v36,v37
CV v218,v38,v39
M3 a[48:63],a[252:255],v[212:215],a[48:63]
TR a[248:249],v7 offset:51200
TR a[250:251],v7 offset:51712
CV v219,v88,v89
v_lshlrev_b32 v34, 16, v220
v_and_b32 v35, s52, v220
v_lshlrev_b32 v36, 16, v221
v_and_b32 v37, s52, v221
s_waitcnt lgkmcnt(6)
M3 a[0:15],a[224:227],v[216:219],a[0:15]
TR a[252:253],v9 offset:51200
TR a[254:255],v9 offset:51712
v_lshlrev_b32 v38, 16, v222
v_and_b32 v39, s52, v222
v_lshlrev_b32 v88, 16, v223
v_and_b32 v89, s52, v223
v_fma_f32 v34, v34, v32, v33
M3 a[16:31],a[228:231],v[216:219],a[16:31]
v_fma_f32 v35, v35, v32, v33
v_fma_f32 v36, v36, v32, v33
v_fma_f32 v37, v37, v32, v33
v_fma_f32 v38, v38, v32, v33
v_fma_f32 v39, v39, v32, v33
M3 a[32:47],a[232:235],v[216:219],a[32:47]
v_fma_f32 v88, v88, v32, v33
v_fma_f32 v89, v89, v32, v33
CV v220,v34,v35
CV v221,v36,v37
CV v222,v38,v39
M3 a[48:63],a[236:239],v[216:219],a[48:63]
s_waitcnt vmcnt(12) lgkmcnt(0)
s_barrier
TR a[224:225],v2 offset:15360
TR a[226:227],v2 offset:15872
TR a[228:229],v4 offset:15360
TR a[230:231],v4 offset:15872
CV v223,v88,v89
v_lshlrev_b32 v34, 16, v224
v_and_b32 v35, s52, v224
v_lshlrev_b32 v36, 16, v225
v_and_b32 v37, s52, v225
M3 a[0:15],a[240:243],v[220:223],a[0:15]
TR a[232:233],v6 offset:15360
TR a[234:235],v6 offset:15872
TR a[236:237],v8 offset:15360
TR a[238:239],v8 offset:15872
v_lshlrev_b32 v38, 16, v226
v_and_b32 v39, s52, v226
v_lshlrev_b32 v88, 16, v227
v_and_b32 v89, s52, v227
v_fma_f32 v34, v34, v32, v33
s_add_u32 m0, s6, 10240
s_bfe_u32 s60, s58, 0x40008
s_mul_i32 s60, s60, 221184
s_add_u32 s60, s60, s41
BL v10,s[12:15],s60 offen lds
M3 a[16:31],a[244:247],v[220:223],a[16:31]
TR a[240:241],v2 offset:56320
TR a[242:243],v2 offset:56832
v_fma_f32 v35, v35, v32, v33
v_fma_f32 v36, v36, v32, v33
v_fma_f32 v37, v37, v32, v33
v_fma_f32 v38, v38, v32, v33
v_fma_f32 v39, v39, v32, v33
M3 a[32:47],a[248:251],v[220:223],a[32:47]
TR a[244:245],v4 offset:56320
TR a[246:247],v4 offset:56832
v_fma_f32 v88, v88, v32, v33
v_fma_f32 v89, v89, v32, v33
CV v224,v34,v35
CV v225,v36,v37
CV v226,v38,v39
BL v11,s[12:15],s60 offen offset:1024 lds
M3 a[48:63],a[252:255],v[220:223],a[48:63]
TR a[248:249],v6 offset:56320
TR a[250:251],v6 offset:56832
CV v227,v88,v89
v_lshlrev_b32 v34, 16, v228
v_and_b32 v35, s52, v228
v_lshlrev_b32 v36, 16, v229
v_and_b32 v37, s52, v229
s_waitcnt lgkmcnt(6)
M3 a[0:15],a[224:227],v[224:227],a[0:15]
TR a[252:253],v8 offset:56320
TR a[254:255],v8 offset:56832
v_lshlrev_b32 v38, 16, v230
v_and_b32 v39, s52, v230
v_lshlrev_b32 v88, 16, v231
v_and_b32 v89, s52, v231
v_fma_f32 v34, v34, v32, v33
BL v12,s[16:19],s60 offen offset:2048 lds
M3 a[16:31],a[228:231],v[224:227],a[16:31]
TR a[224:225],v3 offset:15360
TR a[226:227],v3 offset:15872
v_fma_f32 v35, v35, v32, v33
v_fma_f32 v36, v36, v32, v33
v_fma_f32 v37, v37, v32, v33
v_fma_f32 v38, v38, v32, v33
v_fma_f32 v39, v39, v32, v33
M3 a[32:47],a[232:235],v[224:227],a[32:47]
TR a[228:229],v5 offset:15360
TR a[230:231],v5 offset:15872
v_fma_f32 v88, v88, v32, v33
v_fma_f32 v89, v89, v32, v33
CV v228,v34,v35
CV v229,v36,v37
CV v230,v38,v39
BL v13,s[16:19],s60 offen offset:3072 lds
M3 a[48:63],a[236:239],v[224:227],a[48:63]
TR a[232:233],v7 offset:15360
TR a[234:235],v7 offset:15872
CV v231,v88,v89
v_lshlrev_b32 v34, 16, v232
v_and_b32 v35, s52, v232
v_lshlrev_b32 v36, 16, v233
v_and_b32 v37, s52, v233
s_waitcnt lgkmcnt(6)
M3 a[0:15],a[240:243],v[228:231],a[0:15]
TR a[236:237],v9 offset:15360
TR a[238:239],v9 offset:15872
v_lshlrev_b32 v38, 16, v234
v_and_b32 v39, s52, v234
v_lshlrev_b32 v88, 16, v235
v_and_b32 v89, s52, v235
v_fma_f32 v34, v34, v32, v33
M3 a[16:31],a[244:247],v[228:231],a[16:31]
TR a[240:241],v3 offset:56320
TR a[242:243],v3 offset:56832
v_fma_f32 v35, v35, v32, v33
v_fma_f32 v36, v36, v32, v33
v_fma_f32 v37, v37, v32, v33
v_fma_f32 v38, v38, v32, v33
v_fma_f32 v39, v39, v32, v33
M3 a[32:47],a[248:251],v[228:231],a[32:47]
TR a[244:245],v5 offset:56320
TR a[246:247],v5 offset:56832
v_fma_f32 v88, v88, v32, v33
v_fma_f32 v89, v89, v32, v33
CV v232,v34,v35
CV v233,v36,v37
CV v234,v38,v39
M3 a[48:63],a[252:255],v[228:231],a[48:63]
TR a[248:249],v7 offset:56320
TR a[250:251],v7 offset:56832
CV v235,v88,v89
v_lshlrev_b32 v34, 16, v236
v_and_b32 v35, s52, v236
v_lshlrev_b32 v36, 16, v237
v_and_b32 v37, s52, v237
s_waitcnt lgkmcnt(6)
M3 a[0:15],a[224:227],v[232:235],a[0:15]
TR a[252:253],v9 offset:56320
TR a[254:255],v9 offset:56832
v_lshlrev_b32 v38, 16, v238
v_and_b32 v39, s52, v238
v_lshlrev_b32 v88, 16, v239
v_and_b32 v89, s52, v239
v_fma_f32 v34, v34, v32, v33
M3 a[16:31],a[228:231],v[232:235],a[16:31]
v_fma_f32 v35, v35, v32, v33
v_fma_f32 v36, v36, v32, v33
v_fma_f32 v37, v37, v32, v33
v_fma_f32 v38, v38, v32, v33
v_fma_f32 v39, v39, v32, v33
M3 a[32:47],a[232:235],v[232:235],a[32:47]
v_fma_f32 v88, v88, v32, v33
v_fma_f32 v89, v89, v32, v33
CV v236,v34,v35
CV v237,v36,v37
CV v238,v38,v39
M3 a[48:63],a[236:239],v[232:235],a[48:63]
s_waitcnt vmcnt(12) lgkmcnt(0)
s_barrier
TR a[224:225],v2 offset:20480
TR a[226:227],v2 offset:20992
TR a[228:229],v4 offset:20480
TR a[230:231],v4 offset:20992
CV v239,v88,v89
v_lshlrev_b32 v34, 16, v240
v_and_b32 v35, s52, v240
v_lshlrev_b32 v36, 16, v241
v_and_b32 v37, s52, v241
M3 a[0:15],a[240:243],v[236:239],a[0:15]
TR a[232:233],v6 offset:20480
TR a[234:235],v6 offset:20992
TR a[236:237],v8 offset:20480
TR a[238:239],v8 offset:20992
v_lshlrev_b32 v38, 16, v242
v_and_b32 v39, s52, v242
v_lshlrev_b32 v88, 16, v243
v_and_b32 v89, s52, v243
v_fma_f32 v34, v34, v32, v33
s_add_u32 m0, s6, 15360
s_bfe_u32 s60, s58, 0x4000c
s_mul_i32 s60, s60, 221184
s_add_u32 s60, s60, s41
BL v10,s[12:15],s60 offen lds
M3 a[16:31],a[244:247],v[236:239],a[16:31]
TR a[240:241],v2 offset:61440
TR a[242:243],v2 offset:61952
v_fma_f32 v35, v35, v32, v33
v_fma_f32 v36, v36, v32, v33
v_fma_f32 v37, v37, v32, v33
v_fma_f32 v38, v38, v32, v33
v_fma_f32 v39, v39, v32, v33
M3 a[32:47],a[248:251],v[236:239],a[32:47]
TR a[244:245],v4 offset:61440
TR a[246:247],v4 offset:61952
v_fma_f32 v88, v88, v32, v33
v_fma_f32 v89, v89, v32, v33
CV v240,v34,v35
CV v241,v36,v37
CV v242,v38,v39
BL v11,s[12:15],s60 offen offset:1024 lds
M3 a[48:63],a[252:255],v[236:239],a[48:63]
TR a[248:249],v6 offset:61440
TR a[250:251],v6 offset:61952
CV v243,v88,v89
v_lshlrev_b32 v34, 16, v244
v_and_b32 v35, s52, v244
v_lshlrev_b32 v36, 16, v245
v_and_b32 v37, s52, v245
s_waitcnt lgkmcnt(6)
M3 a[0:15],a[224:227],v[240:243],a[0:15]
TR a[252:253],v8 offset:61440
TR a[254:255],v8 offset:61952
v_lshlrev_b32 v38, 16, v246
v_and_b32 v39, s52, v246
v_lshlrev_b32 v88, 16, v247
v_and_b32 v89, s52, v247
v_fma_f32 v34, v34, v32, v33
BL v12,s[16:19],s60 offen offset:2048 lds
M3 a[16:31],a[228:231],v[240:243],a[16:31]
TR a[224:225],v3 offset:20480
TR a[226:227],v3 offset:20992
v_fma_f32 v35, v35, v32, v33
v_fma_f32 v36, v36, v32, v33
v_fma_f32 v37, v37, v32, v33
v_fma_f32 v38, v38, v32, v33
v_fma_f32 v39, v39, v32, v33
M3 a[32:47],a[232:235],v[240:243],a[32:47]
TR a[228:229],v5 offset:20480
TR a[230:231],v5 offset:20992
v_fma_f32 v88, v88, v32, v33
v_fma_f32 v89, v89, v32, v33
CV v244,v34,v35
CV v245,v36,v37
CV v246,v38,v39
BL v13,s[16:19],s60 offen offset:3072 lds
M3 a[48:63],a[236:239],v[240:243],a[48:63]
TR a[232:233],v7 offset:20480
TR a[234:235],v7 offset:20992
CV v247,v88,v89
v_lshlrev_b32 v34, 16, v248
v_and_b32 v35, s52, v248
v_lshlrev_b32 v36, 16, v249
v_and_b32 v37, s52, v249
s_waitcnt lgkmcnt(6)
M3 a[0:15],a[240:243],v[244:247],a[0:15]
TR a[236:237],v9 offset:20480
TR a[238:239],v9 offset:20992
v_lshlrev_b32 v38, 16, v250
v_and_b32 v39, s52, v250
v_lshlrev_b32 v88, 16, v251
v_and_b32 v89, s52, v251
v_fma_f32 v34, v34, v32, v33
M3 a[16:31],a[244:247],v[244:247],a[16:31]
TR a[240:241],v3 offset:61440
TR a[242:243],v3 offset:61952
v_fma_f32 v35, v35, v32, v33
v_fma_f32 v36, v36, v32, v33
v_fma_f32 v37, v37, v32, v33
v_fma_f32 v38, v38, v32, v33
v_fma_f32 v39, v39, v32, v33
M3 a[32:47],a[248:251],v[244:247],a[32:47]
TR a[244:245],v5 offset:61440
TR a[246:247],v5 offset:61952
v_fma_f32 v88, v88, v32, v33
v_fma_f32 v89, v89, v32, v33
CV v248,v34,v35
CV v249,v36,v37
CV v250,v38,v39
M3 a[48:63],a[252:255],v[244:247],a[48:63]
TR a[248:249],v7 offset:61440
TR a[250:251],v7 offset:61952
CV v251,v88,v89
v_lshlrev_b32 v34, 16, v252
v_and_b32 v35, s52, v252
v_lshlrev_b32 v36, 16, v253
v_and_b32 v37, s52, v253
s_waitcnt lgkmcnt(6)
M3 a[0:15],a[224:227],v[248:251],a[0:15]
TR a[252:253],v9 offset:61440
TR a[254:255],v9 offset:61952
v_lshlrev_b32 v38, 16, v254
v_and_b32 v39, s52, v254
v_lshlrev_b32 v88, 16, v255
v_and_b32 v89, s52, v255
v_fma_f32 v34, v34, v32, v33
M3 a[16:31],a[228:231],v[248:251],a[16:31]
v_fma_f32 v35, v35, v32, v33
v_fma_f32 v36, v36, v32, v33
v_fma_f32 v37, v37, v32, v33
v_fma_f32 v38, v38, v32, v33
v_fma_f32 v39, v39, v32, v33
M3 a[32:47],a[232:235],v[248:251],a[32:47]
v_fma_f32 v88, v88, v32, v33
v_fma_f32 v89, v89, v32, v33
CV v252,v34,v35
CV v253,v36,v37
CV v254,v38,v39
M3 a[48:63],a[236:239],v[248:251],a[48:63]
s_waitcnt vmcnt(12) lgkmcnt(0)
s_barrier
TR a[224:225],v2
TR a[226:227],v2 offset:512
TR a[228:229],v4
TR a[230:231],v4 offset:512
CV v255,v88,v89
s_nop 1
M3 a[0:15],a[240:243],v[252:255],a[0:15]
TR a[232:233],v6
TR a[234:235],v6 offset:512
TR a[236:237],v8
TR a[238:239],v8 offset:512
s_add_u32 m0, s6, 20480
s_bfe_u32 s60, s58, 0x40010
s_mul_i32 s60, s60, 221184
s_add_u32 s60, s60, s41
BL v10,s[12:15],s60 offen lds
M3 a[16:31],a[244:247],v[252:255],a[16:31]
TR a[240:241],v2 offset:40960
TR a[242:243],v2 offset:41472
M3 a[32:47],a[248:251],v[252:255],a[32:47]
TR a[244:245],v4 offset:40960
TR a[246:247],v4 offset:41472
BL v11,s[12:15],s60 offen offset:1024 lds
M3 a[48:63],a[252:255],v[252:255],a[48:63]
TR a[248:249],v6 offset:40960
TR a[250:251],v6 offset:41472
s_waitcnt lgkmcnt(6)
M3 a[80:95],a[224:227],v[96:99],0
TR a[252:253],v8 offset:40960
TR a[254:255],v8 offset:41472
BL v12,s[16:19],s60 offen offset:2048 lds
s_mov_b32 s57, 15532032
v_lshlrev_b32 v27, 4, v1
v_lshlrev_b32 v95, 2, v1
v_add_u32 v25, 4096, v27
BL v[30:33],v27,s[24:27],s57 offen sc1
buffer_load_dword v94, v95, s[24:27], s57 offen offset:1024 sc1
AR v40,a0
AR v41,a1
AR v42,a2
AR v43,a3
AR v44,a8
M3 a[96:111],a[228:231],v[96:99],0
TR a[224:225],v3
TR a[226:227],v3 offset:512
AR v45,a9
AR v46,a10
AR v47,a11
v_mul_f32 v48, s50, v40
v_mul_f32 v49, s50, v41
v_mul_f32 v50, s50, v42
v_mul_f32 v51, s50, v43
M3 a[112:127],a[232:235],v[96:99],0
TR a[228:229],v5
TR a[230:231],v5 offset:512
BL v13,s[16:19],s60 offen offset:3072 lds
v_exp_f32 v48, v48
v_mul_f32 v40, v40, v44
v_exp_f32 v49, v49
M3 a[128:143],a[236:239],v[96:99],0
TR a[232:233],v7
TR a[234:235],v7 offset:512
v_mul_f32 v41, v41, v45
v_exp_f32 v50, v50
v_mul_f32 v42, v42, v46
v_exp_f32 v51, v51
v_mul_f32 v43, v43, v47
s_waitcnt lgkmcnt(6)
M3 a[80:95],a[240:243],v[100:103],a[80:95]
TR a[236:237],v9
TR a[238:239],v9 offset:512
v_add_f32 v48, 1.0, v48
v_add_f32 v49, 1.0, v49
v_add_f32 v50, 1.0, v50
v_add_f32 v51, 1.0, v51
v_rcp_f32 v48, v48
M3 a[96:111],a[244:247],v[100:103],a[96:111]
TR a[240:241],v3 offset:40960
TR a[242:243],v3 offset:41472
v_rcp_f32 v49, v49
v_rcp_f32 v50, v50
v_rcp_f32 v51, v51
v_mul_f32 v56, v40, v48
M3 a[112:127],a[248:251],v[100:103],a[112:127]
TR a[244:245],v5 offset:40960
TR a[246:247],v5 offset:41472
v_mul_f32 v57, v41, v49
v_mul_f32 v58, v42, v50
v_mul_f32 v59, v43, v51
AR v40,a4
AR v41,a5
AR v42,a6
AR v43,a7
M3 a[128:143],a[252:255],v[100:103],a[128:143]
TR a[248:249],v7 offset:40960
TR a[250:251],v7 offset:41472
AR v44,a12
AR v45,a13
AR v46,a14
AR v47,a15
v_mul_f32 v48, s50, v40
v_mul_f32 v49, s50, v41
v_mul_f32 v50, s50, v42
s_waitcnt lgkmcnt(6)
M3 a[80:95],a[224:227],v[104:107],a[80:95]
TR a[252:253],v9 offset:40960
TR a[254:255],v9 offset:41472
v_mul_f32 v51, s50, v43
v_exp_f32 v48, v48
v_mul_f32 v40, v40, v44
v_exp_f32 v49, v49
v_mul_f32 v41, v41, v45
M3 a[96:111],a[228:231],v[104:107],a[96:111]
v_exp_f32 v50, v50
v_mul_f32 v42, v42, v46
v_exp_f32 v51, v51
v_mul_f32 v43, v43, v47
v_add_f32 v48, 1.0, v48
v_add_f32 v49, 1.0, v49
v_add_f32 v50, 1.0, v50
M3 a[112:127],a[232:235],v[104:107],a[112:127]
v_add_f32 v51, 1.0, v51
v_rcp_f32 v48, v48
v_rcp_f32 v49, v49
v_rcp_f32 v50, v50
v_rcp_f32 v51, v51
M3 a[128:143],a[236:239],v[104:107],a[128:143]
s_waitcnt vmcnt(14) lgkmcnt(0)
s_barrier
TR a[224:225],v2 offset:5120
TR a[226:227],v2 offset:5632
TR a[228:229],v4 offset:5120
TR a[230:231],v4 offset:5632
v_mul_f32 v60, v40, v48
v_mul_f32 v61, v41, v49
v_mul_f32 v62, v42, v50
M3 a[80:95],a[240:243],v[108:111],a[80:95]
TR a[232:233],v6 offset:5120
TR a[234:235],v6 offset:5632
TR a[236:237],v8 offset:5120
TR a[238:239],v8 offset:5632
s_add_u32 m0, s6, 0
s_bfe_u32 s60, s58, 0x40014
s_mul_i32 s60, s60, 221184
s_add_u32 s60, s60, s41
BL v10,s[12:15],s60 offen lds
M3 a[96:111],a[244:247],v[108:111],a[96:111]
TR a[240:241],v2 offset:46080
TR a[242:243],v2 offset:46592
v_mul_f32 v63, v43, v51
CV v64,v56,v57
CV v65,v58,v59
CV v66,v60,v61
CV v67,v62,v63
M3 a[112:127],a[248:251],v[108:111],a[112:127]
TR a[244:245],v4 offset:46080
TR a[246:247],v4 offset:46592
BL v11,s[12:15],s60 offen offset:1024 lds
buffer_store_dwordx4 v[64:67], v28, s[24:27], s46 offen sc1
AR v40,a16
AR v41,a17
AR v42,a18
M3 a[128:143],a[252:255],v[108:111],a[128:143]
TR a[248:249],v6 offset:46080
TR a[250:251],v6 offset:46592
AR v43,a19
AR v44,a24
AR v45,a25
AR v46,a26
AR v47,a27
v_mul_f32 v48, s50, v40
v_mul_f32 v49, s50, v41
s_waitcnt lgkmcnt(6)
M3 a[80:95],a[224:227],v[112:115],a[80:95]
TR a[252:253],v8 offset:46080
TR a[254:255],v8 offset:46592
BL v12,s[16:19],s60 offen offset:2048 lds
s_waitcnt vmcnt(5)
K1_GU2_W_chk:
v_cmp_ne_u32 vcc, v30, v26
v_cmp_ne_u32 s[84:85], v31, v26
s_nop 0
s_or_b64 vcc, vcc, s[84:85]
v_cmp_ne_u32 s[84:85], v32, v26
s_nop 0
s_or_b64 vcc, vcc, s[84:85]
v_cmp_ne_u32 s[84:85], v33, v26
s_nop 0
s_or_b64 vcc, vcc, s[84:85]
v_cmp_ne_u32 s[84:85], v94, v26
s_nop 0
s_or_b64 vcc, vcc, s[84:85]
s_cmp_eq_u64 vcc, 0
s_cbranch_scc1 K1_GU2_W_ok
s_cmp_eq_u32 s101, 0
s_cbranch_scc1 K1_GU2_W_ok
s_sub_u32 s101, s101, 1
s_sleep 10
BL v[30:33],v27,s[24:27],s57 offen sc1
buffer_load_dword v94, v95, s[24:27], s57 offen offset:1024 sc1
s_waitcnt vmcnt(0)
s_branch K1_GU2_W_chk
K1_GU2_W_ok:
M3 a[96:111],a[228:231],v[112:115],a[96:111]
TR a[224:225],v3 offset:5120
TR a[226:227],v3 offset:5632
v_mul_f32 v50, s50, v42
M3 a[112:127],a[232:235],v[112:115],a[112:127]
TR a[228:229],v5 offset:5120
TR a[230:231],v5 offset:5632
BL v13,s[16:19],s60 offen offset:3072 lds
v_mul_f32 v51, s50, v43
v_exp_f32 v48, v48
v_mul_f32 v40, v40, v44
M3 a[128:143],a[236:239],v[112:115],a[128:143]
TR a[232:233],v7 offset:5120
TR a[234:235],v7 offset:5632
v_exp_f32 v49, v49
v_mul_f32 v41, v41, v45
v_exp_f32 v50, v50
v_mul_f32 v42, v42, v46
s_waitcnt lgkmcnt(6)
M3 a[80:95],a[240:243],v[116:119],a[80:95]
TR a[236:237],v9 offset:5120
TR a[238:239],v9 offset:5632
s_bfe_u32 s65, s87, 0x80000
s_mul_i32 s65, s65, 40960
BL a[160:163],v27,s[32:35],s65 offen sc1
v_exp_f32 v51, v51
v_mul_f32 v43, v43, v47
M3 a[96:111],a[244:247],v[116:119],a[96:111]
TR a[240:241],v3 offset:46080
TR a[242:243],v3 offset:46592
v_add_f32 v48, 1.0, v48
v_add_f32 v49, 1.0, v49
v_add_f32 v50, 1.0, v50
v_add_f32 v51, 1.0, v51
v_rcp_f32 v48, v48
M3 a[112:127],a[248:251],v[116:119],a[112:127]
TR a[244:245],v5 offset:46080
TR a[246:247],v5 offset:46592
BL a[164:167],v27,s[32:35],s65 offen offset:1024 sc1
v_rcp_f32 v49, v49
v_rcp_f32 v50, v50
M3 a[128:143],a[252:255],v[116:119],a[128:143]
TR a[248:249],v7 offset:46080
TR a[250:251],v7 offset:46592
v_rcp_f32 v51, v51
v_mul_f32 v56, v40, v48
v_mul_f32 v57, v41, v49
v_mul_f32 v58, v42, v50
v_mul_f32 v59, v43, v51
AR v40,a20
s_waitcnt lgkmcnt(6)
M3 a[80:95],a[224:227],v[120:123],a[80:95]
TR a[252:253],v9 offset:46080
TR a[254:255],v9 offset:46592
BL a[168:171],v27,s[32:35],s65 offen offset:2048 sc1
AR v41,a21
AR v42,a22
AR v43,a23
AR v44,a28
AR v45,a29
M3 a[96:111],a[228:231],v[120:123],a[96:111]
AR v46,a30
AR v47,a31
v_mul_f32 v48, s50, v40
v_mul_f32 v49, s50, v41
v_mul_f32 v50, s50, v42
v_mul_f32 v51, s50, v43
v_exp_f32 v48, v48
v_mul_f32 v40, v40, v44
M3 a[112:127],a[232:235],v[120:123],a[112:127]
BL a[172:175],v27,s[32:35],s65 offen offset:3072 sc1
v_exp_f32 v49, v49
v_mul_f32 v41, v41, v45
v_exp_f32 v50, v50
v_mul_f32 v42, v42, v46
M3 a[128:143],a[236:239],v[120:123],a[128:143]
s_waitcnt lgkmcnt(0)
s_barrier
TR a[224:225],v2 offset:10240
TR a[226:227],v2 offset:10752
TR a[228:229],v4 offset:10240
TR a[230:231],v4 offset:10752
v_exp_f32 v51, v51
v_mul_f32 v43, v43, v47
M3 a[80:95],a[240:243],v[124:127],a[80:95]
TR a[232:233],v6 offset:10240
TR a[234:235],v6 offset:10752
TR a[236:237],v8 offset:10240
TR a[238:239],v8 offset:10752
s_add_u32 m0, s6, 5120
s_bfe_u32 s60, s58, 0x40018
s_mul_i32 s60, s60, 221184
s_add_u32 s60, s60, s41
BL v10,s[12:15],s60 offen lds
M3 a[96:111],a[244:247],v[124:127],a[96:111]
TR a[240:241],v2 offset:51200
TR a[242:243],v2 offset:51712
v_add_f32 v48, 1.0, v48
v_add_f32 v49, 1.0, v49
v_add_f32 v50, 1.0, v50
v_add_f32 v51, 1.0, v51
v_rcp_f32 v48, v48
M3 a[112:127],a[248:251],v[124:127],a[112:127]
TR a[244:245],v4 offset:51200
TR a[246:247],v4 offset:51712
BL v11,s[12:15],s60 offen offset:1024 lds
v_rcp_f32 v49, v49
v_rcp_f32 v50, v50
M3 a[128:143],a[252:255],v[124:127],a[128:143]
TR a[248:249],v6 offset:51200
TR a[250:251],v6 offset:51712
v_rcp_f32 v51, v51
v_mul_f32 v60, v40, v48
v_mul_f32 v61, v41, v49
v_mul_f32 v62, v42, v50
v_mul_f32 v63, v43, v51
CV v68,v56,v57
s_waitcnt lgkmcnt(6)
M3 a[80:95],a[224:227],v[128:131],a[80:95]
TR a[252:253],v8 offset:51200
TR a[254:255],v8 offset:51712
BL v12,s[16:19],s60 offen offset:2048 lds
CV v69,v58,v59
CV v70,v60,v61
CV v71,v62,v63
buffer_store_dwordx4 v[68:71], v28, s[24:27], s46 offen offset:512 sc1
M3 a[96:111],a[228:231],v[128:131],a[96:111]
TR a[224:225],v3 offset:10240
TR a[226:227],v3 offset:10752
AR v40,a32
AR v41,a33
AR v42,a34
AR v43,a35
AR v44,a40
AR v45,a41
AR v46,a42
M3 a[112:127],a[232:235],v[128:131],a[112:127]
TR a[228:229],v5 offset:10240
TR a[230:231],v5 offset:10752
BL v13,s[16:19],s60 offen offset:3072 lds
AR v47,a43
v_mul_f32 v48, s50, v40
v_mul_f32 v49, s50, v41
v_mul_f32 v50, s50, v42
v_mul_f32 v51, s50, v43
M3 a[128:143],a[236:239],v[128:131],a[128:143]
TR a[232:233],v7 offset:10240
TR a[234:235],v7 offset:10752
v_exp_f32 v48, v48
v_mul_f32 v40, v40, v44
v_exp_f32 v49, v49
v_mul_f32 v41, v41, v45
s_waitcnt lgkmcnt(6)
M3 a[80:95],a[240:243],v[132:135],a[80:95]
TR a[236:237],v9 offset:10240
TR a[238:239],v9 offset:10752
BL a[176:179],v25,s[32:35],s65 offen sc1
v_exp_f32 v50, v50
v_mul_f32 v42, v42, v46
v_exp_f32 v51, v51
M3 a[96:111],a[244:247],v[132:135],a[96:111]
TR a[240:241],v3 offset:51200
TR a[242:243],v3 offset:51712
v_mul_f32 v43, v43, v47
v_add_f32 v48, 1.0, v48
v_add_f32 v49, 1.0, v49
v_add_f32 v50, 1.0, v50
v_add_f32 v51, 1.0, v51
v_rcp_f32 v48, v48
M3 a[112:127],a[248:251],v[132:135],a[112:127]
TR a[244:245],v5 offset:51200
TR a[246:247],v5 offset:51712
s_bfe_u32 s65, s87, 0x80008
s_mul_i32 s65, s65, 40960
BL a[180:183],v27,s[32:35],s65 offen sc1
v_rcp_f32 v49, v49
M3 a[128:143],a[252:255],v[132:135],a[128:143]
TR a[248:249],v7 offset:51200
TR a[250:251],v7 offset:51712
v_rcp_f32 v50, v50
v_rcp_f32 v51, v51
v_mul_f32 v56, v40, v48
v_mul_f32 v57, v41, v49
v_mul_f32 v58, v42, v50
s_waitcnt lgkmcnt(6)
M3 a[80:95],a[224:227],v[136:139],a[80:95]
TR a[252:253],v9 offset:51200
TR a[254:255],v9 offset:51712
BL a[184:187],v27,s[32:35],s65 offen offset:1024 sc1
v_mul_f32 v59, v43, v51
AR v40,a36
AR v41,a37
AR v42,a38
AR v43,a39
M3 a[96:111],a[228:231],v[136:139],a[96:111]
AR v44,a44
AR v45,a45
AR v46,a46
AR v47,a47
v_mul_f32 v48, s50, v40
v_mul_f32 v49, s50, v41
v_mul_f32 v50, s50, v42
v_mul_f32 v51, s50, v43
M3 a[112:127],a[232:235],v[136:139],a[112:127]
BL a[188:191],v27,s[32:35],s65 offen offset:2048 sc1
v_exp_f32 v48, v48
v_mul_f32 v40, v40, v44
v_exp_f32 v49, v49
v_mul_f32 v41, v41, v45
M3 a[128:143],a[236:239],v[136:139],a[128:143]
s_waitcnt lgkmcnt(0)
s_barrier
TR a[224:225],v2 offset:15360
TR a[226:227],v2 offset:15872
TR a[228:229],v4 offset:15360
TR a[230:231],v4 offset:15872
v_exp_f32 v50, v50
v_mul_f32 v42, v42, v46
M3 a[80:95],a[240:243],v[140:143],a[80:95]
TR a[232:233],v6 offset:15360
TR a[234:235],v6 offset:15872
TR a[236:237],v8 offset:15360
TR a[238:239],v8 offset:15872
s_add_u32 m0, s6, 10240
s_bfe_u32 s60, s58, 0x4001c
s_mul_i32 s60, s60, 221184
s_add_u32 s60, s60, s41
BL v10,s[12:15],s60 offen lds
M3 a[96:111],a[244:247],v[140:143],a[96:111]
TR a[240:241],v2 offset:56320
TR a[242:243],v2 offset:56832
v_exp_f32 v51, v51
v_mul_f32 v43, v43, v47
v_add_f32 v48, 1.0, v48
v_add_f32 v49, 1.0, v49
v_add_f32 v50, 1.0, v50
M3 a[112:127],a[248:251],v[140:143],a[112:127]
TR a[244:245],v4 offset:56320
TR a[246:247],v4 offset:56832
BL v11,s[12:15],s60 offen offset:1024 lds
v_add_f32 v51, 1.0, v51
v_rcp_f32 v48, v48
v_rcp_f32 v49, v49
M3 a[128:143],a[252:255],v[140:143],a[128:143]
TR a[248:249],v6 offset:56320
TR a[250:251],v6 offset:56832
v_rcp_f32 v50, v50
v_rcp_f32 v51, v51
v_mul_f32 v60, v40, v48
v_mul_f32 v61, v41, v49
v_mul_f32 v62, v42, v50
s_waitcnt lgkmcnt(6)
M3 a[80:95],a[224:227],v[144:147],a[80:95]
TR a[252:253],v8 offset:56320
TR a[254:255],v8 offset:56832
BL v12,s[16:19],s60 offen offset:2048 lds
v_mul_f32 v63, v43, v51
CV v64,v56,v57
CV v65,v58,v59
CV v66,v60,v61
CV v67,v62,v63
M3 a[96:111],a[228:231],v[144:147],a[96:111]
TR a[224:225],v3 offset:15360
TR a[226:227],v3 offset:15872
buffer_store_dwordx4 v[64:67], v29, s[24:27], s46 offen sc1
AR v40,a48
AR v41,a49
AR v42,a50
AR v43,a51
AR v44,a56
M3 a[112:127],a[232:235],v[144:147],a[112:127]
TR a[228:229],v5 offset:15360
TR a[230:231],v5 offset:15872
BL v13,s[16:19],s60 offen offset:3072 lds
AR v45,a57
AR v46,a58
AR v47,a59
v_mul_f32 v48, s50, v40
v_mul_f32 v49, s50, v41
M3 a[128:143],a[236:239],v[144:147],a[128:143]
TR a[232:233],v7 offset:15360
TR a[234:235],v7 offset:15872
v_mul_f32 v50, s50, v42
v_mul_f32 v51, s50, v43
v_exp_f32 v48, v48
v_mul_f32 v40, v40, v44
v_exp_f32 v49, v49
s_waitcnt lgkmcnt(6)
M3 a[80:95],a[240:243],v[148:151],a[80:95]
TR a[236:237],v9 offset:15360
TR a[238:239],v9 offset:15872
BL a[192:195],v27,s[32:35],s65 offen offset:3072 sc1
v_mul_f32 v41, v41, v45
v_exp_f32 v50, v50
v_mul_f32 v42, v42, v46
M3 a[96:111],a[244:247],v[148:151],a[96:111]
TR a[240:241],v3 offset:56320
TR a[242:243],v3 offset:56832
v_exp_f32 v51, v51
v_mul_f32 v43, v43, v47
v_add_f32 v48, 1.0, v48
v_add_f32 v49, 1.0, v49
v_add_f32 v50, 1.0, v50
v_add_f32 v51, 1.0, v51
M3 a[112:127],a[248:251],v[148:151],a[112:127]
TR a[244:245],v5 offset:56320
TR a[246:247],v5 offset:56832
BL a[196:199],v25,s[32:35],s65 offen sc1
v_rcp_f32 v48, v48
v_rcp_f32 v49, v49
M3 a[128:143],a[252:255],v[148:151],a[128:143]
TR a[248:249],v7 offset:56320
TR a[250:251],v7 offset:56832
v_rcp_f32 v50, v50
v_rcp_f32 v51, v51
v_mul_f32 v56, v40, v48
v_mul_f32 v57, v41, v49
v_mul_f32 v58, v42, v50
s_waitcnt lgkmcnt(6)
M3 a[80:95],a[224:227],v[152:155],a[80:95]
TR a[252:253],v9 offset:56320
TR a[254:255],v9 offset:56832
s_bfe_u32 s65, s87, 0x80010
s_mul_i32 s65, s65, 40960
BL a[200:203],v27,s[32:35],s65 offen sc1
v_mul_f32 v59, v43, v51
AR v40,a52
AR v41,a53
M3 a[96:111],a[228:231],v[152:155],a[96:111]
AR v42,a54
AR v43,a55
AR v44,a60
AR v45,a61
AR v46,a62
AR v47,a63
v_mul_f32 v48, s50, v40
v_mul_f32 v49, s50, v41
v_mul_f32 v50, s50, v42
M3 a[112:127],a[232:235],v[152:155],a[112:127]
BL a[204:207],v27,s[32:35],s65 offen offset:1024 sc1
v_mul_f32 v51, s50, v43
v_exp_f32 v48, v48
v_mul_f32 v40, v40, v44
v_exp_f32 v49, v49
v_mul_f32 v41, v41, v45
M3 a[128:143],a[236:239],v[152:155],a[128:143]
s_waitcnt vmcnt(27) lgkmcnt(0)
s_barrier
TR a[224:225],v2 offset:20480
TR a[226:227],v2 offset:20992
TR a[228:229],v4 offset:20480
TR a[230:231],v4 offset:20992
v_exp_f32 v50, v50
v_mul_f32 v42, v42, v46
M3 a[80:95],a[240:243],v[156:159],a[80:95]
TR a[232:233],v6 offset:20480
TR a[234:235],v6 offset:20992
TR a[236:237],v8 offset:20480
TR a[238:239],v8 offset:20992
s_add_u32 m0, s6, 15360
s_bfe_u32 s60, s59, 0x40000
s_mul_i32 s60, s60, 221184
s_add_u32 s60, s60, s41
BL v10,s[12:15],s60 offen lds
M3 a[96:111],a[244:247],v[156:159],a[96:111]
TR a[240:241],v2 offset:61440
TR a[242:243],v2 offset:61952
v_exp_f32 v51, v51
v_mul_f32 v43, v43, v47
v_add_f32 v48, 1.0, v48
v_add_f32 v49, 1.0, v49
v_add_f32 v50, 1.0, v50
M3 a[112:127],a[248:251],v[156:159],a[112:127]
TR a[244:245],v4 offset:61440
TR a[246:247],v4 offset:61952
BL v11,s[12:15],s60 offen offset:1024 lds
v_add_f32 v51, 1.0, v51
v_rcp_f32 v48, v48
v_rcp_f32 v49, v49
M3 a[128:143],a[252:255],v[156:159],a[128:143]
TR a[248:249],v6 offset:61440
TR a[250:251],v6 offset:61952
v_rcp_f32 v50, v50
v_rcp_f32 v51, v51
v_mul_f32 v60, v40, v48
v_mul_f32 v61, v41, v49
v_mul_f32 v62, v42, v50
s_waitcnt lgkmcnt(6)
M3 a[80:95],a[224:227],v[160:163],a[80:95]
TR a[252:253],v8 offset:61440
TR a[254:255],v8 offset:61952
BL v12,s[16:19],s60 offen offset:2048 lds
v_mul_f32 v63, v43, v51
CV v68,v56,v57
CV v69,v58,v59
CV v70,v60,v61
CV v71,v62,v63
M3 a[96:111],a[228:231],v[160:163],a[96:111]
TR a[224:225],v3 offset:20480
TR a[226:227],v3 offset:20992
buffer_store_dwordx4 v[68:71], v29, s[24:27], s46 offen offset:512 sc1
M3 a[112:127],a[232:235],v[160:163],a[112:127]
TR a[228:229],v5 offset:20480
TR a[230:231],v5 offset:20992
BL v13,s[16:19],s60 offen offset:3072 lds
M3 a[128:143],a[236:239],v[160:163],a[128:143]
TR a[232:233],v7 offset:20480
TR a[234:235],v7 offset:20992
s_waitcnt lgkmcnt(6)
M3 a[80:95],a[240:243],v[164:167],a[80:95]
TR a[236:237],v9 offset:20480
TR a[238:239],v9 offset:20992
BL a[208:211],v27,s[32:35],s65 offen offset:2048 sc1
M3 a[96:111],a[244:247],v[164:167],a[96:111]
TR a[240:241],v3 offset:61440
TR a[242:243],v3 offset:61952
M3 a[112:127],a[248:251],v[164:167],a[112:127]
TR a[244:245],v5 offset:61440
TR a[246:247],v5 offset:61952
BL a[212:215],v27,s[32:35],s65 offen offset:3072 sc1
M3 a[128:143],a[252:255],v[164:167],a[128:143]
TR a[248:249],v7 offset:61440
TR a[250:251],v7 offset:61952
s_waitcnt lgkmcnt(6)
M3 a[80:95],a[224:227],v[168:171],a[80:95]
TR a[252:253],v9 offset:61440
TR a[254:255],v9 offset:61952
BL a[216:219],v25,s[32:35],s65 offen sc1
M3 a[96:111],a[228:231],v[168:171],a[96:111]
M3 a[112:127],a[232:235],v[168:171],a[112:127]
s_bfe_u32 s65, s87, 0x80018
s_mul_i32 s65, s65, 40960
BL a[220:223],v27,s[32:35],s65 offen sc1
M3 a[128:143],a[236:239],v[168:171],a[128:143]
s_waitcnt vmcnt(31) lgkmcnt(0)
s_barrier
TR a[224:225],v2
TR a[226:227],v2 offset:512
TR a[228:229],v4
TR a[230:231],v4 offset:512
M3 a[80:95],a[240:243],v[172:175],a[80:95]
TR a[232:233],v6
TR a[234:235],v6 offset:512
TR a[236:237],v8
TR a[238:239],v8 offset:512
s_add_u32 m0, s6, 20480
s_bfe_u32 s60, s59, 0x40004
s_mul_i32 s60, s60, 221184
s_add_u32 s60, s60, s41
BL v10,s[12:15],s60 offen lds
M3 a[96:111],a[244:247],v[172:175],a[96:111]
TR a[240:241],v2 offset:40960
TR a[242:243],v2 offset:41472
M3 a[112:127],a[248:251],v[172:175],a[112:127]
TR a[244:245],v4 offset:40960
TR a[246:247],v4 offset:41472
BL v11,s[12:15],s60 offen offset:1024 lds
M3 a[128:143],a[252:255],v[172:175],a[128:143]
TR a[248:249],v6 offset:40960
TR a[250:251],v6 offset:41472
s_waitcnt lgkmcnt(6)
M3 a[80:95],a[224:227],v[176:179],a[80:95]
TR a[252:253],v8 offset:40960
TR a[254:255],v8 offset:41472
BL v12,s[16:19],s60 offen offset:2048 lds
M3 a[96:111],a[228:231],v[176:179],a[96:111]
TR a[224:225],v3
TR a[226:227],v3 offset:512
M3 a[112:127],a[232:235],v[176:179],a[112:127]
TR a[228:229],v5
TR a[230:231],v5 offset:512
BL v13,s[16:19],s60 offen offset:3072 lds
M3 a[128:143],a[236:239],v[176:179],a[128:143]
TR a[232:233],v7
TR a[234:235],v7 offset:512
s_waitcnt lgkmcnt(6)
M3 a[80:95],a[240:243],v[180:183],a[80:95]
TR a[236:237],v9
TR a[238:239],v9 offset:512
s_add_u32 m0, s6, 32768
s_nop 0
BL v27,s[32:35],s65 offen offset:1024 sc1 lds
M3 a[96:111],a[244:247],v[180:183],a[96:111]
TR a[240:241],v3 offset:40960
TR a[242:243],v3 offset:41472
s_waitcnt vmcnt(10)
s_add_u32 s7, s96, 4294836224
buffer_store_dword v26, v20, s[24:27], s7 offen sc1
s_add_u32 s7, s96, 4294901760
buffer_store_dword v26, v20, s[24:27], s7 offen sc1
M3 a[112:127],a[248:251],v[180:183],a[112:127]
TR a[244:245],v5 offset:40960
TR a[246:247],v5 offset:41472
BL v27,s[32:35],s65 offen offset:2048 sc1 lds
M3 a[128:143],a[252:255],v[180:183],a[128:143]
TR a[248:249],v7 offset:40960
TR a[250:251],v7 offset:41472
s_waitcnt lgkmcnt(6)
M3 a[80:95],a[224:227],v[184:187],a[80:95]
TR a[252:253],v9 offset:40960
TR a[254:255],v9 offset:41472
BL v27,s[32:35],s65 offen offset:3072 sc1 lds
M3 a[96:111],a[228:231],v[184:187],a[96:111]
M3 a[112:127],a[232:235],v[184:187],a[112:127]
s_add_u32 m0, s6, 36864
s_nop 0
BL v25,s[32:35],s65 offen sc1 lds
M3 a[128:143],a[236:239],v[184:187],a[128:143]
s_waitcnt lgkmcnt(0)
s_barrier
TR a[224:225],v2 offset:5120
TR a[226:227],v2 offset:5632
TR a[228:229],v4 offset:5120
TR a[230:231],v4 offset:5632
M3 a[80:95],a[240:243],v[188:191],a[80:95]
TR a[232:233],v6 offset:5120
TR a[234:235],v6 offset:5632
TR a[236:237],v8 offset:5120
TR a[238:239],v8 offset:5632
s_add_u32 m0, s6, 37888
s_bfe_u32 s65, s88, 0x80000
s_mul_i32 s65, s65, 40960
BL v27,s[32:35],s65 offen sc1 lds
M3 a[96:111],a[244:247],v[188:191],a[96:111]
TR a[240:241],v2 offset:46080
TR a[242:243],v2 offset:46592
M3 a[112:127],a[248:251],v[188:191],a[112:127]
TR a[244:245],v4 offset:46080
TR a[246:247],v4 offset:46592
BL v27,s[32:35],s65 offen offset:1024 sc1 lds
M3 a[128:143],a[252:255],v[188:191],a[128:143]
TR a[248:249],v6 offset:46080
TR a[250:251],v6 offset:46592
s_waitcnt lgkmcnt(6)
M3 a[80:95],a[224:227],v[192:195],a[80:95]
TR a[252:253],v8 offset:46080
TR a[254:255],v8 offset:46592
BL v27,s[32:35],s65 offen offset:2048 sc1 lds
M3 a[96:111],a[228:231],v[192:195],a[96:111]
TR a[224:225],v3 offset:5120
TR a[226:227],v3 offset:5632
M3 a[112:127],a[232:235],v[192:195],a[112:127]
TR a[228:229],v5 offset:5120
TR a[230:231],v5 offset:5632
BL a[64:67],v27,s[32:35],s65 offen offset:3072 sc1
M3 a[128:143],a[236:239],v[192:195],a[128:143]
TR a[232:233],v7 offset:5120
TR a[234:235],v7 offset:5632
s_waitcnt lgkmcnt(6)
M3 a[80:95],a[240:243],v[196:199],a[80:95]
TR a[236:237],v9 offset:5120
TR a[238:239],v9 offset:5632
BL a[68:71],v25,s[32:35],s65 offen sc1
M3 a[96:111],a[244:247],v[196:199],a[96:111]
TR a[240:241],v3 offset:46080
TR a[242:243],v3 offset:46592
M3 a[112:127],a[248:251],v[196:199],a[112:127]
TR a[244:245],v5 offset:46080
TR a[246:247],v5 offset:46592
s_bfe_u32 s65, s88, 0x80008
s_mul_i32 s65, s65, 40960
BL a[72:75],v27,s[32:35],s65 offen sc1
M3 a[128:143],a[252:255],v[196:199],a[128:143]
TR a[248:249],v7 offset:46080
TR a[250:251],v7 offset:46592
s_waitcnt lgkmcnt(6)
M3 a[80:95],a[224:227],v[200:203],a[80:95]
TR a[252:253],v9 offset:46080
TR a[254:255],v9 offset:46592
s_lshr_b32 s7, s5, 3
s_lshl_b32 s98, s4, 1
s_add_u32 s98, s98, s7
s_mul_i32 s99, s98, 74
s_mul_i32 s61, s3, 14
s_add_u32 s99, s99, s61
s_lshl_b32 s99, s99, 12
s_add_u32 s99, s99, 0
s_add_u32 s36, s82, s99
s_addc_u32 s37, s83, 0
s_sub_u32 s38, 74, s61
s_lshl_b32 s38, s38, 12
s_mov_b32 s39, 0x20000
v_and_b32 v86, 1, v1
v_lshlrev_b32 v86, 2, v86
v_and_b32 v87, 2, v1
v_lshl_add_u32 v86, v87, 6, v86
s_lshl_b32 s7, s3, 8
s_add_u32 s7, s7, 1024
v_add_u32 v86, s7, v86
s_add_u32 s98, s97, 4294836224
s_add_u32 s99, s97, 4294901760
buffer_load_dword v87, v86, s[24:27], s98 offen sc1
BL a[76:79],v27,s[32:35],s65 offen offset:1024 sc1
M3 a[96:111],a[228:231],v[200:203],a[96:111]
M3 a[112:127],a[232:235],v[200:203],a[112:127]
s_add_u32 m0, s6, 23552
s_nop 0
BL v27,s[32:35],s65 offen offset:2048 sc1 lds
M3 a[128:143],a[236:239],v[200:203],a[128:143]
s_waitcnt lgkmcnt(0)
s_barrier
TR a[224:225],v2 offset:10240
TR a[226:227],v2 offset:10752
TR a[228:229],v4 offset:10240
TR a[230:231],v4 offset:10752
M3 a[80:95],a[240:243],v[204:207],a[80:95]
TR a[232:233],v6 offset:10240
TR a[234:235],v6 offset:10752
TR a[236:237],v8 offset:10240
TR a[238:239],v8 offset:10752
BL v27,s[32:35],s65 offen offset:3072 sc1 lds
M3 a[96:111],a[244:247],v[204:207],a[96:111]
TR a[240:241],v2 offset:51200
TR a[242:243],v2 offset:51712
M3 a[112:127],a[248:251],v[204:207],a[112:127]
TR a[244:245],v4 offset:51200
TR a[246:247],v4 offset:51712
s_add_u32 m0, s6, 27648
s_nop 0
BL v25,s[32:35],s65 offen sc1 lds
M3 a[128:143],a[252:255],v[204:207],a[128:143]
TR a[248:249],v6 offset:51200
TR a[250:251],v6 offset:51712
s_waitcnt lgkmcnt(6)
M3 a[80:95],a[224:227],v[208:211],a[80:95]
TR a[252:253],v8 offset:51200
TR a[254:255],v8 offset:51712
s_add_u32 m0, s6, 28672
s_bfe_u32 s65, s88, 0x80010
s_mul_i32 s65, s65, 40960
BL v27,s[32:35],s65 offen sc1 lds
M3 a[96:111],a[228:231],v[208:211],a[96:111]
TR a[224:225],v3 offset:10240
TR a[226:227],v3 offset:10752
M3 a[112:127],a[232:235],v[208:211],a[112:127]
TR a[228:229],v5 offset:10240
TR a[230:231],v5 offset:10752
BL v27,s[32:35],s65 offen offset:1024 sc1 lds
M3 a[128:143],a[236:239],v[208:211],a[128:143]
TR a[232:233],v7 offset:10240
TR a[234:235],v7 offset:10752
s_waitcnt lgkmcnt(6)
M3 a[80:95],a[240:243],v[212:215],a[80:95]
TR a[236:237],v9 offset:10240
TR a[238:239],v9 offset:10752
BL v27,s[32:35],s65 offen offset:2048 sc1 lds
M3 a[96:111],a[244:247],v[212:215],a[96:111]
TR a[240:241],v3 offset:51200
TR a[242:243],v3 offset:51712
M3 a[112:127],a[248:251],v[212:215],a[112:127]
TR a[244:245],v5 offset:51200
TR a[246:247],v5 offset:51712
BL v27,s[32:35],s65 offen offset:3072 sc1 lds
M3 a[128:143],a[252:255],v[212:215],a[128:143]
TR a[248:249],v7 offset:51200
TR a[250:251],v7 offset:51712
s_waitcnt lgkmcnt(6)
M3 a[80:95],a[224:227],v[216:219],a[80:95]
TR a[252:253],v9 offset:51200
TR a[254:255],v9 offset:51712
s_add_u32 m0, s6, 32768
s_nop 0
BL v25,s[32:35],s65 offen sc1 lds
M3 a[96:111],a[228:231],v[216:219],a[96:111]
M3 a[112:127],a[232:235],v[216:219],a[112:127]
s_bfe_u32 s65, s88, 0x80018
s_mul_i32 s65, s65, 40960
BL a[0:3],v27,s[32:35],s65 offen sc1
M3 a[128:143],a[236:239],v[216:219],a[128:143]
s_waitcnt vmcnt(31) lgkmcnt(0)
s_barrier
TR a[224:225],v2 offset:15360
TR a[226:227],v2 offset:15872
TR a[228:229],v4 offset:15360
TR a[230:231],v4 offset:15872
M3 a[80:95],a[240:243],v[220:223],a[80:95]
TR a[232:233],v6 offset:15360
TR a[234:235],v6 offset:15872
TR a[236:237],v8 offset:15360
TR a[238:239],v8 offset:15872
BL a[4:7],v27,s[32:35],s65 offen offset:1024 sc1
M3 a[96:111],a[244:247],v[220:223],a[96:111]
TR a[240:241],v2 offset:56320
TR a[242:243],v2 offset:56832
M3 a[112:127],a[248:251],v[220:223],a[112:127]
TR a[244:245],v4 offset:56320
TR a[246:247],v4 offset:56832
BL a[8:11],v27,s[32:35],s65 offen offset:2048 sc1
M3 a[128:143],a[252:255],v[220:223],a[128:143]
TR a[248:249],v6 offset:56320
TR a[250:251],v6 offset:56832
s_waitcnt lgkmcnt(6)
M3 a[80:95],a[224:227],v[224:227],a[80:95]
TR a[252:253],v8 offset:56320
TR a[254:255],v8 offset:56832
s_waitcnt vmcnt(12)
K1_GU2_E_chk:
v_cmp_ne_u32 vcc, v87, v26
s_nop 0
s_cmp_eq_u64 vcc, 0
s_cbranch_scc1 K1_GU2_E_ok
s_cmp_eq_u32 s101, 0
s_cbranch_scc1 K1_GU2_E_ok
s_sub_u32 s101, s101, 1
s_sleep 10
buffer_load_dword v87, v86, s[24:27], s98 offen sc1
s_waitcnt vmcnt(0)
s_branch K1_GU2_E_chk
K1_GU2_E_ok:
s_bfe_u32 s61, s87, 0x80000
s_mul_i32 s61, s61, 4096
BL v[96:99],v27,s[36:39],s61 offen sc1
M3 a[96:111],a[228:231],v[224:227],a[96:111]
TR a[224:225],v3 offset:15360
TR a[226:227],v3 offset:15872
M3 a[112:127],a[232:235],v[224:227],a[112:127]
TR a[228:229],v5 offset:15360
TR a[230:231],v5 offset:15872
s_bfe_u32 s61, s87, 0x80000
s_mul_i32 s61, s61, 4096
BL v[100:103],v27,s[36:39],s61 offen offset:1024 sc1
M3 a[128:143],a[236:239],v[224:227],a[128:143]
TR a[232:233],v7 offset:15360
TR a[234:235],v7 offset:15872
s_waitcnt lgkmcnt(6)
M3 a[80:95],a[240:243],v[228:231],a[80:95]
TR a[236:237],v9 offset:15360
TR a[238:239],v9 offset:15872
s_bfe_u32 s61, s87, 0x80000
s_mul_i32 s61, s61, 4096
BL v[104:107],v27,s[36:39],s61 offen offset:2048 sc1
M3 a[96:111],a[244:247],v[228:231],a[96:111]
TR a[240:241],v3 offset:56320
TR a[242:243],v3 offset:56832
M3 a[112:127],a[248:251],v[228:231],a[112:127]
TR a[244:245],v5 offset:56320
TR a[246:247],v5 offset:56832
s_bfe_u32 s61, s87, 0x80000
s_mul_i32 s61, s61, 4096
BL v[108:111],v27,s[36:39],s61 offen offset:3072 sc1
M3 a[128:143],a[252:255],v[228:231],a[128:143]
TR a[248:249],v7 offset:56320
TR a[250:251],v7 offset:56832
s_waitcnt lgkmcnt(6)
M3 a[80:95],a[224:227],v[232:235],a[80:95]
TR a[252:253],v9 offset:56320
TR a[254:255],v9 offset:56832
s_bfe_u32 s61, s87, 0x80008
s_mul_i32 s61, s61, 4096
BL v[112:115],v27,s[36:39],s61 offen sc1
M3 a[96:111],a[228:231],v[232:235],a[96:111]
M3 a[112:127],a[232:235],v[232:235],a[112:127]
s_bfe_u32 s61, s87, 0x80008
s_mul_i32 s61, s61, 4096
BL v[116:119],v27,s[36:39],s61 offen offset:1024 sc1
M3 a[128:143],a[236:239],v[232:235],a[128:143]
s_waitcnt lgkmcnt(0)
s_barrier
TR a[224:225],v2 offset:20480
TR a[226:227],v2 offset:20992
TR a[228:229],v4 offset:20480
TR a[230:231],v4 offset:20992
M3 a[80:95],a[240:243],v[236:239],a[80:95]
TR a[232:233],v6 offset:20480
TR a[234:235],v6 offset:20992
TR a[236:237],v8 offset:20480
TR a[238:239],v8 offset:20992
s_bfe_u32 s61, s87, 0x80008
s_mul_i32 s61, s61, 4096
BL v[120:123],v27,s[36:39],s61 offen offset:2048 sc1
M3 a[96:111],a[244:247],v[236:239],a[96:111]
TR a[240:241],v2 offset:61440
TR a[242:243],v2 offset:61952
M3 a[112:127],a[248:251],v[236:239],a[112:127]
TR a[244:245],v4 offset:61440
TR a[246:247],v4 offset:61952
s_bfe_u32 s61, s87, 0x80008
s_mul_i32 s61, s61, 4096
BL v[124:127],v27,s[36:39],s61 offen offset:3072 sc1
M3 a[128:143],a[252:255],v[236:239],a[128:143]
TR a[248:249],v6 offset:61440
TR a[250:251],v6 offset:61952
s_waitcnt lgkmcnt(6)
M3 a[80:95],a[224:227],v[240:243],a[80:95]
TR a[252:253],v8 offset:61440
TR a[254:255],v8 offset:61952
s_bfe_u32 s61, s87, 0x80010
s_mul_i32 s61, s61, 4096
BL v[128:131],v27,s[36:39],s61 offen sc1
M3 a[96:111],a[228:231],v[240:243],a[96:111]
TR a[224:225],v3 offset:20480
TR a[226:227],v3 offset:20992
M3 a[112:127],a[232:235],v[240:243],a[112:127]
TR a[228:229],v5 offset:20480
TR a[230:231],v5 offset:20992
s_bfe_u32 s61, s87, 0x80010
s_mul_i32 s61, s61, 4096
BL v[132:135],v27,s[36:39],s61 offen offset:1024 sc1
M3 a[128:143],a[236:239],v[240:243],a[128:143]
TR a[232:233],v7 offset:20480
TR a[234:235],v7 offset:20992
s_waitcnt lgkmcnt(6)
M3 a[80:95],a[240:243],v[244:247],a[80:95]
TR a[236:237],v9 offset:20480
TR a[238:239],v9 offset:20992
s_bfe_u32 s61, s87, 0x80010
s_mul_i32 s61, s61, 4096
BL v[136:139],v27,s[36:39],s61 offen offset:2048 sc1
M3 a[96:111],a[244:247],v[244:247],a[96:111]
TR a[240:241],v3 offset:61440
TR a[242:243],v3 offset:61952
M3 a[112:127],a[248:251],v[244:247],a[112:127]
TR a[244:245],v5 offset:61440
TR a[246:247],v5 offset:61952
s_bfe_u32 s61, s87, 0x80010
s_mul_i32 s61, s61, 4096
BL v[140:143],v27,s[36:39],s61 offen offset:3072 sc1
M3 a[128:143],a[252:255],v[244:247],a[128:143]
TR a[248:249],v7 offset:61440
TR a[250:251],v7 offset:61952
s_waitcnt lgkmcnt(6)
M3 a[80:95],a[224:227],v[248:251],a[80:95]
TR a[252:253],v9 offset:61440
TR a[254:255],v9 offset:61952
s_bfe_u32 s61, s87, 0x80018
s_mul_i32 s61, s61, 4096
BL v[144:147],v27,s[36:39],s61 offen sc1
M3 a[96:111],a[228:231],v[248:251],a[96:111]
M3 a[112:127],a[232:235],v[248:251],a[112:127]
s_bfe_u32 s61, s87, 0x80018
s_mul_i32 s61, s61, 4096
BL v[148:151],v27,s[36:39],s61 offen offset:1024 sc1
M3 a[128:143],a[236:239],v[248:251],a[128:143]
s_waitcnt lgkmcnt(0)
M3 a[80:95],a[240:243],v[252:255],a[80:95]
s_bfe_u32 s61, s87, 0x80018
s_mul_i32 s61, s61, 4096
BL v[152:155],v27,s[36:39],s61 offen offset:2048 sc1
M3 a[96:111],a[244:247],v[252:255],a[96:111]
M3 a[112:127],a[248:251],v[252:255],a[112:127]
s_bfe_u32 s61, s87, 0x80018
s_mul_i32 s61, s61, 4096
BL v[156:159],v27,s[36:39],s61 offen offset:3072 sc1
M3 a[128:143],a[252:255],v[252:255],a[128:143]
s_barrier
s_nop 1
AR v40,a80
AR v41,a81
AR v42,a82
AR v43,a83
AR v44,a88
AR v45,a89
AR v46,a90
AR v47,a91
v_pk_mul_f32 v[48:49], v[40:41], s[50:51] op_sel_hi:[1,0]
v_pk_mul_f32 v[50:51], v[42:43], s[50:51] op_sel_hi:[1,0]
v_exp_f32 v48, v48
v_exp_f32 v49, v49
v_exp_f32 v50, v50
v_exp_f32 v51, v51
v_pk_mul_f32 v[40:41], v[40:41], v[44:45]
v_pk_mul_f32 v[42:43], v[42:43], v[46:47]
v_pk_add_f32 v[48:49], v[48:49], 1.0 op_sel_hi:[1,0]
v_pk_add_f32 v[50:51], v[50:51], 1.0 op_sel_hi:[1,0]
v_rcp_f32 v48, v48
v_rcp_f32 v49, v49
v_rcp_f32 v50, v50
v_rcp_f32 v51, v51
v_pk_mul_f32 v[56:57], v[40:41], v[48:49]
v_pk_mul_f32 v[58:59], v[42:43], v[50:51]
AR v40,a84
AR v41,a85
AR v42,a86
AR v43,a87
AR v44,a92
AR v45,a93
AR v46,a94
AR v47,a95
v_pk_mul_f32 v[48:49], v[40:41], s[50:51] op_sel_hi:[1,0]
v_pk_mul_f32 v[50:51], v[42:43], s[50:51] op_sel_hi:[1,0]
v_exp_f32 v48, v48
v_exp_f32 v49, v49
v_exp_f32 v50, v50
v_exp_f32 v51, v51
v_pk_mul_f32 v[40:41], v[40:41], v[44:45]
v_pk_mul_f32 v[42:43], v[42:43], v[46:47]
v_pk_add_f32 v[48:49], v[48:49], 1.0 op_sel_hi:[1,0]
v_pk_add_f32 v[50:51], v[50:51], 1.0 op_sel_hi:[1,0]
v_rcp_f32 v48, v48
v_rcp_f32 v49, v49
v_rcp_f32 v50, v50
v_rcp_f32 v51, v51
v_pk_mul_f32 v[60:61], v[40:41], v[48:49]
v_pk_mul_f32 v[62:63], v[42:43], v[50:51]
CV v64,v56,v57
CV v65,v58,v59
CV v66,v60,v61
CV v67,v62,v63
buffer_store_dwordx4 v[64:67], v28, s[24:27], s47 offen sc1
AR v40,a96
AR v41,a97
AR v42,a98
AR v43,a99
AR v44,a104
AR v45,a105
AR v46,a106
AR v47,a107
v_pk_mul_f32 v[48:49], v[40:41], s[50:51] op_sel_hi:[1,0]
v_pk_mul_f32 v[50:51], v[42:43], s[50:51] op_sel_hi:[1,0]
v_exp_f32 v48, v48
v_exp_f32 v49, v49
v_exp_f32 v50, v50
v_exp_f32 v51, v51
v_pk_mul_f32 v[40:41], v[40:41], v[44:45]
v_pk_mul_f32 v[42:43], v[42:43], v[46:47]
v_pk_add_f32 v[48:49], v[48:49], 1.0 op_sel_hi:[1,0]
v_pk_add_f32 v[50:51], v[50:51], 1.0 op_sel_hi:[1,0]
v_rcp_f32 v48, v48
v_rcp_f32 v49, v49
v_rcp_f32 v50, v50
v_rcp_f32 v51, v51
v_pk_mul_f32 v[56:57], v[40:41], v[48:49]
v_pk_mul_f32 v[58:59], v[42:43], v[50:51]
AR v40,a100
AR v41,a101
AR v42,a102
AR v43,a103
AR v44,a108
AR v45,a109
AR v46,a110
AR v47,a111
v_pk_mul_f32 v[48:49], v[40:41], s[50:51] op_sel_hi:[1,0]
v_pk_mul_f32 v[50:51], v[42:43], s[50:51] op_sel_hi:[1,0]
v_exp_f32 v48, v48
v_exp_f32 v49, v49
v_exp_f32 v50, v50
v_exp_f32 v51, v51
v_pk_mul_f32 v[40:41], v[40:41], v[44:45]
v_pk_mul_f32 v[42:43], v[42:43], v[46:47]
v_pk_add_f32 v[48:49], v[48:49], 1.0 op_sel_hi:[1,0]
v_pk_add_f32 v[50:51], v[50:51], 1.0 op_sel_hi:[1,0]
v_rcp_f32 v48, v48
v_rcp_f32 v49, v49
v_rcp_f32 v50, v50
v_rcp_f32 v51, v51
v_pk_mul_f32 v[60:61], v[40:41], v[48:49]
v_pk_mul_f32 v[62:63], v[42:43], v[50:51]
CV v68,v56,v57
CV v69,v58,v59
CV v70,v60,v61
CV v71,v62,v63
buffer_store_dwordx4 v[68:71], v28, s[24:27], s47 offen offset:512 sc1
AR v40,a112
AR v41,a113
AR v42,a114
AR v43,a115
AR v44,a120
AR v45,a121
AR v46,a122
AR v47,a123
v_pk_mul_f32 v[48:49], v[40:41], s[50:51] op_sel_hi:[1,0]
v_pk_mul_f32 v[50:51], v[42:43], s[50:51] op_sel_hi:[1,0]
v_exp_f32 v48, v48
v_exp_f32 v49, v49
v_exp_f32 v50, v50
v_exp_f32 v51, v51
v_pk_mul_f32 v[40:41], v[40:41], v[44:45]
v_pk_mul_f32 v[42:43], v[42:43], v[46:47]
v_pk_add_f32 v[48:49], v[48:49], 1.0 op_sel_hi:[1,0]
v_pk_add_f32 v[50:51], v[50:51], 1.0 op_sel_hi:[1,0]
v_rcp_f32 v48, v48
v_rcp_f32 v49, v49
v_rcp_f32 v50, v50
v_rcp_f32 v51, v51
v_pk_mul_f32 v[56:57], v[40:41], v[48:49]
v_pk_mul_f32 v[58:59], v[42:43], v[50:51]
AR v40,a116
AR v41,a117
AR v42,a118
AR v43,a119
AR v44,a124
AR v45,a125
AR v46,a126
AR v47,a127
v_pk_mul_f32 v[48:49], v[40:41], s[50:51] op_sel_hi:[1,0]
v_pk_mul_f32 v[50:51], v[42:43], s[50:51] op_sel_hi:[1,0]
v_exp_f32 v48, v48
v_exp_f32 v49, v49
v_exp_f32 v50, v50
v_exp_f32 v51, v51
v_pk_mul_f32 v[40:41], v[40:41], v[44:45]
v_pk_mul_f32 v[42:43], v[42:43], v[46:47]
v_pk_add_f32 v[48:49], v[48:49], 1.0 op_sel_hi:[1,0]
v_pk_add_f32 v[50:51], v[50:51], 1.0 op_sel_hi:[1,0]
v_rcp_f32 v48, v48
v_rcp_f32 v49, v49
v_rcp_f32 v50, v50
v_rcp_f32 v51, v51
v_pk_mul_f32 v[60:61], v[40:41], v[48:49]
v_pk_mul_f32 v[62:63], v[42:43], v[50:51]
CV v64,v56,v57
CV v65,v58,v59
CV v66,v60,v61
CV v67,v62,v63
buffer_store_dwordx4 v[64:67], v29, s[24:27], s47 offen sc1
AR v40,a128
AR v41,a129
AR v42,a130
AR v43,a131
AR v44,a136
AR v45,a137
AR v46,a138
AR v47,a139
v_pk_mul_f32 v[48:49], v[40:41], s[50:51] op_sel_hi:[1,0]
v_pk_mul_f32 v[50:51], v[42:43], s[50:51] op_sel_hi:[1,0]
v_exp_f32 v48, v48
v_exp_f32 v49, v49
v_exp_f32 v50, v50
v_exp_f32 v51, v51
v_pk_mul_f32 v[40:41], v[40:41], v[44:45]
v_pk_mul_f32 v[42:43], v[42:43], v[46:47]
v_pk_add_f32 v[48:49], v[48:49], 1.0 op_sel_hi:[1,0]
v_pk_add_f32 v[50:51], v[50:51], 1.0 op_sel_hi:[1,0]
v_rcp_f32 v48, v48
v_rcp_f32 v49, v49
v_rcp_f32 v50, v50
v_rcp_f32 v51, v51
v_pk_mul_f32 v[56:57], v[40:41], v[48:49]
v_pk_mul_f32 v[58:59], v[42:43], v[50:51]
AR v40,a132
AR v41,a133
AR v42,a134
AR v43,a135
AR v44,a140
AR v45,a141
AR v46,a142
AR v47,a143
v_pk_mul_f32 v[48:49], v[40:41], s[50:51] op_sel_hi:[1,0]
v_pk_mul_f32 v[50:51], v[42:43], s[50:51] op_sel_hi:[1,0]
v_exp_f32 v48, v48
v_exp_f32 v49, v49
v_exp_f32 v50, v50
v_exp_f32 v51, v51
v_pk_mul_f32 v[40:41], v[40:41], v[44:45]
v_pk_mul_f32 v[42:43], v[42:43], v[46:47]
v_pk_add_f32 v[48:49], v[48:49], 1.0 op_sel_hi:[1,0]
v_pk_add_f32 v[50:51], v[50:51], 1.0 op_sel_hi:[1,0]
v_rcp_f32 v48, v48
v_rcp_f32 v49, v49
v_rcp_f32 v50, v50
v_rcp_f32 v51, v51
v_pk_mul_f32 v[60:61], v[40:41], v[48:49]
v_pk_mul_f32 v[62:63], v[42:43], v[50:51]
CV v68,v56,v57
CV v69,v58,v59
CV v70,v60,v61
CV v71,v62,v63
buffer_store_dwordx4 v[68:71], v29, s[24:27], s47 offen offset:512 sc1
s_waitcnt vmcnt(0)
buffer_store_dword v26, v20, s[24:27], s96 offen sc1
v_and_b32 v2, 1, v1
v_lshlrev_b32 v2, 2, v2
v_and_b32 v7, 2, v1
v_lshl_add_u32 v2, v7, 6, v2
s_lshl_b32 s7, s3, 8
s_add_u32 s7, s7, 1024
v_add_u32 v2, s7, v2
v_and_b32 v3, 1, v1
v_lshlrev_b32 v3, 2, v3
s_lshl_b32 s7, s3, 7
v_add_u32 v3, s7, v3
v_add_u32 v19, 512, v3
buffer_load_dword v6, v2, s[24:27], s99 offen sc1
buffer_load_dword v7, v19, s[24:27], s97 offen sc1
s_load_dwordx2 s[48:49], s[0:1], 56
s_and_b32 s7, s5, 7
s_lshl_b32 s40, s4, 1
s_lshr_b32 s7, s5, 3
s_add_u32 s40, s40, s7
s_and_b32 s7, s5, 7
s_mul_i32 s47, s40, 81920
s_mul_i32 s7, s7, 160
s_add_u32 s47, s47, s7
v_add_u32 v88, 0, v0
v_mul_u32_u24 v89, 6554, v88
v_lshrrev_b32 v89, 16, v89
v_mul_u32_u24 v90, 10, v89
v_sub_u32 v90, v88, v90
v_mul_u32_u24 v91, 1280, v89
v_lshl_add_u32 v10, v90, 4, v91
v_bfe_u32 v91, v89, 1, 2
v_lshlrev_b32 v90, 1, v90
v_xor_b32 v90, v90, v91
v_mul_u32_u24 v91, 320, v89
v_lshl_add_u32 v28, v90, 4, v91
v_xor_b32 v29, 16, v28
v_add_u32 v30, 81920, v28
v_add_u32 v31, 81920, v29
v_add_u32 v88, 256, v0
v_mul_u32_u24 v89, 6554, v88
v_lshrrev_b32 v89, 16, v89
v_mul_u32_u24 v90, 10, v89
v_sub_u32 v90, v88, v90
v_mul_u32_u24 v91, 1280, v89
v_lshl_add_u32 v11, v90, 4, v91
v_bfe_u32 v91, v89, 1, 2
v_lshlrev_b32 v90, 1, v90
v_xor_b32 v90, v90, v91
v_mul_u32_u24 v91, 320, v89
v_lshl_add_u32 v32, v90, 4, v91
v_xor_b32 v33, 16, v32
v_add_u32 v34, 81920, v32
v_add_u32 v35, 81920, v33
v_add_u32 v88, 512, v0
v_mul_u32_u24 v89, 6554, v88
v_lshrrev_b32 v89, 16, v89
v_mul_u32_u24 v90, 10, v89
v_sub_u32 v90, v88, v90
v_mul_u32_u24 v91, 1280, v89
v_lshl_add_u32 v12, v90, 4, v91
v_bfe_u32 v91, v89, 1, 2
v_lshlrev_b32 v90, 1, v90
v_xor_b32 v90, v90, v91
v_mul_u32_u24 v91, 320, v89
v_lshl_add_u32 v36, v90, 4, v91
v_xor_b32 v37, 16, v36
v_add_u32 v38, 81920, v36
v_add_u32 v39, 81920, v37
v_mov_b32 v91, 1073741824
v_cmp_gt_u32 vcc, 128, v0
s_nop 1
v_cndmask_b32 v12, v91, v12, vcc
v_and_b32 v88, 15, v1
v_bfe_u32 v90, v1, 1, 2
v_mul_u32_u24 v88, 320, v88
v_lshrrev_b32 v89, 4, v1
v_xor_b32 v89, v89, v90
v_lshl_add_u32 v88, v89, 4, v88
v_add_u32 v9, s6, v88
v_add_u32 v8, s6, v27
s_waitcnt lgkmcnt(0)
s_mov_b32 s12, s48
s_mov_b32 s13, s49
s_mov_b32 s14, 2621440
s_mov_b32 s15, 0x20000
M1 v[176:179],a[160:163],v[96:99],0
M1 v[192:195],a[164:167],v[96:99],0
BL a[12:15],v27,s[32:35],s65 offen offset:3072 sc1
M1 v[208:211],a[168:171],v[96:99],0
M1 v[224:227],a[172:175],v[96:99],0
BL a[16:19],v25,s[32:35],s65 offen sc1
M1 v[240:243],a[176:179],v[96:99],0
M1 v[180:183],a[160:163],v[100:103],0
M1 v[196:199],a[164:167],v[100:103],0
s_bfe_u32 s65, s70, 0x80000
s_mul_i32 s65, s65, 40960
BL a[20:23],v27,s[32:35],s65 offen sc1
M1 v[212:215],a[168:171],v[100:103],0
M1 v[228:231],a[172:175],v[100:103],0
BL a[24:27],v27,s[32:35],s65 offen offset:1024 sc1
M1 v[244:247],a[176:179],v[100:103],0
M1 v[184:187],a[160:163],v[104:107],0
M1 v[200:203],a[164:167],v[104:107],0
BL a[28:31],v27,s[32:35],s65 offen offset:2048 sc1
M1 v[216:219],a[168:171],v[104:107],0
M1 v[232:235],a[172:175],v[104:107],0
M1 v[248:251],a[176:179],v[104:107],0
M1 v[188:191],a[160:163],v[108:111],0
M1 v[204:207],a[164:167],v[108:111],0
M1 v[220:223],a[168:171],v[108:111],0
M1 v[236:239],a[172:175],v[108:111],0
M1 v[252:255],a[176:179],v[108:111],0
s_waitcnt vmcnt(6)
P2_GU2_E_chk:
v_cmp_ne_u32 vcc, v6, v26
s_nop 0
s_cmp_eq_u64 vcc, 0
s_cbranch_scc1 P2_GU2_E_ok
s_cmp_eq_u32 s101, 0
s_cbranch_scc1 P2_GU2_E_ok
s_sub_u32 s101, s101, 1
s_sleep 10
buffer_load_dword v6, v2, s[24:27], s99 offen sc1
s_waitcnt vmcnt(0)
s_branch P2_GU2_E_chk
P2_GU2_E_ok:
M1 v[176:179],a[180:183],v[112:115],v[176:179]
M1 v[192:195],a[184:187],v[112:115],v[192:195]
s_bfe_u32 s41, s88, 0x80000
s_mul_i32 s41, s41, 4096
BL a[80:83],v27,s[36:39],s41 offen sc1
M1 v[208:211],a[188:191],v[112:115],v[208:211]
M1 v[224:227],a[192:195],v[112:115],v[224:227]
BL a[84:87],v27,s[36:39],s41 offen offset:1024 sc1
M1 v[240:243],a[196:199],v[112:115],v[240:243]
M1 v[180:183],a[180:183],v[116:119],v[180:183]
M1 v[196:199],a[184:187],v[116:119],v[196:199]
BL a[88:91],v27,s[36:39],s41 offen offset:2048 sc1
M1 v[212:215],a[188:191],v[116:119],v[212:215]
M1 v[228:231],a[192:195],v[116:119],v[228:231]
BL a[92:95],v27,s[36:39],s41 offen offset:3072 sc1
M1 v[244:247],a[196:199],v[116:119],v[244:247]
M1 v[184:187],a[180:183],v[120:123],v[184:187]
M1 v[200:203],a[184:187],v[120:123],v[200:203]
s_bfe_u32 s41, s88, 0x80008
s_mul_i32 s41, s41, 4096
BL a[96:99],v27,s[36:39],s41 offen sc1
M1 v[216:219],a[188:191],v[120:123],v[216:219]
M1 v[232:235],a[192:195],v[120:123],v[232:235]
BL a[100:103],v27,s[36:39],s41 offen offset:1024 sc1
M1 v[248:251],a[196:199],v[120:123],v[248:251]
M1 v[188:191],a[180:183],v[124:127],v[188:191]
M1 v[204:207],a[184:187],v[124:127],v[204:207]
BL a[104:107],v27,s[36:39],s41 offen offset:2048 sc1
M1 v[220:223],a[188:191],v[124:127],v[220:223]
M1 v[236:239],a[192:195],v[124:127],v[236:239]
BL a[108:111],v27,s[36:39],s41 offen offset:3072 sc1
M1 v[252:255],a[196:199],v[124:127],v[252:255]
s_bfe_u32 s41, s88, 0x80010
s_mul_i32 s41, s41, 4096
BL a[112:115],v27,s[36:39],s41 offen sc1
BL a[116:119],v27,s[36:39],s41 offen offset:1024 sc1
BL a[120:123],v27,s[36:39],s41 offen offset:2048 sc1
BL a[124:127],v27,s[36:39],s41 offen offset:3072 sc1
s_bfe_u32 s41, s88, 0x80018
s_mul_i32 s41, s41, 4096
BL a[128:131],v27,s[36:39],s41 offen sc1
BL a[132:135],v27,s[36:39],s41 offen offset:1024 sc1
BL a[136:139],v27,s[36:39],s41 offen offset:2048 sc1
BL a[140:143],v27,s[36:39],s41 offen offset:3072 sc1
BL a[32:35],v27,s[32:35],s65 offen offset:3072 sc1
BL a[36:39],v25,s[32:35],s65 offen sc1
s_bfe_u32 s65, s70, 0x80008
s_mul_i32 s65, s65, 40960
BL a[40:43],v27,s[32:35],s65 offen sc1
BL a[44:47],v27,s[32:35],s65 offen offset:1024 sc1
BL a[48:51],v27,s[32:35],s65 offen offset:2048 sc1
s_waitcnt vmcnt(26)
P2_GU2_K_chk:
v_cmp_ne_u32 vcc, v7, v26
s_nop 0
s_cmp_eq_u64 vcc, 0
s_cbranch_scc1 P2_GU2_K_ok
s_cmp_eq_u32 s101, 0
s_cbranch_scc1 P2_GU2_K_ok
s_sub_u32 s101, s101, 1
s_sleep 10
buffer_load_dword v7, v19, s[24:27], s97 offen sc1
s_waitcnt vmcnt(0)
s_branch P2_GU2_K_chk
P2_GU2_K_ok:
M1 v[176:179],a[200:203],v[128:131],v[176:179]
M1 v[192:195],a[204:207],v[128:131],v[192:195]
ds_read_b128 v[64:67], v8 offset:33792
M1 v[208:211],a[208:211],v[128:131],v[208:211]
M1 v[224:227],a[212:215],v[128:131],v[224:227]
ds_read_b128 v[68:71], v8 offset:34816
M1 v[240:243],a[216:219],v[128:131],v[240:243]
M1 v[180:183],a[200:203],v[132:135],v[180:183]
M1 v[196:199],a[204:207],v[132:135],v[196:199]
ds_read_b128 v[72:75], v8 offset:35840
M1 v[212:215],a[208:211],v[132:135],v[212:215]
M1 v[228:231],a[212:215],v[132:135],v[228:231]
ds_read_b128 v[76:79], v8 offset:36864
M1 v[244:247],a[216:219],v[132:135],v[244:247]
M1 v[184:187],a[200:203],v[136:139],v[184:187]
M1 v[200:203],a[204:207],v[136:139],v[200:203]
s_bfe_u32 s41, s70, 0x80000
s_mul_i32 s41, s41, 4096
BL a[160:163],v27,s[36:39],s41 offen sc1
M1 v[216:219],a[208:211],v[136:139],v[216:219]
M1 v[232:235],a[212:215],v[136:139],v[232:235]
BL a[164:167],v27,s[36:39],s41 offen offset:1024 sc1
M1 v[248:251],a[216:219],v[136:139],v[248:251]
M1 v[188:191],a[200:203],v[140:143],v[188:191]
M1 v[204:207],a[204:207],v[140:143],v[204:207]
BL a[168:171],v27,s[36:39],s41 offen offset:2048 sc1
M1 v[220:223],a[208:211],v[140:143],v[220:223]
M1 v[236:239],a[212:215],v[140:143],v[236:239]
BL a[172:175],v27,s[36:39],s41 offen offset:3072 sc1
M1 v[252:255],a[216:219],v[140:143],v[252:255]
s_bfe_u32 s41, s70, 0x80008
s_mul_i32 s41, s41, 4096
BL a[176:179],v27,s[36:39],s41 offen sc1
BL a[180:183],v27,s[36:39],s41 offen offset:1024 sc1
BL a[184:187],v27,s[36:39],s41 offen offset:2048 sc1
BL a[188:191],v27,s[36:39],s41 offen offset:3072 sc1
buffer_load_dword v4, v2, s[24:27], s97 offen sc1
BL a[52:55],v27,s[32:35],s65 offen offset:3072 sc1
BL a[56:59],v25,s[32:35],s65 offen sc1
s_add_u32 m0, s6, 0
s_bfe_u32 s65, s89, 0x80000
s_mul_i32 s65, s65, 40960
BL v27,s[32:35],s65 offen sc1 lds
BL v27,s[32:35],s65 offen offset:1024 sc1 lds
BL v27,s[32:35],s65 offen offset:2048 sc1 lds
M1 v[176:179],a[220:223],v[144:147],v[176:179]
s_waitcnt lgkmcnt(3)
M1 v[192:195],v[64:67],v[144:147],v[192:195]
ds_read_b128 v[40:43], v8 offset:37888
s_waitcnt lgkmcnt(3)
M1 v[208:211],v[68:71],v[144:147],v[208:211]
s_waitcnt lgkmcnt(2)
M1 v[224:227],v[72:75],v[144:147],v[224:227]
ds_read_b128 v[44:47], v8 offset:38912
s_waitcnt lgkmcnt(2)
M1 v[240:243],v[76:79],v[144:147],v[240:243]
M1 v[180:183],a[220:223],v[148:151],v[180:183]
M1 v[196:199],v[64:67],v[148:151],v[196:199]
ds_read_b128 v[48:51], v8 offset:39936
M1 v[212:215],v[68:71],v[148:151],v[212:215]
M1 v[228:231],v[72:75],v[148:151],v[228:231]
BL v27,s[32:35],s65 offen offset:3072 sc1 lds
M1 v[244:247],v[76:79],v[148:151],v[244:247]
M1 v[184:187],a[220:223],v[152:155],v[184:187]
M1 v[200:203],v[64:67],v[152:155],v[200:203]
s_add_u32 m0, s6, 4096
s_nop 0
BL v25,s[32:35],s65 offen sc1 lds
M1 v[216:219],v[68:71],v[152:155],v[216:219]
M1 v[232:235],v[72:75],v[152:155],v[232:235]
s_add_u32 m0, s6, 5120
s_bfe_u32 s65, s89, 0x80008
s_mul_i32 s65, s65, 40960
BL v27,s[32:35],s65 offen sc1 lds
M1 v[248:251],v[76:79],v[152:155],v[248:251]
M1 v[188:191],a[220:223],v[156:159],v[188:191]
M1 v[204:207],v[64:67],v[156:159],v[204:207]
BL v27,s[32:35],s65 offen offset:1024 sc1 lds
M1 v[220:223],v[68:71],v[156:159],v[220:223]
M1 v[236:239],v[72:75],v[156:159],v[236:239]
BL v27,s[32:35],s65 offen offset:2048 sc1 lds
M1 v[252:255],v[76:79],v[156:159],v[252:255]
s_waitcnt vmcnt(10)
P2_GU2_L_chk:
v_cmp_ne_u32 vcc, v4, v26
s_nop 0
s_cmp_eq_u64 vcc, 0
s_cbranch_scc1 P2_GU2_L_ok
s_cmp_eq_u32 s101, 0
s_cbranch_scc1 P2_GU2_L_ok
s_sub_u32 s101, s101, 1
s_sleep 10
buffer_load_dword v4, v2, s[24:27], s97 offen sc1
s_waitcnt vmcnt(0)
s_branch P2_GU2_L_chk
P2_GU2_L_ok:
s_waitcnt lgkmcnt(2)
M1 v[176:179],v[40:43],a[80:83],v[176:179]
s_waitcnt lgkmcnt(1)
M1 v[192:195],v[44:47],a[80:83],v[192:195]
ds_read_b128 v[68:71], v8 offset:25600
s_waitcnt lgkmcnt(1)
M1 v[208:211],v[48:51],a[80:83],v[208:211]
M1 v[224:227],a[64:67],a[80:83],v[224:227]
ds_read_b128 v[72:75], v8 offset:26624
M1 v[240:243],a[68:71],a[80:83],v[240:243]
M1 v[180:183],v[40:43],a[84:87],v[180:183]
M1 v[196:199],v[44:47],a[84:87],v[196:199]
ds_read_b128 v[76:79], v8 offset:27648
M1 v[212:215],v[48:51],a[84:87],v[212:215]
M1 v[228:231],a[64:67],a[84:87],v[228:231]
s_bfe_u32 s41, s89, 0x80000
s_mul_i32 s41, s41, 4096
BL v[96:99],v27,s[36:39],s41 offen sc1
M1 v[244:247],a[68:71],a[84:87],v[244:247]
M1 v[184:187],v[40:43],a[88:91],v[184:187]
M1 v[200:203],v[44:47],a[88:91],v[200:203]
BL v[100:103],v27,s[36:39],s41 offen offset:1024 sc1
M1 v[216:219],v[48:51],a[88:91],v[216:219]
M1 v[232:235],a[64:67],a[88:91],v[232:235]
BL v[104:107],v27,s[36:39],s41 offen offset:2048 sc1
M1 v[248:251],a[68:71],a[88:91],v[248:251]
M1 v[188:191],v[40:43],a[92:95],v[188:191]
M1 v[204:207],v[44:47],a[92:95],v[204:207]
BL v[108:111],v27,s[36:39],s41 offen offset:3072 sc1
M1 v[220:223],v[48:51],a[92:95],v[220:223]
M1 v[236:239],a[64:67],a[92:95],v[236:239]
s_bfe_u32 s41, s89, 0x80008
s_mul_i32 s41, s41, 4096
BL v[112:115],v27,s[36:39],s41 offen sc1
M1 v[252:255],a[68:71],a[92:95],v[252:255]
BL v[116:119],v27,s[36:39],s41 offen offset:1024 sc1
BL v[120:123],v27,s[36:39],s41 offen offset:2048 sc1
BL v[124:127],v27,s[36:39],s41 offen offset:3072 sc1
s_bfe_u32 s41, s89, 0x80010
s_mul_i32 s41, s41, 4096
BL v[128:131],v27,s[36:39],s41 offen sc1
BL v[132:135],v27,s[36:39],s41 offen offset:1024 sc1
BL v[136:139],v27,s[36:39],s41 offen offset:2048 sc1
BL v[140:143],v27,s[36:39],s41 offen offset:3072 sc1
s_bfe_u32 s41, s89, 0x80018
s_mul_i32 s41, s41, 4096
BL v[144:147],v27,s[36:39],s41 offen sc1
BL v[148:151],v27,s[36:39],s41 offen offset:1024 sc1
BL v[152:155],v27,s[36:39],s41 offen offset:2048 sc1
BL v[156:159],v27,s[36:39],s41 offen offset:3072 sc1
BL v27,s[32:35],s65 offen offset:3072 sc1 lds
s_add_u32 m0, s6, 9216
s_nop 0
BL v25,s[32:35],s65 offen sc1 lds
s_add_u32 m0, s6, 10240
s_bfe_u32 s65, s89, 0x80010
s_mul_i32 s65, s65, 40960
BL v27,s[32:35],s65 offen sc1 lds
BL v27,s[32:35],s65 offen offset:1024 sc1 lds
BL v27,s[32:35],s65 offen offset:2048 sc1 lds
M1 v[176:179],a[72:75],a[96:99],v[176:179]
M1 v[192:195],a[76:79],a[96:99],v[192:195]
ds_read_b128 v[40:43], v8 offset:28672
s_waitcnt lgkmcnt(3)
M1 v[208:211],v[68:71],a[96:99],v[208:211]
s_waitcnt lgkmcnt(2)
M1 v[224:227],v[72:75],a[96:99],v[224:227]
ds_read_b128 v[44:47], v8 offset:29696
s_waitcnt lgkmcnt(2)
M1 v[240:243],v[76:79],a[96:99],v[240:243]
M1 v[180:183],a[72:75],a[100:103],v[180:183]
M1 v[196:199],a[76:79],a[100:103],v[196:199]
ds_read_b128 v[48:51], v8 offset:30720
M1 v[212:215],v[68:71],a[100:103],v[212:215]
M1 v[228:231],v[72:75],a[100:103],v[228:231]
ds_read_b128 v[52:55], v8 offset:31744
M1 v[244:247],v[76:79],a[100:103],v[244:247]
M1 v[184:187],a[72:75],a[104:107],v[184:187]
M1 v[200:203],a[76:79],a[104:107],v[200:203]
ds_read_b128 v[56:59], v8 offset:32768
M1 v[216:219],v[68:71],a[104:107],v[216:219]
M1 v[232:235],v[72:75],a[104:107],v[232:235]
BL v27,s[32:35],s65 offen offset:3072 sc1 lds
M1 v[248:251],v[76:79],a[104:107],v[248:251]
M1 v[188:191],a[72:75],a[108:111],v[188:191]
M1 v[204:207],a[76:79],a[108:111],v[204:207]
s_add_u32 m0, s6, 14336
s_nop 0
BL v25,s[32:35],s65 offen sc1 lds
M1 v[220:223],v[68:71],a[108:111],v[220:223]
M1 v[236:239],v[72:75],a[108:111],v[236:239]
s_add_u32 m0, s6, 15360
s_bfe_u32 s65, s89, 0x80018
s_mul_i32 s65, s65, 40960
BL v27,s[32:35],s65 offen sc1 lds
M1 v[252:255],v[76:79],a[108:111],v[252:255]
BL v27,s[32:35],s65 offen offset:1024 sc1 lds
BL v27,s[32:35],s65 offen offset:2048 sc1 lds
s_waitcnt lgkmcnt(4)
M1 v[176:179],v[40:43],a[112:115],v[176:179]
s_waitcnt lgkmcnt(3)
M1 v[192:195],v[44:47],a[112:115],v[192:195]
BL v27,s[32:35],s65 offen offset:3072 sc1 lds
s_waitcnt lgkmcnt(2)
M1 v[208:211],v[48:51],a[112:115],v[208:211]
s_waitcnt lgkmcnt(1)
M1 v[224:227],v[52:55],a[112:115],v[224:227]
s_add_u32 m0, s6, 19456
s_nop 0
BL v25,s[32:35],s65 offen sc1 lds
s_waitcnt lgkmcnt(0)
M1 v[240:243],v[56:59],a[112:115],v[240:243]
M1 v[180:183],v[40:43],a[116:119],v[180:183]
M1 v[196:199],v[44:47],a[116:119],v[196:199]
s_add_u32 m0, s6, 20480
s_bfe_u32 s65, s71, 0x80000
s_mul_i32 s65, s65, 40960
BL v27,s[32:35],s65 offen sc1 lds
M1 v[212:215],v[48:51],a[116:119],v[212:215]
M1 v[228:231],v[52:55],a[116:119],v[228:231]
BL v27,s[32:35],s65 offen offset:1024 sc1 lds
M1 v[244:247],v[56:59],a[116:119],v[244:247]
M1 v[184:187],v[40:43],a[120:123],v[184:187]
M1 v[200:203],v[44:47],a[120:123],v[200:203]
BL v27,s[32:35],s65 offen offset:2048 sc1 lds
M1 v[216:219],v[48:51],a[120:123],v[216:219]
M1 v[232:235],v[52:55],a[120:123],v[232:235]
M1 v[248:251],v[56:59],a[120:123],v[248:251]
M1 v[188:191],v[40:43],a[124:127],v[188:191]
M1 v[204:207],v[44:47],a[124:127],v[204:207]
M1 v[220:223],v[48:51],a[124:127],v[220:223]
M1 v[236:239],v[52:55],a[124:127],v[236:239]
M1 v[252:255],v[56:59],a[124:127],v[252:255]
M1 v[176:179],a[0:3],a[128:131],v[176:179]
M1 v[192:195],a[4:7],a[128:131],v[192:195]
BL v27,s[32:35],s65 offen offset:3072 sc1 lds
M1 v[208:211],a[8:11],a[128:131],v[208:211]
M1 v[224:227],a[12:15],a[128:131],v[224:227]
s_add_u32 m0, s6, 24576
s_nop 0
BL v25,s[32:35],s65 offen sc1 lds
M1 v[240:243],a[16:19],a[128:131],v[240:243]
M1 v[180:183],a[0:3],a[132:135],v[180:183]
M1 v[196:199],a[4:7],a[132:135],v[196:199]
s_bfe_u32 s65, s71, 0x80008
s_mul_i32 s65, s65, 40960
BL a[224:227],v27,s[32:35],s65 offen sc1
M1 v[212:215],a[8:11],a[132:135],v[212:215]
M1 v[228:231],a[12:15],a[132:135],v[228:231]
BL a[228:231],v27,s[32:35],s65 offen offset:1024 sc1
M1 v[244:247],a[16:19],a[132:135],v[244:247]
M1 v[184:187],a[0:3],a[136:139],v[184:187]
M1 v[200:203],a[4:7],a[136:139],v[200:203]
BL a[232:235],v27,s[32:35],s65 offen offset:2048 sc1
M1 v[216:219],a[8:11],a[136:139],v[216:219]
M1 v[232:235],a[12:15],a[136:139],v[232:235]
M1 v[248:251],a[16:19],a[136:139],v[248:251]
M1 v[188:191],a[0:3],a[140:143],v[188:191]
M1 v[204:207],a[4:7],a[140:143],v[204:207]
M1 v[220:223],a[8:11],a[140:143],v[220:223]
M1 v[236:239],a[12:15],a[140:143],v[236:239]
M1 v[252:255],a[16:19],a[140:143],v[252:255]
M1 v[176:179],a[20:23],a[160:163],v[176:179]
M1 v[192:195],a[24:27],a[160:163],v[192:195]
BL a[236:239],v27,s[32:35],s65 offen offset:3072 sc1
M1 v[208:211],a[28:31],a[160:163],v[208:211]
M1 v[224:227],a[32:35],a[160:163],v[224:227]
BL a[240:243],v25,s[32:35],s65 offen sc1
M1 v[240:243],a[36:39],a[160:163],v[240:243]
M1 v[180:183],a[20:23],a[164:167],v[180:183]
M1 v[196:199],a[24:27],a[164:167],v[196:199]
s_bfe_u32 s65, s71, 0x80010
s_mul_i32 s65, s65, 40960
BL a[244:247],v27,s[32:35],s65 offen sc1
M1 v[212:215],a[28:31],a[164:167],v[212:215]
M1 v[228:231],a[32:35],a[164:167],v[228:231]
BL a[248:251],v27,s[32:35],s65 offen offset:1024 sc1
M1 v[244:247],a[36:39],a[164:167],v[244:247]
M1 v[184:187],a[20:23],a[168:171],v[184:187]
M1 v[200:203],a[24:27],a[168:171],v[200:203]
BL a[252:255],v27,s[32:35],s65 offen offset:2048 sc1
M1 v[216:219],a[28:31],a[168:171],v[216:219]
M1 v[232:235],a[32:35],a[168:171],v[232:235]
M1 v[248:251],a[36:39],a[168:171],v[248:251]
M1 v[188:191],a[20:23],a[172:175],v[188:191]
M1 v[204:207],a[24:27],a[172:175],v[204:207]
M1 v[220:223],a[28:31],a[172:175],v[220:223]
M1 v[236:239],a[32:35],a[172:175],v[236:239]
M1 v[252:255],a[36:39],a[172:175],v[252:255]
M1 v[176:179],a[40:43],a[176:179],v[176:179]
M1 v[192:195],a[44:47],a[176:179],v[192:195]
s_waitcnt vmcnt(48)
ds_read_b128 v[40:43], v8
M1 v[208:211],a[48:51],a[176:179],v[208:211]
M1 v[224:227],a[52:55],a[176:179],v[224:227]
s_waitcnt vmcnt(47)
ds_read_b128 v[44:47], v8 offset:1024
M1 v[240:243],a[56:59],a[176:179],v[240:243]
M1 v[180:183],a[40:43],a[180:183],v[180:183]
M1 v[196:199],a[44:47],a[180:183],v[196:199]
s_waitcnt vmcnt(46)
ds_read_b128 v[48:51], v8 offset:2048
M1 v[212:215],a[48:51],a[180:183],v[212:215]
M1 v[228:231],a[52:55],a[180:183],v[228:231]
s_waitcnt vmcnt(45)
ds_read_b128 v[52:55], v8 offset:3072
M1 v[244:247],a[56:59],a[180:183],v[244:247]
M1 v[184:187],a[40:43],a[184:187],v[184:187]
M1 v[200:203],a[44:47],a[184:187],v[200:203]
s_waitcnt vmcnt(44)
ds_read_b128 v[56:59], v8 offset:4096
M1 v[216:219],a[48:51],a[184:187],v[216:219]
M1 v[232:235],a[52:55],a[184:187],v[232:235]
BL v[160:163],v27,s[32:35],s65 offen offset:3072 sc1
M1 v[248:251],a[56:59],a[184:187],v[248:251]
M1 v[188:191],a[40:43],a[188:191],v[188:191]
M1 v[204:207],a[44:47],a[188:191],v[204:207]
BL v[164:167],v25,s[32:35],s65 offen sc1
M1 v[220:223],a[48:51],a[188:191],v[220:223]
M1 v[236:239],a[52:55],a[188:191],v[236:239]
s_bfe_u32 s65, s71, 0x80018
s_mul_i32 s65, s65, 40960
BL v[168:171],v27,s[32:35],s65 offen sc1
M1 v[252:255],a[56:59],a[188:191],v[252:255]
BL v[172:175],v27,s[32:35],s65 offen offset:1024 sc1
BL a[144:147],v27,s[32:35],s65 offen offset:2048 sc1
s_waitcnt vmcnt(45)
s_waitcnt lgkmcnt(4)
M1 v[176:179],v[40:43],v[96:99],v[176:179]
s_waitcnt lgkmcnt(3)
M1 v[192:195],v[44:47],v[96:99],v[192:195]
ds_read_b128 v[60:63], v8 offset:5120
s_waitcnt lgkmcnt(3)
M1 v[208:211],v[48:51],v[96:99],v[208:211]
s_waitcnt lgkmcnt(2)
M1 v[224:227],v[52:55],v[96:99],v[224:227]
ds_read_b128 v[64:67], v8 offset:6144
s_waitcnt lgkmcnt(2)
M1 v[240:243],v[56:59],v[96:99],v[240:243]
s_waitcnt vmcnt(44)
M1 v[180:183],v[40:43],v[100:103],v[180:183]
M1 v[196:199],v[44:47],v[100:103],v[196:199]
ds_read_b128 v[68:71], v8 offset:7168
M1 v[212:215],v[48:51],v[100:103],v[212:215]
M1 v[228:231],v[52:55],v[100:103],v[228:231]
s_waitcnt vmcnt(29)
ds_read_b128 v[72:75], v8 offset:8192
M1 v[244:247],v[56:59],v[100:103],v[244:247]
M1 v[184:187],v[40:43],v[104:107],v[184:187]
M1 v[200:203],v[44:47],v[104:107],v[200:203]
s_waitcnt vmcnt(28)
ds_read_b128 v[76:79], v8 offset:9216
M1 v[216:219],v[48:51],v[104:107],v[216:219]
M1 v[232:235],v[52:55],v[104:107],v[232:235]
BL v[80:83],v10,s[8:11],s47 offen
M1 v[248:251],v[56:59],v[104:107],v[248:251]
M1 v[188:191],v[40:43],v[108:111],v[188:191]
M1 v[204:207],v[44:47],v[108:111],v[204:207]
BL v[84:87],v11,s[8:11],s47 offen
M1 v[220:223],v[48:51],v[108:111],v[220:223]
M1 v[236:239],v[52:55],v[108:111],v[236:239]
BL v[88:91],v12,s[8:11],s47 offen
M1 v[252:255],v[56:59],v[108:111],v[252:255]
buffer_load_dword v5, v3, s[24:27], s97 offen sc1
BL a[148:151],v27,s[32:35],s65 offen offset:3072 sc1
BL a[152:155],v25,s[32:35],s65 offen sc1
s_bfe_u32 s65, s70, 0x80010
s_mul_i32 s65, s65, 40960
BL a[156:159],v27,s[32:35],s65 offen sc1
BL a[208:211],v27,s[32:35],s65 offen offset:1024 sc1
BL a[212:215],v27,s[32:35],s65 offen offset:2048 sc1
s_waitcnt lgkmcnt(4)
M1 v[176:179],v[60:63],v[112:115],v[176:179]
s_waitcnt lgkmcnt(3)
M1 v[192:195],v[64:67],v[112:115],v[192:195]
s_waitcnt vmcnt(36)
ds_read_b128 v[40:43], v8 offset:10240
s_waitcnt lgkmcnt(3)
M1 v[208:211],v[68:71],v[112:115],v[208:211]
s_waitcnt lgkmcnt(2)
M1 v[224:227],v[72:75],v[112:115],v[224:227]
s_waitcnt vmcnt(35)
ds_read_b128 v[44:47], v8 offset:11264
s_waitcnt lgkmcnt(2)
M1 v[240:243],v[76:79],v[112:115],v[240:243]
M1 v[180:183],v[60:63],v[116:119],v[180:183]
M1 v[196:199],v[64:67],v[116:119],v[196:199]
s_waitcnt vmcnt(34)
ds_read_b128 v[48:51], v8 offset:12288
M1 v[212:215],v[68:71],v[116:119],v[212:215]
M1 v[228:231],v[72:75],v[116:119],v[228:231]
s_waitcnt vmcnt(33)
ds_read_b128 v[52:55], v8 offset:13312
M1 v[244:247],v[76:79],v[116:119],v[244:247]
M1 v[184:187],v[60:63],v[120:123],v[184:187]
M1 v[200:203],v[64:67],v[120:123],v[200:203]
s_waitcnt vmcnt(32)
ds_read_b128 v[56:59], v8 offset:14336
M1 v[216:219],v[68:71],v[120:123],v[216:219]
M1 v[232:235],v[72:75],v[120:123],v[232:235]
BL a[216:219],v27,s[32:35],s65 offen offset:3072 sc1
M1 v[248:251],v[76:79],v[120:123],v[248:251]
M1 v[188:191],v[60:63],v[124:127],v[188:191]
M1 v[204:207],v[64:67],v[124:127],v[204:207]
BL a[220:223],v25,s[32:35],s65 offen sc1
M1 v[220:223],v[68:71],v[124:127],v[220:223]
M1 v[236:239],v[72:75],v[124:127],v[236:239]
M1 v[252:255],v[76:79],v[124:127],v[252:255]
s_waitcnt vmcnt(7)
P2_GU2_O_chk:
v_cmp_ne_u32 vcc, v5, v26
s_nop 0
s_cmp_eq_u64 vcc, 0
s_cbranch_scc1 P2_GU2_O_ok
s_cmp_eq_u32 s101, 0
s_cbranch_scc1 P2_GU2_O_ok
s_sub_u32 s101, s101, 1
s_sleep 4
buffer_load_dword v5, v3, s[24:27], s97 offen sc1
s_waitcnt vmcnt(0)
s_branch P2_GU2_O_chk
P2_GU2_O_ok:
s_waitcnt lgkmcnt(4)
M1 v[176:179],v[40:43],v[128:131],v[176:179]
s_waitcnt lgkmcnt(3)
M1 v[192:195],v[44:47],v[128:131],v[192:195]
ds_read_b128 v[60:63], v8 offset:15360
s_waitcnt lgkmcnt(3)
M1 v[208:211],v[48:51],v[128:131],v[208:211]
s_waitcnt lgkmcnt(2)
M1 v[224:227],v[52:55],v[128:131],v[224:227]
ds_read_b128 v[64:67], v8 offset:16384
s_waitcnt lgkmcnt(2)
M1 v[240:243],v[56:59],v[128:131],v[240:243]
M1 v[180:183],v[40:43],v[132:135],v[180:183]
M1 v[196:199],v[44:47],v[132:135],v[196:199]
ds_read_b128 v[68:71], v8 offset:17408
M1 v[212:215],v[48:51],v[132:135],v[212:215]
M1 v[228:231],v[52:55],v[132:135],v[228:231]
ds_read_b128 v[72:75], v8 offset:18432
M1 v[244:247],v[56:59],v[132:135],v[244:247]
M1 v[184:187],v[40:43],v[136:139],v[184:187]
M1 v[200:203],v[44:47],v[136:139],v[200:203]
ds_read_b128 v[76:79], v8 offset:19456
M1 v[216:219],v[48:51],v[136:139],v[216:219]
M1 v[232:235],v[52:55],v[136:139],v[232:235]
s_bfe_u32 s41, s71, 0x80000
s_mul_i32 s41, s41, 4096
BL a[80:83],v27,s[36:39],s41 offen sc1
M1 v[248:251],v[56:59],v[136:139],v[248:251]
M1 v[188:191],v[40:43],v[140:143],v[188:191]
M1 v[204:207],v[44:47],v[140:143],v[204:207]
BL a[84:87],v27,s[36:39],s41 offen offset:1024 sc1
M1 v[220:223],v[48:51],v[140:143],v[220:223]
M1 v[236:239],v[52:55],v[140:143],v[236:239]
BL a[88:91],v27,s[36:39],s41 offen offset:2048 sc1
M1 v[252:255],v[56:59],v[140:143],v[252:255]
BL a[92:95],v27,s[36:39],s41 offen offset:3072 sc1
s_bfe_u32 s41, s71, 0x80008
s_mul_i32 s41, s41, 4096
BL a[96:99],v27,s[36:39],s41 offen sc1
BL a[100:103],v27,s[36:39],s41 offen offset:1024 sc1
BL a[104:107],v27,s[36:39],s41 offen offset:2048 sc1
BL a[108:111],v27,s[36:39],s41 offen offset:3072 sc1
s_bfe_u32 s41, s71, 0x80010
s_mul_i32 s41, s41, 4096
BL a[112:115],v27,s[36:39],s41 offen sc1
BL a[116:119],v27,s[36:39],s41 offen offset:1024 sc1
BL a[120:123],v27,s[36:39],s41 offen offset:2048 sc1
BL a[124:127],v27,s[36:39],s41 offen offset:3072 sc1
s_bfe_u32 s41, s71, 0x80018
s_mul_i32 s41, s41, 4096
BL a[128:131],v27,s[36:39],s41 offen sc1
BL a[132:135],v27,s[36:39],s41 offen offset:1024 sc1
BL a[136:139],v27,s[36:39],s41 offen offset:2048 sc1
BL a[140:143],v27,s[36:39],s41 offen offset:3072 sc1
s_bfe_u32 s41, s70, 0x80010
s_mul_i32 s41, s41, 4096
BL a[192:195],v27,s[36:39],s41 offen sc1
BL a[196:199],v27,s[36:39],s41 offen offset:1024 sc1
BL a[200:203],v27,s[36:39],s41 offen offset:2048 sc1
BL a[204:207],v27,s[36:39],s41 offen offset:3072 sc1
s_waitcnt lgkmcnt(4)
M1 v[176:179],v[60:63],v[144:147],v[176:179]
s_waitcnt lgkmcnt(3)
M1 v[192:195],v[64:67],v[144:147],v[192:195]
ds_read_b128 v[40:43], v8 offset:20480
s_waitcnt lgkmcnt(3)
M1 v[208:211],v[68:71],v[144:147],v[208:211]
s_waitcnt lgkmcnt(2)
M1 v[224:227],v[72:75],v[144:147],v[224:227]
ds_read_b128 v[44:47], v8 offset:21504
s_waitcnt lgkmcnt(2)
M1 v[240:243],v[76:79],v[144:147],v[240:243]
M1 v[180:183],v[60:63],v[148:151],v[180:183]
M1 v[196:199],v[64:67],v[148:151],v[196:199]
ds_read_b128 v[48:51], v8 offset:22528
M1 v[212:215],v[68:71],v[148:151],v[212:215]
M1 v[228:231],v[72:75],v[148:151],v[228:231]
ds_read_b128 v[52:55], v8 offset:23552
M1 v[244:247],v[76:79],v[148:151],v[244:247]
M1 v[184:187],v[60:63],v[152:155],v[184:187]
M1 v[200:203],v[64:67],v[152:155],v[200:203]
ds_read_b128 v[56:59], v8 offset:24576
M1 v[216:219],v[68:71],v[152:155],v[216:219]
M1 v[232:235],v[72:75],v[152:155],v[232:235]
M1 v[248:251],v[76:79],v[152:155],v[248:251]
M1 v[188:191],v[60:63],v[156:159],v[188:191]
M1 v[204:207],v[64:67],v[156:159],v[204:207]
M1 v[220:223],v[68:71],v[156:159],v[220:223]
M1 v[236:239],v[72:75],v[156:159],v[236:239]
M1 v[252:255],v[76:79],v[156:159],v[252:255]
s_waitcnt vmcnt(19)
s_waitcnt lgkmcnt(4)
M1 a[0:3],v[40:43],a[80:83],0
s_waitcnt lgkmcnt(3)
M1 a[16:19],v[44:47],a[80:83],0
s_waitcnt lgkmcnt(2)
M1 a[32:35],v[48:51],a[80:83],0
s_waitcnt lgkmcnt(1)
M1 a[48:51],v[52:55],a[80:83],0
s_waitcnt lgkmcnt(0)
M1 a[64:67],v[56:59],a[80:83],0
s_waitcnt vmcnt(18)
M1 a[4:7],v[40:43],a[84:87],0
M1 a[20:23],v[44:47],a[84:87],0
M1 a[36:39],v[48:51],a[84:87],0
M1 a[52:55],v[52:55],a[84:87],0
M1 a[68:71],v[56:59],a[84:87],0
s_waitcnt vmcnt(17)
M1 a[8:11],v[40:43],a[88:91],0
M1 a[24:27],v[44:47],a[88:91],0
ds_write_b128 v9, v[176:179]
M1 a[40:43],v[48:51],a[88:91],0
M1 a[56:59],v[52:55],a[88:91],0
ds_write_b128 v9, v[180:183] offset:5120
M1 a[72:75],v[56:59],a[88:91],0
s_waitcnt vmcnt(16)
M1 a[12:15],v[40:43],a[92:95],0
M1 a[28:31],v[44:47],a[92:95],0
ds_write_b128 v9, v[184:187] offset:10240
M1 a[44:47],v[48:51],a[92:95],0
M1 a[60:63],v[52:55],a[92:95],0
ds_write_b128 v9, v[188:191] offset:15360
M1 a[76:79],v[56:59],a[92:95],0
s_waitcnt vmcnt(15)
M1 a[0:3],a[224:227],a[96:99],a[0:3]
M1 a[16:19],a[228:231],a[96:99],a[16:19]
ds_write_b128 v9, v[192:195] offset:64
M1 a[32:35],a[232:235],a[96:99],a[32:35]
M1 a[48:51],a[236:239],a[96:99],a[48:51]
ds_write_b128 v9, v[196:199] offset:5184
M1 a[64:67],a[240:243],a[96:99],a[64:67]
s_waitcnt vmcnt(14)
M1 a[4:7],a[224:227],a[100:103],a[4:7]
M1 a[20:23],a[228:231],a[100:103],a[20:23]
ds_write_b128 v9, v[200:203] offset:10304
M1 a[36:39],a[232:235],a[100:103],a[36:39]
M1 a[52:55],a[236:239],a[100:103],a[52:55]
ds_write_b128 v9, v[204:207] offset:15424
M1 a[68:71],a[240:243],a[100:103],a[68:71]
s_waitcnt vmcnt(13)
M1 a[8:11],a[224:227],a[104:107],a[8:11]
M1 a[24:27],a[228:231],a[104:107],a[24:27]
ds_write_b128 v9, v[208:211] offset:128
M1 a[40:43],a[232:235],a[104:107],a[40:43]
M1 a[56:59],a[236:239],a[104:107],a[56:59]
ds_write_b128 v9, v[212:215] offset:5248
M1 a[72:75],a[240:243],a[104:107],a[72:75]
s_waitcnt vmcnt(12)
M1 a[12:15],a[224:227],a[108:111],a[12:15]
M1 a[28:31],a[228:231],a[108:111],a[28:31]
ds_write_b128 v9, v[216:219] offset:10368
M1 a[44:47],a[232:235],a[108:111],a[44:47]
M1 a[60:63],a[236:239],a[108:111],a[60:63]
ds_write_b128 v9, v[220:223] offset:15488
M1 a[76:79],a[240:243],a[108:111],a[76:79]
s_waitcnt vmcnt(11)
M1 a[0:3],a[244:247],a[112:115],a[0:3]
M1 a[16:19],a[248:251],a[112:115],a[16:19]
ds_write_b128 v9, v[224:227] offset:192
M1 a[32:35],a[252:255],a[112:115],a[32:35]
M1 a[48:51],v[160:163],a[112:115],a[48:51]
ds_write_b128 v9, v[228:231] offset:5312
M1 a[64:67],v[164:167],a[112:115],a[64:67]
s_waitcnt vmcnt(10)
M1 a[4:7],a[244:247],a[116:119],a[4:7]
M1 a[20:23],a[248:251],a[116:119],a[20:23]
ds_write_b128 v9, v[232:235] offset:10432
M1 a[36:39],a[252:255],a[116:119],a[36:39]
M1 a[52:55],v[160:163],a[116:119],a[52:55]
ds_write_b128 v9, v[236:239] offset:15552
M1 a[68:71],v[164:167],a[116:119],a[68:71]
s_waitcnt vmcnt(9)
M1 a[8:11],a[244:247],a[120:123],a[8:11]
M1 a[24:27],a[248:251],a[120:123],a[24:27]
ds_write_b128 v9, v[240:243] offset:256
M1 a[40:43],a[252:255],a[120:123],a[40:43]
M1 a[56:59],v[160:163],a[120:123],a[56:59]
ds_write_b128 v9, v[244:247] offset:5376
M1 a[72:75],v[164:167],a[120:123],a[72:75]
s_waitcnt vmcnt(8)
M1 a[12:15],a[244:247],a[124:127],a[12:15]
M1 a[28:31],a[248:251],a[124:127],a[28:31]
ds_write_b128 v9, v[248:251] offset:10496
M1 a[44:47],a[252:255],a[124:127],a[44:47]
M1 a[60:63],v[160:163],a[124:127],a[60:63]
ds_write_b128 v9, v[252:255] offset:15616
M1 a[76:79],v[164:167],a[124:127],a[76:79]
s_waitcnt vmcnt(7)
M1 a[0:3],v[168:171],a[128:131],a[0:3]
M1 a[16:19],v[172:175],a[128:131],a[16:19]
M1 a[32:35],a[144:147],a[128:131],a[32:35]
M1 a[48:51],a[148:151],a[128:131],a[48:51]
M1 a[64:67],a[152:155],a[128:131],a[64:67]
s_waitcnt vmcnt(6)
M1 a[4:7],v[168:171],a[132:135],a[4:7]
M1 a[20:23],v[172:175],a[132:135],a[20:23]
M1 a[36:39],a[144:147],a[132:135],a[36:39]
M1 a[52:55],a[148:151],a[132:135],a[52:55]
M1 a[68:71],a[152:155],a[132:135],a[68:71]
s_waitcnt vmcnt(5)
M1 a[8:11],v[168:171],a[136:139],a[8:11]
M1 a[24:27],v[172:175],a[136:139],a[24:27]
M1 a[40:43],a[144:147],a[136:139],a[40:43]
M1 a[56:59],a[148:151],a[136:139],a[56:59]
M1 a[72:75],a[152:155],a[136:139],a[72:75]
s_waitcnt vmcnt(4)
M1 a[12:15],v[168:171],a[140:143],a[12:15]
M1 a[28:31],v[172:175],a[140:143],a[28:31]
M1 a[44:47],a[144:147],a[140:143],a[44:47]
M1 a[60:63],a[148:151],a[140:143],a[60:63]
M1 a[76:79],a[152:155],a[140:143],a[76:79]
s_waitcnt lgkmcnt(0)
s_barrier
s_waitcnt vmcnt(3)
M1 a[0:3],a[156:159],a[192:195],a[0:3]
M1 a[16:19],a[208:211],a[192:195],a[16:19]
ds_read_b128 v[96:99], v28
ds_read_b128 v[100:103], v29
ds_read_b128 v[104:107], v28 offset:40960
M1 a[32:35],a[212:215],a[192:195],a[32:35]
M1 a[48:51],a[216:219],a[192:195],a[48:51]
ds_read_b128 v[108:111], v29 offset:40960
ds_read_b128 v[112:115], v30
ds_read_b128 v[116:119], v31
M1 a[64:67],a[220:223],a[192:195],a[64:67]
s_waitcnt vmcnt(2)
M1 a[4:7],a[156:159],a[196:199],a[4:7]
M1 a[20:23],a[208:211],a[196:199],a[20:23]
ds_read_b128 v[120:123], v30 offset:40960
ds_read_b128 v[124:127], v31 offset:40960
ds_read_b128 v[160:163], v32
M1 a[36:39],a[212:215],a[196:199],a[36:39]
M1 a[52:55],a[216:219],a[196:199],a[52:55]
ds_read_b128 v[164:167], v33
ds_read_b128 v[168:171], v32 offset:40960
ds_read_b128 v[172:175], v33 offset:40960
M1 a[68:71],a[220:223],a[196:199],a[68:71]
s_waitcnt vmcnt(1)
M1 a[8:11],a[156:159],a[200:203],a[8:11]
M1 a[24:27],a[208:211],a[200:203],a[24:27]
ds_read_b128 v[176:179], v34
ds_read_b128 v[180:183], v35
ds_read_b128 v[184:187], v34 offset:40960
M1 a[40:43],a[212:215],a[200:203],a[40:43]
M1 a[56:59],a[216:219],a[200:203],a[56:59]
ds_read_b128 v[188:191], v35 offset:40960
ds_read_b128 v[224:227], v36
ds_read_b128 v[228:231], v37
M1 a[72:75],a[220:223],a[200:203],a[72:75]
s_waitcnt vmcnt(0)
M1 a[12:15],a[156:159],a[204:207],a[12:15]
M1 a[28:31],a[208:211],a[204:207],a[28:31]
ds_read_b128 v[232:235], v36 offset:40960
ds_read_b128 v[236:239], v37 offset:40960
ds_read_b128 v[240:243], v38
M1 a[44:47],a[212:215],a[204:207],a[44:47]
M1 a[60:63],a[216:219],a[204:207],a[60:63]
ds_read_b128 v[244:247], v39
ds_read_b128 v[248:251], v38 offset:40960
ds_read_b128 v[252:255], v39 offset:40960
M1 a[76:79],a[220:223],a[204:207],a[76:79]
ds_write_b128 v9, a[0:3] offset:20480
s_waitcnt lgkmcnt(15)
v_pk_add_f32 v[96:97], v[96:97], v[104:105]
v_pk_add_f32 v[98:99], v[98:99], v[106:107]
v_pk_add_f32 v[100:101], v[100:101], v[108:109]
v_pk_add_f32 v[102:103], v[102:103], v[110:111]
v_pk_add_f32 v[112:113], v[112:113], v[120:121]
v_pk_add_f32 v[114:115], v[114:115], v[122:123]
ds_write_b128 v9, a[4:7] offset:25600
v_pk_add_f32 v[116:117], v[116:117], v[124:125]
v_pk_add_f32 v[118:119], v[118:119], v[126:127]
v_pk_add_f32 v[96:97], v[96:97], v[112:113]
v_pk_add_f32 v[98:99], v[98:99], v[114:115]
v_pk_add_f32 v[100:101], v[100:101], v[116:117]
v_pk_add_f32 v[102:103], v[102:103], v[118:119]
v_pk_mul_f32 v[104:105], v[96:97], s[50:51] op_sel_hi:[1,0]
ds_write_b128 v9, a[8:11] offset:30720
v_pk_mul_f32 v[106:107], v[98:99], s[50:51] op_sel_hi:[1,0]
v_pk_mul_f32 v[108:109], v[100:101], s[50:51] op_sel_hi:[1,0]
v_pk_mul_f32 v[110:111], v[102:103], s[50:51] op_sel_hi:[1,0]
v_exp_f32 v104, v104
v_lshlrev_b32 v112, 16, v80
v_exp_f32 v105, v105
v_and_b32 v113, s52, v80
ds_write_b128 v9, a[12:15] offset:35840
v_exp_f32 v106, v106
v_lshlrev_b32 v114, 16, v81
v_exp_f32 v107, v107
v_and_b32 v115, s52, v81
v_exp_f32 v108, v108
v_lshlrev_b32 v116, 16, v82
v_exp_f32 v109, v109
ds_write_b128 v9, a[16:19] offset:20544
v_and_b32 v117, s52, v82
v_exp_f32 v110, v110
v_lshlrev_b32 v118, 16, v83
v_exp_f32 v111, v111
v_and_b32 v119, s52, v83
v_pk_add_f32 v[104:105], v[104:105], 1.0 op_sel_hi:[1,0]
v_pk_add_f32 v[106:107], v[106:107], 1.0 op_sel_hi:[1,0]
ds_write_b128 v9, a[20:23] offset:25664
v_pk_add_f32 v[108:109], v[108:109], 1.0 op_sel_hi:[1,0]
v_pk_add_f32 v[110:111], v[110:111], 1.0 op_sel_hi:[1,0]
v_rcp_f32 v104, v104
v_rcp_f32 v105, v105
v_rcp_f32 v106, v106
v_rcp_f32 v107, v107
v_rcp_f32 v108, v108
ds_write_b128 v9, a[24:27] offset:30784
v_rcp_f32 v109, v109
v_rcp_f32 v110, v110
v_rcp_f32 v111, v111
v_pk_mul_f32 v[96:97], v[96:97], v[104:105]
v_pk_mul_f32 v[98:99], v[98:99], v[106:107]
v_pk_mul_f32 v[100:101], v[100:101], v[108:109]
v_pk_mul_f32 v[102:103], v[102:103], v[110:111]
ds_write_b128 v9, a[28:31] offset:35904
s_waitcnt lgkmcnt(15)
v_pk_add_f32 v[160:161], v[160:161], v[168:169]
v_pk_add_f32 v[162:163], v[162:163], v[170:171]
v_pk_add_f32 v[164:165], v[164:165], v[172:173]
v_pk_add_f32 v[166:167], v[166:167], v[174:175]
v_pk_add_f32 v[176:177], v[176:177], v[184:185]
v_pk_add_f32 v[178:179], v[178:179], v[186:187]
ds_write_b128 v9, a[32:35] offset:20608
v_pk_add_f32 v[180:181], v[180:181], v[188:189]
v_pk_add_f32 v[182:183], v[182:183], v[190:191]
v_pk_add_f32 v[160:161], v[160:161], v[176:177]
v_pk_add_f32 v[162:163], v[162:163], v[178:179]
v_pk_add_f32 v[164:165], v[164:165], v[180:181]
v_pk_add_f32 v[166:167], v[166:167], v[182:183]
v_pk_mul_f32 v[168:169], v[160:161], s[50:51] op_sel_hi:[1,0]
ds_write_b128 v9, a[36:39] offset:25728
v_pk_mul_f32 v[170:171], v[162:163], s[50:51] op_sel_hi:[1,0]
v_pk_mul_f32 v[172:173], v[164:165], s[50:51] op_sel_hi:[1,0]
v_pk_mul_f32 v[174:175], v[166:167], s[50:51] op_sel_hi:[1,0]
v_exp_f32 v168, v168
v_lshlrev_b32 v176, 16, v84
v_exp_f32 v169, v169
v_and_b32 v177, s52, v84
ds_write_b128 v9, a[40:43] offset:30848
v_exp_f32 v170, v170
v_lshlrev_b32 v178, 16, v85
v_exp_f32 v171, v171
v_and_b32 v179, s52, v85
v_exp_f32 v172, v172
v_lshlrev_b32 v180, 16, v86
v_exp_f32 v173, v173
ds_write_b128 v9, a[44:47] offset:35968
v_and_b32 v181, s52, v86
v_exp_f32 v174, v174
v_lshlrev_b32 v182, 16, v87
v_exp_f32 v175, v175
v_and_b32 v183, s52, v87
v_pk_add_f32 v[168:169], v[168:169], 1.0 op_sel_hi:[1,0]
v_pk_add_f32 v[170:171], v[170:171], 1.0 op_sel_hi:[1,0]
ds_write_b128 v9, a[48:51] offset:20672
v_pk_add_f32 v[172:173], v[172:173], 1.0 op_sel_hi:[1,0]
v_pk_add_f32 v[174:175], v[174:175], 1.0 op_sel_hi:[1,0]
v_rcp_f32 v168, v168
v_rcp_f32 v169, v169
v_rcp_f32 v170, v170
v_rcp_f32 v171, v171
v_rcp_f32 v172, v172
ds_write_b128 v9, a[52:55] offset:25792
v_rcp_f32 v173, v173
v_rcp_f32 v174, v174
v_rcp_f32 v175, v175
v_pk_mul_f32 v[160:161], v[160:161], v[168:169]
v_pk_mul_f32 v[162:163], v[162:163], v[170:171]
v_pk_mul_f32 v[164:165], v[164:165], v[172:173]
v_pk_mul_f32 v[166:167], v[166:167], v[174:175]
ds_write_b128 v9, a[56:59] offset:30912
s_waitcnt lgkmcnt(15)
v_pk_add_f32 v[224:225], v[224:225], v[232:233]
v_pk_add_f32 v[226:227], v[226:227], v[234:235]
v_pk_add_f32 v[228:229], v[228:229], v[236:237]
v_pk_add_f32 v[230:231], v[230:231], v[238:239]
v_pk_add_f32 v[240:241], v[240:241], v[248:249]
v_pk_add_f32 v[242:243], v[242:243], v[250:251]
ds_write_b128 v9, a[60:63] offset:36032
v_pk_add_f32 v[244:245], v[244:245], v[252:253]
v_pk_add_f32 v[246:247], v[246:247], v[254:255]
v_pk_add_f32 v[224:225], v[224:225], v[240:241]
v_pk_add_f32 v[226:227], v[226:227], v[242:243]
v_pk_add_f32 v[228:229], v[228:229], v[244:245]
v_pk_add_f32 v[230:231], v[230:231], v[246:247]
v_pk_mul_f32 v[232:233], v[224:225], s[50:51] op_sel_hi:[1,0]
ds_write_b128 v9, a[64:67] offset:20736
v_pk_mul_f32 v[234:235], v[226:227], s[50:51] op_sel_hi:[1,0]
v_pk_mul_f32 v[236:237], v[228:229], s[50:51] op_sel_hi:[1,0]
v_pk_mul_f32 v[238:239], v[230:231], s[50:51] op_sel_hi:[1,0]
v_exp_f32 v232, v232
v_lshlrev_b32 v240, 16, v88
v_exp_f32 v233, v233
v_and_b32 v241, s52, v88
ds_write_b128 v9, a[68:71] offset:25856
v_exp_f32 v234, v234
v_lshlrev_b32 v242, 16, v89
v_exp_f32 v235, v235
v_and_b32 v243, s52, v89
v_exp_f32 v236, v236
v_lshlrev_b32 v244, 16, v90
v_exp_f32 v237, v237
ds_write_b128 v9, a[72:75] offset:30976
v_and_b32 v245, s52, v90
v_exp_f32 v238, v238
v_lshlrev_b32 v246, 16, v91
v_exp_f32 v239, v239
v_and_b32 v247, s52, v91
v_pk_add_f32 v[232:233], v[232:233], 1.0 op_sel_hi:[1,0]
v_pk_add_f32 v[234:235], v[234:235], 1.0 op_sel_hi:[1,0]
ds_write_b128 v9, a[76:79] offset:36096
v_pk_add_f32 v[236:237], v[236:237], 1.0 op_sel_hi:[1,0]
v_pk_add_f32 v[238:239], v[238:239], 1.0 op_sel_hi:[1,0]
v_rcp_f32 v232, v232
v_rcp_f32 v233, v233
v_rcp_f32 v234, v234
v_rcp_f32 v235, v235
v_rcp_f32 v236, v236
v_rcp_f32 v237, v237
v_rcp_f32 v238, v238
v_rcp_f32 v239, v239
v_pk_mul_f32 v[224:225], v[224:225], v[232:233]
v_pk_mul_f32 v[226:227], v[226:227], v[234:235]
v_pk_mul_f32 v[228:229], v[228:229], v[236:237]
v_pk_mul_f32 v[230:231], v[230:231], v[238:239]
s_waitcnt lgkmcnt(0)
s_barrier
ds_read_b128 v[128:131], v28 offset:20480
ds_read_b128 v[132:135], v29 offset:20480
ds_read_b128 v[136:139], v28 offset:61440
ds_read_b128 v[140:143], v29 offset:61440
ds_read_b128 v[144:147], v30 offset:20480
ds_read_b128 v[148:151], v31 offset:20480
ds_read_b128 v[152:155], v30 offset:61440
ds_read_b128 v[156:159], v31 offset:61440
ds_read_b128 v[192:195], v32 offset:20480
ds_read_b128 v[196:199], v33 offset:20480
ds_read_b128 v[200:203], v32 offset:61440
ds_read_b128 v[204:207], v33 offset:61440
ds_read_b128 v[208:211], v34 offset:20480
ds_read_b128 v[212:215], v35 offset:20480
ds_read_b128 v[216:219], v34 offset:61440
ds_read_b128 v[220:223], v35 offset:61440
ds_read_b128 v[40:43], v36 offset:20480
ds_read_b128 v[44:47], v37 offset:20480
ds_read_b128 v[48:51], v36 offset:61440
ds_read_b128 v[52:55], v37 offset:61440
ds_read_b128 v[56:59], v38 offset:20480
ds_read_b128 v[60:63], v39 offset:20480
ds_read_b128 v[64:67], v38 offset:61440
ds_read_b128 v[68:71], v39 offset:61440
s_waitcnt lgkmcnt(15)
v_pk_add_f32 v[128:129], v[128:129], v[136:137]
v_pk_add_f32 v[130:131], v[130:131], v[138:139]
v_pk_add_f32 v[132:133], v[132:133], v[140:141]
v_pk_add_f32 v[134:135], v[134:135], v[142:143]
v_pk_add_f32 v[144:145], v[144:145], v[152:153]
v_pk_add_f32 v[146:147], v[146:147], v[154:155]
v_pk_add_f32 v[148:149], v[148:149], v[156:157]
v_pk_add_f32 v[150:151], v[150:151], v[158:159]
v_pk_add_f32 v[128:129], v[128:129], v[144:145]
v_pk_add_f32 v[130:131], v[130:131], v[146:147]
v_pk_add_f32 v[132:133], v[132:133], v[148:149]
v_pk_add_f32 v[134:135], v[134:135], v[150:151]
v_pk_fma_f32 v[96:97], v[96:97], v[128:129], v[112:113]
v_pk_fma_f32 v[98:99], v[98:99], v[130:131], v[114:115]
v_pk_fma_f32 v[100:101], v[100:101], v[132:133], v[116:117]
v_pk_fma_f32 v[102:103], v[102:103], v[134:135], v[118:119]
CV v104,v96,v97
CV v105,v98,v99
CV v106,v100,v101
CV v107,v102,v103
buffer_store_dwordx4 v[104:107], v10, s[12:15], s47 offen sc1
s_waitcnt lgkmcnt(8)
v_pk_add_f32 v[192:193], v[192:193], v[200:201]
v_pk_add_f32 v[194:195], v[194:195], v[202:203]
v_pk_add_f32 v[196:197], v[196:197], v[204:205]
v_pk_add_f32 v[198:199], v[198:199], v[206:207]
v_pk_add_f32 v[208:209], v[208:209], v[216:217]
v_pk_add_f32 v[210:211], v[210:211], v[218:219]
v_pk_add_f32 v[212:213], v[212:213], v[220:221]
v_pk_add_f32 v[214:215], v[214:215], v[222:223]
v_pk_add_f32 v[192:193], v[192:193], v[208:209]
v_pk_add_f32 v[194:195], v[194:195], v[210:211]
v_pk_add_f32 v[196:197], v[196:197], v[212:213]
v_pk_add_f32 v[198:199], v[198:199], v[214:215]
v_pk_fma_f32 v[160:161], v[160:161], v[192:193], v[176:177]
v_pk_fma_f32 v[162:163], v[162:163], v[194:195], v[178:179]
v_pk_fma_f32 v[164:165], v[164:165], v[196:197], v[180:181]
v_pk_fma_f32 v[166:167], v[166:167], v[198:199], v[182:183]
CV v168,v160,v161
CV v169,v162,v163
CV v170,v164,v165
CV v171,v166,v167
buffer_store_dwordx4 v[168:171], v11, s[12:15], s47 offen sc1
s_waitcnt lgkmcnt(0)
v_pk_add_f32 v[40:41], v[40:41], v[48:49]
v_pk_add_f32 v[42:43], v[42:43], v[50:51]
v_pk_add_f32 v[44:45], v[44:45], v[52:53]
v_pk_add_f32 v[46:47], v[46:47], v[54:55]
v_pk_add_f32 v[56:57], v[56:57], v[64:65]
v_pk_add_f32 v[58:59], v[58:59], v[66:67]
v_pk_add_f32 v[60:61], v[60:61], v[68:69]
v_pk_add_f32 v[62:63], v[62:63], v[70:71]
v_pk_add_f32 v[40:41], v[40:41], v[56:57]
v_pk_add_f32 v[42:43], v[42:43], v[58:59]
v_pk_add_f32 v[44:45], v[44:45], v[60:61]
v_pk_add_f32 v[46:47], v[46:47], v[62:63]
v_pk_fma_f32 v[224:225], v[224:225], v[40:41], v[240:241]
v_pk_fma_f32 v[226:227], v[226:227], v[42:43], v[242:243]
v_pk_fma_f32 v[228:229], v[228:229], v[44:45], v[244:245]
v_pk_fma_f32 v[230:231], v[230:231], v[46:47], v[246:247]
CV v232,v224,v225
CV v233,v226,v227
CV v234,v228,v229
CV v235,v230,v231
buffer_store_dwordx4 v[232:235], v12, s[12:15], s47 offen sc1
s_endpgm
.p2align 6
K1_GU3:
v_and_b32 v56, 31, v1
v_lshrrev_b32 v57, 5, v1
v_bfe_u32 v58, v1, 1, 3
v_lshlrev_b32 v59, 7, v56
v_add_u32 v59, s6, v59
s_mov_b32 s49, 0x3f803f80
v_add_u32 v60, 0, v57
v_xor_b32 v60, v60, v58
v_lshl_add_u32 v34, v60, 4, v59
v_add_u32 v60, 2, v57
v_xor_b32 v60, v60, v58
v_lshl_add_u32 v35, v60, 4, v59
v_add_u32 v60, 4, v57
v_xor_b32 v60, v60, v58
v_lshl_add_u32 v36, v60, 4, v59
v_add_u32 v60, 6, v57
v_xor_b32 v60, v60, v58
v_lshl_add_u32 v37, v60, 4, v59
v_mov_b32 v48, 0
v_mov_b32 v49, 0
v_mov_b32 v50, 0
v_mov_b32 v51, 0
v_mov_b32 v52, 0
v_mov_b32 v53, 0
v_mov_b32 v54, 0
v_mov_b32 v55, 0
v_lshrrev_b32 v40, 3, v1
v_mul_u32_u24 v41, 3456, v40
v_and_b32 v42, 7, v1
v_and_b32 v40, 2, v40
v_xor_b32 v42, v42, v40
v_lshl_add_u32 v42, v42, 4, v41
v_xor_b32 v43, 64, v42
v_add_u32 v10, 3072, v42
v_add_u32 v11, 29696, v42
v_add_u32 v12, 1024, v43
v_add_u32 v13, 27648, v43
s_sub_u32 s7, s5, 8
s_lshr_b32 s46, s7, 1
s_and_b32 s7, s7, 1
s_waitcnt vmcnt(12)
ds_read_b128 v[96:99], v34 offset:12288
ds_read_b128 v[100:103], v35 offset:12288
ds_read_b128 v[104:107], v36 offset:12288
ds_read_b128 v[108:111], v37 offset:12288
s_bfe_u32 s44, s58, 0x40010
s_mul_i32 s44, s44, 128
s_add_u32 s44, s44, s43
s_add_u32 s61, s44, 20480
s_add_u32 m0, s6, 28672
s_nop 0
BL v30,s[8:11],s44 offen lds
s_mul_i32 s47, s46, 7
s_add_u32 s47, s47, s7
s_add_u32 s48, s47, 5
s_cmp_eq_u32 s46, 3
s_cselect_b32 s42, 1, 0
s_sub_u32 s48, s48, s42
s_add_u32 m0, s6, 29696
s_nop 0
BL v31,s[8:11],s44 offen lds
s_mul_i32 s41, s3, 55296
s_lshl_b32 s42, s47, 7
s_add_u32 s40, s41, s42
s_lshl_b32 s42, s48, 7
s_add_u32 s42, s41, s42
s_add_u32 s41, s40, 256
s_add_u32 m0, s6, 30720
s_nop 0
BL v30,s[8:11],s61 offen lds
s_lshl_b32 s46, s47, 13
s_lshl_b32 s48, s48, 13
v_lshrrev_b32 v40, 4, v1
v_and_b32 v41, 1, v40
v_lshrrev_b32 v40, 1, v40
v_bfe_u32 v42, v1, 2, 2
s_add_u32 m0, s6, 31744
s_nop 0
BL v31,s[8:11],s61 offen lds
v_and_b32 v43, 3, v1
v_lshl_add_u32 v44, v40, 3, v42
v_lshlrev_b32 v44, 7, v44
v_lshl_add_u32 v44, v41, 11, v44
v_and_b32 v45, 1, v43
v_lshl_add_u32 v44, v45, 3, v44
s_waitcnt vmcnt(12)
ds_read_b128 v[112:115], v34 offset:16384
ds_read_b128 v[116:119], v35 offset:16384
ds_read_b128 v[120:123], v36 offset:16384
ds_read_b128 v[124:127], v37 offset:16384
s_waitcnt lgkmcnt(4)
s_bfe_u32 s44, s58, 0x40014
s_mul_i32 s44, s44, 128
s_add_u32 s44, s44, s43
s_add_u32 s61, s44, 20480
s_add_u32 m0, s6, 32768
s_nop 0
BL v30,s[8:11],s44 offen lds
D2 v48,v96,s49,v48
D2 v52,v96,v96,v52
D2 v49,v97,s49,v49
D2 v53,v97,v97,v53
D2 v50,v98,s49,v50
D2 v54,v98,v98,v54
D2 v51,v99,s49,v51
D2 v55,v99,v99,v55
v_and_b32 v45, 2, v42
v_lshl_add_u32 v45, v41, 2, v45
v_lshrrev_b32 v43, 1, v43
v_xor_b32 v46, 0, v45
v_add_u32 v46, v46, v43
v_lshl_add_u32 v2, v46, 4, v44
s_add_u32 m0, s6, 33792
s_nop 0
BL v31,s[8:11],s44 offen lds
D2 v48,v100,s49,v48
D2 v52,v100,v100,v52
D2 v49,v101,s49,v49
D2 v53,v101,v101,v53
D2 v50,v102,s49,v50
D2 v54,v102,v102,v54
D2 v51,v103,s49,v51
D2 v55,v103,v103,v55
v_add_u32 v3, 81920, v2
v_xor_b32 v46, 2, v45
v_add_u32 v46, v46, v43
v_lshl_add_u32 v4, v46, 4, v44
v_add_u32 v5, 81920, v4
v_xor_b32 v46, 4, v45
s_add_u32 m0, s6, 34816
s_nop 0
BL v30,s[8:11],s61 offen lds
D2 v48,v104,s49,v48
D2 v52,v104,v104,v52
D2 v49,v105,s49,v49
D2 v53,v105,v105,v53
D2 v50,v106,s49,v50
D2 v54,v106,v106,v54
D2 v51,v107,s49,v51
D2 v55,v107,v107,v55
v_add_u32 v46, v46, v43
v_lshl_add_u32 v6, v46, 4, v44
v_add_u32 v7, 81920, v6
v_xor_b32 v46, 6, v45
v_add_u32 v46, v46, v43
v_lshl_add_u32 v8, v46, 4, v44
s_add_u32 m0, s6, 35840
s_nop 0
BL v31,s[8:11],s61 offen lds
D2 v48,v108,s49,v48
D2 v52,v108,v108,v52
D2 v49,v109,s49,v49
D2 v53,v109,v109,v53
D2 v50,v110,s49,v50
D2 v54,v110,v110,v54
D2 v51,v111,s49,v51
D2 v55,v111,v111,v55
v_add_u32 v9, 81920, v8
s_lshl_b32 s7, s4, 1
s_lshr_b32 s45, s3, 1
s_add_u32 s7, s7, s45
s_mul_i32 s45, s7, 303104
s_and_b32 s7, s3, 1
s_waitcnt vmcnt(12)
ds_read_b128 v[128:131], v34 offset:20480
ds_read_b128 v[132:135], v35 offset:20480
ds_read_b128 v[136:139], v36 offset:20480
ds_read_b128 v[140:143], v37 offset:20480
s_waitcnt lgkmcnt(4)
s_bfe_u32 s44, s58, 0x40018
s_mul_i32 s44, s44, 128
s_add_u32 s44, s44, s43
s_add_u32 s61, s44, 20480
s_add_u32 m0, s6, 36864
s_nop 0
BL v30,s[8:11],s44 offen lds
D2 v48,v112,s49,v48
D2 v52,v112,v112,v52
D2 v49,v113,s49,v49
D2 v53,v113,v113,v53
D2 v50,v114,s49,v50
D2 v54,v114,v114,v54
D2 v51,v115,s49,v51
D2 v55,v115,v115,v55
s_lshl_b32 s7, s7, 11
s_add_u32 s45, s45, s7
v_bfe_u32 v40, v1, 4, 1
v_lshlrev_b32 v40, 10, v40
v_lshrrev_b32 v41, 5, v1
v_lshl_add_u32 v40, v41, 8, v40
s_add_u32 m0, s6, 37888
s_nop 0
BL v31,s[8:11],s44 offen lds
D2 v48,v116,s49,v48
D2 v52,v116,v116,v52
D2 v49,v117,s49,v49
D2 v53,v117,v117,v53
D2 v50,v118,s49,v50
D2 v54,v118,v118,v54
D2 v51,v119,s49,v51
D2 v55,v119,v119,v55
v_and_b32 v41, 15, v1
v_lshl_add_u32 v28, v41, 4, v40
v_add_u32 v29, 4096, v28
s_mov_b32 s50, 0xbfb8aa3b
s_mov_b32 s51, 0x3fb8aa3b
s_mov_b32 s52, 0xffff0000
s_add_u32 m0, s6, 38912
s_nop 0
BL v30,s[8:11],s61 offen lds
D2 v48,v120,s49,v48
D2 v52,v120,v120,v52
D2 v49,v121,s49,v49
D2 v53,v121,v121,v53
D2 v50,v122,s49,v50
D2 v54,v122,v122,v54
D2 v51,v123,s49,v51
D2 v55,v123,v123,v55
s_mov_b32 s53, 0x358637bd
s_add_u32 s46, s46, s45
s_add_u32 s47, s46, 16384
s_add_u32 s48, s48, s45
s_and_b32 s7, s5, 7
s_mul_i32 s32, s3, 112
s_add_u32 m0, s6, 39936
s_nop 0
BL v31,s[8:11],s61 offen lds
D2 v48,v124,s49,v48
D2 v52,v124,v124,v52
D2 v49,v125,s49,v49
D2 v53,v125,v125,v53
D2 v50,v126,s49,v50
D2 v54,v126,v126,v54
D2 v51,v127,s49,v51
D2 v55,v127,v127,v55
s_add_u32 s7, s7, s32
s_mul_i32 s7, s7, 5120
s_sub_u32 s34, 3031040, s7
s_add_u32 s7, s7, 10485760
s_add_u32 s32, s82, s7
s_addc_u32 s33, s83, 0
s_mov_b32 s35, 0x20000
s_waitcnt vmcnt(12)
ds_read_b128 v[144:147], v34 offset:24576
ds_read_b128 v[148:151], v35 offset:24576
ds_read_b128 v[152:155], v36 offset:24576
ds_read_b128 v[156:159], v37 offset:24576
s_waitcnt lgkmcnt(4)
s_bfe_u32 s44, s58, 0x4001c
s_mul_i32 s44, s44, 128
s_add_u32 s44, s44, s43
s_add_u32 s61, s44, 20480
s_add_u32 m0, s6, 12288
s_nop 0
BL v30,s[8:11],s44 offen lds
D2 v48,v128,s49,v48
D2 v52,v128,v128,v52
D2 v49,v129,s49,v49
D2 v53,v129,v129,v53
D2 v50,v130,s49,v50
D2 v54,v130,v130,v54
D2 v51,v131,s49,v51
D2 v55,v131,v131,v55
s_and_b32 s7, s5, 7
s_add_u32 s7, s7, s4
s_and_b32 s7, s7, 3
s_mul_i32 s7, s7, 0
s_mov_b32 s84, 0x03020100
s_mov_b32 s85, s84
s_add_u32 m0, s6, 13312
s_nop 0
BL v31,s[8:11],s44 offen lds
D2 v48,v132,s49,v48
D2 v52,v132,v132,v52
D2 v49,v133,s49,v49
D2 v53,v133,v133,v53
D2 v50,v134,s49,v50
D2 v54,v134,v134,v54
D2 v51,v135,s49,v51
D2 v55,v135,v135,v55
s_lshr_b64 s[84:85], s[84:85], s7
s_mov_b32 s87, s84
s_add_u32 s89, s84, 0x0a0a0a0a
s_sub_u32 s70, s89, 0x02020202
s_cmp_eq_u32 s3, 3
s_cselect_b32 s89, s70, s89
s_mov_b32 s70, 0x0908
s_cselect_b32 s70, 0x0706, s70
s_mov_b32 s84, 0x07060504
s_cselect_b32 s84, 0xffff0504, s84
s_add_u32 m0, s6, 14336
s_nop 0
BL v30,s[8:11],s61 offen lds
D2 v48,v136,s49,v48
D2 v52,v136,v136,v52
D2 v49,v137,s49,v49
D2 v53,v137,v137,v53
D2 v50,v138,s49,v50
D2 v54,v138,v138,v54
D2 v51,v139,s49,v51
D2 v55,v139,v139,v55
s_mul_i32 s71, s3, 9
s_sub_u32 s71, 54, s71
s_add_u32 s85, s71, 4
s_lshl_b32 s85, s85, 16
s_or_b32 s70, s70, s85
s_mul_i32 s71, s71, 0x01010101
s_add_u32 m0, s6, 15360
s_nop 0
BL v31,s[8:11],s61 offen lds
D2 v48,v140,s49,v48
D2 v52,v140,v140,v52
D2 v49,v141,s49,v49
D2 v53,v141,v141,v53
D2 v50,v142,s49,v50
D2 v54,v142,v142,v54
D2 v51,v143,s49,v51
D2 v55,v143,v143,v55
s_add_u32 s71, s71, s87
s_mov_b32 s85, s84
s_lshr_b64 s[84:85], s[84:85], s7
s_mov_b32 s88, s84
s_lshl_b32 s96, s4, 12
s_lshr_b32 s7, s3, 1
s_waitcnt vmcnt(12)
ds_read_b128 v[160:163], v34 offset:28672
ds_read_b128 v[164:167], v35 offset:28672
ds_read_b128 v[168:171], v36 offset:28672
ds_read_b128 v[172:175], v37 offset:28672
s_waitcnt lgkmcnt(4)
s_bfe_u32 s44, s59, 0x40000
s_mul_i32 s44, s44, 128
s_add_u32 s44, s44, s43
s_add_u32 s61, s44, 20480
s_add_u32 m0, s6, 16384
s_nop 0
BL v30,s[8:11],s44 offen lds
D2 v48,v144,s49,v48
D2 v52,v144,v144,v52
D2 v49,v145,s49,v49
D2 v53,v145,v145,v53
D2 v50,v146,s49,v50
D2 v54,v146,v146,v54
D2 v51,v147,s49,v51
D2 v55,v147,v147,v55
s_lshl_b32 s7, s7, 11
s_add_u32 s96, s96, s7
s_lshl_b32 s7, s5, 7
s_add_u32 s96, s96, s7
s_and_b32 s7, s3, 1
s_lshl_b32 s7, s7, 2
s_add_u32 m0, s6, 17408
s_nop 0
BL v31,s[8:11],s44 offen lds
D2 v48,v148,s49,v48
D2 v52,v148,v148,v52
D2 v49,v149,s49,v49
D2 v53,v149,v149,v53
D2 v50,v150,s49,v50
D2 v54,v150,v150,v54
D2 v51,v151,s49,v51
D2 v55,v151,v151,v55
s_add_u32 s96, s96, s7
s_add_u32 s96, s96, 15466496
s_lshl_b32 s97, s4, 12
s_lshr_b32 s7, s5, 3
s_lshl_b32 s7, s7, 11
s_add_u32 s97, s97, s7
s_add_u32 m0, s6, 18432
s_nop 0
BL v30,s[8:11],s61 offen lds
D2 v48,v152,s49,v48
D2 v52,v152,v152,v52
D2 v49,v153,s49,v49
D2 v53,v153,v153,v53
D2 v50,v154,s49,v50
D2 v54,v154,v154,v54
D2 v51,v155,s49,v51
D2 v55,v155,v155,v55
s_add_u32 s97, s97, 15466496
s_add_u32 m0, s6, 19456
s_nop 0
BL v31,s[8:11],s61 offen lds
D2 v48,v156,s49,v48
D2 v52,v156,v156,v52
D2 v49,v157,s49,v49
D2 v53,v157,v157,v53
D2 v50,v158,s49,v50
D2 v54,v158,v158,v54
D2 v51,v159,s49,v51
D2 v55,v159,v159,v55
s_waitcnt vmcnt(12)
ds_read_b128 v[176:179], v34 offset:32768
ds_read_b128 v[180:183], v35 offset:32768
ds_read_b128 v[184:187], v36 offset:32768
ds_read_b128 v[188:191], v37 offset:32768
s_waitcnt lgkmcnt(4)
s_bfe_u32 s44, s59, 0x40004
s_mul_i32 s44, s44, 128
s_add_u32 s44, s44, s43
s_add_u32 s61, s44, 20480
s_add_u32 m0, s6, 20480
s_nop 0
BL v30,s[8:11],s44 offen lds
D2 v48,v160,s49,v48
D2 v52,v160,v160,v52
D2 v49,v161,s49,v49
D2 v53,v161,v161,v53
D2 v50,v162,s49,v50
D2 v54,v162,v162,v54
D2 v51,v163,s49,v51
D2 v55,v163,v163,v55
s_add_u32 m0, s6, 21504
s_nop 0
BL v31,s[8:11],s44 offen lds
D2 v48,v164,s49,v48
D2 v52,v164,v164,v52
D2 v49,v165,s49,v49
D2 v53,v165,v165,v53
D2 v50,v166,s49,v50
D2 v54,v166,v166,v54
D2 v51,v167,s49,v51
D2 v55,v167,v167,v55
s_add_u32 m0, s6, 22528
s_nop 0
BL v30,s[8:11],s61 offen lds
D2 v48,v168,s49,v48
D2 v52,v168,v168,v52
D2 v49,v169,s49,v49
D2 v53,v169,v169,v53
D2 v50,v170,s49,v50
D2 v54,v170,v170,v54
D2 v51,v171,s49,v51
D2 v55,v171,v171,v55
s_add_u32 m0, s6, 23552
s_nop 0
BL v31,s[8:11],s61 offen lds
D2 v48,v172,s49,v48
D2 v52,v172,v172,v52
D2 v49,v173,s49,v49
D2 v53,v173,v173,v53
D2 v50,v174,s49,v50
D2 v54,v174,v174,v54
D2 v51,v175,s49,v51
D2 v55,v175,v175,v55
s_waitcnt vmcnt(12)
ds_read_b128 v[192:195], v34 offset:36864
ds_read_b128 v[196:199], v35 offset:36864
ds_read_b128 v[200:203], v36 offset:36864
ds_read_b128 v[204:207], v37 offset:36864
s_waitcnt lgkmcnt(4)
D2 v48,v176,s49,v48
D2 v52,v176,v176,v52
D2 v49,v177,s49,v49
D2 v53,v177,v177,v53
D2 v50,v178,s49,v50
D2 v54,v178,v178,v54
D2 v51,v179,s49,v51
D2 v55,v179,v179,v55
D2 v48,v180,s49,v48
D2 v52,v180,v180,v52
D2 v49,v181,s49,v49
D2 v53,v181,v181,v53
D2 v50,v182,s49,v50
D2 v54,v182,v182,v54
D2 v51,v183,s49,v51
D2 v55,v183,v183,v55
D2 v48,v184,s49,v48
D2 v52,v184,v184,v52
D2 v49,v185,s49,v49
D2 v53,v185,v185,v53
D2 v50,v186,s49,v50
D2 v54,v186,v186,v54
D2 v51,v187,s49,v51
D2 v55,v187,v187,v55
D2 v48,v188,s49,v48
D2 v52,v188,v188,v52
D2 v49,v189,s49,v49
D2 v53,v189,v189,v53
D2 v50,v190,s49,v50
D2 v54,v190,v190,v54
D2 v51,v191,s49,v51
D2 v55,v191,v191,v55
s_waitcnt vmcnt(8)
ds_read_b128 v[208:211], v34 offset:12288
ds_read_b128 v[212:215], v35 offset:12288
ds_read_b128 v[216:219], v36 offset:12288
ds_read_b128 v[220:223], v37 offset:12288
s_waitcnt lgkmcnt(4)
s_add_u32 m0, s6, 0
s_bfe_u32 s60, s58, 0x40000
s_mul_i32 s60, s60, 221184
s_add_u32 s60, s60, s40
BL v10,s[12:15],s60 offen lds
D2 v48,v192,s49,v48
D2 v52,v192,v192,v52
D2 v49,v193,s49,v49
D2 v53,v193,v193,v53
D2 v50,v194,s49,v50
D2 v54,v194,v194,v54
D2 v51,v195,s49,v51
D2 v55,v195,v195,v55
BL v11,s[12:15],s60 offen offset:1024 lds
D2 v48,v196,s49,v48
D2 v52,v196,v196,v52
D2 v49,v197,s49,v49
D2 v53,v197,v197,v53
D2 v50,v198,s49,v50
D2 v54,v198,v198,v54
D2 v51,v199,s49,v51
D2 v55,v199,v199,v55
BL v12,s[16:19],s60 offen offset:2048 lds
D2 v48,v200,s49,v48
D2 v52,v200,v200,v52
D2 v49,v201,s49,v49
D2 v53,v201,v201,v53
D2 v50,v202,s49,v50
D2 v54,v202,v202,v54
D2 v51,v203,s49,v51
D2 v55,v203,v203,v55
BL v13,s[16:19],s60 offen offset:3072 lds
D2 v48,v204,s49,v48
D2 v52,v204,v204,v52
D2 v49,v205,s49,v49
D2 v53,v205,v205,v53
D2 v50,v206,s49,v50
D2 v54,v206,v206,v54
D2 v51,v207,s49,v51
D2 v55,v207,v207,v55
s_waitcnt vmcnt(8)
ds_read_b128 v[224:227], v34 offset:16384
ds_read_b128 v[228:231], v35 offset:16384
ds_read_b128 v[232:235], v36 offset:16384
ds_read_b128 v[236:239], v37 offset:16384
s_waitcnt lgkmcnt(4)
D2 v48,v208,s49,v48
D2 v52,v208,v208,v52
D2 v49,v209,s49,v49
D2 v53,v209,v209,v53
D2 v50,v210,s49,v50
D2 v54,v210,v210,v54
D2 v51,v211,s49,v51
D2 v55,v211,v211,v55
D2 v48,v212,s49,v48
D2 v52,v212,v212,v52
D2 v49,v213,s49,v49
D2 v53,v213,v213,v53
D2 v50,v214,s49,v50
D2 v54,v214,v214,v54
D2 v51,v215,s49,v51
D2 v55,v215,v215,v55
D2 v48,v216,s49,v48
D2 v52,v216,v216,v52
D2 v49,v217,s49,v49
D2 v53,v217,v217,v53
D2 v50,v218,s49,v50
D2 v54,v218,v218,v54
D2 v51,v219,s49,v51
D2 v55,v219,v219,v55
D2 v48,v220,s49,v48
D2 v52,v220,v220,v52
D2 v49,v221,s49,v49
D2 v53,v221,v221,v53
D2 v50,v222,s49,v50
D2 v54,v222,v222,v54
D2 v51,v223,s49,v51
D2 v55,v223,v223,v55
s_waitcnt vmcnt(4)
ds_read_b128 v[240:243], v34 offset:20480
ds_read_b128 v[244:247], v35 offset:20480
ds_read_b128 v[248:251], v36 offset:20480
ds_read_b128 v[252:255], v37 offset:20480
s_waitcnt lgkmcnt(4)
s_add_u32 m0, s6, 5120
s_bfe_u32 s60, s58, 0x40004
s_mul_i32 s60, s60, 221184
s_add_u32 s60, s60, s40
BL v10,s[12:15],s60 offen lds
D2 v48,v224,s49,v48
D2 v52,v224,v224,v52
D2 v49,v225,s49,v49
D2 v53,v225,v225,v53
D2 v50,v226,s49,v50
D2 v54,v226,v226,v54
D2 v51,v227,s49,v51
D2 v55,v227,v227,v55
BL v11,s[12:15],s60 offen offset:1024 lds
D2 v48,v228,s49,v48
D2 v52,v228,v228,v52
D2 v49,v229,s49,v49
D2 v53,v229,v229,v53
D2 v50,v230,s49,v50
D2 v54,v230,v230,v54
D2 v51,v231,s49,v51
D2 v55,v231,v231,v55
BL v12,s[16:19],s60 offen offset:2048 lds
D2 v48,v232,s49,v48
D2 v52,v232,v232,v52
D2 v49,v233,s49,v49
D2 v53,v233,v233,v53
D2 v50,v234,s49,v50
D2 v54,v234,v234,v54
D2 v51,v235,s49,v51
D2 v55,v235,v235,v55
BL v13,s[16:19],s60 offen offset:3072 lds
D2 v48,v236,s49,v48
D2 v52,v236,v236,v52
D2 v49,v237,s49,v49
D2 v53,v237,v237,v53
D2 v50,v238,s49,v50
D2 v54,v238,v238,v54
D2 v51,v239,s49,v51
D2 v55,v239,v239,v55
s_waitcnt lgkmcnt(0)
D2 v48,v240,s49,v48
D2 v52,v240,v240,v52
D2 v49,v241,s49,v49
D2 v53,v241,v241,v53
D2 v50,v242,s49,v50
D2 v54,v242,v242,v54
D2 v51,v243,s49,v51
D2 v55,v243,v243,v55
D2 v48,v244,s49,v48
D2 v52,v244,v244,v52
D2 v49,v245,s49,v49
D2 v53,v245,v245,v53
D2 v50,v246,s49,v50
D2 v54,v246,v246,v54
D2 v51,v247,s49,v51
D2 v55,v247,v247,v55
D2 v48,v248,s49,v48
D2 v52,v248,v248,v52
D2 v49,v249,s49,v49
D2 v53,v249,v249,v53
D2 v50,v250,s49,v50
D2 v54,v250,v250,v54
D2 v51,v251,s49,v51
D2 v55,v251,v251,v55
D2 v48,v252,s49,v48
D2 v52,v252,v252,v52
D2 v49,v253,s49,v49
D2 v53,v253,v253,v53
D2 v50,v254,s49,v50
D2 v54,v254,v254,v54
D2 v51,v255,s49,v51
D2 v55,v255,v255,v55
s_nop 2
v_add_f32 v48, v48, v49
v_add_f32 v50, v50, v51
v_add_f32 v52, v52, v53
v_add_f32 v54, v54, v55
v_add_f32 v48, v48, v50
v_add_f32 v52, v52, v54
v_mov_b32 v49, v48
v_mov_b32 v53, v52
s_nop 0
v_permlane32_swap_b32 v48, v49
v_permlane32_swap_b32 v52, v53
v_add_f32 v48, v48, v49
v_add_f32 v52, v52, v53
v_mul_f32 v48, 0x3acccccd, v48
v_mul_f32 v52, 0x3acccccd, v52
v_fma_f32 v52, -v48, v48, v52
v_max_f32 v52, 0, v52
CV v50,v48,v52
v_and_b32 v52, s52, v50
v_lshlrev_b32 v48, 16, v50
v_add_f32 v52, 0x3727c5ac, v52
CV v52,v52,v52
v_and_b32 v52, s52, v52
v_sqrt_f32 v52, v52
s_nop 0
CV v52,v52,v52
v_and_b32 v52, s52, v52
v_rcp_f32 v32, v52
s_nop 0
v_mul_f32 v33, v48, v32
v_sub_f32 v33, 0, v33
s_waitcnt vmcnt(4)
s_barrier
TR a[224:225],v2
TR a[226:227],v2 offset:512
TR a[228:229],v4
TR a[230:231],v4 offset:512
TR a[232:233],v6
TR a[234:235],v6 offset:512
TR a[236:237],v8
TR a[238:239],v8 offset:512
TR a[240:241],v2 offset:40960
TR a[242:243],v2 offset:41472
TR a[244:245],v4 offset:40960
TR a[246:247],v4 offset:41472
TR a[248:249],v6 offset:40960
TR a[250:251],v6 offset:41472
v_lshlrev_b32 v34, 16, v96
v_and_b32 v35, s52, v96
v_lshlrev_b32 v36, 16, v97
v_and_b32 v37, s52, v97
v_lshlrev_b32 v38, 16, v98
v_and_b32 v39, s52, v98
v_lshlrev_b32 v88, 16, v99
v_and_b32 v89, s52, v99
v_fma_f32 v34, v34, v32, v33
v_fma_f32 v35, v35, v32, v33
v_fma_f32 v36, v36, v32, v33
v_fma_f32 v37, v37, v32, v33
v_fma_f32 v38, v38, v32, v33
v_fma_f32 v39, v39, v32, v33
v_fma_f32 v88, v88, v32, v33
v_fma_f32 v89, v89, v32, v33
CV v96,v34,v35
CV v97,v36,v37
CV v98,v38,v39
CV v99,v88,v89
v_lshlrev_b32 v34, 16, v100
v_and_b32 v35, s52, v100
v_lshlrev_b32 v36, 16, v101
v_and_b32 v37, s52, v101
s_waitcnt lgkmcnt(6)
M3 a[80:95],a[224:227],v[96:99],0
TR a[252:253],v8 offset:40960
TR a[254:255],v8 offset:41472
v_lshlrev_b32 v38, 16, v102
v_and_b32 v39, s52, v102
v_lshlrev_b32 v88, 16, v103
v_and_b32 v89, s52, v103
v_fma_f32 v34, v34, v32, v33
s_add_u32 m0, s6, 10240
s_bfe_u32 s60, s58, 0x40008
s_mul_i32 s60, s60, 221184
s_add_u32 s60, s60, s40
BL v10,s[12:15],s60 offen lds
M3 a[96:111],a[228:231],v[96:99],0
TR a[224:225],v3
TR a[226:227],v3 offset:512
v_fma_f32 v35, v35, v32, v33
v_fma_f32 v36, v36, v32, v33
v_fma_f32 v37, v37, v32, v33
v_fma_f32 v38, v38, v32, v33
v_fma_f32 v39, v39, v32, v33
M3 a[112:127],a[232:235],v[96:99],0
TR a[228:229],v5
TR a[230:231],v5 offset:512
v_fma_f32 v88, v88, v32, v33
v_fma_f32 v89, v89, v32, v33
CV v100,v34,v35
CV v101,v36,v37
CV v102,v38,v39
BL v11,s[12:15],s60 offen offset:1024 lds
M3 a[128:143],a[236:239],v[96:99],0
TR a[232:233],v7
TR a[234:235],v7 offset:512
CV v103,v88,v89
v_lshlrev_b32 v34, 16, v104
v_and_b32 v35, s52, v104
v_lshlrev_b32 v36, 16, v105
v_and_b32 v37, s52, v105
s_waitcnt lgkmcnt(6)
M3 a[80:95],a[240:243],v[100:103],a[80:95]
TR a[236:237],v9
TR a[238:239],v9 offset:512
v_lshlrev_b32 v38, 16, v106
v_and_b32 v39, s52, v106
v_lshlrev_b32 v88, 16, v107
v_and_b32 v89, s52, v107
v_fma_f32 v34, v34, v32, v33
BL v12,s[16:19],s60 offen offset:2048 lds
M3 a[96:111],a[244:247],v[100:103],a[96:111]
TR a[240:241],v3 offset:40960
TR a[242:243],v3 offset:41472
v_fma_f32 v35, v35, v32, v33
v_fma_f32 v36, v36, v32, v33
v_fma_f32 v37, v37, v32, v33
v_fma_f32 v38, v38, v32, v33
v_fma_f32 v39, v39, v32, v33
M3 a[112:127],a[248:251],v[100:103],a[112:127]
TR a[244:245],v5 offset:40960
TR a[246:247],v5 offset:41472
v_fma_f32 v88, v88, v32, v33
v_fma_f32 v89, v89, v32, v33
CV v104,v34,v35
CV v105,v36,v37
CV v106,v38,v39
BL v13,s[16:19],s60 offen offset:3072 lds
M3 a[128:143],a[252:255],v[100:103],a[128:143]
TR a[248:249],v7 offset:40960
TR a[250:251],v7 offset:41472
CV v107,v88,v89
v_lshlrev_b32 v34, 16, v108
v_and_b32 v35, s52, v108
v_lshlrev_b32 v36, 16, v109
v_and_b32 v37, s52, v109
s_waitcnt lgkmcnt(6)
M3 a[80:95],a[224:227],v[104:107],a[80:95]
buffer_load_dword v26, v27, s[28:31], 0 offen sc1
TR a[252:253],v9 offset:40960
TR a[254:255],v9 offset:41472
v_lshlrev_b32 v38, 16, v110
v_and_b32 v39, s52, v110
v_lshlrev_b32 v88, 16, v111
v_and_b32 v89, s52, v111
v_fma_f32 v34, v34, v32, v33
s_add_u32 m0, s6, 15360
s_bfe_u32 s60, s58, 0x4000c
s_mul_i32 s60, s60, 221184
s_add_u32 s60, s60, s40
BL v10,s[12:15],s60 offen lds
M3 a[96:111],a[228:231],v[104:107],a[96:111]
v_fma_f32 v35, v35, v32, v33
v_fma_f32 v36, v36, v32, v33
v_fma_f32 v37, v37, v32, v33
v_fma_f32 v38, v38, v32, v33
v_fma_f32 v39, v39, v32, v33
M3 a[112:127],a[232:235],v[104:107],a[112:127]
v_fma_f32 v88, v88, v32, v33
v_fma_f32 v89, v89, v32, v33
CV v108,v34,v35
CV v109,v36,v37
CV v110,v38,v39
BL v11,s[12:15],s60 offen offset:1024 lds
M3 a[128:143],a[236:239],v[104:107],a[128:143]
s_waitcnt vmcnt(7) lgkmcnt(0)
s_barrier
TR a[224:225],v2 offset:5120
TR a[226:227],v2 offset:5632
TR a[228:229],v4 offset:5120
TR a[230:231],v4 offset:5632
CV v111,v88,v89
v_lshlrev_b32 v34, 16, v112
v_and_b32 v35, s52, v112
v_lshlrev_b32 v36, 16, v113
v_and_b32 v37, s52, v113
M3 a[80:95],a[240:243],v[108:111],a[80:95]
TR a[232:233],v6 offset:5120
TR a[234:235],v6 offset:5632
TR a[236:237],v8 offset:5120
TR a[238:239],v8 offset:5632
v_lshlrev_b32 v38, 16, v114
v_and_b32 v39, s52, v114
v_lshlrev_b32 v88, 16, v115
v_and_b32 v89, s52, v115
v_fma_f32 v34, v34, v32, v33
BL v12,s[16:19],s60 offen offset:2048 lds
M3 a[96:111],a[244:247],v[108:111],a[96:111]
TR a[240:241],v2 offset:46080
TR a[242:243],v2 offset:46592
v_fma_f32 v35, v35, v32, v33
v_fma_f32 v36, v36, v32, v33
v_fma_f32 v37, v37, v32, v33
v_fma_f32 v38, v38, v32, v33
v_fma_f32 v39, v39, v32, v33
M3 a[112:127],a[248:251],v[108:111],a[112:127]
TR a[244:245],v4 offset:46080
TR a[246:247],v4 offset:46592
v_fma_f32 v88, v88, v32, v33
v_fma_f32 v89, v89, v32, v33
CV v112,v34,v35
CV v113,v36,v37
CV v114,v38,v39
BL v13,s[16:19],s60 offen offset:3072 lds
M3 a[128:143],a[252:255],v[108:111],a[128:143]
TR a[248:249],v6 offset:46080
TR a[250:251],v6 offset:46592
CV v115,v88,v89
v_lshlrev_b32 v34, 16, v116
v_and_b32 v35, s52, v116
v_lshlrev_b32 v36, 16, v117
v_and_b32 v37, s52, v117
s_waitcnt lgkmcnt(6)
M3 a[80:95],a[224:227],v[112:115],a[80:95]
TR a[252:253],v8 offset:46080
TR a[254:255],v8 offset:46592
v_lshlrev_b32 v38, 16, v118
v_and_b32 v39, s52, v118
v_lshlrev_b32 v88, 16, v119
v_and_b32 v89, s52, v119
v_fma_f32 v34, v34, v32, v33
s_add_u32 m0, s6, 20480
s_bfe_u32 s60, s58, 0x40010
s_mul_i32 s60, s60, 221184
s_add_u32 s60, s60, s40
BL v10,s[12:15],s60 offen lds
M3 a[96:111],a[228:231],v[112:115],a[96:111]
TR a[224:225],v3 offset:5120
TR a[226:227],v3 offset:5632
v_fma_f32 v35, v35, v32, v33
v_fma_f32 v36, v36, v32, v33
v_fma_f32 v37, v37, v32, v33
v_fma_f32 v38, v38, v32, v33
v_fma_f32 v39, v39, v32, v33
M3 a[112:127],a[232:235],v[112:115],a[112:127]
TR a[228:229],v5 offset:5120
TR a[230:231],v5 offset:5632
v_fma_f32 v88, v88, v32, v33
v_fma_f32 v89, v89, v32, v33
CV v116,v34,v35
CV v117,v36,v37
CV v118,v38,v39
BL v11,s[12:15],s60 offen offset:1024 lds
M3 a[128:143],a[236:239],v[112:115],a[128:143]
TR a[232:233],v7 offset:5120
TR a[234:235],v7 offset:5632
CV v119,v88,v89
v_lshlrev_b32 v34, 16, v120
v_and_b32 v35, s52, v120
v_lshlrev_b32 v36, 16, v121
v_and_b32 v37, s52, v121
s_waitcnt lgkmcnt(6)
M3 a[80:95],a[240:243],v[116:119],a[80:95]
TR a[236:237],v9 offset:5120
TR a[238:239],v9 offset:5632
v_lshlrev_b32 v38, 16, v122
v_and_b32 v39, s52, v122
v_lshlrev_b32 v88, 16, v123
v_and_b32 v89, s52, v123
v_fma_f32 v34, v34, v32, v33
BL v12,s[16:19],s60 offen offset:2048 lds
M3 a[96:111],a[244:247],v[116:119],a[96:111]
TR a[240:241],v3 offset:46080
TR a[242:243],v3 offset:46592
v_fma_f32 v35, v35, v32, v33
v_fma_f32 v36, v36, v32, v33
v_fma_f32 v37, v37, v32, v33
v_fma_f32 v38, v38, v32, v33
v_fma_f32 v39, v39, v32, v33
M3 a[112:127],a[248:251],v[116:119],a[112:127]
TR a[244:245],v5 offset:46080
TR a[246:247],v5 offset:46592
v_fma_f32 v88, v88, v32, v33
v_fma_f32 v89, v89, v32, v33
CV v120,v34,v35
CV v121,v36,v37
CV v122,v38,v39
BL v13,s[16:19],s60 offen offset:3072 lds
M3 a[128:143],a[252:255],v[116:119],a[128:143]
TR a[248:249],v7 offset:46080
TR a[250:251],v7 offset:46592
CV v123,v88,v89
v_lshlrev_b32 v34, 16, v124
v_and_b32 v35, s52, v124
v_lshlrev_b32 v36, 16, v125
v_and_b32 v37, s52, v125
s_waitcnt lgkmcnt(6)
M3 a[80:95],a[224:227],v[120:123],a[80:95]
TR a[252:253],v9 offset:46080
TR a[254:255],v9 offset:46592
v_lshlrev_b32 v38, 16, v126
v_and_b32 v39, s52, v126
v_lshlrev_b32 v88, 16, v127
v_and_b32 v89, s52, v127
v_fma_f32 v34, v34, v32, v33
s_add_u32 m0, s6, 0
s_bfe_u32 s60, s58, 0x40014
s_mul_i32 s60, s60, 221184
s_add_u32 s60, s60, s40
BL v10,s[12:15],s60 offen lds
M3 a[96:111],a[228:231],v[120:123],a[96:111]
v_fma_f32 v35, v35, v32, v33
v_fma_f32 v36, v36, v32, v33
v_fma_f32 v37, v37, v32, v33
v_fma_f32 v38, v38, v32, v33
v_fma_f32 v39, v39, v32, v33
M3 a[112:127],a[232:235],v[120:123],a[112:127]
v_fma_f32 v88, v88, v32, v33
v_fma_f32 v89, v89, v32, v33
CV v124,v34,v35
CV v125,v36,v37
CV v126,v38,v39
BL v11,s[12:15],s60 offen offset:1024 lds
M3 a[128:143],a[236:239],v[120:123],a[128:143]
s_waitcnt vmcnt(11) lgkmcnt(0)
s_barrier
TR a[224:225],v2 offset:10240
TR a[226:227],v2 offset:10752
TR a[228:229],v4 offset:10240
TR a[230:231],v4 offset:10752
CV v127,v88,v89
v_lshlrev_b32 v34, 16, v128
v_and_b32 v35, s52, v128
v_lshlrev_b32 v36, 16, v129
v_and_b32 v37, s52, v129
M3 a[80:95],a[240:243],v[124:127],a[80:95]
TR a[232:233],v6 offset:10240
TR a[234:235],v6 offset:10752
TR a[236:237],v8 offset:10240
TR a[238:239],v8 offset:10752
v_lshlrev_b32 v38, 16, v130
v_and_b32 v39, s52, v130
v_lshlrev_b32 v88, 16, v131
v_and_b32 v89, s52, v131
v_fma_f32 v34, v34, v32, v33
BL v12,s[16:19],s60 offen offset:2048 lds
M3 a[96:111],a[244:247],v[124:127],a[96:111]
TR a[240:241],v2 offset:51200
TR a[242:243],v2 offset:51712
v_fma_f32 v35, v35, v32, v33
v_fma_f32 v36, v36, v32, v33
v_fma_f32 v37, v37, v32, v33
v_fma_f32 v38, v38, v32, v33
v_fma_f32 v39, v39, v32, v33
M3 a[112:127],a[248:251],v[124:127],a[112:127]
TR a[244:245],v4 offset:51200
TR a[246:247],v4 offset:51712
v_fma_f32 v88, v88, v32, v33
v_fma_f32 v89, v89, v32, v33
CV v128,v34,v35
CV v129,v36,v37
CV v130,v38,v39
BL v13,s[16:19],s60 offen offset:3072 lds
M3 a[128:143],a[252:255],v[124:127],a[128:143]
TR a[248:249],v6 offset:51200
TR a[250:251],v6 offset:51712
CV v131,v88,v89
v_lshlrev_b32 v34, 16, v132
v_and_b32 v35, s52, v132
v_lshlrev_b32 v36, 16, v133
v_and_b32 v37, s52, v133
s_waitcnt lgkmcnt(6)
M3 a[80:95],a[224:227],v[128:131],a[80:95]
s_waitcnt vmcnt(12)
K1_GU3_N_chk:
v_cmp_eq_u32 vcc, 0, v26
s_nop 0
s_cmp_eq_u64 vcc, 0
s_cbranch_scc1 K1_GU3_N_ok
s_cmp_eq_u32 s101, 0
s_cbranch_scc1 K1_GU3_N_ok
s_sub_u32 s101, s101, 1
s_sleep 10
buffer_load_dword v26, v27, s[28:31], 0 offen sc1
s_waitcnt vmcnt(0)
s_branch K1_GU3_N_chk
K1_GU3_N_ok:
TR a[252:253],v8 offset:51200
TR a[254:255],v8 offset:51712
v_lshlrev_b32 v38, 16, v134
v_and_b32 v39, s52, v134
v_lshlrev_b32 v88, 16, v135
v_and_b32 v89, s52, v135
v_fma_f32 v34, v34, v32, v33
s_add_u32 m0, s6, 5120
s_bfe_u32 s60, s58, 0x40018
s_mul_i32 s60, s60, 221184
s_add_u32 s60, s60, s40
BL v10,s[12:15],s60 offen lds
M3 a[96:111],a[228:231],v[128:131],a[96:111]
TR a[224:225],v3 offset:10240
TR a[226:227],v3 offset:10752
v_fma_f32 v35, v35, v32, v33
v_fma_f32 v36, v36, v32, v33
v_fma_f32 v37, v37, v32, v33
v_fma_f32 v38, v38, v32, v33
v_fma_f32 v39, v39, v32, v33
M3 a[112:127],a[232:235],v[128:131],a[112:127]
TR a[228:229],v5 offset:10240
TR a[230:231],v5 offset:10752
v_fma_f32 v88, v88, v32, v33
v_fma_f32 v89, v89, v32, v33
CV v132,v34,v35
CV v133,v36,v37
CV v134,v38,v39
BL v11,s[12:15],s60 offen offset:1024 lds
M3 a[128:143],a[236:239],v[128:131],a[128:143]
TR a[232:233],v7 offset:10240
TR a[234:235],v7 offset:10752
CV v135,v88,v89
v_lshlrev_b32 v34, 16, v136
v_and_b32 v35, s52, v136
v_lshlrev_b32 v36, 16, v137
v_and_b32 v37, s52, v137
s_waitcnt lgkmcnt(6)
M3 a[80:95],a[240:243],v[132:135],a[80:95]
TR a[236:237],v9 offset:10240
TR a[238:239],v9 offset:10752
v_lshlrev_b32 v38, 16, v138
v_and_b32 v39, s52, v138
v_lshlrev_b32 v88, 16, v139
v_and_b32 v89, s52, v139
v_fma_f32 v34, v34, v32, v33
BL v12,s[16:19],s60 offen offset:2048 lds
M3 a[96:111],a[244:247],v[132:135],a[96:111]
TR a[240:241],v3 offset:51200
TR a[242:243],v3 offset:51712
v_fma_f32 v35, v35, v32, v33
v_fma_f32 v36, v36, v32, v33
v_fma_f32 v37, v37, v32, v33
v_fma_f32 v38, v38, v32, v33
v_fma_f32 v39, v39, v32, v33
M3 a[112:127],a[248:251],v[132:135],a[112:127]
TR a[244:245],v5 offset:51200
TR a[246:247],v5 offset:51712
v_fma_f32 v88, v88, v32, v33
v_fma_f32 v89, v89, v32, v33
CV v136,v34,v35
CV v137,v36,v37
CV v138,v38,v39
BL v13,s[16:19],s60 offen offset:3072 lds
M3 a[128:143],a[252:255],v[132:135],a[128:143]
TR a[248:249],v7 offset:51200
TR a[250:251],v7 offset:51712
CV v139,v88,v89
v_lshlrev_b32 v34, 16, v140
v_and_b32 v35, s52, v140
v_lshlrev_b32 v36, 16, v141
v_and_b32 v37, s52, v141
s_waitcnt lgkmcnt(6)
M3 a[80:95],a[224:227],v[136:139],a[80:95]
TR a[252:253],v9 offset:51200
TR a[254:255],v9 offset:51712
v_lshlrev_b32 v38, 16, v142
v_and_b32 v39, s52, v142
v_lshlrev_b32 v88, 16, v143
v_and_b32 v89, s52, v143
v_fma_f32 v34, v34, v32, v33
M3 a[96:111],a[228:231],v[136:139],a[96:111]
v_fma_f32 v35, v35, v32, v33
v_fma_f32 v36, v36, v32, v33
v_fma_f32 v37, v37, v32, v33
v_fma_f32 v38, v38, v32, v33
v_fma_f32 v39, v39, v32, v33
M3 a[112:127],a[232:235],v[136:139],a[112:127]
v_fma_f32 v88, v88, v32, v33
v_fma_f32 v89, v89, v32, v33
CV v140,v34,v35
CV v141,v36,v37
CV v142,v38,v39
M3 a[128:143],a[236:239],v[136:139],a[128:143]
s_waitcnt vmcnt(12) lgkmcnt(0)
s_barrier
TR a[224:225],v2 offset:15360
TR a[226:227],v2 offset:15872
TR a[228:229],v4 offset:15360
TR a[230:231],v4 offset:15872
CV v143,v88,v89
v_lshlrev_b32 v34, 16, v144
v_and_b32 v35, s52, v144
v_lshlrev_b32 v36, 16, v145
v_and_b32 v37, s52, v145
M3 a[80:95],a[240:243],v[140:143],a[80:95]
TR a[232:233],v6 offset:15360
TR a[234:235],v6 offset:15872
TR a[236:237],v8 offset:15360
TR a[238:239],v8 offset:15872
v_lshlrev_b32 v38, 16, v146
v_and_b32 v39, s52, v146
v_lshlrev_b32 v88, 16, v147
v_and_b32 v89, s52, v147
v_fma_f32 v34, v34, v32, v33
s_add_u32 m0, s6, 10240
s_bfe_u32 s60, s58, 0x4001c
s_mul_i32 s60, s60, 221184
s_add_u32 s60, s60, s40
BL v10,s[12:15],s60 offen lds
M3 a[96:111],a[244:247],v[140:143],a[96:111]
TR a[240:241],v2 offset:56320
TR a[242:243],v2 offset:56832
v_fma_f32 v35, v35, v32, v33
v_fma_f32 v36, v36, v32, v33
v_fma_f32 v37, v37, v32, v33
v_fma_f32 v38, v38, v32, v33
v_fma_f32 v39, v39, v32, v33
M3 a[112:127],a[248:251],v[140:143],a[112:127]
TR a[244:245],v4 offset:56320
TR a[246:247],v4 offset:56832
v_fma_f32 v88, v88, v32, v33
v_fma_f32 v89, v89, v32, v33
CV v144,v34,v35
CV v145,v36,v37
CV v146,v38,v39
BL v11,s[12:15],s60 offen offset:1024 lds
M3 a[128:143],a[252:255],v[140:143],a[128:143]
TR a[248:249],v6 offset:56320
TR a[250:251],v6 offset:56832
CV v147,v88,v89
v_lshlrev_b32 v34, 16, v148
v_and_b32 v35, s52, v148
v_lshlrev_b32 v36, 16, v149
v_and_b32 v37, s52, v149
s_waitcnt lgkmcnt(6)
M3 a[80:95],a[224:227],v[144:147],a[80:95]
TR a[252:253],v8 offset:56320
TR a[254:255],v8 offset:56832
v_lshlrev_b32 v38, 16, v150
v_and_b32 v39, s52, v150
v_lshlrev_b32 v88, 16, v151
v_and_b32 v89, s52, v151
v_fma_f32 v34, v34, v32, v33
BL v12,s[16:19],s60 offen offset:2048 lds
M3 a[96:111],a[228:231],v[144:147],a[96:111]
TR a[224:225],v3 offset:15360
TR a[226:227],v3 offset:15872
v_fma_f32 v35, v35, v32, v33
v_fma_f32 v36, v36, v32, v33
v_fma_f32 v37, v37, v32, v33
v_fma_f32 v38, v38, v32, v33
v_fma_f32 v39, v39, v32, v33
M3 a[112:127],a[232:235],v[144:147],a[112:127]
TR a[228:229],v5 offset:15360
TR a[230:231],v5 offset:15872
v_fma_f32 v88, v88, v32, v33
v_fma_f32 v89, v89, v32, v33
CV v148,v34,v35
CV v149,v36,v37
CV v150,v38,v39
BL v13,s[16:19],s60 offen offset:3072 lds
M3 a[128:143],a[236:239],v[144:147],a[128:143]
TR a[232:233],v7 offset:15360
TR a[234:235],v7 offset:15872
CV v151,v88,v89
v_lshlrev_b32 v34, 16, v152
v_and_b32 v35, s52, v152
v_lshlrev_b32 v36, 16, v153
v_and_b32 v37, s52, v153
s_waitcnt lgkmcnt(6)
M3 a[80:95],a[240:243],v[148:151],a[80:95]
TR a[236:237],v9 offset:15360
TR a[238:239],v9 offset:15872
v_lshlrev_b32 v38, 16, v154
v_and_b32 v39, s52, v154
v_lshlrev_b32 v88, 16, v155
v_and_b32 v89, s52, v155
v_fma_f32 v34, v34, v32, v33
M3 a[96:111],a[244:247],v[148:151],a[96:111]
TR a[240:241],v3 offset:56320
TR a[242:243],v3 offset:56832
v_fma_f32 v35, v35, v32, v33
v_fma_f32 v36, v36, v32, v33
v_fma_f32 v37, v37, v32, v33
v_fma_f32 v38, v38, v32, v33
v_fma_f32 v39, v39, v32, v33
M3 a[112:127],a[248:251],v[148:151],a[112:127]
TR a[244:245],v5 offset:56320
TR a[246:247],v5 offset:56832
v_fma_f32 v88, v88, v32, v33
v_fma_f32 v89, v89, v32, v33
CV v152,v34,v35
CV v153,v36,v37
CV v154,v38,v39
M3 a[128:143],a[252:255],v[148:151],a[128:143]
TR a[248:249],v7 offset:56320
TR a[250:251],v7 offset:56832
CV v155,v88,v89
v_lshlrev_b32 v34, 16, v156
v_and_b32 v35, s52, v156
v_lshlrev_b32 v36, 16, v157
v_and_b32 v37, s52, v157
s_waitcnt lgkmcnt(6)
M3 a[80:95],a[224:227],v[152:155],a[80:95]
TR a[252:253],v9 offset:56320
TR a[254:255],v9 offset:56832
v_lshlrev_b32 v38, 16, v158
v_and_b32 v39, s52, v158
v_lshlrev_b32 v88, 16, v159
v_and_b32 v89, s52, v159
v_fma_f32 v34, v34, v32, v33
M3 a[96:111],a[228:231],v[152:155],a[96:111]
v_fma_f32 v35, v35, v32, v33
v_fma_f32 v36, v36, v32, v33
v_fma_f32 v37, v37, v32, v33
v_fma_f32 v38, v38, v32, v33
v_fma_f32 v39, v39, v32, v33
M3 a[112:127],a[232:235],v[152:155],a[112:127]
v_fma_f32 v88, v88, v32, v33
v_fma_f32 v89, v89, v32, v33
CV v156,v34,v35
CV v157,v36,v37
CV v158,v38,v39
M3 a[128:143],a[236:239],v[152:155],a[128:143]
s_waitcnt vmcnt(12) lgkmcnt(0)
s_barrier
TR a[224:225],v2 offset:20480
TR a[226:227],v2 offset:20992
TR a[228:229],v4 offset:20480
TR a[230:231],v4 offset:20992
CV v159,v88,v89
v_lshlrev_b32 v34, 16, v160
v_and_b32 v35, s52, v160
v_lshlrev_b32 v36, 16, v161
v_and_b32 v37, s52, v161
M3 a[80:95],a[240:243],v[156:159],a[80:95]
TR a[232:233],v6 offset:20480
TR a[234:235],v6 offset:20992
TR a[236:237],v8 offset:20480
TR a[238:239],v8 offset:20992
v_lshlrev_b32 v38, 16, v162
v_and_b32 v39, s52, v162
v_lshlrev_b32 v88, 16, v163
v_and_b32 v89, s52, v163
v_fma_f32 v34, v34, v32, v33
s_add_u32 m0, s6, 15360
s_bfe_u32 s60, s59, 0x40000
s_mul_i32 s60, s60, 221184
s_add_u32 s60, s60, s40
BL v10,s[12:15],s60 offen lds
M3 a[96:111],a[244:247],v[156:159],a[96:111]
TR a[240:241],v2 offset:61440
TR a[242:243],v2 offset:61952
v_fma_f32 v35, v35, v32, v33
v_fma_f32 v36, v36, v32, v33
v_fma_f32 v37, v37, v32, v33
v_fma_f32 v38, v38, v32, v33
v_fma_f32 v39, v39, v32, v33
M3 a[112:127],a[248:251],v[156:159],a[112:127]
TR a[244:245],v4 offset:61440
TR a[246:247],v4 offset:61952
v_fma_f32 v88, v88, v32, v33
v_fma_f32 v89, v89, v32, v33
CV v160,v34,v35
CV v161,v36,v37
CV v162,v38,v39
BL v11,s[12:15],s60 offen offset:1024 lds
M3 a[128:143],a[252:255],v[156:159],a[128:143]
TR a[248:249],v6 offset:61440
TR a[250:251],v6 offset:61952
CV v163,v88,v89
v_lshlrev_b32 v34, 16, v164
v_and_b32 v35, s52, v164
v_lshlrev_b32 v36, 16, v165
v_and_b32 v37, s52, v165
s_waitcnt lgkmcnt(6)
M3 a[80:95],a[224:227],v[160:163],a[80:95]
TR a[252:253],v8 offset:61440
TR a[254:255],v8 offset:61952
v_lshlrev_b32 v38, 16, v166
v_and_b32 v39, s52, v166
v_lshlrev_b32 v88, 16, v167
v_and_b32 v89, s52, v167
v_fma_f32 v34, v34, v32, v33
BL v12,s[16:19],s60 offen offset:2048 lds
M3 a[96:111],a[228:231],v[160:163],a[96:111]
TR a[224:225],v3 offset:20480
TR a[226:227],v3 offset:20992
v_fma_f32 v35, v35, v32, v33
v_fma_f32 v36, v36, v32, v33
v_fma_f32 v37, v37, v32, v33
v_fma_f32 v38, v38, v32, v33
v_fma_f32 v39, v39, v32, v33
M3 a[112:127],a[232:235],v[160:163],a[112:127]
TR a[228:229],v5 offset:20480
TR a[230:231],v5 offset:20992
v_fma_f32 v88, v88, v32, v33
v_fma_f32 v89, v89, v32, v33
CV v164,v34,v35
CV v165,v36,v37
CV v166,v38,v39
BL v13,s[16:19],s60 offen offset:3072 lds
M3 a[128:143],a[236:239],v[160:163],a[128:143]
TR a[232:233],v7 offset:20480
TR a[234:235],v7 offset:20992
CV v167,v88,v89
v_lshlrev_b32 v34, 16, v168
v_and_b32 v35, s52, v168
v_lshlrev_b32 v36, 16, v169
v_and_b32 v37, s52, v169
s_waitcnt lgkmcnt(6)
M3 a[80:95],a[240:243],v[164:167],a[80:95]
TR a[236:237],v9 offset:20480
TR a[238:239],v9 offset:20992
v_lshlrev_b32 v38, 16, v170
v_and_b32 v39, s52, v170
v_lshlrev_b32 v88, 16, v171
v_and_b32 v89, s52, v171
v_fma_f32 v34, v34, v32, v33
M3 a[96:111],a[244:247],v[164:167],a[96:111]
TR a[240:241],v3 offset:61440
TR a[242:243],v3 offset:61952
v_fma_f32 v35, v35, v32, v33
v_fma_f32 v36, v36, v32, v33
v_fma_f32 v37, v37, v32, v33
v_fma_f32 v38, v38, v32, v33
v_fma_f32 v39, v39, v32, v33
M3 a[112:127],a[248:251],v[164:167],a[112:127]
TR a[244:245],v5 offset:61440
TR a[246:247],v5 offset:61952
v_fma_f32 v88, v88, v32, v33
v_fma_f32 v89, v89, v32, v33
CV v168,v34,v35
CV v169,v36,v37
CV v170,v38,v39
M3 a[128:143],a[252:255],v[164:167],a[128:143]
TR a[248:249],v7 offset:61440
TR a[250:251],v7 offset:61952
CV v171,v88,v89
v_lshlrev_b32 v34, 16, v172
v_and_b32 v35, s52, v172
v_lshlrev_b32 v36, 16, v173
v_and_b32 v37, s52, v173
s_waitcnt lgkmcnt(6)
M3 a[80:95],a[224:227],v[168:171],a[80:95]
TR a[252:253],v9 offset:61440
TR a[254:255],v9 offset:61952
v_lshlrev_b32 v38, 16, v174
v_and_b32 v39, s52, v174
v_lshlrev_b32 v88, 16, v175
v_and_b32 v89, s52, v175
v_fma_f32 v34, v34, v32, v33
M3 a[96:111],a[228:231],v[168:171],a[96:111]
v_fma_f32 v35, v35, v32, v33
v_fma_f32 v36, v36, v32, v33
v_fma_f32 v37, v37, v32, v33
v_fma_f32 v38, v38, v32, v33
v_fma_f32 v39, v39, v32, v33
M3 a[112:127],a[232:235],v[168:171],a[112:127]
v_fma_f32 v88, v88, v32, v33
v_fma_f32 v89, v89, v32, v33
CV v172,v34,v35
CV v173,v36,v37
CV v174,v38,v39
M3 a[128:143],a[236:239],v[168:171],a[128:143]
s_waitcnt vmcnt(12) lgkmcnt(0)
s_barrier
TR a[224:225],v2
TR a[226:227],v2 offset:512
TR a[228:229],v4
TR a[230:231],v4 offset:512
CV v175,v88,v89
v_lshlrev_b32 v34, 16, v176
v_and_b32 v35, s52, v176
v_lshlrev_b32 v36, 16, v177
v_and_b32 v37, s52, v177
M3 a[80:95],a[240:243],v[172:175],a[80:95]
TR a[232:233],v6
TR a[234:235],v6 offset:512
TR a[236:237],v8
TR a[238:239],v8 offset:512
v_lshlrev_b32 v38, 16, v178
v_and_b32 v39, s52, v178
v_lshlrev_b32 v88, 16, v179
v_and_b32 v89, s52, v179
v_fma_f32 v34, v34, v32, v33
s_add_u32 m0, s6, 20480
s_bfe_u32 s60, s59, 0x40004
s_mul_i32 s60, s60, 221184
s_add_u32 s60, s60, s40
BL v10,s[12:15],s60 offen lds
M3 a[96:111],a[244:247],v[172:175],a[96:111]
TR a[240:241],v2 offset:40960
TR a[242:243],v2 offset:41472
v_fma_f32 v35, v35, v32, v33
v_fma_f32 v36, v36, v32, v33
v_fma_f32 v37, v37, v32, v33
v_fma_f32 v38, v38, v32, v33
v_fma_f32 v39, v39, v32, v33
M3 a[112:127],a[248:251],v[172:175],a[112:127]
TR a[244:245],v4 offset:40960
TR a[246:247],v4 offset:41472
v_fma_f32 v88, v88, v32, v33
v_fma_f32 v89, v89, v32, v33
CV v176,v34,v35
CV v177,v36,v37
CV v178,v38,v39
BL v11,s[12:15],s60 offen offset:1024 lds
M3 a[128:143],a[252:255],v[172:175],a[128:143]
TR a[248:249],v6 offset:40960
TR a[250:251],v6 offset:41472
CV v179,v88,v89
v_lshlrev_b32 v34, 16, v180
v_and_b32 v35, s52, v180
v_lshlrev_b32 v36, 16, v181
v_and_b32 v37, s52, v181
s_waitcnt lgkmcnt(6)
M3 a[80:95],a[224:227],v[176:179],a[80:95]
TR a[252:253],v8 offset:40960
TR a[254:255],v8 offset:41472
v_lshlrev_b32 v38, 16, v182
v_and_b32 v39, s52, v182
v_lshlrev_b32 v88, 16, v183
v_and_b32 v89, s52, v183
v_fma_f32 v34, v34, v32, v33
BL v12,s[16:19],s60 offen offset:2048 lds
M3 a[96:111],a[228:231],v[176:179],a[96:111]
TR a[224:225],v3
TR a[226:227],v3 offset:512
v_fma_f32 v35, v35, v32, v33
v_fma_f32 v36, v36, v32, v33
v_fma_f32 v37, v37, v32, v33
v_fma_f32 v38, v38, v32, v33
v_fma_f32 v39, v39, v32, v33
M3 a[112:127],a[232:235],v[176:179],a[112:127]
TR a[228:229],v5
TR a[230:231],v5 offset:512
v_fma_f32 v88, v88, v32, v33
v_fma_f32 v89, v89, v32, v33
CV v180,v34,v35
CV v181,v36,v37
CV v182,v38,v39
BL v13,s[16:19],s60 offen offset:3072 lds
M3 a[128:143],a[236:239],v[176:179],a[128:143]
TR a[232:233],v7
TR a[234:235],v7 offset:512
CV v183,v88,v89
v_lshlrev_b32 v34, 16, v184
v_and_b32 v35, s52, v184
v_lshlrev_b32 v36, 16, v185
v_and_b32 v37, s52, v185
s_waitcnt lgkmcnt(6)
M3 a[80:95],a[240:243],v[180:183],a[80:95]
TR a[236:237],v9
TR a[238:239],v9 offset:512
v_lshlrev_b32 v38, 16, v186
v_and_b32 v39, s52, v186
v_lshlrev_b32 v88, 16, v187
v_and_b32 v89, s52, v187
v_fma_f32 v34, v34, v32, v33
M3 a[96:111],a[244:247],v[180:183],a[96:111]
TR a[240:241],v3 offset:40960
TR a[242:243],v3 offset:41472
v_fma_f32 v35, v35, v32, v33
v_fma_f32 v36, v36, v32, v33
v_fma_f32 v37, v37, v32, v33
v_fma_f32 v38, v38, v32, v33
v_fma_f32 v39, v39, v32, v33
M3 a[112:127],a[248:251],v[180:183],a[112:127]
TR a[244:245],v5 offset:40960
TR a[246:247],v5 offset:41472
v_fma_f32 v88, v88, v32, v33
v_fma_f32 v89, v89, v32, v33
CV v184,v34,v35
CV v185,v36,v37
CV v186,v38,v39
M3 a[128:143],a[252:255],v[180:183],a[128:143]
TR a[248:249],v7 offset:40960
TR a[250:251],v7 offset:41472
CV v187,v88,v89
v_lshlrev_b32 v34, 16, v188
v_and_b32 v35, s52, v188
v_lshlrev_b32 v36, 16, v189
v_and_b32 v37, s52, v189
s_waitcnt lgkmcnt(6)
M3 a[80:95],a[224:227],v[184:187],a[80:95]
TR a[252:253],v9 offset:40960
TR a[254:255],v9 offset:41472
v_lshlrev_b32 v38, 16, v190
v_and_b32 v39, s52, v190
v_lshlrev_b32 v88, 16, v191
v_and_b32 v89, s52, v191
v_fma_f32 v34, v34, v32, v33
M3 a[96:111],a[228:231],v[184:187],a[96:111]
v_fma_f32 v35, v35, v32, v33
v_fma_f32 v36, v36, v32, v33
v_fma_f32 v37, v37, v32, v33
v_fma_f32 v38, v38, v32, v33
v_fma_f32 v39, v39, v32, v33
M3 a[112:127],a[232:235],v[184:187],a[112:127]
v_fma_f32 v88, v88, v32, v33
v_fma_f32 v89, v89, v32, v33
CV v188,v34,v35
CV v189,v36,v37
CV v190,v38,v39
M3 a[128:143],a[236:239],v[184:187],a[128:143]
s_waitcnt vmcnt(12) lgkmcnt(0)
s_barrier
TR a[224:225],v2 offset:5120
TR a[226:227],v2 offset:5632
TR a[228:229],v4 offset:5120
TR a[230:231],v4 offset:5632
CV v191,v88,v89
v_lshlrev_b32 v34, 16, v192
v_and_b32 v35, s52, v192
v_lshlrev_b32 v36, 16, v193
v_and_b32 v37, s52, v193
M3 a[80:95],a[240:243],v[188:191],a[80:95]
TR a[232:233],v6 offset:5120
TR a[234:235],v6 offset:5632
TR a[236:237],v8 offset:5120
TR a[238:239],v8 offset:5632
v_lshlrev_b32 v38, 16, v194
v_and_b32 v39, s52, v194
v_lshlrev_b32 v88, 16, v195
v_and_b32 v89, s52, v195
v_fma_f32 v34, v34, v32, v33
s_add_u32 m0, s6, 0
s_bfe_u32 s60, s58, 0x40000
s_mul_i32 s60, s60, 221184
s_add_u32 s60, s60, s41
BL v10,s[12:15],s60 offen lds
M3 a[96:111],a[244:247],v[188:191],a[96:111]
TR a[240:241],v2 offset:46080
TR a[242:243],v2 offset:46592
v_fma_f32 v35, v35, v32, v33
v_fma_f32 v36, v36, v32, v33
v_fma_f32 v37, v37, v32, v33
v_fma_f32 v38, v38, v32, v33
v_fma_f32 v39, v39, v32, v33
M3 a[112:127],a[248:251],v[188:191],a[112:127]
TR a[244:245],v4 offset:46080
TR a[246:247],v4 offset:46592
v_fma_f32 v88, v88, v32, v33
v_fma_f32 v89, v89, v32, v33
CV v192,v34,v35
CV v193,v36,v37
CV v194,v38,v39
BL v11,s[12:15],s60 offen offset:1024 lds
M3 a[128:143],a[252:255],v[188:191],a[128:143]
TR a[248:249],v6 offset:46080
TR a[250:251],v6 offset:46592
CV v195,v88,v89
v_lshlrev_b32 v34, 16, v196
v_and_b32 v35, s52, v196
v_lshlrev_b32 v36, 16, v197
v_and_b32 v37, s52, v197
s_waitcnt lgkmcnt(6)
M3 a[80:95],a[224:227],v[192:195],a[80:95]
TR a[252:253],v8 offset:46080
TR a[254:255],v8 offset:46592
v_lshlrev_b32 v38, 16, v198
v_and_b32 v39, s52, v198
v_lshlrev_b32 v88, 16, v199
v_and_b32 v89, s52, v199
v_fma_f32 v34, v34, v32, v33
BL v12,s[16:19],s60 offen offset:2048 lds
M3 a[96:111],a[228:231],v[192:195],a[96:111]
TR a[224:225],v3 offset:5120
TR a[226:227],v3 offset:5632
v_fma_f32 v35, v35, v32, v33
v_fma_f32 v36, v36, v32, v33
v_fma_f32 v37, v37, v32, v33
v_fma_f32 v38, v38, v32, v33
v_fma_f32 v39, v39, v32, v33
M3 a[112:127],a[232:235],v[192:195],a[112:127]
TR a[228:229],v5 offset:5120
TR a[230:231],v5 offset:5632
v_fma_f32 v88, v88, v32, v33
v_fma_f32 v89, v89, v32, v33
CV v196,v34,v35
CV v197,v36,v37
CV v198,v38,v39
BL v13,s[16:19],s60 offen offset:3072 lds
M3 a[128:143],a[236:239],v[192:195],a[128:143]
TR a[232:233],v7 offset:5120
TR a[234:235],v7 offset:5632
CV v199,v88,v89
v_lshlrev_b32 v34, 16, v200
v_and_b32 v35, s52, v200
v_lshlrev_b32 v36, 16, v201
v_and_b32 v37, s52, v201
s_waitcnt lgkmcnt(6)
M3 a[80:95],a[240:243],v[196:199],a[80:95]
TR a[236:237],v9 offset:5120
TR a[238:239],v9 offset:5632
v_lshlrev_b32 v38, 16, v202
v_and_b32 v39, s52, v202
v_lshlrev_b32 v88, 16, v203
v_and_b32 v89, s52, v203
v_fma_f32 v34, v34, v32, v33
M3 a[96:111],a[244:247],v[196:199],a[96:111]
TR a[240:241],v3 offset:46080
TR a[242:243],v3 offset:46592
v_fma_f32 v35, v35, v32, v33
v_fma_f32 v36, v36, v32, v33
v_fma_f32 v37, v37, v32, v33
v_fma_f32 v38, v38, v32, v33
v_fma_f32 v39, v39, v32, v33
M3 a[112:127],a[248:251],v[196:199],a[112:127]
TR a[244:245],v5 offset:46080
TR a[246:247],v5 offset:46592
v_fma_f32 v88, v88, v32, v33
v_fma_f32 v89, v89, v32, v33
CV v200,v34,v35
CV v201,v36,v37
CV v202,v38,v39
M3 a[128:143],a[252:255],v[196:199],a[128:143]
TR a[248:249],v7 offset:46080
TR a[250:251],v7 offset:46592
CV v203,v88,v89
v_lshlrev_b32 v34, 16, v204
v_and_b32 v35, s52, v204
v_lshlrev_b32 v36, 16, v205
v_and_b32 v37, s52, v205
s_waitcnt lgkmcnt(6)
M3 a[80:95],a[224:227],v[200:203],a[80:95]
TR a[252:253],v9 offset:46080
TR a[254:255],v9 offset:46592
v_lshlrev_b32 v38, 16, v206
v_and_b32 v39, s52, v206
v_lshlrev_b32 v88, 16, v207
v_and_b32 v89, s52, v207
v_fma_f32 v34, v34, v32, v33
M3 a[96:111],a[228:231],v[200:203],a[96:111]
v_fma_f32 v35, v35, v32, v33
v_fma_f32 v36, v36, v32, v33
v_fma_f32 v37, v37, v32, v33
v_fma_f32 v38, v38, v32, v33
v_fma_f32 v39, v39, v32, v33
M3 a[112:127],a[232:235],v[200:203],a[112:127]
v_fma_f32 v88, v88, v32, v33
v_fma_f32 v89, v89, v32, v33
CV v204,v34,v35
CV v205,v36,v37
CV v206,v38,v39
M3 a[128:143],a[236:239],v[200:203],a[128:143]
s_waitcnt vmcnt(12) lgkmcnt(0)
s_barrier
TR a[224:225],v2 offset:10240
TR a[226:227],v2 offset:10752
TR a[228:229],v4 offset:10240
TR a[230:231],v4 offset:10752
CV v207,v88,v89
v_lshlrev_b32 v34, 16, v208
v_and_b32 v35, s52, v208
v_lshlrev_b32 v36, 16, v209
v_and_b32 v37, s52, v209
M3 a[80:95],a[240:243],v[204:207],a[80:95]
TR a[232:233],v6 offset:10240
TR a[234:235],v6 offset:10752
TR a[236:237],v8 offset:10240
TR a[238:239],v8 offset:10752
v_lshlrev_b32 v38, 16, v210
v_and_b32 v39, s52, v210
v_lshlrev_b32 v88, 16, v211
v_and_b32 v89, s52, v211
v_fma_f32 v34, v34, v32, v33
s_add_u32 m0, s6, 5120
s_bfe_u32 s60, s58, 0x40004
s_mul_i32 s60, s60, 221184
s_add_u32 s60, s60, s41
BL v10,s[12:15],s60 offen lds
M3 a[96:111],a[244:247],v[204:207],a[96:111]
TR a[240:241],v2 offset:51200
TR a[242:243],v2 offset:51712
v_fma_f32 v35, v35, v32, v33
v_fma_f32 v36, v36, v32, v33
v_fma_f32 v37, v37, v32, v33
v_fma_f32 v38, v38, v32, v33
v_fma_f32 v39, v39, v32, v33
M3 a[112:127],a[248:251],v[204:207],a[112:127]
TR a[244:245],v4 offset:51200
TR a[246:247],v4 offset:51712
v_fma_f32 v88, v88, v32, v33
v_fma_f32 v89, v89, v32, v33
CV v208,v34,v35
CV v209,v36,v37
CV v210,v38,v39
BL v11,s[12:15],s60 offen offset:1024 lds
M3 a[128:143],a[252:255],v[204:207],a[128:143]
TR a[248:249],v6 offset:51200
TR a[250:251],v6 offset:51712
CV v211,v88,v89
v_lshlrev_b32 v34, 16, v212
v_and_b32 v35, s52, v212
v_lshlrev_b32 v36, 16, v213
v_and_b32 v37, s52, v213
s_waitcnt lgkmcnt(6)
M3 a[80:95],a[224:227],v[208:211],a[80:95]
TR a[252:253],v8 offset:51200
TR a[254:255],v8 offset:51712
v_lshlrev_b32 v38, 16, v214
v_and_b32 v39, s52, v214
v_lshlrev_b32 v88, 16, v215
v_and_b32 v89, s52, v215
v_fma_f32 v34, v34, v32, v33
BL v12,s[16:19],s60 offen offset:2048 lds
M3 a[96:111],a[228:231],v[208:211],a[96:111]
TR a[224:225],v3 offset:10240
TR a[226:227],v3 offset:10752
v_fma_f32 v35, v35, v32, v33
v_fma_f32 v36, v36, v32, v33
v_fma_f32 v37, v37, v32, v33
v_fma_f32 v38, v38, v32, v33
v_fma_f32 v39, v39, v32, v33
M3 a[112:127],a[232:235],v[208:211],a[112:127]
TR a[228:229],v5 offset:10240
TR a[230:231],v5 offset:10752
v_fma_f32 v88, v88, v32, v33
v_fma_f32 v89, v89, v32, v33
CV v212,v34,v35
CV v213,v36,v37
CV v214,v38,v39
BL v13,s[16:19],s60 offen offset:3072 lds
M3 a[128:143],a[236:239],v[208:211],a[128:143]
TR a[232:233],v7 offset:10240
TR a[234:235],v7 offset:10752
CV v215,v88,v89
v_lshlrev_b32 v34, 16, v216
v_and_b32 v35, s52, v216
v_lshlrev_b32 v36, 16, v217
v_and_b32 v37, s52, v217
s_waitcnt lgkmcnt(6)
M3 a[80:95],a[240:243],v[212:215],a[80:95]
TR a[236:237],v9 offset:10240
TR a[238:239],v9 offset:10752
v_lshlrev_b32 v38, 16, v218
v_and_b32 v39, s52, v218
v_lshlrev_b32 v88, 16, v219
v_and_b32 v89, s52, v219
v_fma_f32 v34, v34, v32, v33
M3 a[96:111],a[244:247],v[212:215],a[96:111]
TR a[240:241],v3 offset:51200
TR a[242:243],v3 offset:51712
v_fma_f32 v35, v35, v32, v33
v_fma_f32 v36, v36, v32, v33
v_fma_f32 v37, v37, v32, v33
v_fma_f32 v38, v38, v32, v33
v_fma_f32 v39, v39, v32, v33
M3 a[112:127],a[248:251],v[212:215],a[112:127]
TR a[244:245],v5 offset:51200
TR a[246:247],v5 offset:51712
v_fma_f32 v88, v88, v32, v33
v_fma_f32 v89, v89, v32, v33
CV v216,v34,v35
CV v217,v36,v37
CV v218,v38,v39
M3 a[128:143],a[252:255],v[212:215],a[128:143]
TR a[248:249],v7 offset:51200
TR a[250:251],v7 offset:51712
CV v219,v88,v89
v_lshlrev_b32 v34, 16, v220
v_and_b32 v35, s52, v220
v_lshlrev_b32 v36, 16, v221
v_and_b32 v37, s52, v221
s_waitcnt lgkmcnt(6)
M3 a[80:95],a[224:227],v[216:219],a[80:95]
TR a[252:253],v9 offset:51200
TR a[254:255],v9 offset:51712
v_lshlrev_b32 v38, 16, v222
v_and_b32 v39, s52, v222
v_lshlrev_b32 v88, 16, v223
v_and_b32 v89, s52, v223
v_fma_f32 v34, v34, v32, v33
M3 a[96:111],a[228:231],v[216:219],a[96:111]
v_fma_f32 v35, v35, v32, v33
v_fma_f32 v36, v36, v32, v33
v_fma_f32 v37, v37, v32, v33
v_fma_f32 v38, v38, v32, v33
v_fma_f32 v39, v39, v32, v33
M3 a[112:127],a[232:235],v[216:219],a[112:127]
v_fma_f32 v88, v88, v32, v33
v_fma_f32 v89, v89, v32, v33
CV v220,v34,v35
CV v221,v36,v37
CV v222,v38,v39
M3 a[128:143],a[236:239],v[216:219],a[128:143]
s_waitcnt vmcnt(12) lgkmcnt(0)
s_barrier
TR a[224:225],v2 offset:15360
TR a[226:227],v2 offset:15872
TR a[228:229],v4 offset:15360
TR a[230:231],v4 offset:15872
CV v223,v88,v89
v_lshlrev_b32 v34, 16, v224
v_and_b32 v35, s52, v224
v_lshlrev_b32 v36, 16, v225
v_and_b32 v37, s52, v225
M3 a[80:95],a[240:243],v[220:223],a[80:95]
TR a[232:233],v6 offset:15360
TR a[234:235],v6 offset:15872
TR a[236:237],v8 offset:15360
TR a[238:239],v8 offset:15872
v_lshlrev_b32 v38, 16, v226
v_and_b32 v39, s52, v226
v_lshlrev_b32 v88, 16, v227
v_and_b32 v89, s52, v227
v_fma_f32 v34, v34, v32, v33
s_add_u32 m0, s6, 10240
s_bfe_u32 s60, s58, 0x40008
s_mul_i32 s60, s60, 221184
s_add_u32 s60, s60, s41
BL v10,s[12:15],s60 offen lds
M3 a[96:111],a[244:247],v[220:223],a[96:111]
TR a[240:241],v2 offset:56320
TR a[242:243],v2 offset:56832
v_fma_f32 v35, v35, v32, v33
v_fma_f32 v36, v36, v32, v33
v_fma_f32 v37, v37, v32, v33
v_fma_f32 v38, v38, v32, v33
v_fma_f32 v39, v39, v32, v33
M3 a[112:127],a[248:251],v[220:223],a[112:127]
TR a[244:245],v4 offset:56320
TR a[246:247],v4 offset:56832
v_fma_f32 v88, v88, v32, v33
v_fma_f32 v89, v89, v32, v33
CV v224,v34,v35
CV v225,v36,v37
CV v226,v38,v39
BL v11,s[12:15],s60 offen offset:1024 lds
M3 a[128:143],a[252:255],v[220:223],a[128:143]
TR a[248:249],v6 offset:56320
TR a[250:251],v6 offset:56832
CV v227,v88,v89
v_lshlrev_b32 v34, 16, v228
v_and_b32 v35, s52, v228
v_lshlrev_b32 v36, 16, v229
v_and_b32 v37, s52, v229
s_waitcnt lgkmcnt(6)
M3 a[80:95],a[224:227],v[224:227],a[80:95]
TR a[252:253],v8 offset:56320
TR a[254:255],v8 offset:56832
v_lshlrev_b32 v38, 16, v230
v_and_b32 v39, s52, v230
v_lshlrev_b32 v88, 16, v231
v_and_b32 v89, s52, v231
v_fma_f32 v34, v34, v32, v33
BL v12,s[16:19],s60 offen offset:2048 lds
M3 a[96:111],a[228:231],v[224:227],a[96:111]
TR a[224:225],v3 offset:15360
TR a[226:227],v3 offset:15872
v_fma_f32 v35, v35, v32, v33
v_fma_f32 v36, v36, v32, v33
v_fma_f32 v37, v37, v32, v33
v_fma_f32 v38, v38, v32, v33
v_fma_f32 v39, v39, v32, v33
M3 a[112:127],a[232:235],v[224:227],a[112:127]
TR a[228:229],v5 offset:15360
TR a[230:231],v5 offset:15872
v_fma_f32 v88, v88, v32, v33
v_fma_f32 v89, v89, v32, v33
CV v228,v34,v35
CV v229,v36,v37
CV v230,v38,v39
BL v13,s[16:19],s60 offen offset:3072 lds
M3 a[128:143],a[236:239],v[224:227],a[128:143]
TR a[232:233],v7 offset:15360
TR a[234:235],v7 offset:15872
CV v231,v88,v89
v_lshlrev_b32 v34, 16, v232
v_and_b32 v35, s52, v232
v_lshlrev_b32 v36, 16, v233
v_and_b32 v37, s52, v233
s_waitcnt lgkmcnt(6)
M3 a[80:95],a[240:243],v[228:231],a[80:95]
TR a[236:237],v9 offset:15360
TR a[238:239],v9 offset:15872
v_lshlrev_b32 v38, 16, v234
v_and_b32 v39, s52, v234
v_lshlrev_b32 v88, 16, v235
v_and_b32 v89, s52, v235
v_fma_f32 v34, v34, v32, v33
M3 a[96:111],a[244:247],v[228:231],a[96:111]
TR a[240:241],v3 offset:56320
TR a[242:243],v3 offset:56832
v_fma_f32 v35, v35, v32, v33
v_fma_f32 v36, v36, v32, v33
v_fma_f32 v37, v37, v32, v33
v_fma_f32 v38, v38, v32, v33
v_fma_f32 v39, v39, v32, v33
M3 a[112:127],a[248:251],v[228:231],a[112:127]
TR a[244:245],v5 offset:56320
TR a[246:247],v5 offset:56832
v_fma_f32 v88, v88, v32, v33
v_fma_f32 v89, v89, v32, v33
CV v232,v34,v35
CV v233,v36,v37
CV v234,v38,v39
M3 a[128:143],a[252:255],v[228:231],a[128:143]
TR a[248:249],v7 offset:56320
TR a[250:251],v7 offset:56832
CV v235,v88,v89
v_lshlrev_b32 v34, 16, v236
v_and_b32 v35, s52, v236
v_lshlrev_b32 v36, 16, v237
v_and_b32 v37, s52, v237
s_waitcnt lgkmcnt(6)
M3 a[80:95],a[224:227],v[232:235],a[80:95]
TR a[252:253],v9 offset:56320
TR a[254:255],v9 offset:56832
v_lshlrev_b32 v38, 16, v238
v_and_b32 v39, s52, v238
v_lshlrev_b32 v88, 16, v239
v_and_b32 v89, s52, v239
v_fma_f32 v34, v34, v32, v33
M3 a[96:111],a[228:231],v[232:235],a[96:111]
v_fma_f32 v35, v35, v32, v33
v_fma_f32 v36, v36, v32, v33
v_fma_f32 v37, v37, v32, v33
v_fma_f32 v38, v38, v32, v33
v_fma_f32 v39, v39, v32, v33
M3 a[112:127],a[232:235],v[232:235],a[112:127]
v_fma_f32 v88, v88, v32, v33
v_fma_f32 v89, v89, v32, v33
CV v236,v34,v35
CV v237,v36,v37
CV v238,v38,v39
M3 a[128:143],a[236:239],v[232:235],a[128:143]
s_waitcnt vmcnt(12) lgkmcnt(0)
s_barrier
TR a[224:225],v2 offset:20480
TR a[226:227],v2 offset:20992
TR a[228:229],v4 offset:20480
TR a[230:231],v4 offset:20992
CV v239,v88,v89
v_lshlrev_b32 v34, 16, v240
v_and_b32 v35, s52, v240
v_lshlrev_b32 v36, 16, v241
v_and_b32 v37, s52, v241
M3 a[80:95],a[240:243],v[236:239],a[80:95]
TR a[232:233],v6 offset:20480
TR a[234:235],v6 offset:20992
TR a[236:237],v8 offset:20480
TR a[238:239],v8 offset:20992
v_lshlrev_b32 v38, 16, v242
v_and_b32 v39, s52, v242
v_lshlrev_b32 v88, 16, v243
v_and_b32 v89, s52, v243
v_fma_f32 v34, v34, v32, v33
s_add_u32 m0, s6, 15360
s_bfe_u32 s60, s58, 0x4000c
s_mul_i32 s60, s60, 221184
s_add_u32 s60, s60, s41
BL v10,s[12:15],s60 offen lds
M3 a[96:111],a[244:247],v[236:239],a[96:111]
TR a[240:241],v2 offset:61440
TR a[242:243],v2 offset:61952
v_fma_f32 v35, v35, v32, v33
v_fma_f32 v36, v36, v32, v33
v_fma_f32 v37, v37, v32, v33
v_fma_f32 v38, v38, v32, v33
v_fma_f32 v39, v39, v32, v33
M3 a[112:127],a[248:251],v[236:239],a[112:127]
TR a[244:245],v4 offset:61440
TR a[246:247],v4 offset:61952
v_fma_f32 v88, v88, v32, v33
v_fma_f32 v89, v89, v32, v33
CV v240,v34,v35
CV v241,v36,v37
CV v242,v38,v39
BL v11,s[12:15],s60 offen offset:1024 lds
M3 a[128:143],a[252:255],v[236:239],a[128:143]
TR a[248:249],v6 offset:61440
TR a[250:251],v6 offset:61952
CV v243,v88,v89
v_lshlrev_b32 v34, 16, v244
v_and_b32 v35, s52, v244
v_lshlrev_b32 v36, 16, v245
v_and_b32 v37, s52, v245
s_waitcnt lgkmcnt(6)
M3 a[80:95],a[224:227],v[240:243],a[80:95]
TR a[252:253],v8 offset:61440
TR a[254:255],v8 offset:61952
v_lshlrev_b32 v38, 16, v246
v_and_b32 v39, s52, v246
v_lshlrev_b32 v88, 16, v247
v_and_b32 v89, s52, v247
v_fma_f32 v34, v34, v32, v33
BL v12,s[16:19],s60 offen offset:2048 lds
M3 a[96:111],a[228:231],v[240:243],a[96:111]
TR a[224:225],v3 offset:20480
TR a[226:227],v3 offset:20992
v_fma_f32 v35, v35, v32, v33
v_fma_f32 v36, v36, v32, v33
v_fma_f32 v37, v37, v32, v33
v_fma_f32 v38, v38, v32, v33
v_fma_f32 v39, v39, v32, v33
M3 a[112:127],a[232:235],v[240:243],a[112:127]
TR a[228:229],v5 offset:20480
TR a[230:231],v5 offset:20992
v_fma_f32 v88, v88, v32, v33
v_fma_f32 v89, v89, v32, v33
CV v244,v34,v35
CV v245,v36,v37
CV v246,v38,v39
BL v13,s[16:19],s60 offen offset:3072 lds
M3 a[128:143],a[236:239],v[240:243],a[128:143]
TR a[232:233],v7 offset:20480
TR a[234:235],v7 offset:20992
CV v247,v88,v89
v_lshlrev_b32 v34, 16, v248
v_and_b32 v35, s52, v248
v_lshlrev_b32 v36, 16, v249
v_and_b32 v37, s52, v249
s_waitcnt lgkmcnt(6)
M3 a[80:95],a[240:243],v[244:247],a[80:95]
TR a[236:237],v9 offset:20480
TR a[238:239],v9 offset:20992
v_lshlrev_b32 v38, 16, v250
v_and_b32 v39, s52, v250
v_lshlrev_b32 v88, 16, v251
v_and_b32 v89, s52, v251
v_fma_f32 v34, v34, v32, v33
M3 a[96:111],a[244:247],v[244:247],a[96:111]
TR a[240:241],v3 offset:61440
TR a[242:243],v3 offset:61952
v_fma_f32 v35, v35, v32, v33
v_fma_f32 v36, v36, v32, v33
v_fma_f32 v37, v37, v32, v33
v_fma_f32 v38, v38, v32, v33
v_fma_f32 v39, v39, v32, v33
M3 a[112:127],a[248:251],v[244:247],a[112:127]
TR a[244:245],v5 offset:61440
TR a[246:247],v5 offset:61952
v_fma_f32 v88, v88, v32, v33
v_fma_f32 v89, v89, v32, v33
CV v248,v34,v35
CV v249,v36,v37
CV v250,v38,v39
M3 a[128:143],a[252:255],v[244:247],a[128:143]
TR a[248:249],v7 offset:61440
TR a[250:251],v7 offset:61952
CV v251,v88,v89
v_lshlrev_b32 v34, 16, v252
v_and_b32 v35, s52, v252
v_lshlrev_b32 v36, 16, v253
v_and_b32 v37, s52, v253
s_waitcnt lgkmcnt(6)
M3 a[80:95],a[224:227],v[248:251],a[80:95]
TR a[252:253],v9 offset:61440
TR a[254:255],v9 offset:61952
v_lshlrev_b32 v38, 16, v254
v_and_b32 v39, s52, v254
v_lshlrev_b32 v88, 16, v255
v_and_b32 v89, s52, v255
v_fma_f32 v34, v34, v32, v33
M3 a[96:111],a[228:231],v[248:251],a[96:111]
v_fma_f32 v35, v35, v32, v33
v_fma_f32 v36, v36, v32, v33
v_fma_f32 v37, v37, v32, v33
v_fma_f32 v38, v38, v32, v33
v_fma_f32 v39, v39, v32, v33
M3 a[112:127],a[232:235],v[248:251],a[112:127]
v_fma_f32 v88, v88, v32, v33
v_fma_f32 v89, v89, v32, v33
CV v252,v34,v35
CV v253,v36,v37
CV v254,v38,v39
M3 a[128:143],a[236:239],v[248:251],a[128:143]
s_waitcnt vmcnt(12) lgkmcnt(0)
s_barrier
TR a[224:225],v2
TR a[226:227],v2 offset:512
TR a[228:229],v4
TR a[230:231],v4 offset:512
CV v255,v88,v89
s_nop 1
M3 a[80:95],a[240:243],v[252:255],a[80:95]
TR a[232:233],v6
TR a[234:235],v6 offset:512
TR a[236:237],v8
TR a[238:239],v8 offset:512
s_add_u32 m0, s6, 20480
s_bfe_u32 s60, s58, 0x40010
s_mul_i32 s60, s60, 221184
s_add_u32 s60, s60, s41
BL v10,s[12:15],s60 offen lds
M3 a[96:111],a[244:247],v[252:255],a[96:111]
TR a[240:241],v2 offset:40960
TR a[242:243],v2 offset:41472
M3 a[112:127],a[248:251],v[252:255],a[112:127]
TR a[244:245],v4 offset:40960
TR a[246:247],v4 offset:41472
BL v11,s[12:15],s60 offen offset:1024 lds
M3 a[128:143],a[252:255],v[252:255],a[128:143]
TR a[248:249],v6 offset:40960
TR a[250:251],v6 offset:41472
s_waitcnt lgkmcnt(6)
M3 a[0:15],a[224:227],v[96:99],0
TR a[252:253],v8 offset:40960
TR a[254:255],v8 offset:41472
BL v12,s[16:19],s60 offen offset:2048 lds
s_mov_b32 s57, 15532032
v_lshlrev_b32 v27, 4, v1
v_lshlrev_b32 v95, 2, v1
v_add_u32 v25, 4096, v27
BL v[30:33],v27,s[24:27],s57 offen sc1
buffer_load_dword v94, v95, s[24:27], s57 offen offset:1024 sc1
AR v40,a80
AR v41,a81
M3 a[16:31],a[228:231],v[96:99],0
TR a[224:225],v3
TR a[226:227],v3 offset:512
AR v42,a82
AR v43,a83
AR v44,a88
AR v45,a89
M3 a[32:47],a[232:235],v[96:99],0
TR a[228:229],v5
TR a[230:231],v5 offset:512
BL v13,s[16:19],s60 offen offset:3072 lds
AR v46,a90
AR v47,a91
M3 a[48:63],a[236:239],v[96:99],0
TR a[232:233],v7
TR a[234:235],v7 offset:512
v_mul_f32 v48, s50, v40
v_mul_f32 v49, s50, v41
v_mul_f32 v50, s50, v42
v_mul_f32 v51, s50, v43
s_waitcnt lgkmcnt(6)
M3 a[0:15],a[240:243],v[100:103],a[0:15]
TR a[236:237],v9
TR a[238:239],v9 offset:512
v_exp_f32 v48, v48
v_mul_f32 v40, v40, v44
M3 a[16:31],a[244:247],v[100:103],a[16:31]
TR a[240:241],v3 offset:40960
TR a[242:243],v3 offset:41472
v_exp_f32 v49, v49
v_mul_f32 v41, v41, v45
M3 a[32:47],a[248:251],v[100:103],a[32:47]
TR a[244:245],v5 offset:40960
TR a[246:247],v5 offset:41472
v_exp_f32 v50, v50
v_mul_f32 v42, v42, v46
M3 a[48:63],a[252:255],v[100:103],a[48:63]
TR a[248:249],v7 offset:40960
TR a[250:251],v7 offset:41472
v_exp_f32 v51, v51
v_mul_f32 v43, v43, v47
v_add_f32 v48, 1.0, v48
s_waitcnt lgkmcnt(6)
M3 a[0:15],a[224:227],v[104:107],a[0:15]
TR a[252:253],v9 offset:40960
TR a[254:255],v9 offset:41472
v_add_f32 v49, 1.0, v49
v_add_f32 v50, 1.0, v50
v_add_f32 v51, 1.0, v51
M3 a[16:31],a[228:231],v[104:107],a[16:31]
v_rcp_f32 v48, v48
v_rcp_f32 v49, v49
v_rcp_f32 v50, v50
M3 a[32:47],a[232:235],v[104:107],a[32:47]
v_rcp_f32 v51, v51
v_mul_f32 v56, v40, v48
v_mul_f32 v57, v41, v49
v_mul_f32 v58, v42, v50
v_mul_f32 v59, v43, v51
M3 a[48:63],a[236:239],v[104:107],a[48:63]
s_waitcnt vmcnt(14) lgkmcnt(0)
s_barrier
TR a[224:225],v2 offset:5120
TR a[226:227],v2 offset:5632
TR a[228:229],v4 offset:5120
TR a[230:231],v4 offset:5632
M3 a[0:15],a[240:243],v[108:111],a[0:15]
TR a[232:233],v6 offset:5120
TR a[234:235],v6 offset:5632
TR a[236:237],v8 offset:5120
TR a[238:239],v8 offset:5632
s_add_u32 m0, s6, 0
s_bfe_u32 s60, s58, 0x40014
s_mul_i32 s60, s60, 221184
s_add_u32 s60, s60, s41
BL v10,s[12:15],s60 offen lds
M3 a[16:31],a[244:247],v[108:111],a[16:31]
TR a[240:241],v2 offset:46080
TR a[242:243],v2 offset:46592
M3 a[32:47],a[248:251],v[108:111],a[32:47]
TR a[244:245],v4 offset:46080
TR a[246:247],v4 offset:46592
BL v11,s[12:15],s60 offen offset:1024 lds
AR v40,a84
AR v41,a85
M3 a[48:63],a[252:255],v[108:111],a[48:63]
TR a[248:249],v6 offset:46080
TR a[250:251],v6 offset:46592
AR v42,a86
AR v43,a87
AR v44,a92
AR v45,a93
s_waitcnt lgkmcnt(6)
M3 a[0:15],a[224:227],v[112:115],a[0:15]
TR a[252:253],v8 offset:46080
TR a[254:255],v8 offset:46592
BL v12,s[16:19],s60 offen offset:2048 lds
s_waitcnt vmcnt(4)
K1_GU3_W_chk:
v_cmp_ne_u32 vcc, v30, v26
v_cmp_ne_u32 s[84:85], v31, v26
s_nop 0
s_or_b64 vcc, vcc, s[84:85]
v_cmp_ne_u32 s[84:85], v32, v26
s_nop 0
s_or_b64 vcc, vcc, s[84:85]
v_cmp_ne_u32 s[84:85], v33, v26
s_nop 0
s_or_b64 vcc, vcc, s[84:85]
v_cmp_ne_u32 s[84:85], v94, v26
s_nop 0
s_or_b64 vcc, vcc, s[84:85]
s_cmp_eq_u64 vcc, 0
s_cbranch_scc1 K1_GU3_W_ok
s_cmp_eq_u32 s101, 0
s_cbranch_scc1 K1_GU3_W_ok
s_sub_u32 s101, s101, 1
s_sleep 10
BL v[30:33],v27,s[24:27],s57 offen sc1
buffer_load_dword v94, v95, s[24:27], s57 offen offset:1024 sc1
s_waitcnt vmcnt(0)
s_branch K1_GU3_W_chk
K1_GU3_W_ok:
M3 a[16:31],a[228:231],v[112:115],a[16:31]
TR a[224:225],v3 offset:5120
TR a[226:227],v3 offset:5632
M3 a[32:47],a[232:235],v[112:115],a[32:47]
TR a[228:229],v5 offset:5120
TR a[230:231],v5 offset:5632
BL v13,s[16:19],s60 offen offset:3072 lds
M3 a[48:63],a[236:239],v[112:115],a[48:63]
TR a[232:233],v7 offset:5120
TR a[234:235],v7 offset:5632
AR v46,a94
AR v47,a95
v_mul_f32 v48, s50, v40
v_mul_f32 v49, s50, v41
s_waitcnt lgkmcnt(6)
M3 a[0:15],a[240:243],v[116:119],a[0:15]
TR a[236:237],v9 offset:5120
TR a[238:239],v9 offset:5632
s_bfe_u32 s65, s87, 0x80000
s_mul_i32 s65, s65, 40960
BL a[160:163],v27,s[32:35],s65 offen sc1
M3 a[16:31],a[244:247],v[116:119],a[16:31]
TR a[240:241],v3 offset:46080
TR a[242:243],v3 offset:46592
v_mul_f32 v50, s50, v42
v_mul_f32 v51, s50, v43
v_exp_f32 v48, v48
M3 a[32:47],a[248:251],v[116:119],a[32:47]
TR a[244:245],v5 offset:46080
TR a[246:247],v5 offset:46592
BL a[164:167],v27,s[32:35],s65 offen offset:1024 sc1
v_mul_f32 v40, v40, v44
M3 a[48:63],a[252:255],v[116:119],a[48:63]
TR a[248:249],v7 offset:46080
TR a[250:251],v7 offset:46592
v_exp_f32 v49, v49
v_mul_f32 v41, v41, v45
s_waitcnt lgkmcnt(6)
M3 a[0:15],a[224:227],v[120:123],a[0:15]
TR a[252:253],v9 offset:46080
TR a[254:255],v9 offset:46592
BL a[168:171],v27,s[32:35],s65 offen offset:2048 sc1
v_exp_f32 v50, v50
M3 a[16:31],a[228:231],v[120:123],a[16:31]
v_mul_f32 v42, v42, v46
v_exp_f32 v51, v51
v_mul_f32 v43, v43, v47
v_add_f32 v48, 1.0, v48
v_add_f32 v49, 1.0, v49
M3 a[32:47],a[232:235],v[120:123],a[32:47]
BL a[172:175],v27,s[32:35],s65 offen offset:3072 sc1
v_add_f32 v50, 1.0, v50
v_add_f32 v51, 1.0, v51
v_rcp_f32 v48, v48
M3 a[48:63],a[236:239],v[120:123],a[48:63]
s_waitcnt lgkmcnt(0)
s_barrier
TR a[224:225],v2 offset:10240
TR a[226:227],v2 offset:10752
TR a[228:229],v4 offset:10240
TR a[230:231],v4 offset:10752
M3 a[0:15],a[240:243],v[124:127],a[0:15]
TR a[232:233],v6 offset:10240
TR a[234:235],v6 offset:10752
TR a[236:237],v8 offset:10240
TR a[238:239],v8 offset:10752
s_add_u32 m0, s6, 5120
s_bfe_u32 s60, s58, 0x40018
s_mul_i32 s60, s60, 221184
s_add_u32 s60, s60, s41
BL v10,s[12:15],s60 offen lds
M3 a[16:31],a[244:247],v[124:127],a[16:31]
TR a[240:241],v2 offset:51200
TR a[242:243],v2 offset:51712
M3 a[32:47],a[248:251],v[124:127],a[32:47]
TR a[244:245],v4 offset:51200
TR a[246:247],v4 offset:51712
BL v11,s[12:15],s60 offen offset:1024 lds
v_rcp_f32 v49, v49
M3 a[48:63],a[252:255],v[124:127],a[48:63]
TR a[248:249],v6 offset:51200
TR a[250:251],v6 offset:51712
v_rcp_f32 v50, v50
v_rcp_f32 v51, v51
s_waitcnt lgkmcnt(6)
M3 a[0:15],a[224:227],v[128:131],a[0:15]
TR a[252:253],v8 offset:51200
TR a[254:255],v8 offset:51712
BL v12,s[16:19],s60 offen offset:2048 lds
v_mul_f32 v60, v40, v48
v_mul_f32 v61, v41, v49
M3 a[16:31],a[228:231],v[128:131],a[16:31]
TR a[224:225],v3 offset:10240
TR a[226:227],v3 offset:10752
v_mul_f32 v62, v42, v50
v_mul_f32 v63, v43, v51
CV v64,v56,v57
CV v65,v58,v59
M3 a[32:47],a[232:235],v[128:131],a[32:47]
TR a[228:229],v5 offset:10240
TR a[230:231],v5 offset:10752
BL v13,s[16:19],s60 offen offset:3072 lds
CV v66,v60,v61
CV v67,v62,v63
M3 a[48:63],a[236:239],v[128:131],a[48:63]
TR a[232:233],v7 offset:10240
TR a[234:235],v7 offset:10752
buffer_store_dwordx4 v[64:67], v28, s[24:27], s46 offen sc1
AR v40,a96
AR v41,a97
s_waitcnt lgkmcnt(6)
M3 a[0:15],a[240:243],v[132:135],a[0:15]
TR a[236:237],v9 offset:10240
TR a[238:239],v9 offset:10752
BL a[176:179],v25,s[32:35],s65 offen sc1
AR v42,a98
AR v43,a99
M3 a[16:31],a[244:247],v[132:135],a[16:31]
TR a[240:241],v3 offset:51200
TR a[242:243],v3 offset:51712
AR v44,a104
AR v45,a105
AR v46,a106
AR v47,a107
M3 a[32:47],a[248:251],v[132:135],a[32:47]
TR a[244:245],v5 offset:51200
TR a[246:247],v5 offset:51712
s_bfe_u32 s65, s87, 0x80008
s_mul_i32 s65, s65, 40960
BL a[180:183],v27,s[32:35],s65 offen sc1
M3 a[48:63],a[252:255],v[132:135],a[48:63]
TR a[248:249],v7 offset:51200
TR a[250:251],v7 offset:51712
v_mul_f32 v48, s50, v40
v_mul_f32 v49, s50, v41
v_mul_f32 v50, s50, v42
v_mul_f32 v51, s50, v43
s_waitcnt lgkmcnt(6)
M3 a[0:15],a[224:227],v[136:139],a[0:15]
TR a[252:253],v9 offset:51200
TR a[254:255],v9 offset:51712
BL a[184:187],v27,s[32:35],s65 offen offset:1024 sc1
v_exp_f32 v48, v48
M3 a[16:31],a[228:231],v[136:139],a[16:31]
v_mul_f32 v40, v40, v44
v_exp_f32 v49, v49
v_mul_f32 v41, v41, v45
v_exp_f32 v50, v50
M3 a[32:47],a[232:235],v[136:139],a[32:47]
BL a[188:191],v27,s[32:35],s65 offen offset:2048 sc1
v_mul_f32 v42, v42, v46
v_exp_f32 v51, v51
v_mul_f32 v43, v43, v47
M3 a[48:63],a[236:239],v[136:139],a[48:63]
s_waitcnt lgkmcnt(0)
s_barrier
TR a[224:225],v2 offset:15360
TR a[226:227],v2 offset:15872
TR a[228:229],v4 offset:15360
TR a[230:231],v4 offset:15872
M3 a[0:15],a[240:243],v[140:143],a[0:15]
TR a[232:233],v6 offset:15360
TR a[234:235],v6 offset:15872
TR a[236:237],v8 offset:15360
TR a[238:239],v8 offset:15872
s_add_u32 m0, s6, 10240
s_bfe_u32 s60, s58, 0x4001c
s_mul_i32 s60, s60, 221184
s_add_u32 s60, s60, s41
BL v10,s[12:15],s60 offen lds
M3 a[16:31],a[244:247],v[140:143],a[16:31]
TR a[240:241],v2 offset:56320
TR a[242:243],v2 offset:56832
M3 a[32:47],a[248:251],v[140:143],a[32:47]
TR a[244:245],v4 offset:56320
TR a[246:247],v4 offset:56832
BL v11,s[12:15],s60 offen offset:1024 lds
v_add_f32 v48, 1.0, v48
v_add_f32 v49, 1.0, v49
M3 a[48:63],a[252:255],v[140:143],a[48:63]
TR a[248:249],v6 offset:56320
TR a[250:251],v6 offset:56832
v_add_f32 v50, 1.0, v50
v_add_f32 v51, 1.0, v51
v_rcp_f32 v48, v48
s_waitcnt lgkmcnt(6)
M3 a[0:15],a[224:227],v[144:147],a[0:15]
TR a[252:253],v8 offset:56320
TR a[254:255],v8 offset:56832
BL v12,s[16:19],s60 offen offset:2048 lds
v_rcp_f32 v49, v49
M3 a[16:31],a[228:231],v[144:147],a[16:31]
TR a[224:225],v3 offset:15360
TR a[226:227],v3 offset:15872
v_rcp_f32 v50, v50
v_rcp_f32 v51, v51
M3 a[32:47],a[232:235],v[144:147],a[32:47]
TR a[228:229],v5 offset:15360
TR a[230:231],v5 offset:15872
BL v13,s[16:19],s60 offen offset:3072 lds
v_mul_f32 v56, v40, v48
v_mul_f32 v57, v41, v49
M3 a[48:63],a[236:239],v[144:147],a[48:63]
TR a[232:233],v7 offset:15360
TR a[234:235],v7 offset:15872
v_mul_f32 v58, v42, v50
v_mul_f32 v59, v43, v51
AR v40,a100
AR v41,a101
s_waitcnt lgkmcnt(6)
M3 a[0:15],a[240:243],v[148:151],a[0:15]
TR a[236:237],v9 offset:15360
TR a[238:239],v9 offset:15872
BL a[192:195],v27,s[32:35],s65 offen offset:3072 sc1
AR v42,a102
AR v43,a103
M3 a[16:31],a[244:247],v[148:151],a[16:31]
TR a[240:241],v3 offset:56320
TR a[242:243],v3 offset:56832
AR v44,a108
AR v45,a109
AR v46,a110
AR v47,a111
M3 a[32:47],a[248:251],v[148:151],a[32:47]
TR a[244:245],v5 offset:56320
TR a[246:247],v5 offset:56832
BL a[196:199],v25,s[32:35],s65 offen sc1
v_mul_f32 v48, s50, v40
v_mul_f32 v49, s50, v41
M3 a[48:63],a[252:255],v[148:151],a[48:63]
TR a[248:249],v7 offset:56320
TR a[250:251],v7 offset:56832
v_mul_f32 v50, s50, v42
v_mul_f32 v51, s50, v43
v_exp_f32 v48, v48
s_waitcnt lgkmcnt(6)
M3 a[0:15],a[224:227],v[152:155],a[0:15]
TR a[252:253],v9 offset:56320
TR a[254:255],v9 offset:56832
s_bfe_u32 s65, s87, 0x80010
s_mul_i32 s65, s65, 40960
BL a[200:203],v27,s[32:35],s65 offen sc1
M3 a[16:31],a[228:231],v[152:155],a[16:31]
v_mul_f32 v40, v40, v44
v_exp_f32 v49, v49
v_mul_f32 v41, v41, v45
v_exp_f32 v50, v50
M3 a[32:47],a[232:235],v[152:155],a[32:47]
BL a[204:207],v27,s[32:35],s65 offen offset:1024 sc1
v_mul_f32 v42, v42, v46
v_exp_f32 v51, v51
v_mul_f32 v43, v43, v47
M3 a[48:63],a[236:239],v[152:155],a[48:63]
s_waitcnt vmcnt(25) lgkmcnt(0)
s_barrier
TR a[224:225],v2 offset:20480
TR a[226:227],v2 offset:20992
TR a[228:229],v4 offset:20480
TR a[230:231],v4 offset:20992
M3 a[0:15],a[240:243],v[156:159],a[0:15]
TR a[232:233],v6 offset:20480
TR a[234:235],v6 offset:20992
TR a[236:237],v8 offset:20480
TR a[238:239],v8 offset:20992
s_add_u32 m0, s6, 15360
s_bfe_u32 s60, s59, 0x40000
s_mul_i32 s60, s60, 221184
s_add_u32 s60, s60, s41
BL v10,s[12:15],s60 offen lds
M3 a[16:31],a[244:247],v[156:159],a[16:31]
TR a[240:241],v2 offset:61440
TR a[242:243],v2 offset:61952
M3 a[32:47],a[248:251],v[156:159],a[32:47]
TR a[244:245],v4 offset:61440
TR a[246:247],v4 offset:61952
BL v11,s[12:15],s60 offen offset:1024 lds
v_add_f32 v48, 1.0, v48
v_add_f32 v49, 1.0, v49
M3 a[48:63],a[252:255],v[156:159],a[48:63]
TR a[248:249],v6 offset:61440
TR a[250:251],v6 offset:61952
v_add_f32 v50, 1.0, v50
v_add_f32 v51, 1.0, v51
v_rcp_f32 v48, v48
s_waitcnt lgkmcnt(6)
M3 a[0:15],a[224:227],v[160:163],a[0:15]
TR a[252:253],v8 offset:61440
TR a[254:255],v8 offset:61952
BL v12,s[16:19],s60 offen offset:2048 lds
v_rcp_f32 v49, v49
M3 a[16:31],a[228:231],v[160:163],a[16:31]
TR a[224:225],v3 offset:20480
TR a[226:227],v3 offset:20992
v_rcp_f32 v50, v50
v_rcp_f32 v51, v51
M3 a[32:47],a[232:235],v[160:163],a[32:47]
TR a[228:229],v5 offset:20480
TR a[230:231],v5 offset:20992
BL v13,s[16:19],s60 offen offset:3072 lds
v_mul_f32 v60, v40, v48
v_mul_f32 v61, v41, v49
M3 a[48:63],a[236:239],v[160:163],a[48:63]
TR a[232:233],v7 offset:20480
TR a[234:235],v7 offset:20992
v_mul_f32 v62, v42, v50
v_mul_f32 v63, v43, v51
CV v68,v56,v57
CV v69,v58,v59
s_waitcnt lgkmcnt(6)
M3 a[0:15],a[240:243],v[164:167],a[0:15]
TR a[236:237],v9 offset:20480
TR a[238:239],v9 offset:20992
BL a[208:211],v27,s[32:35],s65 offen offset:2048 sc1
CV v70,v60,v61
CV v71,v62,v63
M3 a[16:31],a[244:247],v[164:167],a[16:31]
TR a[240:241],v3 offset:61440
TR a[242:243],v3 offset:61952
buffer_store_dwordx4 v[68:71], v28, s[24:27], s46 offen offset:512 sc1
AR v40,a112
AR v41,a113
M3 a[32:47],a[248:251],v[164:167],a[32:47]
TR a[244:245],v5 offset:61440
TR a[246:247],v5 offset:61952
BL a[212:215],v27,s[32:35],s65 offen offset:3072 sc1
AR v42,a114
AR v43,a115
M3 a[48:63],a[252:255],v[164:167],a[48:63]
TR a[248:249],v7 offset:61440
TR a[250:251],v7 offset:61952
AR v44,a120
AR v45,a121
AR v46,a122
AR v47,a123
s_waitcnt lgkmcnt(6)
M3 a[0:15],a[224:227],v[168:171],a[0:15]
TR a[252:253],v9 offset:61440
TR a[254:255],v9 offset:61952
BL a[216:219],v25,s[32:35],s65 offen sc1
v_mul_f32 v48, s50, v40
v_mul_f32 v49, s50, v41
M3 a[16:31],a[228:231],v[168:171],a[16:31]
v_mul_f32 v50, s50, v42
v_mul_f32 v51, s50, v43
v_exp_f32 v48, v48
v_mul_f32 v40, v40, v44
M3 a[32:47],a[232:235],v[168:171],a[32:47]
s_bfe_u32 s65, s87, 0x80018
s_mul_i32 s65, s65, 40960
BL a[220:223],v27,s[32:35],s65 offen sc1
v_exp_f32 v49, v49
M3 a[48:63],a[236:239],v[168:171],a[48:63]
s_waitcnt vmcnt(30) lgkmcnt(0)
s_barrier
TR a[224:225],v2
TR a[226:227],v2 offset:512
TR a[228:229],v4
TR a[230:231],v4 offset:512
M3 a[0:15],a[240:243],v[172:175],a[0:15]
TR a[232:233],v6
TR a[234:235],v6 offset:512
TR a[236:237],v8
TR a[238:239],v8 offset:512
s_add_u32 m0, s6, 20480
s_bfe_u32 s60, s59, 0x40004
s_mul_i32 s60, s60, 221184
s_add_u32 s60, s60, s41
BL v10,s[12:15],s60 offen lds
M3 a[16:31],a[244:247],v[172:175],a[16:31]
TR a[240:241],v2 offset:40960
TR a[242:243],v2 offset:41472
M3 a[32:47],a[248:251],v[172:175],a[32:47]
TR a[244:245],v4 offset:40960
TR a[246:247],v4 offset:41472
BL v11,s[12:15],s60 offen offset:1024 lds
v_mul_f32 v41, v41, v45
M3 a[48:63],a[252:255],v[172:175],a[48:63]
TR a[248:249],v6 offset:40960
TR a[250:251],v6 offset:41472
v_exp_f32 v50, v50
v_mul_f32 v42, v42, v46
s_waitcnt lgkmcnt(6)
M3 a[0:15],a[224:227],v[176:179],a[0:15]
TR a[252:253],v8 offset:40960
TR a[254:255],v8 offset:41472
BL v12,s[16:19],s60 offen offset:2048 lds
v_exp_f32 v51, v51
M3 a[16:31],a[228:231],v[176:179],a[16:31]
TR a[224:225],v3
TR a[226:227],v3 offset:512
v_mul_f32 v43, v43, v47
v_add_f32 v48, 1.0, v48
v_add_f32 v49, 1.0, v49
v_add_f32 v50, 1.0, v50
M3 a[32:47],a[232:235],v[176:179],a[32:47]
TR a[228:229],v5
TR a[230:231],v5 offset:512
BL v13,s[16:19],s60 offen offset:3072 lds
v_add_f32 v51, 1.0, v51
M3 a[48:63],a[236:239],v[176:179],a[48:63]
TR a[232:233],v7
TR a[234:235],v7 offset:512
v_rcp_f32 v48, v48
v_rcp_f32 v49, v49
s_waitcnt lgkmcnt(6)
M3 a[0:15],a[240:243],v[180:183],a[0:15]
TR a[236:237],v9
TR a[238:239],v9 offset:512
s_add_u32 m0, s6, 32768
s_nop 0
BL v27,s[32:35],s65 offen offset:1024 sc1 lds
M3 a[16:31],a[244:247],v[180:183],a[16:31]
TR a[240:241],v3 offset:40960
TR a[242:243],v3 offset:41472
v_rcp_f32 v50, v50
v_rcp_f32 v51, v51
M3 a[32:47],a[248:251],v[180:183],a[32:47]
TR a[244:245],v5 offset:40960
TR a[246:247],v5 offset:41472
BL v27,s[32:35],s65 offen offset:2048 sc1 lds
v_mul_f32 v56, v40, v48
v_mul_f32 v57, v41, v49
M3 a[48:63],a[252:255],v[180:183],a[48:63]
TR a[248:249],v7 offset:40960
TR a[250:251],v7 offset:41472
v_mul_f32 v58, v42, v50
v_mul_f32 v59, v43, v51
AR v40,a116
AR v41,a117
s_waitcnt lgkmcnt(6)
M3 a[0:15],a[224:227],v[184:187],a[0:15]
TR a[252:253],v9 offset:40960
TR a[254:255],v9 offset:41472
BL v27,s[32:35],s65 offen offset:3072 sc1 lds
AR v42,a118
AR v43,a119
M3 a[16:31],a[228:231],v[184:187],a[16:31]
AR v44,a124
AR v45,a125
AR v46,a126
AR v47,a127
v_mul_f32 v48, s50, v40
v_mul_f32 v49, s50, v41
M3 a[32:47],a[232:235],v[184:187],a[32:47]
s_add_u32 m0, s6, 36864
s_nop 0
BL v25,s[32:35],s65 offen sc1 lds
v_mul_f32 v50, s50, v42
v_mul_f32 v51, s50, v43
M3 a[48:63],a[236:239],v[184:187],a[48:63]
s_waitcnt vmcnt(30) lgkmcnt(0)
s_barrier
TR a[224:225],v2 offset:5120
TR a[226:227],v2 offset:5632
TR a[228:229],v4 offset:5120
TR a[230:231],v4 offset:5632
M3 a[0:15],a[240:243],v[188:191],a[0:15]
TR a[232:233],v6 offset:5120
TR a[234:235],v6 offset:5632
TR a[236:237],v8 offset:5120
TR a[238:239],v8 offset:5632
s_add_u32 m0, s6, 0
s_bfe_u32 s60, s58, 0x40000
s_mul_i32 s60, s60, 221184
s_add_u32 s60, s60, s42
BL v10,s[12:15],s60 offen lds
M3 a[16:31],a[244:247],v[188:191],a[16:31]
TR a[240:241],v2 offset:46080
TR a[242:243],v2 offset:46592
M3 a[32:47],a[248:251],v[188:191],a[32:47]
TR a[244:245],v4 offset:46080
TR a[246:247],v4 offset:46592
BL v11,s[12:15],s60 offen offset:1024 lds
v_exp_f32 v48, v48
M3 a[48:63],a[252:255],v[188:191],a[48:63]
TR a[248:249],v6 offset:46080
TR a[250:251],v6 offset:46592
v_mul_f32 v40, v40, v44
v_exp_f32 v49, v49
v_mul_f32 v41, v41, v45
s_waitcnt lgkmcnt(6)
M3 a[0:15],a[224:227],v[192:195],a[0:15]
TR a[252:253],v8 offset:46080
TR a[254:255],v8 offset:46592
BL v12,s[16:19],s60 offen offset:2048 lds
v_exp_f32 v50, v50
M3 a[16:31],a[228:231],v[192:195],a[16:31]
TR a[224:225],v3 offset:5120
TR a[226:227],v3 offset:5632
v_mul_f32 v42, v42, v46
v_exp_f32 v51, v51
v_mul_f32 v43, v43, v47
M3 a[32:47],a[232:235],v[192:195],a[32:47]
TR a[228:229],v5 offset:5120
TR a[230:231],v5 offset:5632
BL v13,s[16:19],s60 offen offset:3072 lds
v_add_f32 v48, 1.0, v48
v_add_f32 v49, 1.0, v49
M3 a[48:63],a[236:239],v[192:195],a[48:63]
TR a[232:233],v7 offset:5120
TR a[234:235],v7 offset:5632
v_add_f32 v50, 1.0, v50
v_add_f32 v51, 1.0, v51
v_rcp_f32 v48, v48
s_waitcnt lgkmcnt(6)
M3 a[0:15],a[240:243],v[196:199],a[0:15]
TR a[236:237],v9 offset:5120
TR a[238:239],v9 offset:5632
s_add_u32 m0, s6, 37888
s_bfe_u32 s65, s88, 0x80000
s_mul_i32 s65, s65, 40960
BL v27,s[32:35],s65 offen sc1 lds
M3 a[16:31],a[244:247],v[196:199],a[16:31]
TR a[240:241],v3 offset:46080
TR a[242:243],v3 offset:46592
v_rcp_f32 v49, v49
M3 a[32:47],a[248:251],v[196:199],a[32:47]
TR a[244:245],v5 offset:46080
TR a[246:247],v5 offset:46592
BL v27,s[32:35],s65 offen offset:1024 sc1 lds
v_rcp_f32 v50, v50
M3 a[48:63],a[252:255],v[196:199],a[48:63]
TR a[248:249],v7 offset:46080
TR a[250:251],v7 offset:46592
v_rcp_f32 v51, v51
v_mul_f32 v60, v40, v48
v_mul_f32 v61, v41, v49
s_waitcnt lgkmcnt(6)
M3 a[0:15],a[224:227],v[200:203],a[0:15]
TR a[252:253],v9 offset:46080
TR a[254:255],v9 offset:46592
BL v27,s[32:35],s65 offen offset:2048 sc1 lds
v_mul_f32 v62, v42, v50
v_mul_f32 v63, v43, v51
M3 a[16:31],a[228:231],v[200:203],a[16:31]
CV v64,v56,v57
CV v65,v58,v59
CV v66,v60,v61
CV v67,v62,v63
buffer_store_dwordx4 v[64:67], v29, s[24:27], s46 offen sc1
M3 a[32:47],a[232:235],v[200:203],a[32:47]
BL a[64:67],v27,s[32:35],s65 offen offset:3072 sc1
AR v40,a128
AR v41,a129
AR v42,a130
AR v43,a131
M3 a[48:63],a[236:239],v[200:203],a[48:63]
s_waitcnt vmcnt(30) lgkmcnt(0)
s_barrier
TR a[224:225],v2 offset:10240
TR a[226:227],v2 offset:10752
TR a[228:229],v4 offset:10240
TR a[230:231],v4 offset:10752
M3 a[0:15],a[240:243],v[204:207],a[0:15]
TR a[232:233],v6 offset:10240
TR a[234:235],v6 offset:10752
TR a[236:237],v8 offset:10240
TR a[238:239],v8 offset:10752
s_add_u32 m0, s6, 5120
s_bfe_u32 s60, s58, 0x40004
s_mul_i32 s60, s60, 221184
s_add_u32 s60, s60, s42
BL v10,s[12:15],s60 offen lds
M3 a[16:31],a[244:247],v[204:207],a[16:31]
TR a[240:241],v2 offset:51200
TR a[242:243],v2 offset:51712
M3 a[32:47],a[248:251],v[204:207],a[32:47]
TR a[244:245],v4 offset:51200
TR a[246:247],v4 offset:51712
BL v11,s[12:15],s60 offen offset:1024 lds
AR v44,a136
AR v45,a137
M3 a[48:63],a[252:255],v[204:207],a[48:63]
TR a[248:249],v6 offset:51200
TR a[250:251],v6 offset:51712
AR v46,a138
AR v47,a139
v_mul_f32 v48, s50, v40
v_mul_f32 v49, s50, v41
s_waitcnt lgkmcnt(6)
M3 a[0:15],a[224:227],v[208:211],a[0:15]
TR a[252:253],v8 offset:51200
TR a[254:255],v8 offset:51712
BL v12,s[16:19],s60 offen offset:2048 lds
v_mul_f32 v50, s50, v42
v_mul_f32 v51, s50, v43
M3 a[16:31],a[228:231],v[208:211],a[16:31]
TR a[224:225],v3 offset:10240
TR a[226:227],v3 offset:10752
v_exp_f32 v48, v48
v_mul_f32 v40, v40, v44
M3 a[32:47],a[232:235],v[208:211],a[32:47]
TR a[228:229],v5 offset:10240
TR a[230:231],v5 offset:10752
BL v13,s[16:19],s60 offen offset:3072 lds
v_exp_f32 v49, v49
M3 a[48:63],a[236:239],v[208:211],a[48:63]
TR a[232:233],v7 offset:10240
TR a[234:235],v7 offset:10752
v_mul_f32 v41, v41, v45
v_exp_f32 v50, v50
v_mul_f32 v42, v42, v46
s_waitcnt lgkmcnt(6)
M3 a[0:15],a[240:243],v[212:215],a[0:15]
TR a[236:237],v9 offset:10240
TR a[238:239],v9 offset:10752
BL a[68:71],v25,s[32:35],s65 offen sc1
v_exp_f32 v51, v51
M3 a[16:31],a[244:247],v[212:215],a[16:31]
TR a[240:241],v3 offset:51200
TR a[242:243],v3 offset:51712
v_mul_f32 v43, v43, v47
v_add_f32 v48, 1.0, v48
v_add_f32 v49, 1.0, v49
v_add_f32 v50, 1.0, v50
M3 a[32:47],a[248:251],v[212:215],a[32:47]
TR a[244:245],v5 offset:51200
TR a[246:247],v5 offset:51712
s_bfe_u32 s65, s88, 0x80008
s_mul_i32 s65, s65, 40960
BL a[72:75],v27,s[32:35],s65 offen sc1
M3 a[48:63],a[252:255],v[212:215],a[48:63]
TR a[248:249],v7 offset:51200
TR a[250:251],v7 offset:51712
v_add_f32 v51, 1.0, v51
v_rcp_f32 v48, v48
s_waitcnt lgkmcnt(6)
M3 a[0:15],a[224:227],v[216:219],a[0:15]
TR a[252:253],v9 offset:51200
TR a[254:255],v9 offset:51712
BL a[76:79],v27,s[32:35],s65 offen offset:1024 sc1
v_rcp_f32 v49, v49
M3 a[16:31],a[228:231],v[216:219],a[16:31]
v_rcp_f32 v50, v50
v_rcp_f32 v51, v51
v_mul_f32 v56, v40, v48
v_mul_f32 v57, v41, v49
M3 a[32:47],a[232:235],v[216:219],a[32:47]
s_add_u32 m0, s6, 23552
s_nop 0
BL v27,s[32:35],s65 offen offset:2048 sc1 lds
v_mul_f32 v58, v42, v50
v_mul_f32 v59, v43, v51
AR v40,a132
M3 a[48:63],a[236:239],v[216:219],a[48:63]
s_waitcnt vmcnt(30) lgkmcnt(0)
s_barrier
TR a[224:225],v2 offset:15360
TR a[226:227],v2 offset:15872
TR a[228:229],v4 offset:15360
TR a[230:231],v4 offset:15872
M3 a[0:15],a[240:243],v[220:223],a[0:15]
TR a[232:233],v6 offset:15360
TR a[234:235],v6 offset:15872
TR a[236:237],v8 offset:15360
TR a[238:239],v8 offset:15872
s_add_u32 m0, s6, 10240
s_bfe_u32 s60, s58, 0x40008
s_mul_i32 s60, s60, 221184
s_add_u32 s60, s60, s42
BL v10,s[12:15],s60 offen lds
M3 a[16:31],a[244:247],v[220:223],a[16:31]
TR a[240:241],v2 offset:56320
TR a[242:243],v2 offset:56832
M3 a[32:47],a[248:251],v[220:223],a[32:47]
TR a[244:245],v4 offset:56320
TR a[246:247],v4 offset:56832
BL v11,s[12:15],s60 offen offset:1024 lds
AR v41,a133
AR v42,a134
M3 a[48:63],a[252:255],v[220:223],a[48:63]
TR a[248:249],v6 offset:56320
TR a[250:251],v6 offset:56832
AR v43,a135
AR v44,a140
AR v45,a141
AR v46,a142
s_waitcnt lgkmcnt(6)
M3 a[0:15],a[224:227],v[224:227],a[0:15]
TR a[252:253],v8 offset:56320
TR a[254:255],v8 offset:56832
BL v12,s[16:19],s60 offen offset:2048 lds
AR v47,a143
v_mul_f32 v48, s50, v40
M3 a[16:31],a[228:231],v[224:227],a[16:31]
TR a[224:225],v3 offset:15360
TR a[226:227],v3 offset:15872
v_mul_f32 v49, s50, v41
v_mul_f32 v50, s50, v42
v_mul_f32 v51, s50, v43
M3 a[32:47],a[232:235],v[224:227],a[32:47]
TR a[228:229],v5 offset:15360
TR a[230:231],v5 offset:15872
BL v13,s[16:19],s60 offen offset:3072 lds
v_exp_f32 v48, v48
M3 a[48:63],a[236:239],v[224:227],a[48:63]
TR a[232:233],v7 offset:15360
TR a[234:235],v7 offset:15872
v_mul_f32 v40, v40, v44
v_exp_f32 v49, v49
v_mul_f32 v41, v41, v45
s_waitcnt lgkmcnt(6)
M3 a[0:15],a[240:243],v[228:231],a[0:15]
TR a[236:237],v9 offset:15360
TR a[238:239],v9 offset:15872
s_add_u32 m0, s6, 23552
s_nop 0
BL v27,s[32:35],s65 offen offset:3072 sc1 lds
M3 a[16:31],a[244:247],v[228:231],a[16:31]
TR a[240:241],v3 offset:56320
TR a[242:243],v3 offset:56832
v_exp_f32 v50, v50
v_mul_f32 v42, v42, v46
M3 a[32:47],a[248:251],v[228:231],a[32:47]
TR a[244:245],v5 offset:56320
TR a[246:247],v5 offset:56832
s_add_u32 m0, s6, 27648
s_nop 0
BL v25,s[32:35],s65 offen sc1 lds
M3 a[48:63],a[252:255],v[228:231],a[48:63]
TR a[248:249],v7 offset:56320
TR a[250:251],v7 offset:56832
v_exp_f32 v51, v51
v_mul_f32 v43, v43, v47
v_add_f32 v48, 1.0, v48
s_waitcnt lgkmcnt(6)
M3 a[0:15],a[224:227],v[232:235],a[0:15]
TR a[252:253],v9 offset:56320
TR a[254:255],v9 offset:56832
s_add_u32 m0, s6, 28672
s_bfe_u32 s65, s88, 0x80010
s_mul_i32 s65, s65, 40960
BL v27,s[32:35],s65 offen sc1 lds
M3 a[16:31],a[228:231],v[232:235],a[16:31]
v_add_f32 v49, 1.0, v49
v_add_f32 v50, 1.0, v50
v_add_f32 v51, 1.0, v51
v_rcp_f32 v48, v48
M3 a[32:47],a[232:235],v[232:235],a[32:47]
BL v27,s[32:35],s65 offen offset:1024 sc1 lds
v_rcp_f32 v49, v49
v_rcp_f32 v50, v50
M3 a[48:63],a[236:239],v[232:235],a[48:63]
s_waitcnt vmcnt(29) lgkmcnt(0)
s_barrier
TR a[224:225],v2 offset:20480
TR a[226:227],v2 offset:20992
TR a[228:229],v4 offset:20480
TR a[230:231],v4 offset:20992
M3 a[0:15],a[240:243],v[236:239],a[0:15]
TR a[232:233],v6 offset:20480
TR a[234:235],v6 offset:20992
TR a[236:237],v8 offset:20480
TR a[238:239],v8 offset:20992
s_add_u32 m0, s6, 15360
s_bfe_u32 s60, s58, 0x4000c
s_mul_i32 s60, s60, 221184
s_add_u32 s60, s60, s42
BL v10,s[12:15],s60 offen lds
M3 a[16:31],a[244:247],v[236:239],a[16:31]
TR a[240:241],v2 offset:61440
TR a[242:243],v2 offset:61952
M3 a[32:47],a[248:251],v[236:239],a[32:47]
TR a[244:245],v4 offset:61440
TR a[246:247],v4 offset:61952
BL v11,s[12:15],s60 offen offset:1024 lds
v_rcp_f32 v51, v51
M3 a[48:63],a[252:255],v[236:239],a[48:63]
TR a[248:249],v6 offset:61440
TR a[250:251],v6 offset:61952
v_mul_f32 v60, v40, v48
v_mul_f32 v61, v41, v49
v_mul_f32 v62, v42, v50
v_mul_f32 v63, v43, v51
s_waitcnt lgkmcnt(6)
M3 a[0:15],a[224:227],v[240:243],a[0:15]
TR a[252:253],v8 offset:61440
TR a[254:255],v8 offset:61952
BL v12,s[16:19],s60 offen offset:2048 lds
CV v68,v56,v57
CV v69,v58,v59
M3 a[16:31],a[228:231],v[240:243],a[16:31]
TR a[224:225],v3 offset:20480
TR a[226:227],v3 offset:20992
CV v70,v60,v61
CV v71,v62,v63
buffer_store_dwordx4 v[68:71], v29, s[24:27], s46 offen offset:512 sc1
M3 a[32:47],a[232:235],v[240:243],a[32:47]
TR a[228:229],v5 offset:20480
TR a[230:231],v5 offset:20992
BL v13,s[16:19],s60 offen offset:3072 lds
M3 a[48:63],a[236:239],v[240:243],a[48:63]
TR a[232:233],v7 offset:20480
TR a[234:235],v7 offset:20992
s_waitcnt lgkmcnt(6)
M3 a[0:15],a[240:243],v[244:247],a[0:15]
TR a[236:237],v9 offset:20480
TR a[238:239],v9 offset:20992
s_add_u32 m0, s6, 28672
s_nop 0
BL v27,s[32:35],s65 offen offset:2048 sc1 lds
M3 a[16:31],a[244:247],v[244:247],a[16:31]
TR a[240:241],v3 offset:61440
TR a[242:243],v3 offset:61952
M3 a[32:47],a[248:251],v[244:247],a[32:47]
TR a[244:245],v5 offset:61440
TR a[246:247],v5 offset:61952
BL v27,s[32:35],s65 offen offset:3072 sc1 lds
M3 a[48:63],a[252:255],v[244:247],a[48:63]
TR a[248:249],v7 offset:61440
TR a[250:251],v7 offset:61952
s_waitcnt lgkmcnt(6)
M3 a[0:15],a[224:227],v[248:251],a[0:15]
TR a[252:253],v9 offset:61440
TR a[254:255],v9 offset:61952
s_add_u32 m0, s6, 32768
s_nop 0
BL v25,s[32:35],s65 offen sc1 lds
M3 a[16:31],a[228:231],v[248:251],a[16:31]
M3 a[32:47],a[232:235],v[248:251],a[32:47]
M3 a[48:63],a[236:239],v[248:251],a[48:63]
s_waitcnt vmcnt(29) lgkmcnt(0)
s_barrier
TR a[224:225],v2
TR a[226:227],v2 offset:512
TR a[228:229],v4
TR a[230:231],v4 offset:512
M3 a[0:15],a[240:243],v[252:255],a[0:15]
TR a[232:233],v6
TR a[234:235],v6 offset:512
TR a[236:237],v8
TR a[238:239],v8 offset:512
s_add_u32 m0, s6, 20480
s_bfe_u32 s60, s58, 0x40010
s_mul_i32 s60, s60, 221184
s_add_u32 s60, s60, s42
BL v10,s[12:15],s60 offen lds
M3 a[16:31],a[244:247],v[252:255],a[16:31]
TR a[240:241],v2 offset:40960
TR a[242:243],v2 offset:41472
M3 a[32:47],a[248:251],v[252:255],a[32:47]
TR a[244:245],v4 offset:40960
TR a[246:247],v4 offset:41472
BL v11,s[12:15],s60 offen offset:1024 lds
M3 a[48:63],a[252:255],v[252:255],a[48:63]
TR a[248:249],v6 offset:40960
TR a[250:251],v6 offset:41472
s_waitcnt lgkmcnt(6)
M3 a[80:95],a[224:227],v[96:99],0
TR a[252:253],v8 offset:40960
TR a[254:255],v8 offset:41472
BL v12,s[16:19],s60 offen offset:2048 lds
AR v40,a0
AR v41,a1
M3 a[96:111],a[228:231],v[96:99],0
TR a[224:225],v3
TR a[226:227],v3 offset:512
AR v42,a2
AR v43,a3
AR v44,a8
AR v45,a9
M3 a[112:127],a[232:235],v[96:99],0
TR a[228:229],v5
TR a[230:231],v5 offset:512
BL v13,s[16:19],s60 offen offset:3072 lds
AR v46,a10
AR v47,a11
M3 a[128:143],a[236:239],v[96:99],0
TR a[232:233],v7
TR a[234:235],v7 offset:512
v_mul_f32 v48, s50, v40
v_mul_f32 v49, s50, v41
v_mul_f32 v50, s50, v42
v_mul_f32 v51, s50, v43
s_waitcnt lgkmcnt(6)
M3 a[80:95],a[240:243],v[100:103],a[80:95]
TR a[236:237],v9
TR a[238:239],v9 offset:512
s_bfe_u32 s65, s88, 0x80018
s_mul_i32 s65, s65, 40960
BL a[0:3],v27,s[32:35],s65 offen sc1
M3 a[96:111],a[244:247],v[100:103],a[96:111]
TR a[240:241],v3 offset:40960
TR a[242:243],v3 offset:41472
v_exp_f32 v48, v48
v_mul_f32 v40, v40, v44
M3 a[112:127],a[248:251],v[100:103],a[112:127]
TR a[244:245],v5 offset:40960
TR a[246:247],v5 offset:41472
BL a[8:11],v27,s[32:35],s65 offen offset:2048 sc1
v_exp_f32 v49, v49
M3 a[128:143],a[252:255],v[100:103],a[128:143]
TR a[248:249],v7 offset:40960
TR a[250:251],v7 offset:41472
v_mul_f32 v41, v41, v45
v_exp_f32 v50, v50
v_mul_f32 v42, v42, v46
s_waitcnt lgkmcnt(6)
M3 a[80:95],a[224:227],v[104:107],a[80:95]
TR a[252:253],v9 offset:40960
TR a[254:255],v9 offset:41472
v_exp_f32 v51, v51
v_mul_f32 v43, v43, v47
v_add_f32 v48, 1.0, v48
M3 a[96:111],a[228:231],v[104:107],a[96:111]
v_add_f32 v49, 1.0, v49
v_add_f32 v50, 1.0, v50
v_add_f32 v51, 1.0, v51
v_rcp_f32 v48, v48
M3 a[112:127],a[232:235],v[104:107],a[112:127]
v_rcp_f32 v49, v49
v_rcp_f32 v50, v50
v_rcp_f32 v51, v51
M3 a[128:143],a[236:239],v[104:107],a[128:143]
s_waitcnt vmcnt(26) lgkmcnt(0)
s_barrier
TR a[224:225],v2 offset:5120
TR a[226:227],v2 offset:5632
TR a[228:229],v4 offset:5120
TR a[230:231],v4 offset:5632
M3 a[80:95],a[240:243],v[108:111],a[80:95]
TR a[232:233],v6 offset:5120
TR a[234:235],v6 offset:5632
TR a[236:237],v8 offset:5120
TR a[238:239],v8 offset:5632
s_add_u32 m0, s6, 0
s_bfe_u32 s60, s58, 0x40014
s_mul_i32 s60, s60, 221184
s_add_u32 s60, s60, s42
BL v10,s[12:15],s60 offen lds
M3 a[96:111],a[244:247],v[108:111],a[96:111]
TR a[240:241],v2 offset:46080
TR a[242:243],v2 offset:46592
M3 a[112:127],a[248:251],v[108:111],a[112:127]
TR a[244:245],v4 offset:46080
TR a[246:247],v4 offset:46592
BL v11,s[12:15],s60 offen offset:1024 lds
v_mul_f32 v56, v40, v48
v_mul_f32 v57, v41, v49
M3 a[128:143],a[252:255],v[108:111],a[128:143]
TR a[248:249],v6 offset:46080
TR a[250:251],v6 offset:46592
v_mul_f32 v58, v42, v50
v_mul_f32 v59, v43, v51
AR v40,a4
AR v41,a5
s_waitcnt lgkmcnt(6)
M3 a[80:95],a[224:227],v[112:115],a[80:95]
TR a[252:253],v8 offset:46080
TR a[254:255],v8 offset:46592
BL v12,s[16:19],s60 offen offset:2048 lds
AR v42,a6
AR v43,a7
M3 a[96:111],a[228:231],v[112:115],a[96:111]
TR a[224:225],v3 offset:5120
TR a[226:227],v3 offset:5632
AR v44,a12
AR v45,a13
AR v46,a14
AR v47,a15
M3 a[112:127],a[232:235],v[112:115],a[112:127]
TR a[228:229],v5 offset:5120
TR a[230:231],v5 offset:5632
BL v13,s[16:19],s60 offen offset:3072 lds
v_mul_f32 v48, s50, v40
v_mul_f32 v49, s50, v41
M3 a[128:143],a[236:239],v[112:115],a[128:143]
TR a[232:233],v7 offset:5120
TR a[234:235],v7 offset:5632
v_mul_f32 v50, s50, v42
v_mul_f32 v51, s50, v43
v_exp_f32 v48, v48
s_waitcnt lgkmcnt(6)
M3 a[80:95],a[240:243],v[116:119],a[80:95]
TR a[236:237],v9 offset:5120
TR a[238:239],v9 offset:5632
BL a[4:7],v27,s[32:35],s65 offen offset:1024 sc1
v_mul_f32 v40, v40, v44
M3 a[96:111],a[244:247],v[116:119],a[96:111]
TR a[240:241],v3 offset:46080
TR a[242:243],v3 offset:46592
v_exp_f32 v49, v49
v_mul_f32 v41, v41, v45
M3 a[112:127],a[248:251],v[116:119],a[112:127]
TR a[244:245],v5 offset:46080
TR a[246:247],v5 offset:46592
BL a[12:15],v27,s[32:35],s65 offen offset:3072 sc1
v_exp_f32 v50, v50
M3 a[128:143],a[252:255],v[116:119],a[128:143]
TR a[248:249],v7 offset:46080
TR a[250:251],v7 offset:46592
v_mul_f32 v42, v42, v46
v_exp_f32 v51, v51
v_mul_f32 v43, v43, v47
s_waitcnt lgkmcnt(6)
M3 a[80:95],a[224:227],v[120:123],a[80:95]
TR a[252:253],v9 offset:46080
TR a[254:255],v9 offset:46592
v_add_f32 v48, 1.0, v48
v_add_f32 v49, 1.0, v49
v_add_f32 v50, 1.0, v50
v_add_f32 v51, 1.0, v51
M3 a[96:111],a[228:231],v[120:123],a[96:111]
v_rcp_f32 v48, v48
v_rcp_f32 v49, v49
v_rcp_f32 v50, v50
M3 a[112:127],a[232:235],v[120:123],a[112:127]
v_rcp_f32 v51, v51
s_waitcnt vmcnt(16)
s_add_u32 s7, s96, 4294836224
buffer_store_dword v26, v20, s[24:27], s7 offen sc1
v_mul_f32 v60, v40, v48
M3 a[128:143],a[236:239],v[120:123],a[128:143]
s_waitcnt lgkmcnt(0)
s_barrier
TR a[224:225],v2 offset:10240
TR a[226:227],v2 offset:10752
TR a[228:229],v4 offset:10240
TR a[230:231],v4 offset:10752
M3 a[80:95],a[240:243],v[124:127],a[80:95]
TR a[232:233],v6 offset:10240
TR a[234:235],v6 offset:10752
TR a[236:237],v8 offset:10240
TR a[238:239],v8 offset:10752
s_add_u32 m0, s6, 5120
s_bfe_u32 s60, s58, 0x40018
s_mul_i32 s60, s60, 221184
s_add_u32 s60, s60, s42
BL v10,s[12:15],s60 offen lds
M3 a[96:111],a[244:247],v[124:127],a[96:111]
TR a[240:241],v2 offset:51200
TR a[242:243],v2 offset:51712
M3 a[112:127],a[248:251],v[124:127],a[112:127]
TR a[244:245],v4 offset:51200
TR a[246:247],v4 offset:51712
BL v11,s[12:15],s60 offen offset:1024 lds
v_mul_f32 v61, v41, v49
v_mul_f32 v62, v42, v50
M3 a[128:143],a[252:255],v[124:127],a[128:143]
TR a[248:249],v6 offset:51200
TR a[250:251],v6 offset:51712
v_mul_f32 v63, v43, v51
CV v64,v56,v57
CV v65,v58,v59
CV v66,v60,v61
s_waitcnt lgkmcnt(6)
M3 a[80:95],a[224:227],v[128:131],a[80:95]
TR a[252:253],v8 offset:51200
TR a[254:255],v8 offset:51712
BL v12,s[16:19],s60 offen offset:2048 lds
CV v67,v62,v63
M3 a[96:111],a[228:231],v[128:131],a[96:111]
TR a[224:225],v3 offset:10240
TR a[226:227],v3 offset:10752
buffer_store_dwordx4 v[64:67], v28, s[24:27], s47 offen sc1
AR v40,a16
AR v41,a17
M3 a[112:127],a[232:235],v[128:131],a[112:127]
TR a[228:229],v5 offset:10240
TR a[230:231],v5 offset:10752
BL v13,s[16:19],s60 offen offset:3072 lds
AR v42,a18
AR v43,a19
M3 a[128:143],a[236:239],v[128:131],a[128:143]
TR a[232:233],v7 offset:10240
TR a[234:235],v7 offset:10752
AR v44,a24
AR v45,a25
AR v46,a26
AR v47,a27
s_waitcnt lgkmcnt(6)
M3 a[80:95],a[240:243],v[132:135],a[80:95]
TR a[236:237],v9 offset:10240
TR a[238:239],v9 offset:10752
BL a[16:19],v25,s[32:35],s65 offen sc1
v_mul_f32 v48, s50, v40
v_mul_f32 v49, s50, v41
M3 a[96:111],a[244:247],v[132:135],a[96:111]
TR a[240:241],v3 offset:51200
TR a[242:243],v3 offset:51712
v_mul_f32 v50, s50, v42
v_mul_f32 v51, s50, v43
v_exp_f32 v48, v48
M3 a[112:127],a[248:251],v[132:135],a[112:127]
TR a[244:245],v5 offset:51200
TR a[246:247],v5 offset:51712
s_bfe_u32 s65, s70, 0x80000
s_mul_i32 s65, s65, 40960
BL a[24:27],v27,s[32:35],s65 offen offset:1024 sc1
M3 a[128:143],a[252:255],v[132:135],a[128:143]
TR a[248:249],v7 offset:51200
TR a[250:251],v7 offset:51712
v_mul_f32 v40, v40, v44
v_exp_f32 v49, v49
v_mul_f32 v41, v41, v45
s_waitcnt lgkmcnt(6)
M3 a[80:95],a[224:227],v[136:139],a[80:95]
TR a[252:253],v9 offset:51200
TR a[254:255],v9 offset:51712
v_exp_f32 v50, v50
v_mul_f32 v42, v42, v46
M3 a[96:111],a[228:231],v[136:139],a[96:111]
v_exp_f32 v51, v51
v_mul_f32 v43, v43, v47
v_add_f32 v48, 1.0, v48
v_add_f32 v49, 1.0, v49
v_add_f32 v50, 1.0, v50
M3 a[112:127],a[232:235],v[136:139],a[112:127]
v_add_f32 v51, 1.0, v51
v_rcp_f32 v48, v48
v_rcp_f32 v49, v49
M3 a[128:143],a[236:239],v[136:139],a[128:143]
s_waitcnt vmcnt(23) lgkmcnt(0)
s_barrier
TR a[224:225],v2 offset:15360
TR a[226:227],v2 offset:15872
TR a[228:229],v4 offset:15360
TR a[230:231],v4 offset:15872
M3 a[80:95],a[240:243],v[140:143],a[80:95]
TR a[232:233],v6 offset:15360
TR a[234:235],v6 offset:15872
TR a[236:237],v8 offset:15360
TR a[238:239],v8 offset:15872
s_add_u32 m0, s6, 10240
s_bfe_u32 s60, s58, 0x4001c
s_mul_i32 s60, s60, 221184
s_add_u32 s60, s60, s42
BL v10,s[12:15],s60 offen lds
M3 a[96:111],a[244:247],v[140:143],a[96:111]
TR a[240:241],v2 offset:56320
TR a[242:243],v2 offset:56832
M3 a[112:127],a[248:251],v[140:143],a[112:127]
TR a[244:245],v4 offset:56320
TR a[246:247],v4 offset:56832
BL v11,s[12:15],s60 offen offset:1024 lds
v_rcp_f32 v50, v50
M3 a[128:143],a[252:255],v[140:143],a[128:143]
TR a[248:249],v6 offset:56320
TR a[250:251],v6 offset:56832
v_rcp_f32 v51, v51
v_mul_f32 v56, v40, v48
v_mul_f32 v57, v41, v49
s_waitcnt lgkmcnt(6)
M3 a[80:95],a[224:227],v[144:147],a[80:95]
TR a[252:253],v8 offset:56320
TR a[254:255],v8 offset:56832
BL v12,s[16:19],s60 offen offset:2048 lds
v_mul_f32 v58, v42, v50
v_mul_f32 v59, v43, v51
M3 a[96:111],a[228:231],v[144:147],a[96:111]
TR a[224:225],v3 offset:15360
TR a[226:227],v3 offset:15872
AR v40,a20
AR v41,a21
AR v42,a22
AR v43,a23
M3 a[112:127],a[232:235],v[144:147],a[112:127]
TR a[228:229],v5 offset:15360
TR a[230:231],v5 offset:15872
BL v13,s[16:19],s60 offen offset:3072 lds
AR v44,a28
AR v45,a29
M3 a[128:143],a[236:239],v[144:147],a[128:143]
TR a[232:233],v7 offset:15360
TR a[234:235],v7 offset:15872
AR v46,a30
AR v47,a31
v_mul_f32 v48, s50, v40
v_mul_f32 v49, s50, v41
s_waitcnt lgkmcnt(6)
M3 a[80:95],a[240:243],v[148:151],a[80:95]
TR a[236:237],v9 offset:15360
TR a[238:239],v9 offset:15872
BL a[20:23],v27,s[32:35],s65 offen sc1
v_mul_f32 v50, s50, v42
v_mul_f32 v51, s50, v43
M3 a[96:111],a[244:247],v[148:151],a[96:111]
TR a[240:241],v3 offset:56320
TR a[242:243],v3 offset:56832
v_exp_f32 v48, v48
v_mul_f32 v40, v40, v44
M3 a[112:127],a[248:251],v[148:151],a[112:127]
TR a[244:245],v5 offset:56320
TR a[246:247],v5 offset:56832
BL a[28:31],v27,s[32:35],s65 offen offset:2048 sc1
v_exp_f32 v49, v49
M3 a[128:143],a[252:255],v[148:151],a[128:143]
TR a[248:249],v7 offset:56320
TR a[250:251],v7 offset:56832
v_mul_f32 v41, v41, v45
v_exp_f32 v50, v50
v_mul_f32 v42, v42, v46
s_waitcnt lgkmcnt(6)
M3 a[80:95],a[224:227],v[152:155],a[80:95]
TR a[252:253],v9 offset:56320
TR a[254:255],v9 offset:56832
s_lshr_b32 s7, s5, 3
s_lshl_b32 s98, s4, 1
s_add_u32 s98, s98, s7
s_mul_i32 s99, s98, 74
s_mul_i32 s61, s3, 14
s_add_u32 s99, s99, s61
s_lshl_b32 s99, s99, 12
s_add_u32 s99, s99, 0
s_add_u32 s36, s82, s99
s_addc_u32 s37, s83, 0
s_sub_u32 s38, 74, s61
s_lshl_b32 s38, s38, 12
s_mov_b32 s39, 0x20000
v_and_b32 v86, 1, v1
v_lshlrev_b32 v86, 2, v86
v_and_b32 v87, 2, v1
v_lshl_add_u32 v86, v87, 6, v86
s_lshl_b32 s7, s3, 8
s_add_u32 s7, s7, 1024
v_add_u32 v86, s7, v86
s_add_u32 s98, s97, 4294836224
s_add_u32 s99, s97, 4294901760
buffer_load_dword v87, v86, s[24:27], s98 offen sc1
v_exp_f32 v51, v51
v_mul_f32 v43, v43, v47
v_add_f32 v48, 1.0, v48
M3 a[96:111],a[228:231],v[152:155],a[96:111]
v_add_f32 v49, 1.0, v49
v_add_f32 v50, 1.0, v50
v_add_f32 v51, 1.0, v51
v_rcp_f32 v48, v48
M3 a[112:127],a[232:235],v[152:155],a[112:127]
v_rcp_f32 v49, v49
v_rcp_f32 v50, v50
v_rcp_f32 v51, v51
M3 a[128:143],a[236:239],v[152:155],a[128:143]
s_waitcnt vmcnt(23) lgkmcnt(0)
s_barrier
TR a[224:225],v2 offset:20480
TR a[226:227],v2 offset:20992
TR a[228:229],v4 offset:20480
TR a[230:231],v4 offset:20992
M3 a[80:95],a[240:243],v[156:159],a[80:95]
TR a[232:233],v6 offset:20480
TR a[234:235],v6 offset:20992
TR a[236:237],v8 offset:20480
TR a[238:239],v8 offset:20992
s_add_u32 m0, s6, 15360
s_bfe_u32 s60, s59, 0x40000
s_mul_i32 s60, s60, 221184
s_add_u32 s60, s60, s42
BL v10,s[12:15],s60 offen lds
M3 a[96:111],a[244:247],v[156:159],a[96:111]
TR a[240:241],v2 offset:61440
TR a[242:243],v2 offset:61952
M3 a[112:127],a[248:251],v[156:159],a[112:127]
TR a[244:245],v4 offset:61440
TR a[246:247],v4 offset:61952
BL v11,s[12:15],s60 offen offset:1024 lds
v_mul_f32 v60, v40, v48
v_mul_f32 v61, v41, v49
M3 a[128:143],a[252:255],v[156:159],a[128:143]
TR a[248:249],v6 offset:61440
TR a[250:251],v6 offset:61952
v_mul_f32 v62, v42, v50
v_mul_f32 v63, v43, v51
CV v68,v56,v57
CV v69,v58,v59
s_waitcnt lgkmcnt(6)
M3 a[80:95],a[224:227],v[160:163],a[80:95]
TR a[252:253],v8 offset:61440
TR a[254:255],v8 offset:61952
BL v12,s[16:19],s60 offen offset:2048 lds
CV v70,v60,v61
CV v71,v62,v63
M3 a[96:111],a[228:231],v[160:163],a[96:111]
TR a[224:225],v3 offset:20480
TR a[226:227],v3 offset:20992
buffer_store_dwordx4 v[68:71], v28, s[24:27], s47 offen offset:512 sc1
AR v40,a32
AR v41,a33
M3 a[112:127],a[232:235],v[160:163],a[112:127]
TR a[228:229],v5 offset:20480
TR a[230:231],v5 offset:20992
BL v13,s[16:19],s60 offen offset:3072 lds
AR v42,a34
AR v43,a35
M3 a[128:143],a[236:239],v[160:163],a[128:143]
TR a[232:233],v7 offset:20480
TR a[234:235],v7 offset:20992
AR v44,a40
AR v45,a41
AR v46,a42
AR v47,a43
s_waitcnt lgkmcnt(6)
M3 a[80:95],a[240:243],v[164:167],a[80:95]
TR a[236:237],v9 offset:20480
TR a[238:239],v9 offset:20992
BL a[32:35],v27,s[32:35],s65 offen offset:3072 sc1
v_mul_f32 v48, s50, v40
v_mul_f32 v49, s50, v41
M3 a[96:111],a[244:247],v[164:167],a[96:111]
TR a[240:241],v3 offset:61440
TR a[242:243],v3 offset:61952
v_mul_f32 v50, s50, v42
v_mul_f32 v51, s50, v43
v_exp_f32 v48, v48
M3 a[112:127],a[248:251],v[164:167],a[112:127]
TR a[244:245],v5 offset:61440
TR a[246:247],v5 offset:61952
s_bfe_u32 s65, s70, 0x80008
s_mul_i32 s65, s65, 40960
BL a[40:43],v27,s[32:35],s65 offen sc1
M3 a[128:143],a[252:255],v[164:167],a[128:143]
TR a[248:249],v7 offset:61440
TR a[250:251],v7 offset:61952
v_mul_f32 v40, v40, v44
v_exp_f32 v49, v49
v_mul_f32 v41, v41, v45
s_waitcnt lgkmcnt(6)
M3 a[80:95],a[224:227],v[168:171],a[80:95]
TR a[252:253],v9 offset:61440
TR a[254:255],v9 offset:61952
v_exp_f32 v50, v50
v_mul_f32 v42, v42, v46
M3 a[96:111],a[228:231],v[168:171],a[96:111]
v_exp_f32 v51, v51
v_mul_f32 v43, v43, v47
v_add_f32 v48, 1.0, v48
v_add_f32 v49, 1.0, v49
v_add_f32 v50, 1.0, v50
M3 a[112:127],a[232:235],v[168:171],a[112:127]
v_add_f32 v51, 1.0, v51
v_rcp_f32 v48, v48
v_rcp_f32 v49, v49
M3 a[128:143],a[236:239],v[168:171],a[128:143]
s_waitcnt vmcnt(24) lgkmcnt(0)
s_barrier
TR a[224:225],v2
TR a[226:227],v2 offset:512
TR a[228:229],v4
TR a[230:231],v4 offset:512
M3 a[80:95],a[240:243],v[172:175],a[80:95]
TR a[232:233],v6
TR a[234:235],v6 offset:512
TR a[236:237],v8
TR a[238:239],v8 offset:512
s_add_u32 m0, s6, 20480
s_bfe_u32 s60, s59, 0x40004
s_mul_i32 s60, s60, 221184
s_add_u32 s60, s60, s42
BL v10,s[12:15],s60 offen lds
M3 a[96:111],a[244:247],v[172:175],a[96:111]
TR a[240:241],v2 offset:40960
TR a[242:243],v2 offset:41472
M3 a[112:127],a[248:251],v[172:175],a[112:127]
TR a[244:245],v4 offset:40960
TR a[246:247],v4 offset:41472
BL v11,s[12:15],s60 offen offset:1024 lds
v_rcp_f32 v50, v50
M3 a[128:143],a[252:255],v[172:175],a[128:143]
TR a[248:249],v6 offset:40960
TR a[250:251],v6 offset:41472
v_rcp_f32 v51, v51
v_mul_f32 v56, v40, v48
v_mul_f32 v57, v41, v49
s_waitcnt lgkmcnt(6)
M3 a[80:95],a[224:227],v[176:179],a[80:95]
TR a[252:253],v8 offset:40960
TR a[254:255],v8 offset:41472
BL v12,s[16:19],s60 offen offset:2048 lds
s_waitcnt vmcnt(10)
K1_GU3_E_chk:
v_cmp_ne_u32 vcc, v87, v26
s_nop 0
s_cmp_eq_u64 vcc, 0
s_cbranch_scc1 K1_GU3_E_ok
s_cmp_eq_u32 s101, 0
s_cbranch_scc1 K1_GU3_E_ok
s_sub_u32 s101, s101, 1
s_sleep 10
buffer_load_dword v87, v86, s[24:27], s98 offen sc1
s_waitcnt vmcnt(0)
s_branch K1_GU3_E_chk
K1_GU3_E_ok:
v_mul_f32 v58, v42, v50
v_mul_f32 v59, v43, v51
M3 a[96:111],a[228:231],v[176:179],a[96:111]
TR a[224:225],v3
TR a[226:227],v3 offset:512
AR v40,a36
AR v41,a37
AR v42,a38
AR v43,a39
M3 a[112:127],a[232:235],v[176:179],a[112:127]
TR a[228:229],v5
TR a[230:231],v5 offset:512
BL v13,s[16:19],s60 offen offset:3072 lds
AR v44,a44
AR v45,a45
M3 a[128:143],a[236:239],v[176:179],a[128:143]
TR a[232:233],v7
TR a[234:235],v7 offset:512
AR v46,a46
AR v47,a47
v_mul_f32 v48, s50, v40
v_mul_f32 v49, s50, v41
s_waitcnt lgkmcnt(6)
M3 a[80:95],a[240:243],v[180:183],a[80:95]
TR a[236:237],v9
TR a[238:239],v9 offset:512
s_bfe_u32 s61, s87, 0x80000
s_mul_i32 s61, s61, 4096
BL v[96:99],v27,s[36:39],s61 offen sc1
M3 a[96:111],a[244:247],v[180:183],a[96:111]
TR a[240:241],v3 offset:40960
TR a[242:243],v3 offset:41472
v_mul_f32 v50, s50, v42
v_mul_f32 v51, s50, v43
v_exp_f32 v48, v48
M3 a[112:127],a[248:251],v[180:183],a[112:127]
TR a[244:245],v5 offset:40960
TR a[246:247],v5 offset:41472
s_bfe_u32 s61, s87, 0x80000
s_mul_i32 s61, s61, 4096
BL v[100:103],v27,s[36:39],s61 offen offset:1024 sc1
M3 a[128:143],a[252:255],v[180:183],a[128:143]
TR a[248:249],v7 offset:40960
TR a[250:251],v7 offset:41472
v_mul_f32 v40, v40, v44
v_exp_f32 v49, v49
v_mul_f32 v41, v41, v45
s_waitcnt lgkmcnt(6)
M3 a[80:95],a[224:227],v[184:187],a[80:95]
TR a[252:253],v9 offset:40960
TR a[254:255],v9 offset:41472
s_bfe_u32 s61, s87, 0x80000
s_mul_i32 s61, s61, 4096
BL v[104:107],v27,s[36:39],s61 offen offset:2048 sc1
M3 a[96:111],a[228:231],v[184:187],a[96:111]
v_exp_f32 v50, v50
v_mul_f32 v42, v42, v46
v_exp_f32 v51, v51
v_mul_f32 v43, v43, v47
M3 a[112:127],a[232:235],v[184:187],a[112:127]
s_bfe_u32 s61, s87, 0x80000
s_mul_i32 s61, s61, 4096
BL v[108:111],v27,s[36:39],s61 offen offset:3072 sc1
v_add_f32 v48, 1.0, v48
v_add_f32 v49, 1.0, v49
M3 a[128:143],a[236:239],v[184:187],a[128:143]
s_waitcnt lgkmcnt(0)
s_barrier
TR a[224:225],v2 offset:5120
TR a[226:227],v2 offset:5632
TR a[228:229],v4 offset:5120
TR a[230:231],v4 offset:5632
M3 a[80:95],a[240:243],v[188:191],a[80:95]
TR a[232:233],v6 offset:5120
TR a[234:235],v6 offset:5632
TR a[236:237],v8 offset:5120
TR a[238:239],v8 offset:5632
s_bfe_u32 s61, s87, 0x80008
s_mul_i32 s61, s61, 4096
BL v[112:115],v27,s[36:39],s61 offen sc1
M3 a[96:111],a[244:247],v[188:191],a[96:111]
TR a[240:241],v2 offset:46080
TR a[242:243],v2 offset:46592
v_add_f32 v50, 1.0, v50
v_add_f32 v51, 1.0, v51
M3 a[112:127],a[248:251],v[188:191],a[112:127]
TR a[244:245],v4 offset:46080
TR a[246:247],v4 offset:46592
s_bfe_u32 s61, s87, 0x80008
s_mul_i32 s61, s61, 4096
BL v[116:119],v27,s[36:39],s61 offen offset:1024 sc1
M3 a[128:143],a[252:255],v[188:191],a[128:143]
TR a[248:249],v6 offset:46080
TR a[250:251],v6 offset:46592
v_rcp_f32 v48, v48
v_rcp_f32 v49, v49
s_waitcnt lgkmcnt(6)
M3 a[80:95],a[224:227],v[192:195],a[80:95]
TR a[252:253],v8 offset:46080
TR a[254:255],v8 offset:46592
s_bfe_u32 s61, s87, 0x80008
s_mul_i32 s61, s61, 4096
BL v[120:123],v27,s[36:39],s61 offen offset:2048 sc1
M3 a[96:111],a[228:231],v[192:195],a[96:111]
TR a[224:225],v3 offset:5120
TR a[226:227],v3 offset:5632
v_rcp_f32 v50, v50
v_rcp_f32 v51, v51
M3 a[112:127],a[232:235],v[192:195],a[112:127]
TR a[228:229],v5 offset:5120
TR a[230:231],v5 offset:5632
s_bfe_u32 s61, s87, 0x80008
s_mul_i32 s61, s61, 4096
BL v[124:127],v27,s[36:39],s61 offen offset:3072 sc1
M3 a[128:143],a[236:239],v[192:195],a[128:143]
TR a[232:233],v7 offset:5120
TR a[234:235],v7 offset:5632
v_mul_f32 v60, v40, v48
v_mul_f32 v61, v41, v49
v_mul_f32 v62, v42, v50
v_mul_f32 v63, v43, v51
s_waitcnt lgkmcnt(6)
M3 a[80:95],a[240:243],v[196:199],a[80:95]
TR a[236:237],v9 offset:5120
TR a[238:239],v9 offset:5632
s_bfe_u32 s61, s87, 0x80010
s_mul_i32 s61, s61, 4096
BL v[128:131],v27,s[36:39],s61 offen sc1
M3 a[96:111],a[244:247],v[196:199],a[96:111]
TR a[240:241],v3 offset:46080
TR a[242:243],v3 offset:46592
CV v64,v56,v57
CV v65,v58,v59
CV v66,v60,v61
CV v67,v62,v63
M3 a[112:127],a[248:251],v[196:199],a[112:127]
TR a[244:245],v5 offset:46080
TR a[246:247],v5 offset:46592
s_bfe_u32 s61, s87, 0x80010
s_mul_i32 s61, s61, 4096
BL v[132:135],v27,s[36:39],s61 offen offset:1024 sc1
M3 a[128:143],a[252:255],v[196:199],a[128:143]
TR a[248:249],v7 offset:46080
TR a[250:251],v7 offset:46592
buffer_store_dwordx4 v[64:67], v29, s[24:27], s47 offen sc1
AR v40,a48
AR v41,a49
s_waitcnt lgkmcnt(6)
M3 a[80:95],a[224:227],v[200:203],a[80:95]
TR a[252:253],v9 offset:46080
TR a[254:255],v9 offset:46592
s_bfe_u32 s61, s87, 0x80010
s_mul_i32 s61, s61, 4096
BL v[136:139],v27,s[36:39],s61 offen offset:2048 sc1
M3 a[96:111],a[228:231],v[200:203],a[96:111]
AR v42,a50
AR v43,a51
AR v44,a56
AR v45,a57
AR v46,a58
AR v47,a59
M3 a[112:127],a[232:235],v[200:203],a[112:127]
s_bfe_u32 s61, s87, 0x80010
s_mul_i32 s61, s61, 4096
BL v[140:143],v27,s[36:39],s61 offen offset:3072 sc1
v_mul_f32 v48, s50, v40
v_mul_f32 v49, s50, v41
M3 a[128:143],a[236:239],v[200:203],a[128:143]
s_waitcnt lgkmcnt(0)
s_barrier
TR a[224:225],v2 offset:10240
TR a[226:227],v2 offset:10752
TR a[228:229],v4 offset:10240
TR a[230:231],v4 offset:10752
M3 a[80:95],a[240:243],v[204:207],a[80:95]
TR a[232:233],v6 offset:10240
TR a[234:235],v6 offset:10752
TR a[236:237],v8 offset:10240
TR a[238:239],v8 offset:10752
s_bfe_u32 s61, s87, 0x80018
s_mul_i32 s61, s61, 4096
BL v[144:147],v27,s[36:39],s61 offen sc1
M3 a[96:111],a[244:247],v[204:207],a[96:111]
TR a[240:241],v2 offset:51200
TR a[242:243],v2 offset:51712
v_mul_f32 v50, s50, v42
v_mul_f32 v51, s50, v43
M3 a[112:127],a[248:251],v[204:207],a[112:127]
TR a[244:245],v4 offset:51200
TR a[246:247],v4 offset:51712
s_bfe_u32 s61, s87, 0x80018
s_mul_i32 s61, s61, 4096
BL v[148:151],v27,s[36:39],s61 offen offset:1024 sc1
M3 a[128:143],a[252:255],v[204:207],a[128:143]
TR a[248:249],v6 offset:51200
TR a[250:251],v6 offset:51712
v_exp_f32 v48, v48
v_mul_f32 v40, v40, v44
s_waitcnt lgkmcnt(6)
M3 a[80:95],a[224:227],v[208:211],a[80:95]
TR a[252:253],v8 offset:51200
TR a[254:255],v8 offset:51712
s_bfe_u32 s61, s87, 0x80018
s_mul_i32 s61, s61, 4096
BL v[152:155],v27,s[36:39],s61 offen offset:2048 sc1
M3 a[96:111],a[228:231],v[208:211],a[96:111]
TR a[224:225],v3 offset:10240
TR a[226:227],v3 offset:10752
v_exp_f32 v49, v49
v_mul_f32 v41, v41, v45
M3 a[112:127],a[232:235],v[208:211],a[112:127]
TR a[228:229],v5 offset:10240
TR a[230:231],v5 offset:10752
s_bfe_u32 s61, s87, 0x80018
s_mul_i32 s61, s61, 4096
BL v[156:159],v27,s[36:39],s61 offen offset:3072 sc1
M3 a[128:143],a[236:239],v[208:211],a[128:143]
TR a[232:233],v7 offset:10240
TR a[234:235],v7 offset:10752
v_exp_f32 v50, v50
v_mul_f32 v42, v42, v46
s_waitcnt lgkmcnt(6)
M3 a[80:95],a[240:243],v[212:215],a[80:95]
TR a[236:237],v9 offset:10240
TR a[238:239],v9 offset:10752
s_bfe_u32 s65, s70, 0x80000
s_mul_i32 s65, s65, 40960
BL a[36:39],v25,s[32:35],s65 offen sc1
M3 a[96:111],a[244:247],v[212:215],a[96:111]
TR a[240:241],v3 offset:51200
TR a[242:243],v3 offset:51712
v_exp_f32 v51, v51
v_mul_f32 v43, v43, v47
v_add_f32 v48, 1.0, v48
M3 a[112:127],a[248:251],v[212:215],a[112:127]
TR a[244:245],v5 offset:51200
TR a[246:247],v5 offset:51712
s_bfe_u32 s65, s70, 0x80008
s_mul_i32 s65, s65, 40960
BL a[44:47],v27,s[32:35],s65 offen offset:1024 sc1
M3 a[128:143],a[252:255],v[212:215],a[128:143]
TR a[248:249],v7 offset:51200
TR a[250:251],v7 offset:51712
v_add_f32 v49, 1.0, v49
v_add_f32 v50, 1.0, v50
v_add_f32 v51, 1.0, v51
s_waitcnt lgkmcnt(6)
M3 a[80:95],a[224:227],v[216:219],a[80:95]
TR a[252:253],v9 offset:51200
TR a[254:255],v9 offset:51712
BL a[48:51],v27,s[32:35],s65 offen offset:2048 sc1
v_rcp_f32 v48, v48
M3 a[96:111],a[228:231],v[216:219],a[96:111]
v_rcp_f32 v49, v49
v_rcp_f32 v50, v50
v_rcp_f32 v51, v51
M3 a[112:127],a[232:235],v[216:219],a[112:127]
BL a[56:59],v25,s[32:35],s65 offen sc1
v_mul_f32 v56, v40, v48
v_mul_f32 v57, v41, v49
v_mul_f32 v58, v42, v50
v_mul_f32 v59, v43, v51
M3 a[128:143],a[236:239],v[216:219],a[128:143]
s_waitcnt vmcnt(27) lgkmcnt(0)
s_barrier
TR a[224:225],v2 offset:15360
TR a[226:227],v2 offset:15872
TR a[228:229],v4 offset:15360
TR a[230:231],v4 offset:15872
M3 a[80:95],a[240:243],v[220:223],a[80:95]
TR a[232:233],v6 offset:15360
TR a[234:235],v6 offset:15872
TR a[236:237],v8 offset:15360
TR a[238:239],v8 offset:15872
s_add_u32 m0, s6, 0
s_bfe_u32 s65, s89, 0x80000
s_mul_i32 s65, s65, 40960
BL v27,s[32:35],s65 offen sc1 lds
M3 a[96:111],a[244:247],v[220:223],a[96:111]
TR a[240:241],v2 offset:56320
TR a[242:243],v2 offset:56832
AR v40,a52
M3 a[112:127],a[248:251],v[220:223],a[112:127]
TR a[244:245],v4 offset:56320
TR a[246:247],v4 offset:56832
BL v27,s[32:35],s65 offen offset:1024 sc1 lds
AR v41,a53
AR v42,a54
M3 a[128:143],a[252:255],v[220:223],a[128:143]
TR a[248:249],v6 offset:56320
TR a[250:251],v6 offset:56832
AR v43,a55
AR v44,a60
AR v45,a61
AR v46,a62
s_waitcnt lgkmcnt(6)
M3 a[80:95],a[224:227],v[224:227],a[80:95]
TR a[252:253],v8 offset:56320
TR a[254:255],v8 offset:56832
s_bfe_u32 s65, s70, 0x80008
s_mul_i32 s65, s65, 40960
BL a[52:55],v27,s[32:35],s65 offen offset:3072 sc1
M3 a[96:111],a[228:231],v[224:227],a[96:111]
TR a[224:225],v3 offset:15360
TR a[226:227],v3 offset:15872
AR v47,a63
v_mul_f32 v48, s50, v40
v_mul_f32 v49, s50, v41
v_mul_f32 v50, s50, v42
M3 a[112:127],a[232:235],v[224:227],a[112:127]
TR a[228:229],v5 offset:15360
TR a[230:231],v5 offset:15872
s_bfe_u32 s65, s89, 0x80000
s_mul_i32 s65, s65, 40960
BL v27,s[32:35],s65 offen offset:2048 sc1 lds
M3 a[128:143],a[236:239],v[224:227],a[128:143]
TR a[232:233],v7 offset:15360
TR a[234:235],v7 offset:15872
v_mul_f32 v51, s50, v43
v_exp_f32 v48, v48
v_mul_f32 v40, v40, v44
s_waitcnt lgkmcnt(6)
M3 a[80:95],a[240:243],v[228:231],a[80:95]
TR a[236:237],v9 offset:15360
TR a[238:239],v9 offset:15872
BL v27,s[32:35],s65 offen offset:3072 sc1 lds
v_exp_f32 v49, v49
M3 a[96:111],a[244:247],v[228:231],a[96:111]
TR a[240:241],v3 offset:56320
TR a[242:243],v3 offset:56832
v_mul_f32 v41, v41, v45
v_exp_f32 v50, v50
v_mul_f32 v42, v42, v46
M3 a[112:127],a[248:251],v[228:231],a[112:127]
TR a[244:245],v5 offset:56320
TR a[246:247],v5 offset:56832
s_add_u32 m0, s6, 4096
s_nop 0
BL v25,s[32:35],s65 offen sc1 lds
M3 a[128:143],a[252:255],v[228:231],a[128:143]
TR a[248:249],v7 offset:56320
TR a[250:251],v7 offset:56832
v_exp_f32 v51, v51
v_mul_f32 v43, v43, v47
v_add_f32 v48, 1.0, v48
s_waitcnt lgkmcnt(6)
M3 a[80:95],a[224:227],v[232:235],a[80:95]
TR a[252:253],v9 offset:56320
TR a[254:255],v9 offset:56832
s_add_u32 m0, s6, 5120
s_bfe_u32 s65, s89, 0x80008
s_mul_i32 s65, s65, 40960
BL v27,s[32:35],s65 offen sc1 lds
M3 a[96:111],a[228:231],v[232:235],a[96:111]
v_add_f32 v49, 1.0, v49
v_add_f32 v50, 1.0, v50
v_add_f32 v51, 1.0, v51
v_rcp_f32 v48, v48
M3 a[112:127],a[232:235],v[232:235],a[112:127]
BL v27,s[32:35],s65 offen offset:1024 sc1 lds
v_rcp_f32 v49, v49
v_rcp_f32 v50, v50
M3 a[128:143],a[236:239],v[232:235],a[128:143]
s_waitcnt vmcnt(29) lgkmcnt(0)
s_barrier
TR a[224:225],v2 offset:20480
TR a[226:227],v2 offset:20992
TR a[228:229],v4 offset:20480
TR a[230:231],v4 offset:20992
M3 a[80:95],a[240:243],v[236:239],a[80:95]
TR a[232:233],v6 offset:20480
TR a[234:235],v6 offset:20992
TR a[236:237],v8 offset:20480
TR a[238:239],v8 offset:20992
BL v27,s[32:35],s65 offen offset:2048 sc1 lds
M3 a[96:111],a[244:247],v[236:239],a[96:111]
TR a[240:241],v2 offset:61440
TR a[242:243],v2 offset:61952
v_rcp_f32 v51, v51
v_mul_f32 v60, v40, v48
v_mul_f32 v61, v41, v49
M3 a[112:127],a[248:251],v[236:239],a[112:127]
TR a[244:245],v4 offset:61440
TR a[246:247],v4 offset:61952
BL v27,s[32:35],s65 offen offset:3072 sc1 lds
v_mul_f32 v62, v42, v50
v_mul_f32 v63, v43, v51
M3 a[128:143],a[252:255],v[236:239],a[128:143]
TR a[248:249],v6 offset:61440
TR a[250:251],v6 offset:61952
CV v68,v56,v57
CV v69,v58,v59
CV v70,v60,v61
CV v71,v62,v63
s_waitcnt lgkmcnt(6)
M3 a[80:95],a[224:227],v[240:243],a[80:95]
TR a[252:253],v8 offset:61440
TR a[254:255],v8 offset:61952
s_add_u32 m0, s6, 9216
s_nop 0
BL v25,s[32:35],s65 offen sc1 lds
M3 a[96:111],a[228:231],v[240:243],a[96:111]
TR a[224:225],v3 offset:20480
TR a[226:227],v3 offset:20992
buffer_store_dwordx4 v[68:71], v29, s[24:27], s47 offen offset:512 sc1
M3 a[112:127],a[232:235],v[240:243],a[112:127]
TR a[228:229],v5 offset:20480
TR a[230:231],v5 offset:20992
s_add_u32 m0, s6, 10240
s_bfe_u32 s65, s89, 0x80010
s_mul_i32 s65, s65, 40960
BL v27,s[32:35],s65 offen sc1 lds
M3 a[128:143],a[236:239],v[240:243],a[128:143]
TR a[232:233],v7 offset:20480
TR a[234:235],v7 offset:20992
s_waitcnt lgkmcnt(6)
M3 a[80:95],a[240:243],v[244:247],a[80:95]
TR a[236:237],v9 offset:20480
TR a[238:239],v9 offset:20992
BL v27,s[32:35],s65 offen offset:1024 sc1 lds
M3 a[96:111],a[244:247],v[244:247],a[96:111]
TR a[240:241],v3 offset:61440
TR a[242:243],v3 offset:61952
M3 a[112:127],a[248:251],v[244:247],a[112:127]
TR a[244:245],v5 offset:61440
TR a[246:247],v5 offset:61952
BL v27,s[32:35],s65 offen offset:2048 sc1 lds
M3 a[128:143],a[252:255],v[244:247],a[128:143]
TR a[248:249],v7 offset:61440
TR a[250:251],v7 offset:61952
s_waitcnt lgkmcnt(6)
M3 a[80:95],a[224:227],v[248:251],a[80:95]
TR a[252:253],v9 offset:61440
TR a[254:255],v9 offset:61952
BL v27,s[32:35],s65 offen offset:3072 sc1 lds
M3 a[96:111],a[228:231],v[248:251],a[96:111]
M3 a[112:127],a[232:235],v[248:251],a[112:127]
s_add_u32 m0, s6, 14336
s_nop 0
BL v25,s[32:35],s65 offen sc1 lds
M3 a[128:143],a[236:239],v[248:251],a[128:143]
s_waitcnt lgkmcnt(0)
M3 a[80:95],a[240:243],v[252:255],a[80:95]
s_add_u32 m0, s6, 15360
s_bfe_u32 s65, s89, 0x80018
s_mul_i32 s65, s65, 40960
BL v27,s[32:35],s65 offen sc1 lds
M3 a[96:111],a[244:247],v[252:255],a[96:111]
M3 a[112:127],a[248:251],v[252:255],a[112:127]
BL v27,s[32:35],s65 offen offset:1024 sc1 lds
M3 a[128:143],a[252:255],v[252:255],a[128:143]
s_barrier
s_nop 2
AR v40,a80
AR v41,a81
AR v42,a82
AR v43,a83
AR v44,a88
AR v45,a89
AR v46,a90
AR v47,a91
v_pk_mul_f32 v[48:49], v[40:41], s[50:51] op_sel_hi:[1,0]
v_pk_mul_f32 v[50:51], v[42:43], s[50:51] op_sel_hi:[1,0]
v_exp_f32 v48, v48
v_exp_f32 v49, v49
v_exp_f32 v50, v50
v_exp_f32 v51, v51
v_pk_mul_f32 v[40:41], v[40:41], v[44:45]
v_pk_mul_f32 v[42:43], v[42:43], v[46:47]
v_pk_add_f32 v[48:49], v[48:49], 1.0 op_sel_hi:[1,0]
v_pk_add_f32 v[50:51], v[50:51], 1.0 op_sel_hi:[1,0]
v_rcp_f32 v48, v48
v_rcp_f32 v49, v49
v_rcp_f32 v50, v50
v_rcp_f32 v51, v51
v_pk_mul_f32 v[56:57], v[40:41], v[48:49]
v_pk_mul_f32 v[58:59], v[42:43], v[50:51]
AR v40,a84
AR v41,a85
AR v42,a86
AR v43,a87
AR v44,a92
AR v45,a93
AR v46,a94
AR v47,a95
v_pk_mul_f32 v[48:49], v[40:41], s[50:51] op_sel_hi:[1,0]
v_pk_mul_f32 v[50:51], v[42:43], s[50:51] op_sel_hi:[1,0]
v_exp_f32 v48, v48
v_exp_f32 v49, v49
v_exp_f32 v50, v50
v_exp_f32 v51, v51
v_pk_mul_f32 v[40:41], v[40:41], v[44:45]
v_pk_mul_f32 v[42:43], v[42:43], v[46:47]
v_pk_add_f32 v[48:49], v[48:49], 1.0 op_sel_hi:[1,0]
v_pk_add_f32 v[50:51], v[50:51], 1.0 op_sel_hi:[1,0]
v_rcp_f32 v48, v48
v_rcp_f32 v49, v49
v_rcp_f32 v50, v50
v_rcp_f32 v51, v51
v_pk_mul_f32 v[60:61], v[40:41], v[48:49]
v_pk_mul_f32 v[62:63], v[42:43], v[50:51]
CV v64,v56,v57
CV v65,v58,v59
CV v66,v60,v61
CV v67,v62,v63
buffer_store_dwordx4 v[64:67], v28, s[24:27], s48 offen sc1
AR v40,a96
AR v41,a97
AR v42,a98
AR v43,a99
AR v44,a104
AR v45,a105
AR v46,a106
AR v47,a107
v_pk_mul_f32 v[48:49], v[40:41], s[50:51] op_sel_hi:[1,0]
v_pk_mul_f32 v[50:51], v[42:43], s[50:51] op_sel_hi:[1,0]
v_exp_f32 v48, v48
v_exp_f32 v49, v49
v_exp_f32 v50, v50
v_exp_f32 v51, v51
v_pk_mul_f32 v[40:41], v[40:41], v[44:45]
v_pk_mul_f32 v[42:43], v[42:43], v[46:47]
v_pk_add_f32 v[48:49], v[48:49], 1.0 op_sel_hi:[1,0]
v_pk_add_f32 v[50:51], v[50:51], 1.0 op_sel_hi:[1,0]
v_rcp_f32 v48, v48
v_rcp_f32 v49, v49
v_rcp_f32 v50, v50
v_rcp_f32 v51, v51
v_pk_mul_f32 v[56:57], v[40:41], v[48:49]
v_pk_mul_f32 v[58:59], v[42:43], v[50:51]
AR v40,a100
AR v41,a101
AR v42,a102
AR v43,a103
AR v44,a108
AR v45,a109
AR v46,a110
AR v47,a111
v_pk_mul_f32 v[48:49], v[40:41], s[50:51] op_sel_hi:[1,0]
v_pk_mul_f32 v[50:51], v[42:43], s[50:51] op_sel_hi:[1,0]
v_exp_f32 v48, v48
v_exp_f32 v49, v49
v_exp_f32 v50, v50
v_exp_f32 v51, v51
v_pk_mul_f32 v[40:41], v[40:41], v[44:45]
v_pk_mul_f32 v[42:43], v[42:43], v[46:47]
v_pk_add_f32 v[48:49], v[48:49], 1.0 op_sel_hi:[1,0]
v_pk_add_f32 v[50:51], v[50:51], 1.0 op_sel_hi:[1,0]
v_rcp_f32 v48, v48
v_rcp_f32 v49, v49
v_rcp_f32 v50, v50
v_rcp_f32 v51, v51
v_pk_mul_f32 v[60:61], v[40:41], v[48:49]
v_pk_mul_f32 v[62:63], v[42:43], v[50:51]
CV v68,v56,v57
CV v69,v58,v59
CV v70,v60,v61
CV v71,v62,v63
buffer_store_dwordx4 v[68:71], v28, s[24:27], s48 offen offset:512 sc1
AR v40,a112
AR v41,a113
AR v42,a114
AR v43,a115
s_waitcnt vmcnt(9)
s_add_u32 s7, s96, 4294901760
buffer_store_dword v26, v20, s[24:27], s7 offen sc1
AR v44,a120
AR v45,a121
AR v46,a122
AR v47,a123
v_pk_mul_f32 v[48:49], v[40:41], s[50:51] op_sel_hi:[1,0]
v_pk_mul_f32 v[50:51], v[42:43], s[50:51] op_sel_hi:[1,0]
v_exp_f32 v48, v48
v_exp_f32 v49, v49
v_exp_f32 v50, v50
v_exp_f32 v51, v51
v_pk_mul_f32 v[40:41], v[40:41], v[44:45]
v_pk_mul_f32 v[42:43], v[42:43], v[46:47]
v_pk_add_f32 v[48:49], v[48:49], 1.0 op_sel_hi:[1,0]
v_pk_add_f32 v[50:51], v[50:51], 1.0 op_sel_hi:[1,0]
v_rcp_f32 v48, v48
v_rcp_f32 v49, v49
v_rcp_f32 v50, v50
v_rcp_f32 v51, v51
v_pk_mul_f32 v[56:57], v[40:41], v[48:49]
v_pk_mul_f32 v[58:59], v[42:43], v[50:51]
AR v40,a116
AR v41,a117
AR v42,a118
AR v43,a119
AR v44,a124
AR v45,a125
AR v46,a126
AR v47,a127
v_pk_mul_f32 v[48:49], v[40:41], s[50:51] op_sel_hi:[1,0]
v_pk_mul_f32 v[50:51], v[42:43], s[50:51] op_sel_hi:[1,0]
v_exp_f32 v48, v48
v_exp_f32 v49, v49
v_exp_f32 v50, v50
v_exp_f32 v51, v51
v_pk_mul_f32 v[40:41], v[40:41], v[44:45]
v_pk_mul_f32 v[42:43], v[42:43], v[46:47]
v_pk_add_f32 v[48:49], v[48:49], 1.0 op_sel_hi:[1,0]
v_pk_add_f32 v[50:51], v[50:51], 1.0 op_sel_hi:[1,0]
v_rcp_f32 v48, v48
v_rcp_f32 v49, v49
v_rcp_f32 v50, v50
v_rcp_f32 v51, v51
v_pk_mul_f32 v[60:61], v[40:41], v[48:49]
v_pk_mul_f32 v[62:63], v[42:43], v[50:51]
CV v64,v56,v57
CV v65,v58,v59
CV v66,v60,v61
CV v67,v62,v63
buffer_store_dwordx4 v[64:67], v29, s[24:27], s48 offen sc1
AR v40,a128
AR v41,a129
AR v42,a130
AR v43,a131
AR v44,a136
AR v45,a137
AR v46,a138
AR v47,a139
v_pk_mul_f32 v[48:49], v[40:41], s[50:51] op_sel_hi:[1,0]
v_pk_mul_f32 v[50:51], v[42:43], s[50:51] op_sel_hi:[1,0]
v_exp_f32 v48, v48
v_exp_f32 v49, v49
v_exp_f32 v50, v50
v_exp_f32 v51, v51
v_pk_mul_f32 v[40:41], v[40:41], v[44:45]
v_pk_mul_f32 v[42:43], v[42:43], v[46:47]
v_pk_add_f32 v[48:49], v[48:49], 1.0 op_sel_hi:[1,0]
v_pk_add_f32 v[50:51], v[50:51], 1.0 op_sel_hi:[1,0]
v_rcp_f32 v48, v48
v_rcp_f32 v49, v49
v_rcp_f32 v50, v50
v_rcp_f32 v51, v51
v_pk_mul_f32 v[56:57], v[40:41], v[48:49]
v_pk_mul_f32 v[58:59], v[42:43], v[50:51]
AR v40,a132
AR v41,a133
AR v42,a134
AR v43,a135
AR v44,a140
AR v45,a141
AR v46,a142
AR v47,a143
v_pk_mul_f32 v[48:49], v[40:41], s[50:51] op_sel_hi:[1,0]
v_pk_mul_f32 v[50:51], v[42:43], s[50:51] op_sel_hi:[1,0]
v_exp_f32 v48, v48
v_exp_f32 v49, v49
v_exp_f32 v50, v50
v_exp_f32 v51, v51
v_pk_mul_f32 v[40:41], v[40:41], v[44:45]
v_pk_mul_f32 v[42:43], v[42:43], v[46:47]
v_pk_add_f32 v[48:49], v[48:49], 1.0 op_sel_hi:[1,0]
v_pk_add_f32 v[50:51], v[50:51], 1.0 op_sel_hi:[1,0]
v_rcp_f32 v48, v48
v_rcp_f32 v49, v49
v_rcp_f32 v50, v50
v_rcp_f32 v51, v51
v_pk_mul_f32 v[60:61], v[40:41], v[48:49]
v_pk_mul_f32 v[62:63], v[42:43], v[50:51]
CV v68,v56,v57
CV v69,v58,v59
CV v70,v60,v61
CV v71,v62,v63
buffer_store_dwordx4 v[68:71], v29, s[24:27], s48 offen offset:512 sc1
s_waitcnt vmcnt(0)
buffer_store_dword v26, v20, s[24:27], s96 offen sc1
v_and_b32 v2, 1, v1
v_lshlrev_b32 v2, 2, v2
v_and_b32 v7, 2, v1
v_lshl_add_u32 v2, v7, 6, v2
s_lshl_b32 s7, s3, 8
s_add_u32 s7, s7, 1024
v_add_u32 v2, s7, v2
v_and_b32 v3, 1, v1
v_lshlrev_b32 v3, 2, v3
s_lshl_b32 s7, s3, 7
v_add_u32 v3, s7, v3
v_add_u32 v19, 512, v3
buffer_load_dword v6, v2, s[24:27], s99 offen sc1
buffer_load_dword v7, v19, s[24:27], s97 offen sc1
s_load_dwordx2 s[48:49], s[0:1], 56
s_and_b32 s7, s5, 7
s_lshl_b32 s40, s4, 1
s_lshr_b32 s7, s5, 3
s_add_u32 s40, s40, s7
s_and_b32 s7, s5, 7
s_mul_i32 s47, s40, 81920
s_mul_i32 s7, s7, 160
s_add_u32 s47, s47, s7
v_add_u32 v88, 0, v0
v_mul_u32_u24 v89, 6554, v88
v_lshrrev_b32 v89, 16, v89
v_mul_u32_u24 v90, 10, v89
v_sub_u32 v90, v88, v90
v_mul_u32_u24 v91, 1280, v89
v_lshl_add_u32 v10, v90, 4, v91
v_bfe_u32 v91, v89, 1, 2
v_lshlrev_b32 v90, 1, v90
v_xor_b32 v90, v90, v91
v_mul_u32_u24 v91, 320, v89
v_lshl_add_u32 v28, v90, 4, v91
v_xor_b32 v29, 16, v28
v_add_u32 v30, 81920, v28
v_add_u32 v31, 81920, v29
v_add_u32 v88, 256, v0
v_mul_u32_u24 v89, 6554, v88
v_lshrrev_b32 v89, 16, v89
v_mul_u32_u24 v90, 10, v89
v_sub_u32 v90, v88, v90
v_mul_u32_u24 v91, 1280, v89
v_lshl_add_u32 v11, v90, 4, v91
v_bfe_u32 v91, v89, 1, 2
v_lshlrev_b32 v90, 1, v90
v_xor_b32 v90, v90, v91
v_mul_u32_u24 v91, 320, v89
v_lshl_add_u32 v32, v90, 4, v91
v_xor_b32 v33, 16, v32
v_add_u32 v34, 81920, v32
v_add_u32 v35, 81920, v33
v_add_u32 v88, 512, v0
v_mul_u32_u24 v89, 6554, v88
v_lshrrev_b32 v89, 16, v89
v_mul_u32_u24 v90, 10, v89
v_sub_u32 v90, v88, v90
v_mul_u32_u24 v91, 1280, v89
v_lshl_add_u32 v12, v90, 4, v91
v_bfe_u32 v91, v89, 1, 2
v_lshlrev_b32 v90, 1, v90
v_xor_b32 v90, v90, v91
v_mul_u32_u24 v91, 320, v89
v_lshl_add_u32 v36, v90, 4, v91
v_xor_b32 v37, 16, v36
v_add_u32 v38, 81920, v36
v_add_u32 v39, 81920, v37
v_mov_b32 v91, 1073741824
v_cmp_gt_u32 vcc, 128, v0
s_nop 1
v_cndmask_b32 v12, v91, v12, vcc
v_and_b32 v88, 15, v1
v_bfe_u32 v90, v1, 1, 2
v_mul_u32_u24 v88, 320, v88
v_lshrrev_b32 v89, 4, v1
v_xor_b32 v89, v89, v90
v_lshl_add_u32 v88, v89, 4, v88
v_add_u32 v9, s6, v88
v_add_u32 v8, s6, v27
s_waitcnt lgkmcnt(0)
s_mov_b32 s12, s48
s_mov_b32 s13, s49
s_mov_b32 s14, 2621440
s_mov_b32 s15, 0x20000
s_waitcnt vmcnt(1)
P2_GU3_E_chk:
v_cmp_ne_u32 vcc, v6, v26
s_nop 0
s_cmp_eq_u64 vcc, 0
s_cbranch_scc1 P2_GU3_E_ok
s_cmp_eq_u32 s101, 0
s_cbranch_scc1 P2_GU3_E_ok
s_sub_u32 s101, s101, 1
s_sleep 10
buffer_load_dword v6, v2, s[24:27], s99 offen sc1
s_waitcnt vmcnt(0)
s_branch P2_GU3_E_chk
P2_GU3_E_ok:
M1 v[176:179],a[160:163],v[96:99],0
M1 v[192:195],a[164:167],v[96:99],0
s_bfe_u32 s41, s88, 0x80000
s_mul_i32 s41, s41, 4096
BL a[80:83],v27,s[36:39],s41 offen sc1
M1 v[208:211],a[168:171],v[96:99],0
M1 v[224:227],a[172:175],v[96:99],0
BL a[84:87],v27,s[36:39],s41 offen offset:1024 sc1
M1 v[240:243],a[176:179],v[96:99],0
M1 v[180:183],a[160:163],v[100:103],0
M1 v[196:199],a[164:167],v[100:103],0
BL a[88:91],v27,s[36:39],s41 offen offset:2048 sc1
M1 v[212:215],a[168:171],v[100:103],0
M1 v[228:231],a[172:175],v[100:103],0
BL a[92:95],v27,s[36:39],s41 offen offset:3072 sc1
M1 v[244:247],a[176:179],v[100:103],0
M1 v[184:187],a[160:163],v[104:107],0
M1 v[200:203],a[164:167],v[104:107],0
s_bfe_u32 s41, s88, 0x80008
s_mul_i32 s41, s41, 4096
BL a[96:99],v27,s[36:39],s41 offen sc1
M1 v[216:219],a[168:171],v[104:107],0
M1 v[232:235],a[172:175],v[104:107],0
BL a[100:103],v27,s[36:39],s41 offen offset:1024 sc1
M1 v[248:251],a[176:179],v[104:107],0
M1 v[188:191],a[160:163],v[108:111],0
M1 v[204:207],a[164:167],v[108:111],0
BL a[104:107],v27,s[36:39],s41 offen offset:2048 sc1
M1 v[220:223],a[168:171],v[108:111],0
M1 v[236:239],a[172:175],v[108:111],0
BL a[108:111],v27,s[36:39],s41 offen offset:3072 sc1
M1 v[252:255],a[176:179],v[108:111],0
s_bfe_u32 s41, s88, 0x80010
s_mul_i32 s41, s41, 4096
BL a[112:115],v27,s[36:39],s41 offen sc1
BL a[116:119],v27,s[36:39],s41 offen offset:1024 sc1
BL a[120:123],v27,s[36:39],s41 offen offset:2048 sc1
BL a[124:127],v27,s[36:39],s41 offen offset:3072 sc1
s_bfe_u32 s41, s88, 0x80018
s_mul_i32 s41, s41, 4096
BL a[128:131],v27,s[36:39],s41 offen sc1
BL a[132:135],v27,s[36:39],s41 offen offset:1024 sc1
BL a[136:139],v27,s[36:39],s41 offen offset:2048 sc1
BL a[140:143],v27,s[36:39],s41 offen offset:3072 sc1
BL v27,s[32:35],s65 offen offset:2048 sc1 lds
BL v27,s[32:35],s65 offen offset:3072 sc1 lds
s_add_u32 m0, s6, 19456
s_nop 0
BL v25,s[32:35],s65 offen sc1 lds
s_add_u32 m0, s6, 20480
s_bfe_u32 s65, s71, 0x80000
s_mul_i32 s65, s65, 40960
BL v27,s[32:35],s65 offen sc1 lds
BL v27,s[32:35],s65 offen offset:1024 sc1 lds
M1 v[176:179],a[180:183],v[112:115],v[176:179]
M1 v[192:195],a[184:187],v[112:115],v[192:195]
BL v27,s[32:35],s65 offen offset:2048 sc1 lds
M1 v[208:211],a[188:191],v[112:115],v[208:211]
M1 v[224:227],a[192:195],v[112:115],v[224:227]
BL v27,s[32:35],s65 offen offset:3072 sc1 lds
M1 v[240:243],a[196:199],v[112:115],v[240:243]
M1 v[180:183],a[180:183],v[116:119],v[180:183]
M1 v[196:199],a[184:187],v[116:119],v[196:199]
s_add_u32 m0, s6, 24576
s_nop 0
BL v25,s[32:35],s65 offen sc1 lds
M1 v[212:215],a[188:191],v[116:119],v[212:215]
M1 v[228:231],a[192:195],v[116:119],v[228:231]
s_bfe_u32 s65, s71, 0x80008
s_mul_i32 s65, s65, 40960
BL a[224:227],v27,s[32:35],s65 offen sc1
M1 v[244:247],a[196:199],v[116:119],v[244:247]
M1 v[184:187],a[180:183],v[120:123],v[184:187]
M1 v[200:203],a[184:187],v[120:123],v[200:203]
BL a[228:231],v27,s[32:35],s65 offen offset:1024 sc1
M1 v[216:219],a[188:191],v[120:123],v[216:219]
M1 v[232:235],a[192:195],v[120:123],v[232:235]
M1 v[248:251],a[196:199],v[120:123],v[248:251]
M1 v[188:191],a[180:183],v[124:127],v[188:191]
M1 v[204:207],a[184:187],v[124:127],v[204:207]
M1 v[220:223],a[188:191],v[124:127],v[220:223]
M1 v[236:239],a[192:195],v[124:127],v[236:239]
M1 v[252:255],a[196:199],v[124:127],v[252:255]
s_waitcnt vmcnt(26)
P2_GU3_K_chk:
v_cmp_ne_u32 vcc, v7, v26
s_nop 0
s_cmp_eq_u64 vcc, 0
s_cbranch_scc1 P2_GU3_K_ok
s_cmp_eq_u32 s101, 0
s_cbranch_scc1 P2_GU3_K_ok
s_sub_u32 s101, s101, 1
s_sleep 10
buffer_load_dword v7, v19, s[24:27], s97 offen sc1
s_waitcnt vmcnt(0)
s_branch P2_GU3_K_chk
P2_GU3_K_ok:
M1 v[176:179],a[200:203],v[128:131],v[176:179]
M1 v[192:195],a[204:207],v[128:131],v[192:195]
ds_read_b128 v[64:67], v8 offset:33792
M1 v[208:211],a[208:211],v[128:131],v[208:211]
M1 v[224:227],a[212:215],v[128:131],v[224:227]
ds_read_b128 v[68:71], v8 offset:34816
M1 v[240:243],a[216:219],v[128:131],v[240:243]
M1 v[180:183],a[200:203],v[132:135],v[180:183]
M1 v[196:199],a[204:207],v[132:135],v[196:199]
ds_read_b128 v[72:75], v8 offset:35840
M1 v[212:215],a[208:211],v[132:135],v[212:215]
M1 v[228:231],a[212:215],v[132:135],v[228:231]
ds_read_b128 v[76:79], v8 offset:36864
M1 v[244:247],a[216:219],v[132:135],v[244:247]
M1 v[184:187],a[200:203],v[136:139],v[184:187]
M1 v[200:203],a[204:207],v[136:139],v[200:203]
s_bfe_u32 s41, s70, 0x80000
s_mul_i32 s41, s41, 4096
BL a[160:163],v27,s[36:39],s41 offen sc1
M1 v[216:219],a[208:211],v[136:139],v[216:219]
M1 v[232:235],a[212:215],v[136:139],v[232:235]
BL a[164:167],v27,s[36:39],s41 offen offset:1024 sc1
M1 v[248:251],a[216:219],v[136:139],v[248:251]
M1 v[188:191],a[200:203],v[140:143],v[188:191]
M1 v[204:207],a[204:207],v[140:143],v[204:207]
BL a[168:171],v27,s[36:39],s41 offen offset:2048 sc1
M1 v[220:223],a[208:211],v[140:143],v[220:223]
M1 v[236:239],a[212:215],v[140:143],v[236:239]
BL a[172:175],v27,s[36:39],s41 offen offset:3072 sc1
M1 v[252:255],a[216:219],v[140:143],v[252:255]
s_bfe_u32 s41, s70, 0x80008
s_mul_i32 s41, s41, 4096
BL a[176:179],v27,s[36:39],s41 offen sc1
BL a[180:183],v27,s[36:39],s41 offen offset:1024 sc1
BL a[184:187],v27,s[36:39],s41 offen offset:2048 sc1
BL a[188:191],v27,s[36:39],s41 offen offset:3072 sc1
buffer_load_dword v4, v2, s[24:27], s97 offen sc1
BL a[232:235],v27,s[32:35],s65 offen offset:2048 sc1
BL a[236:239],v27,s[32:35],s65 offen offset:3072 sc1
BL a[240:243],v25,s[32:35],s65 offen sc1
s_bfe_u32 s65, s71, 0x80010
s_mul_i32 s65, s65, 40960
BL a[244:247],v27,s[32:35],s65 offen sc1
BL a[248:251],v27,s[32:35],s65 offen offset:1024 sc1
M1 v[176:179],a[220:223],v[144:147],v[176:179]
s_waitcnt lgkmcnt(3)
M1 v[192:195],v[64:67],v[144:147],v[192:195]
ds_read_b128 v[40:43], v8 offset:37888
s_waitcnt lgkmcnt(3)
M1 v[208:211],v[68:71],v[144:147],v[208:211]
s_waitcnt lgkmcnt(2)
M1 v[224:227],v[72:75],v[144:147],v[224:227]
ds_read_b128 v[44:47], v8 offset:38912
s_waitcnt lgkmcnt(2)
M1 v[240:243],v[76:79],v[144:147],v[240:243]
M1 v[180:183],a[220:223],v[148:151],v[180:183]
M1 v[196:199],v[64:67],v[148:151],v[196:199]
ds_read_b128 v[48:51], v8 offset:39936
M1 v[212:215],v[68:71],v[148:151],v[212:215]
M1 v[228:231],v[72:75],v[148:151],v[228:231]
BL a[252:255],v27,s[32:35],s65 offen offset:2048 sc1
M1 v[244:247],v[76:79],v[148:151],v[244:247]
M1 v[184:187],a[220:223],v[152:155],v[184:187]
M1 v[200:203],v[64:67],v[152:155],v[200:203]
BL v[160:163],v27,s[32:35],s65 offen offset:3072 sc1
M1 v[216:219],v[68:71],v[152:155],v[216:219]
M1 v[232:235],v[72:75],v[152:155],v[232:235]
BL v[164:167],v25,s[32:35],s65 offen sc1
M1 v[248:251],v[76:79],v[152:155],v[248:251]
M1 v[188:191],a[220:223],v[156:159],v[188:191]
M1 v[204:207],v[64:67],v[156:159],v[204:207]
s_bfe_u32 s65, s71, 0x80018
s_mul_i32 s65, s65, 40960
BL v[168:171],v27,s[32:35],s65 offen sc1
M1 v[220:223],v[68:71],v[156:159],v[220:223]
M1 v[236:239],v[72:75],v[156:159],v[236:239]
BL v[172:175],v27,s[32:35],s65 offen offset:1024 sc1
M1 v[252:255],v[76:79],v[156:159],v[252:255]
s_waitcnt vmcnt(10)
P2_GU3_L_chk:
v_cmp_ne_u32 vcc, v4, v26
s_nop 0
s_cmp_eq_u64 vcc, 0
s_cbranch_scc1 P2_GU3_L_ok
s_cmp_eq_u32 s101, 0
s_cbranch_scc1 P2_GU3_L_ok
s_sub_u32 s101, s101, 1
s_sleep 10
buffer_load_dword v4, v2, s[24:27], s97 offen sc1
s_waitcnt vmcnt(0)
s_branch P2_GU3_L_chk
P2_GU3_L_ok:
s_waitcnt lgkmcnt(2)
M1 v[176:179],v[40:43],a[80:83],v[176:179]
s_waitcnt lgkmcnt(1)
M1 v[192:195],v[44:47],a[80:83],v[192:195]
ds_read_b128 v[68:71], v8 offset:25600
s_waitcnt lgkmcnt(1)
M1 v[208:211],v[48:51],a[80:83],v[208:211]
M1 v[224:227],a[64:67],a[80:83],v[224:227]
ds_read_b128 v[72:75], v8 offset:26624
M1 v[240:243],a[68:71],a[80:83],v[240:243]
M1 v[180:183],v[40:43],a[84:87],v[180:183]
M1 v[196:199],v[44:47],a[84:87],v[196:199]
ds_read_b128 v[76:79], v8 offset:27648
M1 v[212:215],v[48:51],a[84:87],v[212:215]
M1 v[228:231],a[64:67],a[84:87],v[228:231]
s_bfe_u32 s41, s89, 0x80000
s_mul_i32 s41, s41, 4096
BL v[96:99],v27,s[36:39],s41 offen sc1
M1 v[244:247],a[68:71],a[84:87],v[244:247]
M1 v[184:187],v[40:43],a[88:91],v[184:187]
M1 v[200:203],v[44:47],a[88:91],v[200:203]
BL v[100:103],v27,s[36:39],s41 offen offset:1024 sc1
M1 v[216:219],v[48:51],a[88:91],v[216:219]
M1 v[232:235],a[64:67],a[88:91],v[232:235]
BL v[104:107],v27,s[36:39],s41 offen offset:2048 sc1
M1 v[248:251],a[68:71],a[88:91],v[248:251]
M1 v[188:191],v[40:43],a[92:95],v[188:191]
M1 v[204:207],v[44:47],a[92:95],v[204:207]
BL v[108:111],v27,s[36:39],s41 offen offset:3072 sc1
M1 v[220:223],v[48:51],a[92:95],v[220:223]
M1 v[236:239],a[64:67],a[92:95],v[236:239]
s_bfe_u32 s41, s89, 0x80008
s_mul_i32 s41, s41, 4096
BL v[112:115],v27,s[36:39],s41 offen sc1
M1 v[252:255],a[68:71],a[92:95],v[252:255]
BL v[116:119],v27,s[36:39],s41 offen offset:1024 sc1
BL v[120:123],v27,s[36:39],s41 offen offset:2048 sc1
BL v[124:127],v27,s[36:39],s41 offen offset:3072 sc1
s_bfe_u32 s41, s89, 0x80010
s_mul_i32 s41, s41, 4096
BL v[128:131],v27,s[36:39],s41 offen sc1
BL v[132:135],v27,s[36:39],s41 offen offset:1024 sc1
BL v[136:139],v27,s[36:39],s41 offen offset:2048 sc1
BL v[140:143],v27,s[36:39],s41 offen offset:3072 sc1
s_bfe_u32 s41, s89, 0x80018
s_mul_i32 s41, s41, 4096
BL v[144:147],v27,s[36:39],s41 offen sc1
BL v[148:151],v27,s[36:39],s41 offen offset:1024 sc1
BL v[152:155],v27,s[36:39],s41 offen offset:2048 sc1
BL v[156:159],v27,s[36:39],s41 offen offset:3072 sc1
BL a[144:147],v27,s[32:35],s65 offen offset:2048 sc1
BL a[148:151],v27,s[32:35],s65 offen offset:3072 sc1
BL a[152:155],v25,s[32:35],s65 offen sc1
s_bfe_u32 s65, s70, 0x80010
s_mul_i32 s65, s65, 40960
BL a[156:159],v27,s[32:35],s65 offen sc1
BL a[208:211],v27,s[32:35],s65 offen offset:1024 sc1
M1 v[176:179],a[72:75],a[96:99],v[176:179]
M1 v[192:195],a[76:79],a[96:99],v[192:195]
ds_read_b128 v[40:43], v8 offset:28672
s_waitcnt lgkmcnt(3)
M1 v[208:211],v[68:71],a[96:99],v[208:211]
s_waitcnt lgkmcnt(2)
M1 v[224:227],v[72:75],a[96:99],v[224:227]
ds_read_b128 v[44:47], v8 offset:29696
s_waitcnt lgkmcnt(2)
M1 v[240:243],v[76:79],a[96:99],v[240:243]
M1 v[180:183],a[72:75],a[100:103],v[180:183]
M1 v[196:199],a[76:79],a[100:103],v[196:199]
ds_read_b128 v[48:51], v8 offset:30720
M1 v[212:215],v[68:71],a[100:103],v[212:215]
M1 v[228:231],v[72:75],a[100:103],v[228:231]
ds_read_b128 v[52:55], v8 offset:31744
M1 v[244:247],v[76:79],a[100:103],v[244:247]
M1 v[184:187],a[72:75],a[104:107],v[184:187]
M1 v[200:203],a[76:79],a[104:107],v[200:203]
ds_read_b128 v[56:59], v8 offset:32768
M1 v[216:219],v[68:71],a[104:107],v[216:219]
M1 v[232:235],v[72:75],a[104:107],v[232:235]
BL a[212:215],v27,s[32:35],s65 offen offset:2048 sc1
M1 v[248:251],v[76:79],a[104:107],v[248:251]
M1 v[188:191],a[72:75],a[108:111],v[188:191]
M1 v[204:207],a[76:79],a[108:111],v[204:207]
BL a[216:219],v27,s[32:35],s65 offen offset:3072 sc1
M1 v[220:223],v[68:71],a[108:111],v[220:223]
M1 v[236:239],v[72:75],a[108:111],v[236:239]
BL a[220:223],v25,s[32:35],s65 offen sc1
M1 v[252:255],v[76:79],a[108:111],v[252:255]
s_waitcnt lgkmcnt(4)
M1 v[176:179],v[40:43],a[112:115],v[176:179]
s_waitcnt lgkmcnt(3)
M1 v[192:195],v[44:47],a[112:115],v[192:195]
s_waitcnt lgkmcnt(2)
M1 v[208:211],v[48:51],a[112:115],v[208:211]
s_waitcnt lgkmcnt(1)
M1 v[224:227],v[52:55],a[112:115],v[224:227]
s_waitcnt lgkmcnt(0)
M1 v[240:243],v[56:59],a[112:115],v[240:243]
M1 v[180:183],v[40:43],a[116:119],v[180:183]
M1 v[196:199],v[44:47],a[116:119],v[196:199]
M1 v[212:215],v[48:51],a[116:119],v[212:215]
M1 v[228:231],v[52:55],a[116:119],v[228:231]
M1 v[244:247],v[56:59],a[116:119],v[244:247]
M1 v[184:187],v[40:43],a[120:123],v[184:187]
M1 v[200:203],v[44:47],a[120:123],v[200:203]
M1 v[216:219],v[48:51],a[120:123],v[216:219]
M1 v[232:235],v[52:55],a[120:123],v[232:235]
M1 v[248:251],v[56:59],a[120:123],v[248:251]
M1 v[188:191],v[40:43],a[124:127],v[188:191]
M1 v[204:207],v[44:47],a[124:127],v[204:207]
M1 v[220:223],v[48:51],a[124:127],v[220:223]
M1 v[236:239],v[52:55],a[124:127],v[236:239]
M1 v[252:255],v[56:59],a[124:127],v[252:255]
M1 v[176:179],a[0:3],a[128:131],v[176:179]
M1 v[192:195],a[4:7],a[128:131],v[192:195]
M1 v[208:211],a[8:11],a[128:131],v[208:211]
M1 v[224:227],a[12:15],a[128:131],v[224:227]
M1 v[240:243],a[16:19],a[128:131],v[240:243]
M1 v[180:183],a[0:3],a[132:135],v[180:183]
M1 v[196:199],a[4:7],a[132:135],v[196:199]
M1 v[212:215],a[8:11],a[132:135],v[212:215]
M1 v[228:231],a[12:15],a[132:135],v[228:231]
M1 v[244:247],a[16:19],a[132:135],v[244:247]
M1 v[184:187],a[0:3],a[136:139],v[184:187]
M1 v[200:203],a[4:7],a[136:139],v[200:203]
M1 v[216:219],a[8:11],a[136:139],v[216:219]
M1 v[232:235],a[12:15],a[136:139],v[232:235]
M1 v[248:251],a[16:19],a[136:139],v[248:251]
M1 v[188:191],a[0:3],a[140:143],v[188:191]
M1 v[204:207],a[4:7],a[140:143],v[204:207]
M1 v[220:223],a[8:11],a[140:143],v[220:223]
M1 v[236:239],a[12:15],a[140:143],v[236:239]
M1 v[252:255],a[16:19],a[140:143],v[252:255]
M1 v[176:179],a[20:23],a[160:163],v[176:179]
M1 v[192:195],a[24:27],a[160:163],v[192:195]
M1 v[208:211],a[28:31],a[160:163],v[208:211]
M1 v[224:227],a[32:35],a[160:163],v[224:227]
M1 v[240:243],a[36:39],a[160:163],v[240:243]
M1 v[180:183],a[20:23],a[164:167],v[180:183]
M1 v[196:199],a[24:27],a[164:167],v[196:199]
M1 v[212:215],a[28:31],a[164:167],v[212:215]
M1 v[228:231],a[32:35],a[164:167],v[228:231]
M1 v[244:247],a[36:39],a[164:167],v[244:247]
M1 v[184:187],a[20:23],a[168:171],v[184:187]
M1 v[200:203],a[24:27],a[168:171],v[200:203]
M1 v[216:219],a[28:31],a[168:171],v[216:219]
M1 v[232:235],a[32:35],a[168:171],v[232:235]
M1 v[248:251],a[36:39],a[168:171],v[248:251]
M1 v[188:191],a[20:23],a[172:175],v[188:191]
M1 v[204:207],a[24:27],a[172:175],v[204:207]
M1 v[220:223],a[28:31],a[172:175],v[220:223]
M1 v[236:239],a[32:35],a[172:175],v[236:239]
M1 v[252:255],a[36:39],a[172:175],v[252:255]
M1 v[176:179],a[40:43],a[176:179],v[176:179]
M1 v[192:195],a[44:47],a[176:179],v[192:195]
ds_read_b128 v[40:43], v8
M1 v[208:211],a[48:51],a[176:179],v[208:211]
M1 v[224:227],a[52:55],a[176:179],v[224:227]
ds_read_b128 v[44:47], v8 offset:1024
M1 v[240:243],a[56:59],a[176:179],v[240:243]
M1 v[180:183],a[40:43],a[180:183],v[180:183]
M1 v[196:199],a[44:47],a[180:183],v[196:199]
ds_read_b128 v[48:51], v8 offset:2048
M1 v[212:215],a[48:51],a[180:183],v[212:215]
M1 v[228:231],a[52:55],a[180:183],v[228:231]
ds_read_b128 v[52:55], v8 offset:3072
M1 v[244:247],a[56:59],a[180:183],v[244:247]
M1 v[184:187],a[40:43],a[184:187],v[184:187]
M1 v[200:203],a[44:47],a[184:187],v[200:203]
ds_read_b128 v[56:59], v8 offset:4096
M1 v[216:219],a[48:51],a[184:187],v[216:219]
M1 v[232:235],a[52:55],a[184:187],v[232:235]
M1 v[248:251],a[56:59],a[184:187],v[248:251]
M1 v[188:191],a[40:43],a[188:191],v[188:191]
M1 v[204:207],a[44:47],a[188:191],v[204:207]
M1 v[220:223],a[48:51],a[188:191],v[220:223]
M1 v[236:239],a[52:55],a[188:191],v[236:239]
M1 v[252:255],a[56:59],a[188:191],v[252:255]
s_waitcnt vmcnt(23)
s_waitcnt lgkmcnt(4)
M1 v[176:179],v[40:43],v[96:99],v[176:179]
s_waitcnt lgkmcnt(3)
M1 v[192:195],v[44:47],v[96:99],v[192:195]
ds_read_b128 v[60:63], v8 offset:5120
s_waitcnt lgkmcnt(3)
M1 v[208:211],v[48:51],v[96:99],v[208:211]
s_waitcnt lgkmcnt(2)
M1 v[224:227],v[52:55],v[96:99],v[224:227]
ds_read_b128 v[64:67], v8 offset:6144
s_waitcnt lgkmcnt(2)
M1 v[240:243],v[56:59],v[96:99],v[240:243]
s_waitcnt vmcnt(22)
M1 v[180:183],v[40:43],v[100:103],v[180:183]
M1 v[196:199],v[44:47],v[100:103],v[196:199]
ds_read_b128 v[68:71], v8 offset:7168
M1 v[212:215],v[48:51],v[100:103],v[212:215]
M1 v[228:231],v[52:55],v[100:103],v[228:231]
ds_read_b128 v[72:75], v8 offset:8192
M1 v[244:247],v[56:59],v[100:103],v[244:247]
s_waitcnt vmcnt(21)
M1 v[184:187],v[40:43],v[104:107],v[184:187]
M1 v[200:203],v[44:47],v[104:107],v[200:203]
ds_read_b128 v[76:79], v8 offset:9216
M1 v[216:219],v[48:51],v[104:107],v[216:219]
M1 v[232:235],v[52:55],v[104:107],v[232:235]
BL v[80:83],v10,s[8:11],s47 offen
M1 v[248:251],v[56:59],v[104:107],v[248:251]
s_waitcnt vmcnt(21)
M1 v[188:191],v[40:43],v[108:111],v[188:191]
M1 v[204:207],v[44:47],v[108:111],v[204:207]
BL v[84:87],v11,s[8:11],s47 offen
M1 v[220:223],v[48:51],v[108:111],v[220:223]
M1 v[236:239],v[52:55],v[108:111],v[236:239]
BL v[88:91],v12,s[8:11],s47 offen
M1 v[252:255],v[56:59],v[108:111],v[252:255]
buffer_load_dword v5, v3, s[24:27], s97 offen sc1
s_waitcnt vmcnt(23)
s_waitcnt lgkmcnt(4)
M1 v[176:179],v[60:63],v[112:115],v[176:179]
s_waitcnt lgkmcnt(3)
M1 v[192:195],v[64:67],v[112:115],v[192:195]
ds_read_b128 v[40:43], v8 offset:10240
s_waitcnt lgkmcnt(3)
M1 v[208:211],v[68:71],v[112:115],v[208:211]
s_waitcnt lgkmcnt(2)
M1 v[224:227],v[72:75],v[112:115],v[224:227]
ds_read_b128 v[44:47], v8 offset:11264
s_waitcnt lgkmcnt(2)
M1 v[240:243],v[76:79],v[112:115],v[240:243]
s_waitcnt vmcnt(22)
M1 v[180:183],v[60:63],v[116:119],v[180:183]
M1 v[196:199],v[64:67],v[116:119],v[196:199]
ds_read_b128 v[48:51], v8 offset:12288
M1 v[212:215],v[68:71],v[116:119],v[212:215]
M1 v[228:231],v[72:75],v[116:119],v[228:231]
ds_read_b128 v[52:55], v8 offset:13312
M1 v[244:247],v[76:79],v[116:119],v[244:247]
s_waitcnt vmcnt(21)
M1 v[184:187],v[60:63],v[120:123],v[184:187]
M1 v[200:203],v[64:67],v[120:123],v[200:203]
ds_read_b128 v[56:59], v8 offset:14336
M1 v[216:219],v[68:71],v[120:123],v[216:219]
M1 v[232:235],v[72:75],v[120:123],v[232:235]
M1 v[248:251],v[76:79],v[120:123],v[248:251]
s_waitcnt vmcnt(20)
M1 v[188:191],v[60:63],v[124:127],v[188:191]
M1 v[204:207],v[64:67],v[124:127],v[204:207]
M1 v[220:223],v[68:71],v[124:127],v[220:223]
M1 v[236:239],v[72:75],v[124:127],v[236:239]
M1 v[252:255],v[76:79],v[124:127],v[252:255]
s_waitcnt vmcnt(0)
P2_GU3_O_chk:
v_cmp_ne_u32 vcc, v5, v26
s_nop 0
s_cmp_eq_u64 vcc, 0
s_cbranch_scc1 P2_GU3_O_ok
s_cmp_eq_u32 s101, 0
s_cbranch_scc1 P2_GU3_O_ok
s_sub_u32 s101, s101, 1
s_sleep 4
buffer_load_dword v5, v3, s[24:27], s97 offen sc1
s_waitcnt vmcnt(0)
s_branch P2_GU3_O_chk
P2_GU3_O_ok:
s_waitcnt lgkmcnt(4)
M1 v[176:179],v[40:43],v[128:131],v[176:179]
s_waitcnt lgkmcnt(3)
M1 v[192:195],v[44:47],v[128:131],v[192:195]
ds_read_b128 v[60:63], v8 offset:15360
s_waitcnt lgkmcnt(3)
M1 v[208:211],v[48:51],v[128:131],v[208:211]
s_waitcnt lgkmcnt(2)
M1 v[224:227],v[52:55],v[128:131],v[224:227]
ds_read_b128 v[64:67], v8 offset:16384
s_waitcnt lgkmcnt(2)
M1 v[240:243],v[56:59],v[128:131],v[240:243]
M1 v[180:183],v[40:43],v[132:135],v[180:183]
M1 v[196:199],v[44:47],v[132:135],v[196:199]
ds_read_b128 v[68:71], v8 offset:17408
M1 v[212:215],v[48:51],v[132:135],v[212:215]
M1 v[228:231],v[52:55],v[132:135],v[228:231]
ds_read_b128 v[72:75], v8 offset:18432
M1 v[244:247],v[56:59],v[132:135],v[244:247]
M1 v[184:187],v[40:43],v[136:139],v[184:187]
M1 v[200:203],v[44:47],v[136:139],v[200:203]
ds_read_b128 v[76:79], v8 offset:19456
M1 v[216:219],v[48:51],v[136:139],v[216:219]
M1 v[232:235],v[52:55],v[136:139],v[232:235]
s_bfe_u32 s41, s71, 0x80000
s_mul_i32 s41, s41, 4096
BL a[80:83],v27,s[36:39],s41 offen sc1
M1 v[248:251],v[56:59],v[136:139],v[248:251]
M1 v[188:191],v[40:43],v[140:143],v[188:191]
M1 v[204:207],v[44:47],v[140:143],v[204:207]
BL a[84:87],v27,s[36:39],s41 offen offset:1024 sc1
M1 v[220:223],v[48:51],v[140:143],v[220:223]
M1 v[236:239],v[52:55],v[140:143],v[236:239]
BL a[88:91],v27,s[36:39],s41 offen offset:2048 sc1
M1 v[252:255],v[56:59],v[140:143],v[252:255]
BL a[92:95],v27,s[36:39],s41 offen offset:3072 sc1
s_bfe_u32 s41, s71, 0x80008
s_mul_i32 s41, s41, 4096
BL a[96:99],v27,s[36:39],s41 offen sc1
BL a[100:103],v27,s[36:39],s41 offen offset:1024 sc1
BL a[104:107],v27,s[36:39],s41 offen offset:2048 sc1
BL a[108:111],v27,s[36:39],s41 offen offset:3072 sc1
s_bfe_u32 s41, s71, 0x80010
s_mul_i32 s41, s41, 4096
BL a[112:115],v27,s[36:39],s41 offen sc1
BL a[116:119],v27,s[36:39],s41 offen offset:1024 sc1
BL a[120:123],v27,s[36:39],s41 offen offset:2048 sc1
BL a[124:127],v27,s[36:39],s41 offen offset:3072 sc1
s_bfe_u32 s41, s71, 0x80018
s_mul_i32 s41, s41, 4096
BL a[128:131],v27,s[36:39],s41 offen sc1
BL a[132:135],v27,s[36:39],s41 offen offset:1024 sc1
BL a[136:139],v27,s[36:39],s41 offen offset:2048 sc1
BL a[140:143],v27,s[36:39],s41 offen offset:3072 sc1
s_bfe_u32 s41, s70, 0x80010
s_mul_i32 s41, s41, 4096
BL a[192:195],v27,s[36:39],s41 offen sc1
BL a[196:199],v27,s[36:39],s41 offen offset:1024 sc1
BL a[200:203],v27,s[36:39],s41 offen offset:2048 sc1
BL a[204:207],v27,s[36:39],s41 offen offset:3072 sc1
s_waitcnt lgkmcnt(4)
M1 v[176:179],v[60:63],v[144:147],v[176:179]
s_waitcnt lgkmcnt(3)
M1 v[192:195],v[64:67],v[144:147],v[192:195]
ds_read_b128 v[40:43], v8 offset:20480
s_waitcnt lgkmcnt(3)
M1 v[208:211],v[68:71],v[144:147],v[208:211]
s_waitcnt lgkmcnt(2)
M1 v[224:227],v[72:75],v[144:147],v[224:227]
ds_read_b128 v[44:47], v8 offset:21504
s_waitcnt lgkmcnt(2)
M1 v[240:243],v[76:79],v[144:147],v[240:243]
M1 v[180:183],v[60:63],v[148:151],v[180:183]
M1 v[196:199],v[64:67],v[148:151],v[196:199]
ds_read_b128 v[48:51], v8 offset:22528
M1 v[212:215],v[68:71],v[148:151],v[212:215]
M1 v[228:231],v[72:75],v[148:151],v[228:231]
ds_read_b128 v[52:55], v8 offset:23552
M1 v[244:247],v[76:79],v[148:151],v[244:247]
M1 v[184:187],v[60:63],v[152:155],v[184:187]
M1 v[200:203],v[64:67],v[152:155],v[200:203]
ds_read_b128 v[56:59], v8 offset:24576
M1 v[216:219],v[68:71],v[152:155],v[216:219]
M1 v[232:235],v[72:75],v[152:155],v[232:235]
M1 v[248:251],v[76:79],v[152:155],v[248:251]
M1 v[188:191],v[60:63],v[156:159],v[188:191]
M1 v[204:207],v[64:67],v[156:159],v[204:207]
M1 v[220:223],v[68:71],v[156:159],v[220:223]
M1 v[236:239],v[72:75],v[156:159],v[236:239]
M1 v[252:255],v[76:79],v[156:159],v[252:255]
s_waitcnt vmcnt(19)
s_waitcnt lgkmcnt(4)
M1 a[0:3],v[40:43],a[80:83],0
s_waitcnt lgkmcnt(3)
M1 a[16:19],v[44:47],a[80:83],0
s_waitcnt lgkmcnt(2)
M1 a[32:35],v[48:51],a[80:83],0
s_waitcnt lgkmcnt(1)
M1 a[48:51],v[52:55],a[80:83],0
s_waitcnt lgkmcnt(0)
M1 a[64:67],v[56:59],a[80:83],0
s_waitcnt vmcnt(18)
M1 a[4:7],v[40:43],a[84:87],0
M1 a[20:23],v[44:47],a[84:87],0
M1 a[36:39],v[48:51],a[84:87],0
M1 a[52:55],v[52:55],a[84:87],0
M1 a[68:71],v[56:59],a[84:87],0
s_waitcnt vmcnt(17)
M1 a[8:11],v[40:43],a[88:91],0
M1 a[24:27],v[44:47],a[88:91],0
ds_write_b128 v9, v[176:179]
M1 a[40:43],v[48:51],a[88:91],0
M1 a[56:59],v[52:55],a[88:91],0
ds_write_b128 v9, v[180:183] offset:5120
M1 a[72:75],v[56:59],a[88:91],0
s_waitcnt vmcnt(16)
M1 a[12:15],v[40:43],a[92:95],0
M1 a[28:31],v[44:47],a[92:95],0
ds_write_b128 v9, v[184:187] offset:10240
M1 a[44:47],v[48:51],a[92:95],0
M1 a[60:63],v[52:55],a[92:95],0
ds_write_b128 v9, v[188:191] offset:15360
M1 a[76:79],v[56:59],a[92:95],0
s_waitcnt vmcnt(15)
M1 a[0:3],a[224:227],a[96:99],a[0:3]
M1 a[16:19],a[228:231],a[96:99],a[16:19]
ds_write_b128 v9, v[192:195] offset:64
M1 a[32:35],a[232:235],a[96:99],a[32:35]
M1 a[48:51],a[236:239],a[96:99],a[48:51]
ds_write_b128 v9, v[196:199] offset:5184
M1 a[64:67],a[240:243],a[96:99],a[64:67]
s_waitcnt vmcnt(14)
M1 a[4:7],a[224:227],a[100:103],a[4:7]
M1 a[20:23],a[228:231],a[100:103],a[20:23]
ds_write_b128 v9, v[200:203] offset:10304
M1 a[36:39],a[232:235],a[100:103],a[36:39]
M1 a[52:55],a[236:239],a[100:103],a[52:55]
ds_write_b128 v9, v[204:207] offset:15424
M1 a[68:71],a[240:243],a[100:103],a[68:71]
s_waitcnt vmcnt(13)
M1 a[8:11],a[224:227],a[104:107],a[8:11]
M1 a[24:27],a[228:231],a[104:107],a[24:27]
ds_write_b128 v9, v[208:211] offset:128
M1 a[40:43],a[232:235],a[104:107],a[40:43]
M1 a[56:59],a[236:239],a[104:107],a[56:59]
ds_write_b128 v9, v[212:215] offset:5248
M1 a[72:75],a[240:243],a[104:107],a[72:75]
s_waitcnt vmcnt(12)
M1 a[12:15],a[224:227],a[108:111],a[12:15]
M1 a[28:31],a[228:231],a[108:111],a[28:31]
ds_write_b128 v9, v[216:219] offset:10368
M1 a[44:47],a[232:235],a[108:111],a[44:47]
M1 a[60:63],a[236:239],a[108:111],a[60:63]
ds_write_b128 v9, v[220:223] offset:15488
M1 a[76:79],a[240:243],a[108:111],a[76:79]
s_waitcnt vmcnt(11)
M1 a[0:3],a[244:247],a[112:115],a[0:3]
M1 a[16:19],a[248:251],a[112:115],a[16:19]
ds_write_b128 v9, v[224:227] offset:192
M1 a[32:35],a[252:255],a[112:115],a[32:35]
M1 a[48:51],v[160:163],a[112:115],a[48:51]
ds_write_b128 v9, v[228:231] offset:5312
M1 a[64:67],v[164:167],a[112:115],a[64:67]
s_waitcnt vmcnt(10)
M1 a[4:7],a[244:247],a[116:119],a[4:7]
M1 a[20:23],a[248:251],a[116:119],a[20:23]
ds_write_b128 v9, v[232:235] offset:10432
M1 a[36:39],a[252:255],a[116:119],a[36:39]
M1 a[52:55],v[160:163],a[116:119],a[52:55]
ds_write_b128 v9, v[236:239] offset:15552
M1 a[68:71],v[164:167],a[116:119],a[68:71]
s_waitcnt vmcnt(9)
M1 a[8:11],a[244:247],a[120:123],a[8:11]
M1 a[24:27],a[248:251],a[120:123],a[24:27]
ds_write_b128 v9, v[240:243] offset:256
M1 a[40:43],a[252:255],a[120:123],a[40:43]
M1 a[56:59],v[160:163],a[120:123],a[56:59]
ds_write_b128 v9, v[244:247] offset:5376
M1 a[72:75],v[164:167],a[120:123],a[72:75]
s_waitcnt vmcnt(8)
M1 a[12:15],a[244:247],a[124:127],a[12:15]
M1 a[28:31],a[248:251],a[124:127],a[28:31]
ds_write_b128 v9, v[248:251] offset:10496
M1 a[44:47],a[252:255],a[124:127],a[44:47]
M1 a[60:63],v[160:163],a[124:127],a[60:63]
ds_write_b128 v9, v[252:255] offset:15616
M1 a[76:79],v[164:167],a[124:127],a[76:79]
s_waitcnt vmcnt(7)
M1 a[0:3],v[168:171],a[128:131],a[0:3]
M1 a[16:19],v[172:175],a[128:131],a[16:19]
M1 a[32:35],a[144:147],a[128:131],a[32:35]
M1 a[48:51],a[148:151],a[128:131],a[48:51]
M1 a[64:67],a[152:155],a[128:131],a[64:67]
s_waitcnt vmcnt(6)
M1 a[4:7],v[168:171],a[132:135],a[4:7]
M1 a[20:23],v[172:175],a[132:135],a[20:23]
M1 a[36:39],a[144:147],a[132:135],a[36:39]
M1 a[52:55],a[148:151],a[132:135],a[52:55]
M1 a[68:71],a[152:155],a[132:135],a[68:71]
s_waitcnt vmcnt(5)
M1 a[8:11],v[168:171],a[136:139],a[8:11]
M1 a[24:27],v[172:175],a[136:139],a[24:27]
M1 a[40:43],a[144:147],a[136:139],a[40:43]
M1 a[56:59],a[148:151],a[136:139],a[56:59]
M1 a[72:75],a[152:155],a[136:139],a[72:75]
s_waitcnt vmcnt(4)
M1 a[12:15],v[168:171],a[140:143],a[12:15]
M1 a[28:31],v[172:175],a[140:143],a[28:31]
M1 a[44:47],a[144:147],a[140:143],a[44:47]
M1 a[60:63],a[148:151],a[140:143],a[60:63]
M1 a[76:79],a[152:155],a[140:143],a[76:79]
s_waitcnt lgkmcnt(0)
s_barrier
s_waitcnt vmcnt(3)
M1 a[0:3],a[156:159],a[192:195],a[0:3]
M1 a[16:19],a[208:211],a[192:195],a[16:19]
ds_read_b128 v[96:99], v28
ds_read_b128 v[100:103], v29
ds_read_b128 v[104:107], v28 offset:40960
M1 a[32:35],a[212:215],a[192:195],a[32:35]
M1 a[48:51],a[216:219],a[192:195],a[48:51]
ds_read_b128 v[108:111], v29 offset:40960
ds_read_b128 v[112:115], v30
ds_read_b128 v[116:119], v31
M1 a[64:67],a[220:223],a[192:195],a[64:67]
s_waitcnt vmcnt(2)
M1 a[4:7],a[156:159],a[196:199],a[4:7]
M1 a[20:23],a[208:211],a[196:199],a[20:23]
ds_read_b128 v[120:123], v30 offset:40960
ds_read_b128 v[124:127], v31 offset:40960
ds_read_b128 v[160:163], v32
M1 a[36:39],a[212:215],a[196:199],a[36:39]
M1 a[52:55],a[216:219],a[196:199],a[52:55]
ds_read_b128 v[164:167], v33
ds_read_b128 v[168:171], v32 offset:40960
ds_read_b128 v[172:175], v33 offset:40960
M1 a[68:71],a[220:223],a[196:199],a[68:71]
s_waitcnt vmcnt(1)
M1 a[8:11],a[156:159],a[200:203],a[8:11]
M1 a[24:27],a[208:211],a[200:203],a[24:27]
ds_read_b128 v[176:179], v34
ds_read_b128 v[180:183], v35
ds_read_b128 v[184:187], v34 offset:40960
M1 a[40:43],a[212:215],a[200:203],a[40:43]
M1 a[56:59],a[216:219],a[200:203],a[56:59]
ds_read_b128 v[188:191], v35 offset:40960
ds_read_b128 v[224:227], v36
ds_read_b128 v[228:231], v37
M1 a[72:75],a[220:223],a[200:203],a[72:75]
s_waitcnt vmcnt(0)
M1 a[12:15],a[156:159],a[204:207],a[12:15]
M1 a[28:31],a[208:211],a[204:207],a[28:31]
ds_read_b128 v[232:235], v36 offset:40960
ds_read_b128 v[236:239], v37 offset:40960
ds_read_b128 v[240:243], v38
M1 a[44:47],a[212:215],a[204:207],a[44:47]
M1 a[60:63],a[216:219],a[204:207],a[60:63]
ds_read_b128 v[244:247], v39
ds_read_b128 v[248:251], v38 offset:40960
ds_read_b128 v[252:255], v39 offset:40960
M1 a[76:79],a[220:223],a[204:207],a[76:79]
ds_write_b128 v9, a[0:3] offset:20480
s_waitcnt lgkmcnt(15)
v_pk_add_f32 v[96:97], v[96:97], v[104:105]
v_pk_add_f32 v[98:99], v[98:99], v[106:107]
v_pk_add_f32 v[100:101], v[100:101], v[108:109]
v_pk_add_f32 v[102:103], v[102:103], v[110:111]
v_pk_add_f32 v[112:113], v[112:113], v[120:121]
v_pk_add_f32 v[114:115], v[114:115], v[122:123]
ds_write_b128 v9, a[4:7] offset:25600
v_pk_add_f32 v[116:117], v[116:117], v[124:125]
v_pk_add_f32 v[118:119], v[118:119], v[126:127]
v_pk_add_f32 v[96:97], v[96:97], v[112:113]
v_pk_add_f32 v[98:99], v[98:99], v[114:115]
v_pk_add_f32 v[100:101], v[100:101], v[116:117]
v_pk_add_f32 v[102:103], v[102:103], v[118:119]
v_pk_mul_f32 v[104:105], v[96:97], s[50:51] op_sel_hi:[1,0]
ds_write_b128 v9, a[8:11] offset:30720
v_pk_mul_f32 v[106:107], v[98:99], s[50:51] op_sel_hi:[1,0]
v_pk_mul_f32 v[108:109], v[100:101], s[50:51] op_sel_hi:[1,0]
v_pk_mul_f32 v[110:111], v[102:103], s[50:51] op_sel_hi:[1,0]
v_exp_f32 v104, v104
v_lshlrev_b32 v112, 16, v80
v_exp_f32 v105, v105
v_and_b32 v113, s52, v80
ds_write_b128 v9, a[12:15] offset:35840
v_exp_f32 v106, v106
v_lshlrev_b32 v114, 16, v81
v_exp_f32 v107, v107
v_and_b32 v115, s52, v81
v_exp_f32 v108, v108
v_lshlrev_b32 v116, 16, v82
v_exp_f32 v109, v109
ds_write_b128 v9, a[16:19] offset:20544
v_and_b32 v117, s52, v82
v_exp_f32 v110, v110
v_lshlrev_b32 v118, 16, v83
v_exp_f32 v111, v111
v_and_b32 v119, s52, v83
v_pk_add_f32 v[104:105], v[104:105], 1.0 op_sel_hi:[1,0]
v_pk_add_f32 v[106:107], v[106:107], 1.0 op_sel_hi:[1,0]
ds_write_b128 v9, a[20:23] offset:25664
v_pk_add_f32 v[108:109], v[108:109], 1.0 op_sel_hi:[1,0]
v_pk_add_f32 v[110:111], v[110:111], 1.0 op_sel_hi:[1,0]
v_rcp_f32 v104, v104
v_rcp_f32 v105, v105
v_rcp_f32 v106, v106
v_rcp_f32 v107, v107
v_rcp_f32 v108, v108
ds_write_b128 v9, a[24:27] offset:30784
v_rcp_f32 v109, v109
v_rcp_f32 v110, v110
v_rcp_f32 v111, v111
v_pk_mul_f32 v[96:97], v[96:97], v[104:105]
v_pk_mul_f32 v[98:99], v[98:99], v[106:107]
v_pk_mul_f32 v[100:101], v[100:101], v[108:109]
v_pk_mul_f32 v[102:103], v[102:103], v[110:111]
ds_write_b128 v9, a[28:31] offset:35904
s_waitcnt lgkmcnt(15)
v_pk_add_f32 v[160:161], v[160:161], v[168:169]
v_pk_add_f32 v[162:163], v[162:163], v[170:171]
v_pk_add_f32 v[164:165], v[164:165], v[172:173]
v_pk_add_f32 v[166:167], v[166:167], v[174:175]
v_pk_add_f32 v[176:177], v[176:177], v[184:185]
v_pk_add_f32 v[178:179], v[178:179], v[186:187]
ds_write_b128 v9, a[32:35] offset:20608
v_pk_add_f32 v[180:181], v[180:181], v[188:189]
v_pk_add_f32 v[182:183], v[182:183], v[190:191]
v_pk_add_f32 v[160:161], v[160:161], v[176:177]
v_pk_add_f32 v[162:163], v[162:163], v[178:179]
v_pk_add_f32 v[164:165], v[164:165], v[180:181]
v_pk_add_f32 v[166:167], v[166:167], v[182:183]
v_pk_mul_f32 v[168:169], v[160:161], s[50:51] op_sel_hi:[1,0]
ds_write_b128 v9, a[36:39] offset:25728
v_pk_mul_f32 v[170:171], v[162:163], s[50:51] op_sel_hi:[1,0]
v_pk_mul_f32 v[172:173], v[164:165], s[50:51] op_sel_hi:[1,0]
v_pk_mul_f32 v[174:175], v[166:167], s[50:51] op_sel_hi:[1,0]
v_exp_f32 v168, v168
v_lshlrev_b32 v176, 16, v84
v_exp_f32 v169, v169
v_and_b32 v177, s52, v84
ds_write_b128 v9, a[40:43] offset:30848
v_exp_f32 v170, v170
v_lshlrev_b32 v178, 16, v85
v_exp_f32 v171, v171
v_and_b32 v179, s52, v85
v_exp_f32 v172, v172
v_lshlrev_b32 v180, 16, v86
v_exp_f32 v173, v173
ds_write_b128 v9, a[44:47] offset:35968
v_and_b32 v181, s52, v86
v_exp_f32 v174, v174
v_lshlrev_b32 v182, 16, v87
v_exp_f32 v175, v175
v_and_b32 v183, s52, v87
v_pk_add_f32 v[168:169], v[168:169], 1.0 op_sel_hi:[1,0]
v_pk_add_f32 v[170:171], v[170:171], 1.0 op_sel_hi:[1,0]
ds_write_b128 v9, a[48:51] offset:20672
v_pk_add_f32 v[172:173], v[172:173], 1.0 op_sel_hi:[1,0]
v_pk_add_f32 v[174:175], v[174:175], 1.0 op_sel_hi:[1,0]
v_rcp_f32 v168, v168
v_rcp_f32 v169, v169
v_rcp_f32 v170, v170
v_rcp_f32 v171, v171
v_rcp_f32 v172, v172
ds_write_b128 v9, a[52:55] offset:25792
v_rcp_f32 v173, v173
v_rcp_f32 v174, v174
v_rcp_f32 v175, v175
v_pk_mul_f32 v[160:161], v[160:161], v[168:169]
v_pk_mul_f32 v[162:163], v[162:163], v[170:171]
v_pk_mul_f32 v[164:165], v[164:165], v[172:173]
v_pk_mul_f32 v[166:167], v[166:167], v[174:175]
ds_write_b128 v9, a[56:59] offset:30912
s_waitcnt lgkmcnt(15)
v_pk_add_f32 v[224:225], v[224:225], v[232:233]
v_pk_add_f32 v[226:227], v[226:227], v[234:235]
v_pk_add_f32 v[228:229], v[228:229], v[236:237]
v_pk_add_f32 v[230:231], v[230:231], v[238:239]
v_pk_add_f32 v[240:241], v[240:241], v[248:249]
v_pk_add_f32 v[242:243], v[242:243], v[250:251]
ds_write_b128 v9, a[60:63] offset:36032
v_pk_add_f32 v[244:245], v[244:245], v[252:253]
v_pk_add_f32 v[246:247], v[246:247], v[254:255]
v_pk_add_f32 v[224:225], v[224:225], v[240:241]
v_pk_add_f32 v[226:227], v[226:227], v[242:243]
v_pk_add_f32 v[228:229], v[228:229], v[244:245]
v_pk_add_f32 v[230:231], v[230:231], v[246:247]
v_pk_mul_f32 v[232:233], v[224:225], s[50:51] op_sel_hi:[1,0]
ds_write_b128 v9, a[64:67] offset:20736
v_pk_mul_f32 v[234:235], v[226:227], s[50:51] op_sel_hi:[1,0]
v_pk_mul_f32 v[236:237], v[228:229], s[50:51] op_sel_hi:[1,0]
v_pk_mul_f32 v[238:239], v[230:231], s[50:51] op_sel_hi:[1,0]
v_exp_f32 v232, v232
v_lshlrev_b32 v240, 16, v88
v_exp_f32 v233, v233
v_and_b32 v241, s52, v88
ds_write_b128 v9, a[68:71] offset:25856
v_exp_f32 v234, v234
v_lshlrev_b32 v242, 16, v89
v_exp_f32 v235, v235
v_and_b32 v243, s52, v89
v_exp_f32 v236, v236
v_lshlrev_b32 v244, 16, v90
v_exp_f32 v237, v237
ds_write_b128 v9, a[72:75] offset:30976
v_and_b32 v245, s52, v90
v_exp_f32 v238, v238
v_lshlrev_b32 v246, 16, v91
v_exp_f32 v239, v239
v_and_b32 v247, s52, v91
v_pk_add_f32 v[232:233], v[232:233], 1.0 op_sel_hi:[1,0]
v_pk_add_f32 v[234:235], v[234:235], 1.0 op_sel_hi:[1,0]
ds_write_b128 v9, a[76:79] offset:36096
v_pk_add_f32 v[236:237], v[236:237], 1.0 op_sel_hi:[1,0]
v_pk_add_f32 v[238:239], v[238:239], 1.0 op_sel_hi:[1,0]
v_rcp_f32 v232, v232
v_rcp_f32 v233, v233
v_rcp_f32 v234, v234
v_rcp_f32 v235, v235
v_rcp_f32 v236, v236
v_rcp_f32 v237, v237
v_rcp_f32 v238, v238
v_rcp_f32 v239, v239
v_pk_mul_f32 v[224:225], v[224:225], v[232:233]
v_pk_mul_f32 v[226:227], v[226:227], v[234:235]
v_pk_mul_f32 v[228:229], v[228:229], v[236:237]
v_pk_mul_f32 v[230:231], v[230:231], v[238:239]
s_waitcnt lgkmcnt(0)
s_barrier
ds_read_b128 v[128:131], v28 offset:20480
ds_read_b128 v[132:135], v29 offset:20480
ds_read_b128 v[136:139], v28 offset:61440
ds_read_b128 v[140:143], v29 offset:61440
ds_read_b128 v[144:147], v30 offset:20480
ds_read_b128 v[148:151], v31 offset:20480
ds_read_b128 v[152:155], v30 offset:61440
ds_read_b128 v[156:159], v31 offset:61440
ds_read_b128 v[192:195], v32 offset:20480
ds_read_b128 v[196:199], v33 offset:20480
ds_read_b128 v[200:203], v32 offset:61440
ds_read_b128 v[204:207], v33 offset:61440
ds_read_b128 v[208:211], v34 offset:20480
ds_read_b128 v[212:215], v35 offset:20480
ds_read_b128 v[216:219], v34 offset:61440
ds_read_b128 v[220:223], v35 offset:61440
ds_read_b128 v[40:43], v36 offset:20480
ds_read_b128 v[44:47], v37 offset:20480
ds_read_b128 v[48:51], v36 offset:61440
ds_read_b128 v[52:55], v37 offset:61440
ds_read_b128 v[56:59], v38 offset:20480
ds_read_b128 v[60:63], v39 offset:20480
ds_read_b128 v[64:67], v38 offset:61440
ds_read_b128 v[68:71], v39 offset:61440
s_waitcnt lgkmcnt(15)
v_pk_add_f32 v[128:129], v[128:129], v[136:137]
v_pk_add_f32 v[130:131], v[130:131], v[138:139]
v_pk_add_f32 v[132:133], v[132:133], v[140:141]
v_pk_add_f32 v[134:135], v[134:135], v[142:143]
v_pk_add_f32 v[144:145], v[144:145], v[152:153]
v_pk_add_f32 v[146:147], v[146:147], v[154:155]
v_pk_add_f32 v[148:149], v[148:149], v[156:157]
v_pk_add_f32 v[150:151], v[150:151], v[158:159]
v_pk_add_f32 v[128:129], v[128:129], v[144:145]
v_pk_add_f32 v[130:131], v[130:131], v[146:147]
v_pk_add_f32 v[132:133], v[132:133], v[148:149]
v_pk_add_f32 v[134:135], v[134:135], v[150:151]
v_pk_fma_f32 v[96:97], v[96:97], v[128:129], v[112:113]
v_pk_fma_f32 v[98:99], v[98:99], v[130:131], v[114:115]
v_pk_fma_f32 v[100:101], v[100:101], v[132:133], v[116:117]
v_pk_fma_f32 v[102:103], v[102:103], v[134:135], v[118:119]
CV v104,v96,v97
CV v105,v98,v99
CV v106,v100,v101
CV v107,v102,v103
buffer_store_dwordx4 v[104:107], v10, s[12:15], s47 offen sc1
s_waitcnt lgkmcnt(8)
v_pk_add_f32 v[192:193], v[192:193], v[200:201]
v_pk_add_f32 v[194:195], v[194:195], v[202:203]
v_pk_add_f32 v[196:197], v[196:197], v[204:205]
v_pk_add_f32 v[198:199], v[198:199], v[206:207]
v_pk_add_f32 v[208:209], v[208:209], v[216:217]
v_pk_add_f32 v[210:211], v[210:211], v[218:219]
v_pk_add_f32 v[212:213], v[212:213], v[220:221]
v_pk_add_f32 v[214:215], v[214:215], v[222:223]
v_pk_add_f32 v[192:193], v[192:193], v[208:209]
v_pk_add_f32 v[194:195], v[194:195], v[210:211]
v_pk_add_f32 v[196:197], v[196:197], v[212:213]
v_pk_add_f32 v[198:199], v[198:199], v[214:215]
v_pk_fma_f32 v[160:161], v[160:161], v[192:193], v[176:177]
v_pk_fma_f32 v[162:163], v[162:163], v[194:195], v[178:179]
v_pk_fma_f32 v[164:165], v[164:165], v[196:197], v[180:181]
v_pk_fma_f32 v[166:167], v[166:167], v[198:199], v[182:183]
CV v168,v160,v161
CV v169,v162,v163
CV v170,v164,v165
CV v171,v166,v167
buffer_store_dwordx4 v[168:171], v11, s[12:15], s47 offen sc1
s_waitcnt lgkmcnt(0)
v_pk_add_f32 v[40:41], v[40:41], v[48:49]
v_pk_add_f32 v[42:43], v[42:43], v[50:51]
v_pk_add_f32 v[44:45], v[44:45], v[52:53]
v_pk_add_f32 v[46:47], v[46:47], v[54:55]
v_pk_add_f32 v[56:57], v[56:57], v[64:65]
v_pk_add_f32 v[58:59], v[58:59], v[66:67]
v_pk_add_f32 v[60:61], v[60:61], v[68:69]
v_pk_add_f32 v[62:63], v[62:63], v[70:71]
v_pk_add_f32 v[40:41], v[40:41], v[56:57]
v_pk_add_f32 v[42:43], v[42:43], v[58:59]
v_pk_add_f32 v[44:45], v[44:45], v[60:61]
v_pk_add_f32 v[46:47], v[46:47], v[62:63]
v_pk_fma_f32 v[224:225], v[224:225], v[40:41], v[240:241]
v_pk_fma_f32 v[226:227], v[226:227], v[42:43], v[242:243]
v_pk_fma_f32 v[228:229], v[228:229], v[44:45], v[244:245]
v_pk_fma_f32 v[230:231], v[230:231], v[46:47], v[246:247]
CV v232,v224,v225
CV v233,v226,v227
CV v234,v228,v229
CV v235,v230,v231
buffer_store_dwordx4 v[232:235], v12, s[12:15], s47 offen sc1
s_endpgm
K1_END:
s_endpgm
.section .rodata,"a"
.p2align 6
.amdhsa_kernel recurrent_scan__linear_attn_block__glu_gated_swiglu__prompt_kernel
.amdhsa_next_free_vgpr 512
.amdhsa_next_free_sgpr 102
.amdhsa_accum_offset 256
.amdhsa_group_segment_fixed_size 0
.amdhsa_kernarg_size 80
.amdhsa_user_sgpr_count 2
.amdhsa_user_sgpr_kernarg_segment_ptr 1
.amdhsa_system_sgpr_workgroup_id_x 1
.end_amdhsa_kernel
```
